```python
import torch

def _softmax(x, axis=-1):
    return torch.softmax(x, dim=axis)

def _gelu(x):
    return torch.nn.functional.gelu(x, approximate='tanh')

def _silu(x):
    return torch.nn.functional.silu(x)

def _sigmoid(x):
    return torch.sigmoid(x)

def _layernorm(x, axis=-1, eps=1e-05):
    m = x.mean(dim=axis, keepdim=True)
    v = x.var(dim=axis, keepdim=True, unbiased=False)
    return (x - m) / torch.sqrt(v + eps)

def _scatter_add(tgt, idx, src, axis=0):
    return tgt.clone().index_add_(axis, idx, src)

def _segment_sum(src, seg, n):
    out = torch.zeros((n,) + src.shape[1:], dtype=src.dtype)
    return out.index_add_(0, seg, src)

def _pad(x, pw):
    flat = tuple((v for pair in reversed(pw) for v in pair))
    return torch.nn.functional.pad(x, flat)
kernel_name = 'interleave_layers__memory_aug_recurrent_mem_tr__softmax_full_mha__prompt'

def setup_inputs():

    _w = lambda a: (lambda t: t.to(torch.bfloat16) if t.is_floating_point() else t)(torch.as_tensor(a))

    def _A_setup():
        B, S, Dm = (1, 2048, 512)
        H, Dh = (32, 128)
        M, seg = (8, 32)
        seg = min(seg, S)
        S = S // seg * seg
        return {'x': _w((lambda *s: torch.randn(*s, dtype=torch.bfloat16) * 0.05)(B, S, Dm)), 'mem0': _w((lambda *s: torch.randn(*s, dtype=torch.bfloat16) * 0.2)(B, M, Dm)), 'Wq': _w((lambda *s: torch.randn(*s, dtype=torch.bfloat16) * 1.6)(Dm, H, Dh) * Dm ** (-0.5)), 'Wk': _w((lambda *s: torch.randn(*s, dtype=torch.bfloat16) * 1.6)(Dm, H, Dh) * Dm ** (-0.5)), 'Wv': _w((lambda *s: torch.randn(*s, dtype=torch.bfloat16) * 0.2)(Dm, H, Dh) * Dm ** (-0.5)), 'Wo': _w((lambda *s: torch.randn(*s, dtype=torch.bfloat16) * 0.2)(H, Dh, Dm) * (H * Dh) ** (-0.5)), 'seg_len': seg}
    _A_in = _A_setup()

    def _B_setup():
        B, S, D = (1, 2048, 512)
        return {'x': _w((lambda *s: torch.randn(*s, dtype=torch.bfloat16) * 0.05)(B, S, D)), 'wqkv': _w((lambda *s: torch.randn(*s, dtype=torch.bfloat16) * 0.05)(D, 3 * D)), 'wo': _w((lambda *s: torch.randn(*s, dtype=torch.bfloat16) * 0.05)(D, D))}
    _B_in = _B_setup()
    return {'A_x': _A_in['x'], 'A_mem0': _A_in['mem0'], 'A_Wq': _A_in['Wq'], 'A_Wk': _A_in['Wk'], 'A_Wv': _A_in['Wv'], 'A_Wo': _A_in['Wo'], 'A_seg_len': _A_in['seg_len'], 'B_x': _B_in['x'], 'B_wqkv': _B_in['wqkv'], 'B_wo': _B_in['wo']}

def reference(A_x, A_mem0, A_Wq, A_Wk, A_Wv, A_Wo, A_seg_len, B_x, B_wqkv, B_wo):

    def _A_ref(x, mem0, Wq, Wk, Wv, Wo, seg_len):
        B, S, Dm = x.shape
        H, Dh = (Wq.shape[1], Wq.shape[2])
        M = mem0.shape[1]
        scale = Dh ** (-0.5)
        n_seg = S // seg_len
        L = M + seg_len
        idx = torch.arange(L)
        mask = (idx[:, None] < M) | (idx[:, None] >= idx[None, :])
        mem = mem0
        outs = []
        for s in range(n_seg):
            xs = x[:, s * seg_len:(s + 1) * seg_len, :].clone()
            h = torch.concatenate([mem, xs], axis=1)
            q = torch.einsum('btd,dhe->bhte', h, Wq)
            k = torch.einsum('btd,dhe->bhte', h, Wk)
            v = torch.einsum('btd,dhe->bhte', h, Wv)
            scores = torch.einsum('bhqe,bhke->bhqk', q, k) * scale
            scores = torch.where(mask[None, None], scores, -1000000000.0)
            p = _softmax(scores, axis=-1)
            o = torch.einsum('bhqk,bhke->bhqe', p, v)
            o = torch.einsum('bhte,hed->btd', o, Wo)
            mem = o[:, :M, :].clone()
            outs.append(o[:, M:, :])
        return torch.concatenate(outs, axis=1)

    def _B_ref(x, wqkv, wo):
        B, S, D = x.shape
        H = 32
        Dh = D // H
        qkv = (lambda x, *d: x.permute(*d))((x @ wqkv).reshape(B, S, 3, H, Dh), 2, 0, 3, 1, 4)
        q, k, v = (qkv[0], qkv[1], qkv[2])
        scale = Dh ** (-0.5)
        scores = torch.einsum('bhqd,bhkd->bhqk', q, k) * scale
        p = _softmax(scores, axis=-1)
        o = torch.einsum('bhqk,bhkd->bhqd', p, v)
        return (lambda x, *d: x.permute(*d))(o, 0, 2, 1, 3).reshape(B, S, D) @ wo
    x = A_x
    x = x + _A_ref(_layernorm(x, axis=-1), A_mem0, A_Wq, A_Wk, A_Wv, A_Wo, A_seg_len)
    x = x + _B_ref(_layernorm(x, axis=-1), B_wqkv, B_wo)
    x = x + _A_ref(_layernorm(x, axis=-1), A_mem0, A_Wq, A_Wk, A_Wv, A_Wo, A_seg_len)
    x = x + _B_ref(_layernorm(x, axis=-1), B_wqkv, B_wo)
    return x
```

```asm
; @launch grid=(256,1,1) block=(256,1,1) lds=163840
.amdgcn_target "amdgcn-amd-amdhsa--gfx950"
.text
.globl interleave_layers__memory_aug_recurrent_mem_tr__softmax_full_mha__prompt_kernel
.p2align 8
.type interleave_layers__memory_aug_recurrent_mem_tr__softmax_full_mha__prompt_kernel,@function
interleave_layers__memory_aug_recurrent_mem_tr__softmax_full_mha__prompt_kernel:
    s_cmp_ge_u32 s2, 0x100
    s_cbranch_scc0 L_start
    s_endpgm
L_start:
    s_load_dwordx2 s[6:7], s[0:1], 88
    s_load_dwordx2 s[4:5], s[0:1], 96
    s_getreg_b32 s26, hwreg(HW_REG_XCC_ID)
    s_and_b32 s26, s26, 7
    s_lshl_b32 s26, s26, 2
    s_lshr_b32 s26, 0x76430521, s26
    s_and_b32 s26, s26, 7
    v_lshrrev_b32 v1, 6, v0
    v_and_b32 v0, 63, v0
    s_mov_b32 s28, 0x05040100
    v_readfirstlane_b32 s24, v1
    s_mov_b32 s29, 0x07060302
    s_waitcnt lgkmcnt(0)
    s_mov_b32 s8, s4
    s_mov_b32 s9, s5
    s_mov_b32 s10, 268435456
    s_mov_b32 s11, 0x20000
    s_getreg_b32 s3, hwreg(HW_REG_HW_ID, 4, 2)
    s_lshl_b32 s30, 1, s3
    v_lshlrev_b32 v2, 2, v1
    v_mov_b32 v3, s30
    ds_write_b32 v2, v3 offset:16
    s_cmp_eq_u32 s24, 0
    s_cbranch_scc1 L_rank
    s_cmp_lg_u32 s24, 1
    s_cbranch_scc1 L_rank_done
    s_getpc_b64 s[30:31]
L_pc:
    s_bfe_u32 s32, s2, 0x40003
    s_lshl_b32 s32, s32, 13
    v_lshlrev_b32 v2, 7, v0
    v_add_u32 v2, s32, v2
    v_min_u32 v2, L_code_end - L_pc - 4, v2
    global_load_dword v143, v2, s[30:31]
    s_branch L_rank_done
L_rank:
    s_lshl_b32 s30, s26, 2
    s_add_u32 s30, s30, 128
    s_cmp_eq_u32 s26, 0
    s_cselect_b32 s30, 0, s30
    v_mov_b32 v2, s30
    v_mov_b32 v3, 1
    v_mov_b32 v5, 0
    v_mov_b64 v[8:9], 0
    v_lshlrev_b32 v6, 3, v0
    s_lshl_b32 s31, s2, 9
    s_mov_b64 exec, 1
    global_atomic_add v4, v2, v3, s[6:7] sc0
    s_mov_b64 exec, -1
    buffer_store_dwordx2 v[8:9], v6, s[8:11], s31 offen sc1
    v_mov_b64 v[12:13], -1
    v_mov_b64 v[14:15], -1
    v_lshlrev_b32 v6, 4, v0
    v_lshlrev_b32 v7, 2, v0
    s_lshl_b32 s31, s2, 10
    s_add_u32 s31, s31, 262144
    buffer_store_dwordx4 v[12:15], v6, s[8:11], s31 offen sc1
    s_lshl_b32 s31, s2, 8
    s_add_u32 s31, s31, 131072
    buffer_store_dword v12, v7, s[8:11], s31 offen sc1
    s_mov_b64 exec, 1
    s_waitcnt vmcnt(0)
    global_atomic_add v5, v3, s[6:7] offset:64
    v_readfirstlane_b32 s30, v4
    s_mov_b64 exec, -1
    s_lshl_b32 s25, s26, 5
    s_add_u32 s25, s25, s30
    s_cmp_lt_u32 s30, 32
    s_cbranch_scc1 L_rank_put
    v_mov_b32 v5, 0
    s_mov_b32 s27, 0
L_wi_1:
    global_load_dword v4, v5, s[6:7] offset:64 sc1
    s_waitcnt vmcnt(0)
    v_cmp_gt_u32 vcc, 0x100, v4
    s_cbranch_vccz L_wiok_2
    s_sleep 2
    s_add_u32 s27, s27, 1
    s_cmp_lt_u32 s27, 200000
    s_cbranch_scc1 L_wi_1
    s_branch L_exit
L_wiok_2:
    s_mov_b64 exec, 1
    global_atomic_add v4, v5, v3, s[6:7] offset:68 sc0
    s_mov_b64 exec, -1
    v_lshlrev_b32 v6, 2, v0
    v_add_u32 v6, 128, v6
    v_cmp_eq_u32 vcc, 0, v0
    s_nop 1
    v_cndmask_b32 v6, v6, v5, vcc
    v_and_b32 v6, 0xbf, v6
    global_load_dword v7, v6, s[6:7] sc1
    s_waitcnt vmcnt(0)
    v_readfirstlane_b32 s30, v4
    s_mov_b32 s31, 0
L_hole:
    s_nop 3
    v_readlane_b32 s32, v7, s31
    s_min_u32 s32, s32, 32
    s_sub_u32 s33, 32, s32
    s_lshl_b32 s25, s31, 5
    s_add_u32 s25, s25, s32
    s_add_u32 s25, s25, s30
    s_cmp_lt_u32 s30, s33
    s_cbranch_scc1 L_rank_put
    s_sub_u32 s30, s30, s33
    s_add_u32 s31, s31, 1
    s_cmp_lt_u32 s31, 8
    s_cbranch_scc1 L_hole
    s_mov_b32 s25, 0x100
L_rank_put:
    v_mov_b32 v2, 0
    v_mov_b32 v3, s25
    ds_write_b32 v2, v3
L_rank_done:
    s_waitcnt lgkmcnt(0)
    s_barrier
    v_mov_b32 v2, 0
    ds_read_b32 v3, v2
    ds_read_b128 v[4:7], v2 offset:16
    s_waitcnt lgkmcnt(0)
    v_readfirstlane_b32 s25, v3
    v_or3_b32 v4, v4, v5, v6
    v_or_b32 v4, v4, v7
    s_barrier
    v_readfirstlane_b32 s30, v4
    s_lshl_b32 s3, s3, 2
    s_lshr_b32 s3, 0x3120, s3
    s_and_b32 s3, s3, 3
    s_cmp_eq_u32 s30, 15
    s_cselect_b32 s24, s3, s24
    s_cmp_lt_u32 s25, 0x100
    s_cbranch_scc1 L_dispatch
L_exit:
    s_endpgm
L_dispatch:
    s_cmp_lt_u32 s25, 32
    s_cbranch_scc0 L_d_3
    s_branch L_role_chain
L_d_3:
    s_and_b32 s30, s25, 31
    s_cmp_lt_u32 s25, 160
    s_cbranch_scc0 L_d_4
    s_cmp_lt_u32 s30, 16
    s_cbranch_scc0 L_d_5
    s_branch L_role_p
L_d_5:
    s_branch L_role_batt
L_d_4:
    s_cmp_lt_u32 s30, 16
    s_cbranch_scc0 L_d_6
    s_branch L_role_x2
L_d_6:
    s_cmp_lt_u32 s30, 24
    s_cbranch_scc0 L_d_7
    s_branch L_role_x3
L_d_7:
    s_branch L_role_x1
L_role_chain:
    s_mov_b32 s32, s25
    v_lshrrev_b32 v120, 4, v0
    v_and_b32 v121, 15, v0
    v_lshlrev_b32 v2, 4, v0
    s_mul_i32 s30, s24, 36864
    s_add_u32 s30, s30, 16384
    v_add_u32 v3, s30, v2
    v_lshrrev_b32 v122, 1, v120
    v_and_b32 v123, 1, v120
    v_lshlrev_b32 v16, 19, v122
    v_lshl_add_u32 v16, v123, 17, v16
    v_lshl_add_u32 v16, v121, 2, v16
    s_lshl_b32 s30, s32, 8
    s_lshl_b32 s31, s24, 6
    s_add_u32 s30, s30, s31
    v_add_u32 v16, s30, v16
    v_add_u32 v17, 0x2000, v16
    s_load_dwordx2 s[16:17], s[0:1], 40
    s_load_dwordx2 s[80:81], s[0:1], 16
    s_load_dwordx2 s[84:85], s[0:1], 24
    s_load_dwordx2 s[88:89], s[0:1], 32
    s_waitcnt lgkmcnt(0)
    s_mov_b32 s18, 4194304
    s_mov_b32 s19, 0x20000
    s_mov_b32 s82, 4194304
    s_mov_b32 s83, 0x20000
    s_mov_b32 s86, 4194304
    s_mov_b32 s87, 0x20000
    s_mov_b32 s90, 4194304
    s_mov_b32 s91, 0x20000
    s_lshl_b32 s92, s32, 8
    v_lshrrev_b32 v124, 5, v0
    v_mul_u32_u24 v16, 64, v124
    v_bfe_u32 v124, v0, 4, 1
    v_mul_u32_u24 v124, 16, v124
    v_add_u32 v16, v16, v124
    s_lshr_b32 s30, s24, 1
    s_mul_i32 s30, s30, 128
    s_and_b32 s31, s24, 1
    s_mul_i32 s31, s31, 8
    s_add_u32 s30, s30, s31
    v_add_u32 v16, s30, v16
    v_lshlrev_b32 v16, 13, v16
    v_and_b32 v124, 15, v0
    v_lshl_add_u32 v16, v124, 4, v16
    v_add_u32 v16, s92, v16
    v_lshrrev_b32 v17, 4, v0
    v_lshlrev_b32 v17, 8, v17
    v_lshl_add_u32 v17, v124, 2, v17
    s_lshl_b32 s30, s24, 6
    s_add_u32 s30, s30, 0
    v_add_u32 v17, s30, v17
    v_add_u32 v18, 0x10000, v17
    s_lshl_b32 s31, s24, 12
    s_add_u32 m0, s31, 0
    s_mov_b32 s30, 0
    buffer_load_dwordx4 v16, s[80:83], s30 offen lds
    s_add_u32 m0, s31, 1024
    s_mov_b32 s30, 8192
    buffer_load_dwordx4 v16, s[80:83], s30 offen lds
    s_add_u32 m0, s31, 2048
    s_mov_b32 s30, 262144
    buffer_load_dwordx4 v16, s[80:83], s30 offen lds
    s_add_u32 m0, s31, 3072
    s_mov_b32 s30, 270336
    buffer_load_dwordx4 v16, s[80:83], s30 offen lds
    s_add_u32 m0, s31, 16384
    s_mov_b32 s30, 2097152
    buffer_load_dwordx4 v16, s[80:83], s30 offen lds
    s_add_u32 m0, s31, 17408
    s_mov_b32 s30, 2105344
    buffer_load_dwordx4 v16, s[80:83], s30 offen lds
    s_add_u32 m0, s31, 18432
    s_mov_b32 s30, 2359296
    buffer_load_dwordx4 v16, s[80:83], s30 offen lds
    s_add_u32 m0, s31, 19456
    s_mov_b32 s30, 2367488
    buffer_load_dwordx4 v16, s[80:83], s30 offen lds
    s_add_u32 m0, s31, 32768
    s_mov_b32 s30, 16384
    buffer_load_dwordx4 v16, s[80:83], s30 offen lds
    s_add_u32 m0, s31, 33792
    s_mov_b32 s30, 24576
    buffer_load_dwordx4 v16, s[80:83], s30 offen lds
    s_add_u32 m0, s31, 34816
    s_mov_b32 s30, 278528
    buffer_load_dwordx4 v16, s[80:83], s30 offen lds
    s_add_u32 m0, s31, 35840
    s_mov_b32 s30, 286720
    buffer_load_dwordx4 v16, s[80:83], s30 offen lds
    s_add_u32 m0, s31, 49152
    s_mov_b32 s30, 2113536
    buffer_load_dwordx4 v16, s[80:83], s30 offen lds
    s_add_u32 m0, s31, 50176
    s_mov_b32 s30, 2121728
    buffer_load_dwordx4 v16, s[80:83], s30 offen lds
    s_add_u32 m0, s31, 51200
    s_mov_b32 s30, 2375680
    buffer_load_dwordx4 v16, s[80:83], s30 offen lds
    s_add_u32 m0, s31, 52224
    s_mov_b32 s30, 2383872
    buffer_load_dwordx4 v16, s[80:83], s30 offen lds
    s_add_u32 m0, s31, 65536
    s_mov_b32 s30, 32768
    buffer_load_dwordx4 v16, s[80:83], s30 offen lds
    s_add_u32 m0, s31, 66560
    s_mov_b32 s30, 40960
    buffer_load_dwordx4 v16, s[80:83], s30 offen lds
    s_add_u32 m0, s31, 67584
    s_mov_b32 s30, 294912
    buffer_load_dwordx4 v16, s[80:83], s30 offen lds
    s_add_u32 m0, s31, 68608
    s_mov_b32 s30, 303104
    buffer_load_dwordx4 v16, s[80:83], s30 offen lds
    s_add_u32 m0, s31, 81920
    s_mov_b32 s30, 2129920
    buffer_load_dwordx4 v16, s[80:83], s30 offen lds
    s_add_u32 m0, s31, 82944
    s_mov_b32 s30, 2138112
    buffer_load_dwordx4 v16, s[80:83], s30 offen lds
    s_add_u32 m0, s31, 83968
    s_mov_b32 s30, 2392064
    buffer_load_dwordx4 v16, s[80:83], s30 offen lds
    s_add_u32 m0, s31, 84992
    s_mov_b32 s30, 2400256
    buffer_load_dwordx4 v16, s[80:83], s30 offen lds
    s_waitcnt vmcnt(20)
    s_barrier
    ds_read2st64_b32 v[124:125], v17 offset0:0 offset1:4
    ds_read2st64_b32 v[126:127], v17 offset0:8 offset1:12
    ds_read2st64_b32 v[128:129], v17 offset0:16 offset1:20
    ds_read2st64_b32 v[130:131], v17 offset0:24 offset1:28
    ds_read2st64_b32 v[132:133], v17 offset0:32 offset1:36
    ds_read2st64_b32 v[134:135], v17 offset0:40 offset1:44
    ds_read2st64_b32 v[136:137], v17 offset0:48 offset1:52
    ds_read2st64_b32 v[138:139], v17 offset0:56 offset1:60
    s_add_u32 m0, s31, 98304
    s_mov_b32 s30, 49152
    buffer_load_dwordx4 v16, s[80:83], s30 offen lds
    s_add_u32 m0, s31, 99328
    s_mov_b32 s30, 57344
    buffer_load_dwordx4 v16, s[80:83], s30 offen lds
    s_add_u32 m0, s31, 100352
    s_mov_b32 s30, 311296
    buffer_load_dwordx4 v16, s[80:83], s30 offen lds
    s_add_u32 m0, s31, 101376
    s_mov_b32 s30, 319488
    buffer_load_dwordx4 v16, s[80:83], s30 offen lds
    s_waitcnt lgkmcnt(6)
    v_perm_b32 v40, v125, v124, s28
    v_perm_b32 v48, v125, v124, s29
    v_perm_b32 v41, v127, v126, s28
    v_perm_b32 v49, v127, v126, s29
    s_waitcnt lgkmcnt(4)
    v_perm_b32 v42, v129, v128, s28
    v_perm_b32 v50, v129, v128, s29
    v_perm_b32 v43, v131, v130, s28
    v_perm_b32 v51, v131, v130, s29
    s_waitcnt lgkmcnt(2)
    v_perm_b32 v44, v133, v132, s28
    v_perm_b32 v52, v133, v132, s29
    v_perm_b32 v45, v135, v134, s28
    v_perm_b32 v53, v135, v134, s29
    s_waitcnt lgkmcnt(0)
    v_perm_b32 v46, v137, v136, s28
    v_perm_b32 v54, v137, v136, s29
    v_perm_b32 v47, v139, v138, s28
    v_perm_b32 v55, v139, v138, s29
    s_waitcnt vmcnt(20)
    s_barrier
    ds_read2st64_b32 v[124:125], v17 offset0:64 offset1:68
    ds_read2st64_b32 v[126:127], v17 offset0:72 offset1:76
    ds_read2st64_b32 v[128:129], v17 offset0:80 offset1:84
    ds_read2st64_b32 v[130:131], v17 offset0:88 offset1:92
    ds_read2st64_b32 v[132:133], v17 offset0:96 offset1:100
    ds_read2st64_b32 v[134:135], v17 offset0:104 offset1:108
    ds_read2st64_b32 v[136:137], v17 offset0:112 offset1:116
    ds_read2st64_b32 v[138:139], v17 offset0:120 offset1:124
    s_add_u32 m0, s31, 114688
    s_mov_b32 s30, 2146304
    buffer_load_dwordx4 v16, s[80:83], s30 offen lds
    s_add_u32 m0, s31, 115712
    s_mov_b32 s30, 2154496
    buffer_load_dwordx4 v16, s[80:83], s30 offen lds
    s_add_u32 m0, s31, 116736
    s_mov_b32 s30, 2408448
    buffer_load_dwordx4 v16, s[80:83], s30 offen lds
    s_add_u32 m0, s31, 117760
    s_mov_b32 s30, 2416640
    buffer_load_dwordx4 v16, s[80:83], s30 offen lds
    s_waitcnt lgkmcnt(6)
    v_perm_b32 v56, v125, v124, s28
    v_perm_b32 v64, v125, v124, s29
    v_perm_b32 v57, v127, v126, s28
    v_perm_b32 v65, v127, v126, s29
    s_waitcnt lgkmcnt(4)
    v_perm_b32 v58, v129, v128, s28
    v_perm_b32 v66, v129, v128, s29
    v_perm_b32 v59, v131, v130, s28
    v_perm_b32 v67, v131, v130, s29
    s_waitcnt lgkmcnt(2)
    v_perm_b32 v60, v133, v132, s28
    v_perm_b32 v68, v133, v132, s29
    v_perm_b32 v61, v135, v134, s28
    v_perm_b32 v69, v135, v134, s29
    s_waitcnt lgkmcnt(0)
    v_perm_b32 v62, v137, v136, s28
    v_perm_b32 v70, v137, v136, s29
    v_perm_b32 v63, v139, v138, s28
    v_perm_b32 v71, v139, v138, s29
    s_waitcnt vmcnt(20)
    s_barrier
    ds_read2st64_b32 v[124:125], v17 offset0:128 offset1:132
    ds_read2st64_b32 v[126:127], v17 offset0:136 offset1:140
    ds_read2st64_b32 v[128:129], v17 offset0:144 offset1:148
    ds_read2st64_b32 v[130:131], v17 offset0:152 offset1:156
    ds_read2st64_b32 v[132:133], v17 offset0:160 offset1:164
    ds_read2st64_b32 v[134:135], v17 offset0:168 offset1:172
    ds_read2st64_b32 v[136:137], v17 offset0:176 offset1:180
    ds_read2st64_b32 v[138:139], v17 offset0:184 offset1:188
    s_add_u32 m0, s31, 0
    s_mov_b32 s30, 0
    buffer_load_dwordx4 v16, s[84:87], s30 offen lds
    s_add_u32 m0, s31, 1024
    s_mov_b32 s30, 8192
    buffer_load_dwordx4 v16, s[84:87], s30 offen lds
    s_add_u32 m0, s31, 2048
    s_mov_b32 s30, 262144
    buffer_load_dwordx4 v16, s[84:87], s30 offen lds
    s_add_u32 m0, s31, 3072
    s_mov_b32 s30, 270336
    buffer_load_dwordx4 v16, s[84:87], s30 offen lds
    s_waitcnt lgkmcnt(6)
    v_perm_b32 v72, v125, v124, s28
    v_perm_b32 v141, v125, v124, s29
    v_accvgpr_write_b32 a248, v141
    v_perm_b32 v73, v127, v126, s28
    v_perm_b32 v141, v127, v126, s29
    v_accvgpr_write_b32 a249, v141
    s_waitcnt lgkmcnt(4)
    v_perm_b32 v74, v129, v128, s28
    v_perm_b32 v141, v129, v128, s29
    v_accvgpr_write_b32 a250, v141
    v_perm_b32 v75, v131, v130, s28
    v_perm_b32 v141, v131, v130, s29
    v_accvgpr_write_b32 a251, v141
    s_waitcnt lgkmcnt(2)
    v_perm_b32 v76, v133, v132, s28
    v_perm_b32 v141, v133, v132, s29
    v_accvgpr_write_b32 a252, v141
    v_perm_b32 v77, v135, v134, s28
    v_perm_b32 v141, v135, v134, s29
    v_accvgpr_write_b32 a253, v141
    s_waitcnt lgkmcnt(0)
    v_perm_b32 v78, v137, v136, s28
    v_perm_b32 v141, v137, v136, s29
    v_accvgpr_write_b32 a254, v141
    v_perm_b32 v79, v139, v138, s28
    v_perm_b32 v141, v139, v138, s29
    v_accvgpr_write_b32 a255, v141
    s_waitcnt vmcnt(20)
    s_barrier
    ds_read2st64_b32 v[124:125], v17 offset0:192 offset1:196
    ds_read2st64_b32 v[126:127], v17 offset0:200 offset1:204
    ds_read2st64_b32 v[128:129], v17 offset0:208 offset1:212
    ds_read2st64_b32 v[130:131], v17 offset0:216 offset1:220
    ds_read2st64_b32 v[132:133], v17 offset0:224 offset1:228
    ds_read2st64_b32 v[134:135], v17 offset0:232 offset1:236
    ds_read2st64_b32 v[136:137], v17 offset0:240 offset1:244
    ds_read2st64_b32 v[138:139], v17 offset0:248 offset1:252
    s_add_u32 m0, s31, 16384
    s_mov_b32 s30, 2097152
    buffer_load_dwordx4 v16, s[84:87], s30 offen lds
    s_add_u32 m0, s31, 17408
    s_mov_b32 s30, 2105344
    buffer_load_dwordx4 v16, s[84:87], s30 offen lds
    s_add_u32 m0, s31, 18432
    s_mov_b32 s30, 2359296
    buffer_load_dwordx4 v16, s[84:87], s30 offen lds
    s_add_u32 m0, s31, 19456
    s_mov_b32 s30, 2367488
    buffer_load_dwordx4 v16, s[84:87], s30 offen lds
    s_waitcnt lgkmcnt(6)
    v_perm_b32 v140, v125, v124, s28
    v_accvgpr_write_b32 a240, v140
    v_perm_b32 v141, v125, v124, s29
    v_accvgpr_write_b32 a232, v141
    v_perm_b32 v140, v127, v126, s28
    v_accvgpr_write_b32 a241, v140
    v_perm_b32 v141, v127, v126, s29
    v_accvgpr_write_b32 a233, v141
    s_waitcnt lgkmcnt(4)
    v_perm_b32 v140, v129, v128, s28
    v_accvgpr_write_b32 a242, v140
    v_perm_b32 v141, v129, v128, s29
    v_accvgpr_write_b32 a234, v141
    v_perm_b32 v140, v131, v130, s28
    v_accvgpr_write_b32 a243, v140
    v_perm_b32 v141, v131, v130, s29
    v_accvgpr_write_b32 a235, v141
    s_waitcnt lgkmcnt(2)
    v_perm_b32 v140, v133, v132, s28
    v_accvgpr_write_b32 a244, v140
    v_perm_b32 v141, v133, v132, s29
    v_accvgpr_write_b32 a236, v141
    v_perm_b32 v140, v135, v134, s28
    v_accvgpr_write_b32 a245, v140
    v_perm_b32 v141, v135, v134, s29
    v_accvgpr_write_b32 a237, v141
    s_waitcnt lgkmcnt(0)
    v_perm_b32 v140, v137, v136, s28
    v_accvgpr_write_b32 a246, v140
    v_perm_b32 v141, v137, v136, s29
    v_accvgpr_write_b32 a238, v141
    v_perm_b32 v140, v139, v138, s28
    v_accvgpr_write_b32 a247, v140
    v_perm_b32 v141, v139, v138, s29
    v_accvgpr_write_b32 a239, v141
    s_waitcnt vmcnt(20)
    s_barrier
    ds_read2st64_b32 v[124:125], v18 offset0:0 offset1:4
    ds_read2st64_b32 v[126:127], v18 offset0:8 offset1:12
    ds_read2st64_b32 v[128:129], v18 offset0:16 offset1:20
    ds_read2st64_b32 v[130:131], v18 offset0:24 offset1:28
    ds_read2st64_b32 v[132:133], v18 offset0:32 offset1:36
    ds_read2st64_b32 v[134:135], v18 offset0:40 offset1:44
    ds_read2st64_b32 v[136:137], v18 offset0:48 offset1:52
    ds_read2st64_b32 v[138:139], v18 offset0:56 offset1:60
    s_add_u32 m0, s31, 32768
    s_mov_b32 s30, 16384
    buffer_load_dwordx4 v16, s[84:87], s30 offen lds
    s_add_u32 m0, s31, 33792
    s_mov_b32 s30, 24576
    buffer_load_dwordx4 v16, s[84:87], s30 offen lds
    s_add_u32 m0, s31, 34816
    s_mov_b32 s30, 278528
    buffer_load_dwordx4 v16, s[84:87], s30 offen lds
    s_add_u32 m0, s31, 35840
    s_mov_b32 s30, 286720
    buffer_load_dwordx4 v16, s[84:87], s30 offen lds
    s_waitcnt lgkmcnt(6)
    v_perm_b32 v140, v125, v124, s28
    v_accvgpr_write_b32 a224, v140
    v_perm_b32 v141, v125, v124, s29
    v_accvgpr_write_b32 a216, v141
    v_perm_b32 v140, v127, v126, s28
    v_accvgpr_write_b32 a225, v140
    v_perm_b32 v141, v127, v126, s29
    v_accvgpr_write_b32 a217, v141
    s_waitcnt lgkmcnt(4)
    v_perm_b32 v140, v129, v128, s28
    v_accvgpr_write_b32 a226, v140
    v_perm_b32 v141, v129, v128, s29
    v_accvgpr_write_b32 a218, v141
    v_perm_b32 v140, v131, v130, s28
    v_accvgpr_write_b32 a227, v140
    v_perm_b32 v141, v131, v130, s29
    v_accvgpr_write_b32 a219, v141
    s_waitcnt lgkmcnt(2)
    v_perm_b32 v140, v133, v132, s28
    v_accvgpr_write_b32 a228, v140
    v_perm_b32 v141, v133, v132, s29
    v_accvgpr_write_b32 a220, v141
    v_perm_b32 v140, v135, v134, s28
    v_accvgpr_write_b32 a229, v140
    v_perm_b32 v141, v135, v134, s29
    v_accvgpr_write_b32 a221, v141
    s_waitcnt lgkmcnt(0)
    v_perm_b32 v140, v137, v136, s28
    v_accvgpr_write_b32 a230, v140
    v_perm_b32 v141, v137, v136, s29
    v_accvgpr_write_b32 a222, v141
    v_perm_b32 v140, v139, v138, s28
    v_accvgpr_write_b32 a231, v140
    v_perm_b32 v141, v139, v138, s29
    v_accvgpr_write_b32 a223, v141
    s_waitcnt vmcnt(20)
    s_barrier
    ds_read2st64_b32 v[124:125], v18 offset0:64 offset1:68
    ds_read2st64_b32 v[126:127], v18 offset0:72 offset1:76
    ds_read2st64_b32 v[128:129], v18 offset0:80 offset1:84
    ds_read2st64_b32 v[130:131], v18 offset0:88 offset1:92
    ds_read2st64_b32 v[132:133], v18 offset0:96 offset1:100
    ds_read2st64_b32 v[134:135], v18 offset0:104 offset1:108
    ds_read2st64_b32 v[136:137], v18 offset0:112 offset1:116
    ds_read2st64_b32 v[138:139], v18 offset0:120 offset1:124
    s_add_u32 m0, s31, 49152
    s_mov_b32 s30, 2113536
    buffer_load_dwordx4 v16, s[84:87], s30 offen lds
    s_add_u32 m0, s31, 50176
    s_mov_b32 s30, 2121728
    buffer_load_dwordx4 v16, s[84:87], s30 offen lds
    s_add_u32 m0, s31, 51200
    s_mov_b32 s30, 2375680
    buffer_load_dwordx4 v16, s[84:87], s30 offen lds
    s_add_u32 m0, s31, 52224
    s_mov_b32 s30, 2383872
    buffer_load_dwordx4 v16, s[84:87], s30 offen lds
    s_waitcnt lgkmcnt(6)
    v_perm_b32 v140, v125, v124, s28
    v_accvgpr_write_b32 a208, v140
    v_perm_b32 v141, v125, v124, s29
    v_accvgpr_write_b32 a200, v141
    v_perm_b32 v140, v127, v126, s28
    v_accvgpr_write_b32 a209, v140
    v_perm_b32 v141, v127, v126, s29
    v_accvgpr_write_b32 a201, v141
    s_waitcnt lgkmcnt(4)
    v_perm_b32 v140, v129, v128, s28
    v_accvgpr_write_b32 a210, v140
    v_perm_b32 v141, v129, v128, s29
    v_accvgpr_write_b32 a202, v141
    v_perm_b32 v140, v131, v130, s28
    v_accvgpr_write_b32 a211, v140
    v_perm_b32 v141, v131, v130, s29
    v_accvgpr_write_b32 a203, v141
    s_waitcnt lgkmcnt(2)
    v_perm_b32 v140, v133, v132, s28
    v_accvgpr_write_b32 a212, v140
    v_perm_b32 v141, v133, v132, s29
    v_accvgpr_write_b32 a204, v141
    v_perm_b32 v140, v135, v134, s28
    v_accvgpr_write_b32 a213, v140
    v_perm_b32 v141, v135, v134, s29
    v_accvgpr_write_b32 a205, v141
    s_waitcnt lgkmcnt(0)
    v_perm_b32 v140, v137, v136, s28
    v_accvgpr_write_b32 a214, v140
    v_perm_b32 v141, v137, v136, s29
    v_accvgpr_write_b32 a206, v141
    v_perm_b32 v140, v139, v138, s28
    v_accvgpr_write_b32 a215, v140
    v_perm_b32 v141, v139, v138, s29
    v_accvgpr_write_b32 a207, v141
    s_waitcnt vmcnt(20)
    s_barrier
    ds_read2st64_b32 v[124:125], v18 offset0:128 offset1:132
    ds_read2st64_b32 v[126:127], v18 offset0:136 offset1:140
    ds_read2st64_b32 v[128:129], v18 offset0:144 offset1:148
    ds_read2st64_b32 v[130:131], v18 offset0:152 offset1:156
    ds_read2st64_b32 v[132:133], v18 offset0:160 offset1:164
    ds_read2st64_b32 v[134:135], v18 offset0:168 offset1:172
    ds_read2st64_b32 v[136:137], v18 offset0:176 offset1:180
    ds_read2st64_b32 v[138:139], v18 offset0:184 offset1:188
    s_add_u32 m0, s31, 65536
    s_mov_b32 s30, 32768
    buffer_load_dwordx4 v16, s[84:87], s30 offen lds
    s_add_u32 m0, s31, 66560
    s_mov_b32 s30, 40960
    buffer_load_dwordx4 v16, s[84:87], s30 offen lds
    s_add_u32 m0, s31, 67584
    s_mov_b32 s30, 294912
    buffer_load_dwordx4 v16, s[84:87], s30 offen lds
    s_add_u32 m0, s31, 68608
    s_mov_b32 s30, 303104
    buffer_load_dwordx4 v16, s[84:87], s30 offen lds
    s_waitcnt lgkmcnt(6)
    v_perm_b32 v140, v125, v124, s28
    v_accvgpr_write_b32 a192, v140
    v_perm_b32 v141, v125, v124, s29
    v_accvgpr_write_b32 a184, v141
    v_perm_b32 v140, v127, v126, s28
    v_accvgpr_write_b32 a193, v140
    v_perm_b32 v141, v127, v126, s29
    v_accvgpr_write_b32 a185, v141
    s_waitcnt lgkmcnt(4)
    v_perm_b32 v140, v129, v128, s28
    v_accvgpr_write_b32 a194, v140
    v_perm_b32 v141, v129, v128, s29
    v_accvgpr_write_b32 a186, v141
    v_perm_b32 v140, v131, v130, s28
    v_accvgpr_write_b32 a195, v140
    v_perm_b32 v141, v131, v130, s29
    v_accvgpr_write_b32 a187, v141
    s_waitcnt lgkmcnt(2)
    v_perm_b32 v140, v133, v132, s28
    v_accvgpr_write_b32 a196, v140
    v_perm_b32 v141, v133, v132, s29
    v_accvgpr_write_b32 a188, v141
    v_perm_b32 v140, v135, v134, s28
    v_accvgpr_write_b32 a197, v140
    v_perm_b32 v141, v135, v134, s29
    v_accvgpr_write_b32 a189, v141
    s_waitcnt lgkmcnt(0)
    v_perm_b32 v140, v137, v136, s28
    v_accvgpr_write_b32 a198, v140
    v_perm_b32 v141, v137, v136, s29
    v_accvgpr_write_b32 a190, v141
    v_perm_b32 v140, v139, v138, s28
    v_accvgpr_write_b32 a199, v140
    v_perm_b32 v141, v139, v138, s29
    v_accvgpr_write_b32 a191, v141
    s_waitcnt vmcnt(20)
    s_barrier
    ds_read2st64_b32 v[124:125], v18 offset0:192 offset1:196
    ds_read2st64_b32 v[126:127], v18 offset0:200 offset1:204
    ds_read2st64_b32 v[128:129], v18 offset0:208 offset1:212
    ds_read2st64_b32 v[130:131], v18 offset0:216 offset1:220
    ds_read2st64_b32 v[132:133], v18 offset0:224 offset1:228
    ds_read2st64_b32 v[134:135], v18 offset0:232 offset1:236
    ds_read2st64_b32 v[136:137], v18 offset0:240 offset1:244
    ds_read2st64_b32 v[138:139], v18 offset0:248 offset1:252
    s_add_u32 m0, s31, 81920
    s_mov_b32 s30, 2129920
    buffer_load_dwordx4 v16, s[84:87], s30 offen lds
    s_add_u32 m0, s31, 82944
    s_mov_b32 s30, 2138112
    buffer_load_dwordx4 v16, s[84:87], s30 offen lds
    s_add_u32 m0, s31, 83968
    s_mov_b32 s30, 2392064
    buffer_load_dwordx4 v16, s[84:87], s30 offen lds
    s_add_u32 m0, s31, 84992
    s_mov_b32 s30, 2400256
    buffer_load_dwordx4 v16, s[84:87], s30 offen lds
    s_waitcnt lgkmcnt(6)
    v_perm_b32 v140, v125, v124, s28
    v_accvgpr_write_b32 a176, v140
    v_perm_b32 v141, v125, v124, s29
    v_accvgpr_write_b32 a168, v141
    v_perm_b32 v140, v127, v126, s28
    v_accvgpr_write_b32 a177, v140
    v_perm_b32 v141, v127, v126, s29
    v_accvgpr_write_b32 a169, v141
    s_waitcnt lgkmcnt(4)
    v_perm_b32 v140, v129, v128, s28
    v_accvgpr_write_b32 a178, v140
    v_perm_b32 v141, v129, v128, s29
    v_accvgpr_write_b32 a170, v141
    v_perm_b32 v140, v131, v130, s28
    v_accvgpr_write_b32 a179, v140
    v_perm_b32 v141, v131, v130, s29
    v_accvgpr_write_b32 a171, v141
    s_waitcnt lgkmcnt(2)
    v_perm_b32 v140, v133, v132, s28
    v_accvgpr_write_b32 a180, v140
    v_perm_b32 v141, v133, v132, s29
    v_accvgpr_write_b32 a172, v141
    v_perm_b32 v140, v135, v134, s28
    v_accvgpr_write_b32 a181, v140
    v_perm_b32 v141, v135, v134, s29
    v_accvgpr_write_b32 a173, v141
    s_waitcnt lgkmcnt(0)
    v_perm_b32 v140, v137, v136, s28
    v_accvgpr_write_b32 a182, v140
    v_perm_b32 v141, v137, v136, s29
    v_accvgpr_write_b32 a174, v141
    v_perm_b32 v140, v139, v138, s28
    v_accvgpr_write_b32 a183, v140
    v_perm_b32 v141, v139, v138, s29
    v_accvgpr_write_b32 a175, v141
    s_waitcnt vmcnt(20)
    s_barrier
    ds_read2st64_b32 v[124:125], v17 offset0:0 offset1:4
    ds_read2st64_b32 v[126:127], v17 offset0:8 offset1:12
    ds_read2st64_b32 v[128:129], v17 offset0:16 offset1:20
    ds_read2st64_b32 v[130:131], v17 offset0:24 offset1:28
    ds_read2st64_b32 v[132:133], v17 offset0:32 offset1:36
    ds_read2st64_b32 v[134:135], v17 offset0:40 offset1:44
    ds_read2st64_b32 v[136:137], v17 offset0:48 offset1:52
    ds_read2st64_b32 v[138:139], v17 offset0:56 offset1:60
    s_add_u32 m0, s31, 98304
    s_mov_b32 s30, 49152
    buffer_load_dwordx4 v16, s[84:87], s30 offen lds
    s_add_u32 m0, s31, 99328
    s_mov_b32 s30, 57344
    buffer_load_dwordx4 v16, s[84:87], s30 offen lds
    s_add_u32 m0, s31, 100352
    s_mov_b32 s30, 311296
    buffer_load_dwordx4 v16, s[84:87], s30 offen lds
    s_add_u32 m0, s31, 101376
    s_mov_b32 s30, 319488
    buffer_load_dwordx4 v16, s[84:87], s30 offen lds
    s_waitcnt lgkmcnt(6)
    v_perm_b32 v140, v125, v124, s28
    v_accvgpr_write_b32 a160, v140
    v_perm_b32 v141, v125, v124, s29
    v_accvgpr_write_b32 a152, v141
    v_perm_b32 v140, v127, v126, s28
    v_accvgpr_write_b32 a161, v140
    v_perm_b32 v141, v127, v126, s29
    v_accvgpr_write_b32 a153, v141
    s_waitcnt lgkmcnt(4)
    v_perm_b32 v140, v129, v128, s28
    v_accvgpr_write_b32 a162, v140
    v_perm_b32 v141, v129, v128, s29
    v_accvgpr_write_b32 a154, v141
    v_perm_b32 v140, v131, v130, s28
    v_accvgpr_write_b32 a163, v140
    v_perm_b32 v141, v131, v130, s29
    v_accvgpr_write_b32 a155, v141
    s_waitcnt lgkmcnt(2)
    v_perm_b32 v140, v133, v132, s28
    v_accvgpr_write_b32 a164, v140
    v_perm_b32 v141, v133, v132, s29
    v_accvgpr_write_b32 a156, v141
    v_perm_b32 v140, v135, v134, s28
    v_accvgpr_write_b32 a165, v140
    v_perm_b32 v141, v135, v134, s29
    v_accvgpr_write_b32 a157, v141
    s_waitcnt lgkmcnt(0)
    v_perm_b32 v140, v137, v136, s28
    v_accvgpr_write_b32 a166, v140
    v_perm_b32 v141, v137, v136, s29
    v_accvgpr_write_b32 a158, v141
    v_perm_b32 v140, v139, v138, s28
    v_accvgpr_write_b32 a167, v140
    v_perm_b32 v141, v139, v138, s29
    v_accvgpr_write_b32 a159, v141
    s_waitcnt vmcnt(20)
    s_barrier
    ds_read2st64_b32 v[124:125], v17 offset0:64 offset1:68
    ds_read2st64_b32 v[126:127], v17 offset0:72 offset1:76
    ds_read2st64_b32 v[128:129], v17 offset0:80 offset1:84
    ds_read2st64_b32 v[130:131], v17 offset0:88 offset1:92
    ds_read2st64_b32 v[132:133], v17 offset0:96 offset1:100
    ds_read2st64_b32 v[134:135], v17 offset0:104 offset1:108
    ds_read2st64_b32 v[136:137], v17 offset0:112 offset1:116
    ds_read2st64_b32 v[138:139], v17 offset0:120 offset1:124
    s_add_u32 m0, s31, 114688
    s_mov_b32 s30, 2146304
    buffer_load_dwordx4 v16, s[84:87], s30 offen lds
    s_add_u32 m0, s31, 115712
    s_mov_b32 s30, 2154496
    buffer_load_dwordx4 v16, s[84:87], s30 offen lds
    s_add_u32 m0, s31, 116736
    s_mov_b32 s30, 2408448
    buffer_load_dwordx4 v16, s[84:87], s30 offen lds
    s_add_u32 m0, s31, 117760
    s_mov_b32 s30, 2416640
    buffer_load_dwordx4 v16, s[84:87], s30 offen lds
    s_waitcnt lgkmcnt(6)
    v_perm_b32 v80, v125, v124, s28
    v_perm_b32 v141, v125, v124, s29
    v_accvgpr_write_b32 a144, v141
    v_perm_b32 v81, v127, v126, s28
    v_perm_b32 v141, v127, v126, s29
    v_accvgpr_write_b32 a145, v141
    s_waitcnt lgkmcnt(4)
    v_perm_b32 v82, v129, v128, s28
    v_perm_b32 v141, v129, v128, s29
    v_accvgpr_write_b32 a146, v141
    v_perm_b32 v83, v131, v130, s28
    v_perm_b32 v141, v131, v130, s29
    v_accvgpr_write_b32 a147, v141
    s_waitcnt lgkmcnt(2)
    v_perm_b32 v84, v133, v132, s28
    v_perm_b32 v141, v133, v132, s29
    v_accvgpr_write_b32 a148, v141
    v_perm_b32 v85, v135, v134, s28
    v_perm_b32 v141, v135, v134, s29
    v_accvgpr_write_b32 a149, v141
    s_waitcnt lgkmcnt(0)
    v_perm_b32 v86, v137, v136, s28
    v_perm_b32 v141, v137, v136, s29
    v_accvgpr_write_b32 a150, v141
    v_perm_b32 v87, v139, v138, s28
    v_perm_b32 v141, v139, v138, s29
    v_accvgpr_write_b32 a151, v141
    s_waitcnt vmcnt(20)
    s_barrier
    ds_read2st64_b32 v[124:125], v17 offset0:128 offset1:132
    ds_read2st64_b32 v[126:127], v17 offset0:136 offset1:140
    ds_read2st64_b32 v[128:129], v17 offset0:144 offset1:148
    ds_read2st64_b32 v[130:131], v17 offset0:152 offset1:156
    ds_read2st64_b32 v[132:133], v17 offset0:160 offset1:164
    ds_read2st64_b32 v[134:135], v17 offset0:168 offset1:172
    ds_read2st64_b32 v[136:137], v17 offset0:176 offset1:180
    ds_read2st64_b32 v[138:139], v17 offset0:184 offset1:188
    s_add_u32 m0, s31, 0
    s_mov_b32 s30, 0
    buffer_load_dwordx4 v16, s[88:91], s30 offen lds
    s_add_u32 m0, s31, 1024
    s_mov_b32 s30, 8192
    buffer_load_dwordx4 v16, s[88:91], s30 offen lds
    s_add_u32 m0, s31, 2048
    s_mov_b32 s30, 262144
    buffer_load_dwordx4 v16, s[88:91], s30 offen lds
    s_add_u32 m0, s31, 3072
    s_mov_b32 s30, 270336
    buffer_load_dwordx4 v16, s[88:91], s30 offen lds
    s_waitcnt lgkmcnt(6)
    v_perm_b32 v88, v125, v124, s28
    v_perm_b32 v141, v125, v124, s29
    v_accvgpr_write_b32 a136, v141
    v_perm_b32 v89, v127, v126, s28
    v_perm_b32 v141, v127, v126, s29
    v_accvgpr_write_b32 a137, v141
    s_waitcnt lgkmcnt(4)
    v_perm_b32 v90, v129, v128, s28
    v_perm_b32 v141, v129, v128, s29
    v_accvgpr_write_b32 a138, v141
    v_perm_b32 v91, v131, v130, s28
    v_perm_b32 v141, v131, v130, s29
    v_accvgpr_write_b32 a139, v141
    s_waitcnt lgkmcnt(2)
    v_perm_b32 v92, v133, v132, s28
    v_perm_b32 v141, v133, v132, s29
    v_accvgpr_write_b32 a140, v141
    v_perm_b32 v93, v135, v134, s28
    v_perm_b32 v141, v135, v134, s29
    v_accvgpr_write_b32 a141, v141
    s_waitcnt lgkmcnt(0)
    v_perm_b32 v94, v137, v136, s28
    v_perm_b32 v141, v137, v136, s29
    v_accvgpr_write_b32 a142, v141
    v_perm_b32 v95, v139, v138, s28
    v_perm_b32 v141, v139, v138, s29
    v_accvgpr_write_b32 a143, v141
    s_waitcnt vmcnt(20)
    s_barrier
    ds_read2st64_b32 v[124:125], v17 offset0:192 offset1:196
    ds_read2st64_b32 v[126:127], v17 offset0:200 offset1:204
    ds_read2st64_b32 v[128:129], v17 offset0:208 offset1:212
    ds_read2st64_b32 v[130:131], v17 offset0:216 offset1:220
    ds_read2st64_b32 v[132:133], v17 offset0:224 offset1:228
    ds_read2st64_b32 v[134:135], v17 offset0:232 offset1:236
    ds_read2st64_b32 v[136:137], v17 offset0:240 offset1:244
    ds_read2st64_b32 v[138:139], v17 offset0:248 offset1:252
    s_add_u32 m0, s31, 16384
    s_mov_b32 s30, 2097152
    buffer_load_dwordx4 v16, s[88:91], s30 offen lds
    s_add_u32 m0, s31, 17408
    s_mov_b32 s30, 2105344
    buffer_load_dwordx4 v16, s[88:91], s30 offen lds
    s_add_u32 m0, s31, 18432
    s_mov_b32 s30, 2359296
    buffer_load_dwordx4 v16, s[88:91], s30 offen lds
    s_add_u32 m0, s31, 19456
    s_mov_b32 s30, 2367488
    buffer_load_dwordx4 v16, s[88:91], s30 offen lds
    s_waitcnt lgkmcnt(6)
    v_perm_b32 v140, v125, v124, s28
    v_accvgpr_write_b32 a128, v140
    v_perm_b32 v141, v125, v124, s29
    v_accvgpr_write_b32 a120, v141
    v_perm_b32 v140, v127, v126, s28
    v_accvgpr_write_b32 a129, v140
    v_perm_b32 v141, v127, v126, s29
    v_accvgpr_write_b32 a121, v141
    s_waitcnt lgkmcnt(4)
    v_perm_b32 v140, v129, v128, s28
    v_accvgpr_write_b32 a130, v140
    v_perm_b32 v141, v129, v128, s29
    v_accvgpr_write_b32 a122, v141
    v_perm_b32 v140, v131, v130, s28
    v_accvgpr_write_b32 a131, v140
    v_perm_b32 v141, v131, v130, s29
    v_accvgpr_write_b32 a123, v141
    s_waitcnt lgkmcnt(2)
    v_perm_b32 v140, v133, v132, s28
    v_accvgpr_write_b32 a132, v140
    v_perm_b32 v141, v133, v132, s29
    v_accvgpr_write_b32 a124, v141
    v_perm_b32 v140, v135, v134, s28
    v_accvgpr_write_b32 a133, v140
    v_perm_b32 v141, v135, v134, s29
    v_accvgpr_write_b32 a125, v141
    s_waitcnt lgkmcnt(0)
    v_perm_b32 v140, v137, v136, s28
    v_accvgpr_write_b32 a134, v140
    v_perm_b32 v141, v137, v136, s29
    v_accvgpr_write_b32 a126, v141
    v_perm_b32 v140, v139, v138, s28
    v_accvgpr_write_b32 a135, v140
    v_perm_b32 v141, v139, v138, s29
    v_accvgpr_write_b32 a127, v141
    s_waitcnt vmcnt(20)
    s_barrier
    ds_read2st64_b32 v[124:125], v18 offset0:0 offset1:4
    ds_read2st64_b32 v[126:127], v18 offset0:8 offset1:12
    ds_read2st64_b32 v[128:129], v18 offset0:16 offset1:20
    ds_read2st64_b32 v[130:131], v18 offset0:24 offset1:28
    ds_read2st64_b32 v[132:133], v18 offset0:32 offset1:36
    ds_read2st64_b32 v[134:135], v18 offset0:40 offset1:44
    ds_read2st64_b32 v[136:137], v18 offset0:48 offset1:52
    ds_read2st64_b32 v[138:139], v18 offset0:56 offset1:60
    s_add_u32 m0, s31, 32768
    s_mov_b32 s30, 16384
    buffer_load_dwordx4 v16, s[88:91], s30 offen lds
    s_add_u32 m0, s31, 33792
    s_mov_b32 s30, 24576
    buffer_load_dwordx4 v16, s[88:91], s30 offen lds
    s_add_u32 m0, s31, 34816
    s_mov_b32 s30, 278528
    buffer_load_dwordx4 v16, s[88:91], s30 offen lds
    s_add_u32 m0, s31, 35840
    s_mov_b32 s30, 286720
    buffer_load_dwordx4 v16, s[88:91], s30 offen lds
    s_waitcnt lgkmcnt(6)
    v_perm_b32 v140, v125, v124, s28
    v_accvgpr_write_b32 a112, v140
    v_perm_b32 v141, v125, v124, s29
    v_accvgpr_write_b32 a104, v141
    v_perm_b32 v140, v127, v126, s28
    v_accvgpr_write_b32 a113, v140
    v_perm_b32 v141, v127, v126, s29
    v_accvgpr_write_b32 a105, v141
    s_waitcnt lgkmcnt(4)
    v_perm_b32 v140, v129, v128, s28
    v_accvgpr_write_b32 a114, v140
    v_perm_b32 v141, v129, v128, s29
    v_accvgpr_write_b32 a106, v141
    v_perm_b32 v140, v131, v130, s28
    v_accvgpr_write_b32 a115, v140
    v_perm_b32 v141, v131, v130, s29
    v_accvgpr_write_b32 a107, v141
    s_waitcnt lgkmcnt(2)
    v_perm_b32 v140, v133, v132, s28
    v_accvgpr_write_b32 a116, v140
    v_perm_b32 v141, v133, v132, s29
    v_accvgpr_write_b32 a108, v141
    v_perm_b32 v140, v135, v134, s28
    v_accvgpr_write_b32 a117, v140
    v_perm_b32 v141, v135, v134, s29
    v_accvgpr_write_b32 a109, v141
    s_waitcnt lgkmcnt(0)
    v_perm_b32 v140, v137, v136, s28
    v_accvgpr_write_b32 a118, v140
    v_perm_b32 v141, v137, v136, s29
    v_accvgpr_write_b32 a110, v141
    v_perm_b32 v140, v139, v138, s28
    v_accvgpr_write_b32 a119, v140
    v_perm_b32 v141, v139, v138, s29
    v_accvgpr_write_b32 a111, v141
    s_waitcnt vmcnt(20)
    s_barrier
    ds_read2st64_b32 v[124:125], v18 offset0:64 offset1:68
    ds_read2st64_b32 v[126:127], v18 offset0:72 offset1:76
    ds_read2st64_b32 v[128:129], v18 offset0:80 offset1:84
    ds_read2st64_b32 v[130:131], v18 offset0:88 offset1:92
    ds_read2st64_b32 v[132:133], v18 offset0:96 offset1:100
    ds_read2st64_b32 v[134:135], v18 offset0:104 offset1:108
    ds_read2st64_b32 v[136:137], v18 offset0:112 offset1:116
    ds_read2st64_b32 v[138:139], v18 offset0:120 offset1:124
    s_add_u32 m0, s31, 49152
    s_mov_b32 s30, 2113536
    buffer_load_dwordx4 v16, s[88:91], s30 offen lds
    s_add_u32 m0, s31, 50176
    s_mov_b32 s30, 2121728
    buffer_load_dwordx4 v16, s[88:91], s30 offen lds
    s_add_u32 m0, s31, 51200
    s_mov_b32 s30, 2375680
    buffer_load_dwordx4 v16, s[88:91], s30 offen lds
    s_add_u32 m0, s31, 52224
    s_mov_b32 s30, 2383872
    buffer_load_dwordx4 v16, s[88:91], s30 offen lds
    s_waitcnt lgkmcnt(6)
    v_perm_b32 v140, v125, v124, s28
    v_accvgpr_write_b32 a96, v140
    v_perm_b32 v96, v125, v124, s29
    v_perm_b32 v140, v127, v126, s28
    v_accvgpr_write_b32 a97, v140
    v_perm_b32 v97, v127, v126, s29
    s_waitcnt lgkmcnt(4)
    v_perm_b32 v140, v129, v128, s28
    v_accvgpr_write_b32 a98, v140
    v_perm_b32 v98, v129, v128, s29
    v_perm_b32 v140, v131, v130, s28
    v_accvgpr_write_b32 a99, v140
    v_perm_b32 v99, v131, v130, s29
    s_waitcnt lgkmcnt(2)
    v_perm_b32 v140, v133, v132, s28
    v_accvgpr_write_b32 a100, v140
    v_perm_b32 v100, v133, v132, s29
    v_perm_b32 v140, v135, v134, s28
    v_accvgpr_write_b32 a101, v140
    v_perm_b32 v101, v135, v134, s29
    s_waitcnt lgkmcnt(0)
    v_perm_b32 v140, v137, v136, s28
    v_accvgpr_write_b32 a102, v140
    v_perm_b32 v102, v137, v136, s29
    v_perm_b32 v140, v139, v138, s28
    v_accvgpr_write_b32 a103, v140
    v_perm_b32 v103, v139, v138, s29
    s_waitcnt vmcnt(20)
    s_barrier
    ds_read2st64_b32 v[124:125], v18 offset0:128 offset1:132
    ds_read2st64_b32 v[126:127], v18 offset0:136 offset1:140
    ds_read2st64_b32 v[128:129], v18 offset0:144 offset1:148
    ds_read2st64_b32 v[130:131], v18 offset0:152 offset1:156
    ds_read2st64_b32 v[132:133], v18 offset0:160 offset1:164
    ds_read2st64_b32 v[134:135], v18 offset0:168 offset1:172
    ds_read2st64_b32 v[136:137], v18 offset0:176 offset1:180
    ds_read2st64_b32 v[138:139], v18 offset0:184 offset1:188
    s_add_u32 m0, s31, 65536
    s_mov_b32 s30, 32768
    buffer_load_dwordx4 v16, s[88:91], s30 offen lds
    s_add_u32 m0, s31, 66560
    s_mov_b32 s30, 40960
    buffer_load_dwordx4 v16, s[88:91], s30 offen lds
    s_add_u32 m0, s31, 67584
    s_mov_b32 s30, 294912
    buffer_load_dwordx4 v16, s[88:91], s30 offen lds
    s_add_u32 m0, s31, 68608
    s_mov_b32 s30, 303104
    buffer_load_dwordx4 v16, s[88:91], s30 offen lds
    s_waitcnt lgkmcnt(6)
    v_perm_b32 v140, v125, v124, s28
    v_accvgpr_write_b32 a88, v140
    v_perm_b32 v104, v125, v124, s29
    v_perm_b32 v140, v127, v126, s28
    v_accvgpr_write_b32 a89, v140
    v_perm_b32 v105, v127, v126, s29
    s_waitcnt lgkmcnt(4)
    v_perm_b32 v140, v129, v128, s28
    v_accvgpr_write_b32 a90, v140
    v_perm_b32 v106, v129, v128, s29
    v_perm_b32 v140, v131, v130, s28
    v_accvgpr_write_b32 a91, v140
    v_perm_b32 v107, v131, v130, s29
    s_waitcnt lgkmcnt(2)
    v_perm_b32 v140, v133, v132, s28
    v_accvgpr_write_b32 a92, v140
    v_perm_b32 v108, v133, v132, s29
    v_perm_b32 v140, v135, v134, s28
    v_accvgpr_write_b32 a93, v140
    v_perm_b32 v109, v135, v134, s29
    s_waitcnt lgkmcnt(0)
    v_perm_b32 v140, v137, v136, s28
    v_accvgpr_write_b32 a94, v140
    v_perm_b32 v110, v137, v136, s29
    v_perm_b32 v140, v139, v138, s28
    v_accvgpr_write_b32 a95, v140
    v_perm_b32 v111, v139, v138, s29
    s_waitcnt vmcnt(20)
    s_barrier
    ds_read2st64_b32 v[124:125], v18 offset0:192 offset1:196
    ds_read2st64_b32 v[126:127], v18 offset0:200 offset1:204
    ds_read2st64_b32 v[128:129], v18 offset0:208 offset1:212
    ds_read2st64_b32 v[130:131], v18 offset0:216 offset1:220
    ds_read2st64_b32 v[132:133], v18 offset0:224 offset1:228
    ds_read2st64_b32 v[134:135], v18 offset0:232 offset1:236
    ds_read2st64_b32 v[136:137], v18 offset0:240 offset1:244
    ds_read2st64_b32 v[138:139], v18 offset0:248 offset1:252
    s_add_u32 m0, s31, 81920
    s_mov_b32 s30, 2129920
    buffer_load_dwordx4 v16, s[88:91], s30 offen lds
    s_add_u32 m0, s31, 82944
    s_mov_b32 s30, 2138112
    buffer_load_dwordx4 v16, s[88:91], s30 offen lds
    s_add_u32 m0, s31, 83968
    s_mov_b32 s30, 2392064
    buffer_load_dwordx4 v16, s[88:91], s30 offen lds
    s_add_u32 m0, s31, 84992
    s_mov_b32 s30, 2400256
    buffer_load_dwordx4 v16, s[88:91], s30 offen lds
    s_waitcnt lgkmcnt(6)
    v_perm_b32 v140, v125, v124, s28
    v_accvgpr_write_b32 a80, v140
    v_perm_b32 v112, v125, v124, s29
    v_perm_b32 v140, v127, v126, s28
    v_accvgpr_write_b32 a81, v140
    v_perm_b32 v113, v127, v126, s29
    s_waitcnt lgkmcnt(4)
    v_perm_b32 v140, v129, v128, s28
    v_accvgpr_write_b32 a82, v140
    v_perm_b32 v114, v129, v128, s29
    v_perm_b32 v140, v131, v130, s28
    v_accvgpr_write_b32 a83, v140
    v_perm_b32 v115, v131, v130, s29
    s_waitcnt lgkmcnt(2)
    v_perm_b32 v140, v133, v132, s28
    v_accvgpr_write_b32 a84, v140
    v_perm_b32 v116, v133, v132, s29
    v_perm_b32 v140, v135, v134, s28
    v_accvgpr_write_b32 a85, v140
    v_perm_b32 v117, v135, v134, s29
    s_waitcnt lgkmcnt(0)
    v_perm_b32 v140, v137, v136, s28
    v_accvgpr_write_b32 a86, v140
    v_perm_b32 v118, v137, v136, s29
    v_perm_b32 v140, v139, v138, s28
    v_accvgpr_write_b32 a87, v140
    v_perm_b32 v119, v139, v138, s29
    s_waitcnt vmcnt(20)
    s_barrier
    ds_read2st64_b32 v[124:125], v17 offset0:0 offset1:4
    ds_read2st64_b32 v[126:127], v17 offset0:8 offset1:12
    ds_read2st64_b32 v[128:129], v17 offset0:16 offset1:20
    ds_read2st64_b32 v[130:131], v17 offset0:24 offset1:28
    ds_read2st64_b32 v[132:133], v17 offset0:32 offset1:36
    ds_read2st64_b32 v[134:135], v17 offset0:40 offset1:44
    ds_read2st64_b32 v[136:137], v17 offset0:48 offset1:52
    ds_read2st64_b32 v[138:139], v17 offset0:56 offset1:60
    s_add_u32 m0, s31, 98304
    s_mov_b32 s30, 49152
    buffer_load_dwordx4 v16, s[88:91], s30 offen lds
    s_add_u32 m0, s31, 99328
    s_mov_b32 s30, 57344
    buffer_load_dwordx4 v16, s[88:91], s30 offen lds
    s_add_u32 m0, s31, 100352
    s_mov_b32 s30, 311296
    buffer_load_dwordx4 v16, s[88:91], s30 offen lds
    s_add_u32 m0, s31, 101376
    s_mov_b32 s30, 319488
    buffer_load_dwordx4 v16, s[88:91], s30 offen lds
    s_waitcnt lgkmcnt(6)
    v_perm_b32 v140, v125, v124, s28
    v_accvgpr_write_b32 a72, v140
    v_perm_b32 v141, v125, v124, s29
    v_accvgpr_write_b32 a64, v141
    v_perm_b32 v140, v127, v126, s28
    v_accvgpr_write_b32 a73, v140
    v_perm_b32 v141, v127, v126, s29
    v_accvgpr_write_b32 a65, v141
    s_waitcnt lgkmcnt(4)
    v_perm_b32 v140, v129, v128, s28
    v_accvgpr_write_b32 a74, v140
    v_perm_b32 v141, v129, v128, s29
    v_accvgpr_write_b32 a66, v141
    v_perm_b32 v140, v131, v130, s28
    v_accvgpr_write_b32 a75, v140
    v_perm_b32 v141, v131, v130, s29
    v_accvgpr_write_b32 a67, v141
    s_waitcnt lgkmcnt(2)
    v_perm_b32 v140, v133, v132, s28
    v_accvgpr_write_b32 a76, v140
    v_perm_b32 v141, v133, v132, s29
    v_accvgpr_write_b32 a68, v141
    v_perm_b32 v140, v135, v134, s28
    v_accvgpr_write_b32 a77, v140
    v_perm_b32 v141, v135, v134, s29
    v_accvgpr_write_b32 a69, v141
    s_waitcnt lgkmcnt(0)
    v_perm_b32 v140, v137, v136, s28
    v_accvgpr_write_b32 a78, v140
    v_perm_b32 v141, v137, v136, s29
    v_accvgpr_write_b32 a70, v141
    v_perm_b32 v140, v139, v138, s28
    v_accvgpr_write_b32 a79, v140
    v_perm_b32 v141, v139, v138, s29
    v_accvgpr_write_b32 a71, v141
    s_waitcnt vmcnt(20)
    s_barrier
    ds_read2st64_b32 v[124:125], v17 offset0:64 offset1:68
    ds_read2st64_b32 v[126:127], v17 offset0:72 offset1:76
    ds_read2st64_b32 v[128:129], v17 offset0:80 offset1:84
    ds_read2st64_b32 v[130:131], v17 offset0:88 offset1:92
    ds_read2st64_b32 v[132:133], v17 offset0:96 offset1:100
    ds_read2st64_b32 v[134:135], v17 offset0:104 offset1:108
    ds_read2st64_b32 v[136:137], v17 offset0:112 offset1:116
    ds_read2st64_b32 v[138:139], v17 offset0:120 offset1:124
    s_add_u32 m0, s31, 114688
    s_mov_b32 s30, 2146304
    buffer_load_dwordx4 v16, s[88:91], s30 offen lds
    s_add_u32 m0, s31, 115712
    s_mov_b32 s30, 2154496
    buffer_load_dwordx4 v16, s[88:91], s30 offen lds
    s_add_u32 m0, s31, 116736
    s_mov_b32 s30, 2408448
    buffer_load_dwordx4 v16, s[88:91], s30 offen lds
    s_add_u32 m0, s31, 117760
    s_mov_b32 s30, 2416640
    buffer_load_dwordx4 v16, s[88:91], s30 offen lds
    s_waitcnt lgkmcnt(6)
    v_perm_b32 v140, v125, v124, s28
    v_accvgpr_write_b32 a56, v140
    v_perm_b32 v141, v125, v124, s29
    v_accvgpr_write_b32 a48, v141
    v_perm_b32 v140, v127, v126, s28
    v_accvgpr_write_b32 a57, v140
    v_perm_b32 v141, v127, v126, s29
    v_accvgpr_write_b32 a49, v141
    s_waitcnt lgkmcnt(4)
    v_perm_b32 v140, v129, v128, s28
    v_accvgpr_write_b32 a58, v140
    v_perm_b32 v141, v129, v128, s29
    v_accvgpr_write_b32 a50, v141
    v_perm_b32 v140, v131, v130, s28
    v_accvgpr_write_b32 a59, v140
    v_perm_b32 v141, v131, v130, s29
    v_accvgpr_write_b32 a51, v141
    s_waitcnt lgkmcnt(2)
    v_perm_b32 v140, v133, v132, s28
    v_accvgpr_write_b32 a60, v140
    v_perm_b32 v141, v133, v132, s29
    v_accvgpr_write_b32 a52, v141
    v_perm_b32 v140, v135, v134, s28
    v_accvgpr_write_b32 a61, v140
    v_perm_b32 v141, v135, v134, s29
    v_accvgpr_write_b32 a53, v141
    s_waitcnt lgkmcnt(0)
    v_perm_b32 v140, v137, v136, s28
    v_accvgpr_write_b32 a62, v140
    v_perm_b32 v141, v137, v136, s29
    v_accvgpr_write_b32 a54, v141
    v_perm_b32 v140, v139, v138, s28
    v_accvgpr_write_b32 a63, v140
    v_perm_b32 v141, v139, v138, s29
    v_accvgpr_write_b32 a55, v141
    s_waitcnt vmcnt(20)
    s_barrier
    ds_read2st64_b32 v[124:125], v17 offset0:128 offset1:132
    ds_read2st64_b32 v[126:127], v17 offset0:136 offset1:140
    ds_read2st64_b32 v[128:129], v17 offset0:144 offset1:148
    ds_read2st64_b32 v[130:131], v17 offset0:152 offset1:156
    ds_read2st64_b32 v[132:133], v17 offset0:160 offset1:164
    ds_read2st64_b32 v[134:135], v17 offset0:168 offset1:172
    ds_read2st64_b32 v[136:137], v17 offset0:176 offset1:180
    ds_read2st64_b32 v[138:139], v17 offset0:184 offset1:188
    s_waitcnt lgkmcnt(6)
    v_perm_b32 v140, v125, v124, s28
    v_accvgpr_write_b32 a40, v140
    v_perm_b32 v141, v125, v124, s29
    v_accvgpr_write_b32 a32, v141
    v_perm_b32 v140, v127, v126, s28
    v_accvgpr_write_b32 a41, v140
    v_perm_b32 v141, v127, v126, s29
    v_accvgpr_write_b32 a33, v141
    s_waitcnt lgkmcnt(4)
    v_perm_b32 v140, v129, v128, s28
    v_accvgpr_write_b32 a42, v140
    v_perm_b32 v141, v129, v128, s29
    v_accvgpr_write_b32 a34, v141
    v_perm_b32 v140, v131, v130, s28
    v_accvgpr_write_b32 a43, v140
    v_perm_b32 v141, v131, v130, s29
    v_accvgpr_write_b32 a35, v141
    s_waitcnt lgkmcnt(2)
    v_perm_b32 v140, v133, v132, s28
    v_accvgpr_write_b32 a44, v140
    v_perm_b32 v141, v133, v132, s29
    v_accvgpr_write_b32 a36, v141
    v_perm_b32 v140, v135, v134, s28
    v_accvgpr_write_b32 a45, v140
    v_perm_b32 v141, v135, v134, s29
    v_accvgpr_write_b32 a37, v141
    s_waitcnt lgkmcnt(0)
    v_perm_b32 v140, v137, v136, s28
    v_accvgpr_write_b32 a46, v140
    v_perm_b32 v141, v137, v136, s29
    v_accvgpr_write_b32 a38, v141
    v_perm_b32 v140, v139, v138, s28
    v_accvgpr_write_b32 a47, v140
    v_perm_b32 v141, v139, v138, s29
    v_accvgpr_write_b32 a39, v141
    s_waitcnt vmcnt(16)
    s_barrier
    ds_read2st64_b32 v[124:125], v17 offset0:192 offset1:196
    ds_read2st64_b32 v[126:127], v17 offset0:200 offset1:204
    ds_read2st64_b32 v[128:129], v17 offset0:208 offset1:212
    ds_read2st64_b32 v[130:131], v17 offset0:216 offset1:220
    ds_read2st64_b32 v[132:133], v17 offset0:224 offset1:228
    ds_read2st64_b32 v[134:135], v17 offset0:232 offset1:236
    ds_read2st64_b32 v[136:137], v17 offset0:240 offset1:244
    ds_read2st64_b32 v[138:139], v17 offset0:248 offset1:252
    s_waitcnt lgkmcnt(6)
    v_perm_b32 v140, v125, v124, s28
    v_accvgpr_write_b32 a24, v140
    v_perm_b32 v141, v125, v124, s29
    v_accvgpr_write_b32 a16, v141
    v_perm_b32 v140, v127, v126, s28
    v_accvgpr_write_b32 a25, v140
    v_perm_b32 v141, v127, v126, s29
    v_accvgpr_write_b32 a17, v141
    s_waitcnt lgkmcnt(4)
    v_perm_b32 v140, v129, v128, s28
    v_accvgpr_write_b32 a26, v140
    v_perm_b32 v141, v129, v128, s29
    v_accvgpr_write_b32 a18, v141
    v_perm_b32 v140, v131, v130, s28
    v_accvgpr_write_b32 a27, v140
    v_perm_b32 v141, v131, v130, s29
    v_accvgpr_write_b32 a19, v141
    s_waitcnt lgkmcnt(2)
    v_perm_b32 v140, v133, v132, s28
    v_accvgpr_write_b32 a28, v140
    v_perm_b32 v141, v133, v132, s29
    v_accvgpr_write_b32 a20, v141
    v_perm_b32 v140, v135, v134, s28
    v_accvgpr_write_b32 a29, v140
    v_perm_b32 v141, v135, v134, s29
    v_accvgpr_write_b32 a21, v141
    s_waitcnt lgkmcnt(0)
    v_perm_b32 v140, v137, v136, s28
    v_accvgpr_write_b32 a30, v140
    v_perm_b32 v141, v137, v136, s29
    v_accvgpr_write_b32 a22, v141
    v_perm_b32 v140, v139, v138, s28
    v_accvgpr_write_b32 a31, v140
    v_perm_b32 v141, v139, v138, s29
    v_accvgpr_write_b32 a23, v141
    s_waitcnt vmcnt(12)
    s_barrier
    ds_read2st64_b32 v[124:125], v18 offset0:0 offset1:4
    ds_read2st64_b32 v[126:127], v18 offset0:8 offset1:12
    ds_read2st64_b32 v[128:129], v18 offset0:16 offset1:20
    ds_read2st64_b32 v[130:131], v18 offset0:24 offset1:28
    ds_read2st64_b32 v[132:133], v18 offset0:32 offset1:36
    ds_read2st64_b32 v[134:135], v18 offset0:40 offset1:44
    ds_read2st64_b32 v[136:137], v18 offset0:48 offset1:52
    ds_read2st64_b32 v[138:139], v18 offset0:56 offset1:60
    s_waitcnt lgkmcnt(6)
    v_perm_b32 v140, v125, v124, s28
    v_accvgpr_write_b32 a8, v140
    v_perm_b32 v141, v125, v124, s29
    v_accvgpr_write_b32 a0, v141
    v_perm_b32 v140, v127, v126, s28
    v_accvgpr_write_b32 a9, v140
    v_perm_b32 v141, v127, v126, s29
    v_accvgpr_write_b32 a1, v141
    s_waitcnt lgkmcnt(4)
    v_perm_b32 v140, v129, v128, s28
    v_accvgpr_write_b32 a10, v140
    v_perm_b32 v141, v129, v128, s29
    v_accvgpr_write_b32 a2, v141
    v_perm_b32 v140, v131, v130, s28
    v_accvgpr_write_b32 a11, v140
    v_perm_b32 v141, v131, v130, s29
    v_accvgpr_write_b32 a3, v141
    s_waitcnt lgkmcnt(2)
    v_perm_b32 v140, v133, v132, s28
    v_accvgpr_write_b32 a12, v140
    v_perm_b32 v141, v133, v132, s29
    v_accvgpr_write_b32 a4, v141
    v_perm_b32 v140, v135, v134, s28
    v_accvgpr_write_b32 a13, v140
    v_perm_b32 v141, v135, v134, s29
    v_accvgpr_write_b32 a5, v141
    s_waitcnt lgkmcnt(0)
    v_perm_b32 v140, v137, v136, s28
    v_accvgpr_write_b32 a14, v140
    v_perm_b32 v141, v137, v136, s29
    v_accvgpr_write_b32 a6, v141
    v_perm_b32 v140, v139, v138, s28
    v_accvgpr_write_b32 a15, v140
    v_perm_b32 v141, v139, v138, s29
    v_accvgpr_write_b32 a7, v141
    s_waitcnt vmcnt(8)
    s_barrier
    ds_read2st64_b32 v[124:125], v18 offset0:64 offset1:68
    ds_read2st64_b32 v[126:127], v18 offset0:72 offset1:76
    ds_read2st64_b32 v[128:129], v18 offset0:80 offset1:84
    ds_read2st64_b32 v[130:131], v18 offset0:88 offset1:92
    ds_read2st64_b32 v[132:133], v18 offset0:96 offset1:100
    ds_read2st64_b32 v[134:135], v18 offset0:104 offset1:108
    ds_read2st64_b32 v[136:137], v18 offset0:112 offset1:116
    ds_read2st64_b32 v[138:139], v18 offset0:120 offset1:124
    s_waitcnt lgkmcnt(6)
    v_perm_b32 v248, v125, v124, s28
    v_perm_b32 v240, v125, v124, s29
    v_perm_b32 v249, v127, v126, s28
    v_perm_b32 v241, v127, v126, s29
    s_waitcnt lgkmcnt(4)
    v_perm_b32 v250, v129, v128, s28
    v_perm_b32 v242, v129, v128, s29
    v_perm_b32 v251, v131, v130, s28
    v_perm_b32 v243, v131, v130, s29
    s_waitcnt lgkmcnt(2)
    v_perm_b32 v252, v133, v132, s28
    v_perm_b32 v244, v133, v132, s29
    v_perm_b32 v253, v135, v134, s28
    v_perm_b32 v245, v135, v134, s29
    s_waitcnt lgkmcnt(0)
    v_perm_b32 v254, v137, v136, s28
    v_perm_b32 v246, v137, v136, s29
    v_perm_b32 v255, v139, v138, s28
    v_perm_b32 v247, v139, v138, s29
    s_waitcnt vmcnt(4)
    s_barrier
    ds_read2st64_b32 v[124:125], v18 offset0:128 offset1:132
    ds_read2st64_b32 v[126:127], v18 offset0:136 offset1:140
    ds_read2st64_b32 v[128:129], v18 offset0:144 offset1:148
    ds_read2st64_b32 v[130:131], v18 offset0:152 offset1:156
    ds_read2st64_b32 v[132:133], v18 offset0:160 offset1:164
    ds_read2st64_b32 v[134:135], v18 offset0:168 offset1:172
    ds_read2st64_b32 v[136:137], v18 offset0:176 offset1:180
    ds_read2st64_b32 v[138:139], v18 offset0:184 offset1:188
    s_waitcnt lgkmcnt(6)
    v_perm_b32 v232, v125, v124, s28
    v_perm_b32 v224, v125, v124, s29
    v_perm_b32 v233, v127, v126, s28
    v_perm_b32 v225, v127, v126, s29
    s_waitcnt lgkmcnt(4)
    v_perm_b32 v234, v129, v128, s28
    v_perm_b32 v226, v129, v128, s29
    v_perm_b32 v235, v131, v130, s28
    v_perm_b32 v227, v131, v130, s29
    s_waitcnt lgkmcnt(2)
    v_perm_b32 v236, v133, v132, s28
    v_perm_b32 v228, v133, v132, s29
    v_perm_b32 v237, v135, v134, s28
    v_perm_b32 v229, v135, v134, s29
    s_waitcnt lgkmcnt(0)
    v_perm_b32 v238, v137, v136, s28
    v_perm_b32 v230, v137, v136, s29
    v_perm_b32 v239, v139, v138, s28
    v_perm_b32 v231, v139, v138, s29
    s_waitcnt vmcnt(0)
    s_barrier
    ds_read2st64_b32 v[124:125], v18 offset0:192 offset1:196
    ds_read2st64_b32 v[126:127], v18 offset0:200 offset1:204
    ds_read2st64_b32 v[128:129], v18 offset0:208 offset1:212
    ds_read2st64_b32 v[130:131], v18 offset0:216 offset1:220
    ds_read2st64_b32 v[132:133], v18 offset0:224 offset1:228
    ds_read2st64_b32 v[134:135], v18 offset0:232 offset1:236
    ds_read2st64_b32 v[136:137], v18 offset0:240 offset1:244
    ds_read2st64_b32 v[138:139], v18 offset0:248 offset1:252
    s_waitcnt lgkmcnt(6)
    v_perm_b32 v216, v125, v124, s28
    v_perm_b32 v208, v125, v124, s29
    v_perm_b32 v217, v127, v126, s28
    v_perm_b32 v209, v127, v126, s29
    s_waitcnt lgkmcnt(4)
    v_perm_b32 v218, v129, v128, s28
    v_perm_b32 v210, v129, v128, s29
    v_perm_b32 v219, v131, v130, s28
    v_perm_b32 v211, v131, v130, s29
    s_waitcnt lgkmcnt(2)
    v_perm_b32 v220, v133, v132, s28
    v_perm_b32 v212, v133, v132, s29
    v_perm_b32 v221, v135, v134, s28
    v_perm_b32 v213, v135, v134, s29
    s_waitcnt lgkmcnt(0)
    v_perm_b32 v222, v137, v136, s28
    v_perm_b32 v214, v137, v136, s29
    v_perm_b32 v223, v139, v138, s28
    v_perm_b32 v215, v139, v138, s29
    s_barrier
    ds_write_b128 v3, v[40:43] offset:0
    ds_write_b128 v3, v[44:47] offset:1024
    ds_write_b128 v3, v[48:51] offset:2048
    ds_write_b128 v3, v[52:55] offset:3072
    ds_write_b128 v3, v[56:59] offset:4096
    ds_write_b128 v3, v[60:63] offset:5120
    ds_write_b128 v3, v[64:67] offset:6144
    ds_write_b128 v3, v[68:71] offset:7168
    ds_write_b128 v3, v[72:75] offset:8192
    ds_write_b128 v3, v[76:79] offset:9216
    ds_write_b128 v3, v[80:83] offset:10240
    ds_write_b128 v3, v[84:87] offset:11264
    ds_write_b128 v3, v[88:91] offset:12288
    ds_write_b128 v3, v[92:95] offset:13312
    ds_write_b128 v3, v[96:99] offset:14336
    ds_write_b128 v3, v[100:103] offset:15360
    ds_write_b128 v3, v[104:107] offset:16384
    ds_write_b128 v3, v[108:111] offset:17408
    ds_write_b128 v3, v[112:115] offset:18432
    ds_write_b128 v3, v[116:119] offset:19456
    s_waitcnt lgkmcnt(0)
    v_lshlrev_b32 v16, 12, v120
    v_lshl_add_u32 v16, v121, 4, v16
    s_lshl_b32 s30, s32, 17
    s_lshl_b32 s31, s24, 8
    s_add_u32 s30, s30, s31
    v_add_u32 v16, s30, v16
    v_mov_b32 v20, 0
    global_load_dword v21, v20, s[6:7] offset:64 sc1
    global_load_dword v22, v20, s[6:7] sc1
    s_add_u32 s30, s24, 0
    s_and_b32 s30, s30, 3
    s_lshl_b32 s30, s30, 15
    s_add_u32 s30, s30, 0
    buffer_load_dwordx4 v[24:27], v16, s[16:19], s30 offen
    buffer_load_dwordx4 v[28:31], v16, s[16:19], s30 offen offset:1024
    s_add_u32 s30, s24, 0
    s_and_b32 s30, s30, 3
    s_lshl_b32 s30, s30, 15
    s_add_u32 s30, s30, 2048
    buffer_load_dwordx4 v[32:35], v16, s[16:19], s30 offen
    buffer_load_dwordx4 v[36:39], v16, s[16:19], s30 offen offset:1024
    s_add_u32 s30, s24, 0
    s_and_b32 s30, s30, 3
    s_lshl_b32 s30, s30, 15
    s_add_u32 s30, s30, 16384
    buffer_load_dwordx4 v[40:43], v16, s[16:19], s30 offen
    buffer_load_dwordx4 v[44:47], v16, s[16:19], s30 offen offset:1024
    s_add_u32 s30, s24, 0
    s_and_b32 s30, s30, 3
    s_lshl_b32 s30, s30, 15
    s_add_u32 s30, s30, 18432
    buffer_load_dwordx4 v[48:51], v16, s[16:19], s30 offen
    buffer_load_dwordx4 v[52:55], v16, s[16:19], s30 offen offset:1024
    s_add_u32 s30, s24, 1
    s_and_b32 s30, s30, 3
    s_lshl_b32 s30, s30, 15
    s_add_u32 s30, s30, 0
    buffer_load_dwordx4 v[56:59], v16, s[16:19], s30 offen
    buffer_load_dwordx4 v[60:63], v16, s[16:19], s30 offen offset:1024
    s_add_u32 s30, s24, 1
    s_and_b32 s30, s30, 3
    s_lshl_b32 s30, s30, 15
    s_add_u32 s30, s30, 2048
    buffer_load_dwordx4 v[64:67], v16, s[16:19], s30 offen
    buffer_load_dwordx4 v[68:71], v16, s[16:19], s30 offen offset:1024
    s_add_u32 s30, s24, 1
    s_and_b32 s30, s30, 3
    s_lshl_b32 s30, s30, 15
    s_add_u32 s30, s30, 16384
    buffer_load_dwordx4 v[72:75], v16, s[16:19], s30 offen
    buffer_load_dwordx4 v[76:79], v16, s[16:19], s30 offen offset:1024
    s_add_u32 s30, s24, 1
    s_and_b32 s30, s30, 3
    s_lshl_b32 s30, s30, 15
    s_add_u32 s30, s30, 18432
    buffer_load_dwordx4 v[80:83], v16, s[16:19], s30 offen
    buffer_load_dwordx4 v[84:87], v16, s[16:19], s30 offen offset:1024
    v_bfe_u32 v124, v0, 1, 1
    v_mov_b32 v1, 0x44444444
    v_mov_b32 v125, 0xeeeeeeee
    v_cmp_eq_u32 vcc, 1, v124
    v_bfe_u32 v126, v0, 2, 1
    v_bfe_u32 v127, v0, 3, 1
    v_cndmask_b32 v1, v1, v125, vcc
    v_and_b32 v128, 1, v0
    v_and_b32 v129, 3, v0
    v_bfe_u32 v130, v0, 2, 2
    v_lshl_add_u32 v131, v127, 1, v124
    v_mul_u32_u24 v4, 144, v131
    v_lshl_add_u32 v4, v120, 5, v4
    v_lshl_add_u32 v4, v128, 3, v4
    v_lshl_add_u32 v4, v126, 2, v4
    s_mul_i32 s30, s24, 576
    s_add_u32 s30, s30, 12288
    v_add_u32 v4, s30, v4
    v_lshl_add_u32 v132, v130, 1, v128
    v_mul_u32_u24 v6, 144, v120
    v_lshl_add_u32 v6, v132, 4, v6
    v_lshlrev_b32 v5, 8, v127
    v_lshl_add_u32 v5, v120, 6, v5
    v_lshl_add_u32 v5, v126, 5, v5
    v_lshl_add_u32 v5, v129, 2, v5
    s_lshl_b32 s30, s24, 9
    s_add_u32 s30, s30, 8192
    v_add_u32 v5, s30, v5
    v_lshrrev_b32 v131, 3, v0
    v_and_b32 v133, 7, v0
    v_lshlrev_b32 v7, 13, v131
    v_lshl_add_u32 v7, v133, 3, v7
    s_lshl_b32 s30, s24, 16
    s_lshl_b32 s31, s32, 6
    s_add_u32 s30, s30, s31
    s_add_u32 s30, s30, 262144
    v_add_u32 v7, s30, v7
    v_lshlrev_b32 v8, 5, v124
    v_lshl_add_u32 v8, v123, 4, v8
    v_lshl_add_u32 v8, v128, 3, v8
    v_lshl_add_u32 v8, v122, 2, v8
    s_lshr_b32 s30, s32, 3
    s_lshl_b32 s30, s30, 9
    s_and_b32 s31, s32, 1
    s_lshl_b32 s31, s31, 8
    s_add_u32 s30, s30, s31
    s_bfe_u32 s31, s32, 0x20001
    s_lshl_b32 s31, s31, 6
    s_add_u32 s30, s30, s31
    v_add_u32 v8, s30, v8
    v_lshlrev_b32 v9, 9, v120
    v_lshl_add_u32 v9, v124, 6, v9
    v_lshl_add_u32 v9, v130, 7, v9
    v_lshl_add_u32 v9, v128, 4, v9
    s_lshr_b32 s30, s24, 1
    s_lshl_b32 s30, s30, 12
    s_and_b32 s31, s24, 1
    s_lshl_b32 s31, s31, 5
    s_add_u32 s30, s30, s31
    s_add_u32 s30, s30, 8192
    v_add_u32 v9, s30, v9
    v_lshlrev_b32 v10, 3, v0
    v_lshlrev_b32 v11, 2, v133
    v_and_b32 v12, 31, v0
    v_lshlrev_b32 v12, 2, v12
    v_mov_b32 v15, -1
    v_mov_b32 v134, 0x3f80
    v_lshlrev_b32 v135, 4, v129
    v_lshlrev_b32 v134, v135, v134
    v_cmp_gt_u32 vcc, 2, v129
    v_mov_b32 v135, 0
    s_nop 0
    v_cndmask_b32 v134, v135, v134, vcc
    v_cmp_eq_u32 vcc, 0, v130
    s_nop 1
    v_cndmask_b32 v136, v135, v134, vcc
    v_cmp_eq_u32 vcc, 1, v130
    s_nop 1
    v_cndmask_b32 v137, v135, v134, vcc
    v_cmp_eq_u32 vcc, 2, v130
    s_nop 1
    v_cndmask_b32 v138, v135, v134, vcc
    v_cmp_eq_u32 vcc, 3, v130
    s_nop 1
    v_cndmask_b32 v139, v135, v134, vcc
    ds_write_b128 v2, v[136:139] offset:11264
    s_mov_b32 s52, 0x000f000f
    s_mov_b32 s53, 0x000f000f
    s_mov_b32 s45, 0x3e0293ee
    s_mov_b32 s50, 4096
    s_mov_b32 s54, 0x17800000
    s_mov_b32 s55, 0x50000000
    s_lshl_b32 s30, s24, 11
    s_lshl_b32 s39, s32, 13
    s_add_u32 s39, s39, s30
    s_add_u32 s39, s39, 262144
    s_add_u32 s40, s30, 131072
    s_lshl_b32 s46, s32, 7
    s_add_u32 s47, s46, 4096
    s_add_u32 s46, s46, 0
    s_lshl_b32 s48, s32, 2
    s_add_u32 s48, s48, 9216
    s_mov_b32 s49, 9216
    s_mov_b32 s35, 0
    s_mov_b32 s33, 0
    s_mov_b32 s44, 0
    s_load_dwordx2 s[4:5], s[0:1], 8
    s_waitcnt lgkmcnt(0)
    s_mov_b32 s12, s4
    s_mov_b32 s13, s5
    s_mov_b32 s14, 8192
    s_mov_b32 s15, 0x20000
    s_lshl_b32 s30, s24, 7
    s_add_u32 s30, s30, 128
    s_add_u32 s4, s30, s49
    s_add_u32 s5, s30, s48
    s_waitcnt vmcnt(16)
    v_cmp_gt_u32 vcc, 0x100, v21
    s_cbranch_vccz L_ch_inited
     v_mov_b32 v20, 0
     s_mov_b32 s27, 0
L_wi_8:
     global_load_dword v21, v20, s[6:7] offset:64 sc1
     s_waitcnt vmcnt(0)
     v_cmp_gt_u32 vcc, 0x100, v21
     s_cbranch_vccz L_wiok_9
     s_sleep 2
     s_add_u32 s27, s27, 1
     s_cmp_lt_u32 s27, 200000
     s_cbranch_scc1 L_wi_8
     s_branch L_ch_fail
L_wiok_9:
     global_load_dword v22, v20, s[6:7] sc1
     s_waitcnt vmcnt(0)
L_ch_inited:
    buffer_load_dwordx4 v[140:143], v2, s[8:11], s39 offen offset:0 sc1
    buffer_load_dwordx4 v[140:143], v2, s[8:11], s39 offen offset:1024 sc1
    s_add_u32 s30, s40, 0
    buffer_load_dwordx4 v[140:143], v2, s[8:11], s30 offen sc1
    buffer_load_dwordx4 v[140:143], v2, s[8:11], s30 offen offset:1024 sc1
    s_add_u32 s30, s40, 8192
    buffer_load_dwordx4 v[140:143], v2, s[8:11], s30 offen sc1
    buffer_load_dwordx4 v[140:143], v2, s[8:11], s30 offen offset:1024 sc1
    s_add_u32 s30, s40, 16384
    buffer_load_dwordx4 v[140:143], v2, s[8:11], s30 offen sc1
    buffer_load_dwordx4 v[140:143], v2, s[8:11], s30 offen offset:1024 sc1
    s_add_u32 s30, s40, 24576
    buffer_load_dwordx4 v[140:143], v2, s[8:11], s30 offen sc1
    buffer_load_dwordx4 v[140:143], v2, s[8:11], s30 offen offset:1024 sc1
    buffer_load_dword v140, v11, s[8:11], s4 offen sc1
    v_lshlrev_b32 v23, 7, v0
    buffer_load_dword v140, v23, s[12:15], 0 offen
    s_waitcnt vmcnt(26)
    s_waitcnt lgkmcnt(0)
    v_perm_b32 v200, v28, v24, s28
    v_perm_b32 v201, v28, v24, s29
    v_perm_b32 v168, v29, v25, s28
    v_perm_b32 v169, v29, v25, s29
    v_perm_b32 v152, v30, v26, s28
    v_perm_b32 v153, v30, v26, s29
    v_perm_b32 v144, v31, v27, s28
    v_perm_b32 v145, v31, v27, s29
    s_add_u32 s30, s24, 2
    s_and_b32 s30, s30, 3
    s_lshl_b32 s30, s30, 15
    s_add_u32 s30, s30, 0
    buffer_load_dwordx4 v[24:27], v16, s[16:19], s30 offen
    buffer_load_dwordx4 v[28:31], v16, s[16:19], s30 offen offset:1024
    s_waitcnt vmcnt(26)
    v_perm_b32 v202, v36, v32, s28
    v_perm_b32 v203, v36, v32, s29
    v_perm_b32 v170, v37, v33, s28
    v_perm_b32 v171, v37, v33, s29
    v_perm_b32 v154, v38, v34, s28
    v_perm_b32 v155, v38, v34, s29
    v_perm_b32 v146, v39, v35, s28
    v_perm_b32 v147, v39, v35, s29
    s_add_u32 s30, s24, 2
    s_and_b32 s30, s30, 3
    s_lshl_b32 s30, s30, 15
    s_add_u32 s30, s30, 2048
    buffer_load_dwordx4 v[32:35], v16, s[16:19], s30 offen
    buffer_load_dwordx4 v[36:39], v16, s[16:19], s30 offen offset:1024
    s_waitcnt vmcnt(26)
    v_perm_b32 v204, v44, v40, s28
    v_perm_b32 v205, v44, v40, s29
    v_perm_b32 v172, v45, v41, s28
    v_perm_b32 v173, v45, v41, s29
    v_perm_b32 v156, v46, v42, s28
    v_perm_b32 v157, v46, v42, s29
    v_perm_b32 v148, v47, v43, s28
    v_perm_b32 v149, v47, v43, s29
    s_add_u32 s30, s24, 2
    s_and_b32 s30, s30, 3
    s_lshl_b32 s30, s30, 15
    s_add_u32 s30, s30, 16384
    buffer_load_dwordx4 v[40:43], v16, s[16:19], s30 offen
    buffer_load_dwordx4 v[44:47], v16, s[16:19], s30 offen offset:1024
    s_waitcnt vmcnt(26)
    v_perm_b32 v206, v52, v48, s28
    v_perm_b32 v207, v52, v48, s29
    v_perm_b32 v174, v53, v49, s28
    v_perm_b32 v175, v53, v49, s29
    v_perm_b32 v158, v54, v50, s28
    v_perm_b32 v159, v54, v50, s29
    v_perm_b32 v150, v55, v51, s28
    v_perm_b32 v151, v55, v51, s29
    s_add_u32 s30, s24, 2
    s_and_b32 s30, s30, 3
    s_lshl_b32 s30, s30, 15
    s_add_u32 s30, s30, 18432
    buffer_load_dwordx4 v[48:51], v16, s[16:19], s30 offen
    buffer_load_dwordx4 v[52:55], v16, s[16:19], s30 offen offset:1024
    s_waitcnt vmcnt(26)
    s_waitcnt lgkmcnt(0)
    v_perm_b32 v192, v60, v56, s28
    v_perm_b32 v193, v60, v56, s29
    v_perm_b32 v160, v61, v57, s28
    v_perm_b32 v161, v61, v57, s29
    v_perm_b32 v104, v62, v58, s28
    v_perm_b32 v105, v62, v58, s29
    v_perm_b32 v112, v63, v59, s28
    v_perm_b32 v113, v63, v59, s29
    s_add_u32 s30, s24, 3
    s_and_b32 s30, s30, 3
    s_lshl_b32 s30, s30, 15
    s_add_u32 s30, s30, 0
    buffer_load_dwordx4 v[56:59], v16, s[16:19], s30 offen
    buffer_load_dwordx4 v[60:63], v16, s[16:19], s30 offen offset:1024
    s_waitcnt vmcnt(26)
    v_perm_b32 v194, v68, v64, s28
    v_perm_b32 v195, v68, v64, s29
    v_perm_b32 v162, v69, v65, s28
    v_perm_b32 v163, v69, v65, s29
    v_perm_b32 v106, v70, v66, s28
    v_perm_b32 v107, v70, v66, s29
    v_perm_b32 v114, v71, v67, s28
    v_perm_b32 v115, v71, v67, s29
    s_add_u32 s30, s24, 3
    s_and_b32 s30, s30, 3
    s_lshl_b32 s30, s30, 15
    s_add_u32 s30, s30, 2048
    buffer_load_dwordx4 v[64:67], v16, s[16:19], s30 offen
    buffer_load_dwordx4 v[68:71], v16, s[16:19], s30 offen offset:1024
    s_waitcnt vmcnt(26)
    v_perm_b32 v196, v76, v72, s28
    v_perm_b32 v197, v76, v72, s29
    v_perm_b32 v164, v77, v73, s28
    v_perm_b32 v165, v77, v73, s29
    v_perm_b32 v108, v78, v74, s28
    v_perm_b32 v109, v78, v74, s29
    v_perm_b32 v116, v79, v75, s28
    v_perm_b32 v117, v79, v75, s29
    s_add_u32 s30, s24, 3
    s_and_b32 s30, s30, 3
    s_lshl_b32 s30, s30, 15
    s_add_u32 s30, s30, 16384
    buffer_load_dwordx4 v[72:75], v16, s[16:19], s30 offen
    buffer_load_dwordx4 v[76:79], v16, s[16:19], s30 offen offset:1024
    s_waitcnt vmcnt(26)
    v_perm_b32 v198, v84, v80, s28
    v_perm_b32 v199, v84, v80, s29
    v_perm_b32 v166, v85, v81, s28
    v_perm_b32 v167, v85, v81, s29
    v_perm_b32 v110, v86, v82, s28
    v_perm_b32 v111, v86, v82, s29
    v_perm_b32 v118, v87, v83, s28
    v_perm_b32 v119, v87, v83, s29
    s_add_u32 s30, s24, 3
    s_and_b32 s30, s30, 3
    s_lshl_b32 s30, s30, 15
    s_add_u32 s30, s30, 18432
    buffer_load_dwordx4 v[80:83], v16, s[16:19], s30 offen
    buffer_load_dwordx4 v[84:87], v16, s[16:19], s30 offen offset:1024
    ds_write_b128 v3, v[104:107] offset:24576
    ds_write_b128 v3, v[108:111] offset:25600
    ds_write_b128 v3, v[112:115] offset:30720
    ds_write_b128 v3, v[116:119] offset:31744
    s_waitcnt vmcnt(14)
    s_waitcnt lgkmcnt(0)
    v_perm_b32 v184, v28, v24, s28
    v_perm_b32 v185, v28, v24, s29
    v_perm_b32 v96, v29, v25, s28
    v_perm_b32 v97, v29, v25, s29
    v_perm_b32 v104, v30, v26, s28
    v_perm_b32 v105, v30, v26, s29
    v_perm_b32 v112, v31, v27, s28
    v_perm_b32 v113, v31, v27, s29
    s_waitcnt vmcnt(12)
    v_perm_b32 v186, v36, v32, s28
    v_perm_b32 v187, v36, v32, s29
    v_perm_b32 v98, v37, v33, s28
    v_perm_b32 v99, v37, v33, s29
    v_perm_b32 v106, v38, v34, s28
    v_perm_b32 v107, v38, v34, s29
    v_perm_b32 v114, v39, v35, s28
    v_perm_b32 v115, v39, v35, s29
    s_waitcnt vmcnt(10)
    v_perm_b32 v188, v44, v40, s28
    v_perm_b32 v189, v44, v40, s29
    v_perm_b32 v100, v45, v41, s28
    v_perm_b32 v101, v45, v41, s29
    v_perm_b32 v108, v46, v42, s28
    v_perm_b32 v109, v46, v42, s29
    v_perm_b32 v116, v47, v43, s28
    v_perm_b32 v117, v47, v43, s29
    s_waitcnt vmcnt(8)
    v_perm_b32 v190, v52, v48, s28
    v_perm_b32 v191, v52, v48, s29
    v_perm_b32 v102, v53, v49, s28
    v_perm_b32 v103, v53, v49, s29
    v_perm_b32 v110, v54, v50, s28
    v_perm_b32 v111, v54, v50, s29
    v_perm_b32 v118, v55, v51, s28
    v_perm_b32 v119, v55, v51, s29
    ds_write_b128 v3, v[96:99] offset:20480
    ds_write_b128 v3, v[100:103] offset:21504
    ds_write_b128 v3, v[104:107] offset:26624
    ds_write_b128 v3, v[108:111] offset:27648
    ds_write_b128 v3, v[112:115] offset:32768
    ds_write_b128 v3, v[116:119] offset:33792
    s_waitcnt vmcnt(6)
    s_waitcnt lgkmcnt(0)
    v_perm_b32 v176, v60, v56, s28
    v_perm_b32 v177, v60, v56, s29
    v_perm_b32 v96, v61, v57, s28
    v_perm_b32 v97, v61, v57, s29
    v_perm_b32 v104, v62, v58, s28
    v_perm_b32 v105, v62, v58, s29
    v_perm_b32 v112, v63, v59, s28
    v_perm_b32 v113, v63, v59, s29
    s_waitcnt vmcnt(4)
    v_perm_b32 v178, v68, v64, s28
    v_perm_b32 v179, v68, v64, s29
    v_perm_b32 v98, v69, v65, s28
    v_perm_b32 v99, v69, v65, s29
    v_perm_b32 v106, v70, v66, s28
    v_perm_b32 v107, v70, v66, s29
    v_perm_b32 v114, v71, v67, s28
    v_perm_b32 v115, v71, v67, s29
    s_waitcnt vmcnt(2)
    v_perm_b32 v180, v76, v72, s28
    v_perm_b32 v181, v76, v72, s29
    v_perm_b32 v100, v77, v73, s28
    v_perm_b32 v101, v77, v73, s29
    v_perm_b32 v108, v78, v74, s28
    v_perm_b32 v109, v78, v74, s29
    v_perm_b32 v116, v79, v75, s28
    v_perm_b32 v117, v79, v75, s29
    s_waitcnt vmcnt(0)
    v_perm_b32 v182, v84, v80, s28
    v_perm_b32 v183, v84, v80, s29
    v_perm_b32 v102, v85, v81, s28
    v_perm_b32 v103, v85, v81, s29
    v_perm_b32 v110, v86, v82, s28
    v_perm_b32 v111, v86, v82, s29
    v_perm_b32 v118, v87, v83, s28
    v_perm_b32 v119, v87, v83, s29
    ds_write_b128 v3, v[96:99] offset:22528
    ds_write_b128 v3, v[100:103] offset:23552
    ds_write_b128 v3, v[104:107] offset:28672
    ds_write_b128 v3, v[108:111] offset:29696
    ds_write_b128 v3, v[112:115] offset:34816
    ds_write_b128 v3, v[116:119] offset:35840
    v_readfirstlane_b32 s30, v22
    v_mov_b32 v16, 0x3f803f80
    v_mov_b32 v20, 0
    v_mov_b32 v17, 0x3f803f80
    v_mov_b32 v21, 0
    v_mov_b32 v18, 0x3f803f80
    v_mov_b32 v22, 0
    v_mov_b32 v19, 0x3f803f80
    v_mov_b32 v23, 0
    s_waitcnt lgkmcnt(0)
    s_cmp_ge_u32 s30, 32
    s_cbranch_scc1 L_ch_initF
    s_branch L_ch_initS
L_ch_initF:
    s_cmp_eq_u32 s24, 0
    s_cbranch_scc1 L_ch_layerF0
    s_cmp_eq_u32 s24, 1
    s_cbranch_scc1 L_ch_layerF1
    s_cmp_eq_u32 s24, 2
    s_cbranch_scc1 L_ch_layerF2
    s_branch L_ch_layerF3
L_ch_layerF0:
    s_mov_b32 s30, 0
    s_mul_i32 s41, s32, 24576
    s_add_u32 s41, s41, s30
    s_add_u32 s41, s41, 1048576
    s_lshl_b32 s56, s32, 12
    s_add_u32 s56, s56, 61341696
    s_mul_i32 s42, s32, 4096
    s_add_u32 s42, s42, s30
    s_add_u32 s42, s42, 52428800
    s_lshl_b32 s43, s33, 7
    s_add_u32 s43, s43, 1
    s_mov_b32 s34, 0
    s_mov_b32 m0, 0
    v_bfe_u32 v48, v2, 6, 2
    v_bfe_u32 v49, v2, 4, 1
    v_lshl_add_u32 v48, v48, 1, v49
    v_lshlrev_b32 v48, 10, v48
    v_lshrrev_b32 v49, 8, v2
    v_lshl_add_u32 v48, v49, 7, v48
    v_bfe_u32 v49, v2, 5, 1
    v_lshl_add_u32 v48, v49, 6, v48
    v_add_u32 v48, 0, v48
    buffer_load_dword v40, v48, s[12:15], 0 offen offset:0
    buffer_load_dword v41, v48, s[12:15], 0 offen offset:16
    buffer_load_dword v42, v48, s[12:15], 0 offen offset:32
    buffer_load_dword v43, v48, s[12:15], 0 offen offset:48
    buffer_load_dword v44, v48, s[12:15], 0 offen offset:512
    buffer_load_dword v45, v48, s[12:15], 0 offen offset:528
    buffer_load_dword v46, v48, s[12:15], 0 offen offset:544
    buffer_load_dword v47, v48, s[12:15], 0 offen offset:560
    v_mov_b64 v[72:73], 0
    v_mov_b64 v[74:75], 0
    v_mov_b64 v[76:77], 0
    v_mov_b64 v[78:79], 0
    v_mov_b64 v[80:81], 0
    v_mov_b64 v[82:83], 0
    v_mov_b64 v[84:85], 0
    v_mov_b64 v[86:87], 0
    v_mov_b64 v[88:89], 0
    v_mov_b64 v[90:91], 0
    v_mov_b64 v[92:93], 0
    v_mov_b64 v[94:95], 0
    v_mov_b64 v[96:97], 0
    v_mov_b64 v[98:99], 0
    v_mov_b64 v[100:101], 0
    v_mov_b64 v[102:103], 0
    ds_read_b128 v[104:107], v3 offset:0
    ds_read_b128 v[108:111], v3 offset:1024
    ds_read_b128 v[112:115], v3 offset:2048
    ds_read_b128 v[116:119], v3 offset:3072
    ds_read_b128 v[120:123], v3 offset:4096
    ds_read_b128 v[124:127], v3 offset:5120
    ds_read_b128 v[128:131], v3 offset:6144
    ds_read_b128 v[132:135], v3 offset:7168
    ds_read_b128 v[136:139], v3 offset:8192
    ds_read_b128 v[140:143], v3 offset:9216
    s_waitcnt vmcnt(0)
    v_min_u32 v40, -2, v40
    v_min_u32 v41, -2, v41
    v_min_u32 v42, -2, v42
    v_min_u32 v43, -2, v43
    v_min_u32 v44, -2, v44
    v_min_u32 v45, -2, v45
    v_min_u32 v46, -2, v46
    v_min_u32 v47, -2, v47
    ds_write_b128 v2, v[40:43] offset:0
    ds_write_b128 v2, v[44:47] offset:1024
    s_mov_b32 s27, 0
L_poll_10:
    buffer_load_dword v14, v11, s[8:11], s46 offen sc1
    s_waitcnt vmcnt(0)
    v_cmp_gt_u32 vcc, s43, v14
    s_cbranch_vccz L_pollok_11
    s_sleep 1
    s_add_u32 s27, s27, 1
    s_cmp_lt_u32 s27, 200000
    s_cbranch_scc1 L_poll_10
    s_branch L_ch_fail
L_pollok_11:
    buffer_load_dwordx4 v[24:27], v9, s[8:11], s41 offen sc1
    buffer_load_dwordx4 v[28:31], v9, s[8:11], s41 offen offset:2048 sc1
    s_add_u32 s35, s35, 1
    s_and_b32 s36, s35, 1
    s_xor_b32 s36, s36, 1
    s_add_u32 s30, s35, 3
    s_and_b32 s30, s30, 3
    s_lshl_b32 s30, s30, 13
    s_add_u32 s57, s30, s40
    s_xor_b32 s30, s30, 0x4000
    s_add_u32 s38, s30, s40
    s_add_u32 s44, s44, 1
    s_add_u32 s51, s41, 16384
    s_add_u32 s3, s51, 4096
    s_add_u32 s41, s41, 786432
    s_add_u32 s43, s43, 1
    v_mov_b32 v32, -1
    s_waitcnt lgkmcnt(0)
    s_branch L_ch_inF0
L_ch_stepF0:
    s_waitcnt vmcnt(5)
    v_cmp_gt_u32 vcc, v13, v32
    s_cbranch_vccnz L_ch_hmissF0
L_ch_hokF0:
    s_waitcnt vmcnt(3)

L_ch_inF0:
    s_barrier
    ds_read_b128 v[40:43], v2 offset:0
    ds_read_b128 v[44:47], v2 offset:1024
    ds_read_b128 v[48:51], v2 offset:2048
    buffer_load_dwordx4 v[32:35], v2, s[8:11], s51 offen sc1
    s_waitcnt lgkmcnt(2)
    v_smfmac_f32_16x16x64_bf16 v[72:75], v[40:43], v[104:111], v1
    ds_read_b128 v[52:55], v2 offset:3072
    v_smfmac_f32_16x16x64_bf16 v[76:79], v[40:43], v[112:119], v1
    ds_read_b128 v[56:59], v2 offset:4096
    s_waitcnt lgkmcnt(3)
    v_smfmac_f32_16x16x64_bf16 v[72:75], v[44:47], v[120:127], v1
    buffer_load_dwordx4 v[36:39], v2, s[8:11], s3 offen sc1
    v_smfmac_f32_16x16x64_bf16 v[76:79], v[44:47], v[128:135], v1
    ds_read_b128 v[60:63], v2 offset:5120
    s_waitcnt lgkmcnt(3)
    v_smfmac_f32_16x16x64_bf16 v[72:75], v[48:51], v[136:143], v1
    ds_read_b128 v[64:67], v2 offset:6144
    v_cmp_gt_u32 s[20:21], s43, v14
    v_smfmac_f32_16x16x64_bf16 v[76:79], v[48:51], a[248:255], v1
    s_waitcnt lgkmcnt(3)
    v_smfmac_f32_16x16x64_bf16 v[72:75], v[52:55], a[240:247], v1
    ds_read_b128 v[68:71], v2 offset:7168
    v_smfmac_f32_16x16x64_bf16 v[76:79], v[52:55], a[232:239], v1
    ds_read_b128 v[104:107], v3 offset:10240
    s_waitcnt lgkmcnt(4)
    v_smfmac_f32_16x16x64_bf16 v[72:75], v[56:59], a[224:231], v1
    buffer_store_dwordx2 v[88:89], v10, s[8:11], s56 offen offset:2048 sc1
    s_cmp_lg_u64 s[20:21], 0
    s_waitcnt lgkmcnt(3)
    v_smfmac_f32_16x16x64_bf16 v[72:75], v[60:63], a[208:215], v1
    ds_read_b128 v[108:111], v3 offset:11264
    s_waitcnt lgkmcnt(3)
    v_smfmac_f32_16x16x64_bf16 v[72:75], v[64:67], a[192:199], v1
    s_cbranch_scc1 L_ch_pwaitF0
L_ch_pokF0:
    s_waitcnt lgkmcnt(2)
    v_smfmac_f32_16x16x64_bf16 v[72:75], v[68:71], a[176:183], v1
    ds_read_b128 v[112:115], v3 offset:12288
    v_smfmac_f32_16x16x64_bf16 v[76:79], v[56:59], a[216:223], v1
    ds_read_b128 v[116:119], v3 offset:13312
    v_smfmac_f32_16x16x64_bf16 v[76:79], v[60:63], a[200:207], v1
    buffer_store_dwordx2 v[90:91], v10, s[8:11], s56 offen offset:0 sc1
    v_add_f32 v72, v72, v74
    v_smfmac_f32_16x16x64_bf16 v[76:79], v[64:67], a[184:191], v1
    ds_read_b128 v[120:123], v3 offset:14336
    v_add_f32 v73, v73, v75
    v_smfmac_f32_16x16x64_bf16 v[76:79], v[68:71], a[168:175], v1
    v_cmp_u_f32 vcc, v72, v73
    v_smfmac_f32_16x16x64_bf16 v[80:83], v[40:43], a[160:167], v1
    ds_read_b128 v[124:127], v3 offset:15360
    v_mul_f32 v72, s45, v72
    v_mul_f32 v73, s45, v73
    v_smfmac_f32_16x16x64_bf16 v[84:87], v[40:43], a[152:159], v1
    s_cbranch_vccnz L_ch_missbF0
L_ch_okbF0:
    s_waitcnt lgkmcnt(4)
    v_add_f32 v76, v76, v78
    v_add_f32 v77, v77, v79
    v_smfmac_f32_16x16x64_bf16 v[80:83], v[44:47], v[104:111], v1
    ds_read_b128 v[128:131], v3 offset:16384
    v_mul_f32 v76, s45, v76
    v_mul_f32 v77, s45, v77
    v_smfmac_f32_16x16x64_bf16 v[84:87], v[44:47], a[144:151], v1
    s_waitcnt lgkmcnt(3)
    v_cvt_pk_bf16_f32 v72, v72, v76
    v_cvt_pk_bf16_f32 v73, v73, v77
    v_smfmac_f32_16x16x64_bf16 v[80:83], v[48:51], v[112:119], v1
    ds_write2_b32 v4, v72, v73 offset1:4
    v_smfmac_f32_16x16x64_bf16 v[84:87], v[48:51], a[136:143], v1
    ds_read_b128 v[132:135], v3 offset:17408
    v_mov_b64 v[74:75], 0
    v_smfmac_f32_16x16x64_bf16 v[80:83], v[52:55], a[128:135], v1
    ds_read_b128 v[136:139], v3 offset:18432
    v_mov_b64 v[76:77], 0
    v_smfmac_f32_16x16x64_bf16 v[84:87], v[52:55], a[120:127], v1
    ds_read_b128 v[140:143], v3 offset:19456
    v_mov_b64 v[78:79], 0
    v_smfmac_f32_16x16x64_bf16 v[80:83], v[56:59], a[112:119], v1
    s_waitcnt lgkmcnt(3)
    s_barrier
    v_smfmac_f32_16x16x64_bf16 v[80:83], v[60:63], a[96:103], v1
    ds_read_b128 v[104:107], v6 offset:12288
    v_mov_b64 v[72:73], 0
    v_smfmac_f32_16x16x64_bf16 v[80:83], v[64:67], a[88:95], v1
    ds_read_b128 v[108:111], v6 offset:12864
    v_smfmac_f32_16x16x64_bf16 v[80:83], v[68:71], a[80:87], v1
    ds_read_b128 v[112:115], v6 offset:13440
    v_mov_b64 v[88:89], 0
    v_smfmac_f32_16x16x64_bf16 v[84:87], v[56:59], a[104:111], v1
    ds_read_b128 v[116:119], v6 offset:14016
    v_mov_b64 v[90:91], 0
    v_smfmac_f32_16x16x64_bf16 v[84:87], v[60:63], v[120:127], v1
    s_waitcnt vmcnt(4)
    s_waitcnt lgkmcnt(6)
    v_add_f32 v80, v80, v82
    v_smfmac_f32_16x16x64_bf16 v[84:87], v[64:67], v[128:135], v1
    s_waitcnt lgkmcnt(4)
    v_add_f32 v81, v81, v83
    v_smfmac_f32_16x16x64_bf16 v[84:87], v[68:71], v[136:143], v1
    buffer_load_dword v14, v11, s[8:11], s46 offen sc1
    s_mov_b32 s56, s42
    s_waitcnt lgkmcnt(2)
    v_smfmac_f32_16x16x64_bf16 v[96:99], v[24:27], v[104:111], v1
    s_mov_b32 s37, s57
    s_waitcnt lgkmcnt(0)
    v_smfmac_f32_16x16x64_bf16 v[96:99], v[28:31], v[112:119], v1
    v_add_f32 v84, v84, v86
    v_add_f32 v85, v85, v87
    v_smfmac_f32_16x16x64_bf16 v[88:91], v[40:43], a[72:79], v1
    buffer_load_dwordx4 v[24:27], v9, s[8:11], s41 offen sc1
    v_cvt_pk_bf16_f32 v80, v80, v84
    v_cvt_pk_bf16_f32 v81, v81, v85
    v_smfmac_f32_16x16x64_bf16 v[92:95], v[40:43], a[64:71], v1
    ds_write2_b32 v5, v80, v81 offset1:4
    v_add_f32 v96, v96, v98
    v_add_f32 v97, v97, v99
    v_smfmac_f32_16x16x64_bf16 v[88:91], v[44:47], a[56:63], v1
    buffer_load_dwordx4 v[28:31], v9, s[8:11], s41 offen offset:2048 sc1
    v_exp_f32 v98, v96
    v_exp_f32 v99, v97
    v_mov_b64 v[82:83], 0
    v_cvt_pk_bf16_f32 v98, v98, v99
    v_smfmac_f32_16x16x64_bf16 v[92:95], v[44:47], a[48:55], v1
    ds_write_b32 v2, v98 offset:10240
    v_smfmac_f32_16x16x64_bf16 v[88:91], v[48:51], a[40:47], v1
    buffer_store_dword v15, v8, s[8:11], s38 offen
    v_mov_b64 v[84:85], 0
    v_smfmac_f32_16x16x64_bf16 v[92:95], v[48:51], a[32:39], v1
    ds_read_b128 v[40:43], v3 offset:20480
    v_mov_b64 v[86:87], 0
    v_smfmac_f32_16x16x64_bf16 v[88:91], v[52:55], a[24:31], v1
    ds_read_b128 v[44:47], v3 offset:21504
    v_mov_b64 v[80:81], 0
    v_smfmac_f32_16x16x64_bf16 v[92:95], v[52:55], a[16:23], v1
    s_waitcnt lgkmcnt(2)
    s_barrier
    ds_read_b128 v[120:123], v2 offset:8192
    v_smfmac_f32_16x16x64_bf16 v[88:91], v[56:59], a[8:15], v1
    ds_read_b128 v[124:127], v2 offset:9216
    v_smfmac_f32_16x16x64_bf16 v[88:91], v[60:63], v[248:255], v1
    ds_read_b128 v[128:131], v2 offset:10240
    v_smfmac_f32_16x16x64_bf16 v[88:91], v[64:67], v[232:239], v1
    v_smfmac_f32_16x16x64_bf16 v[88:91], v[68:71], v[216:223], v1
    ds_read_b128 v[48:51], v3 offset:22528
    s_waitcnt lgkmcnt(3)
    v_smfmac_f32_16x16x64_bf16 v[100:103], v[120:123], v[104:111], v1
    ds_read_b128 v[52:55], v3 offset:23552
    s_waitcnt lgkmcnt(3)
    v_smfmac_f32_16x16x64_bf16 v[100:103], v[124:127], v[112:119], v1
    s_waitcnt lgkmcnt(2)
    v_add_f32 v88, v88, v90
    v_mfma_f32_16x16x32_bf16 v[132:135], v[16:19], v[128:131], 0
    ds_read_b128 v[104:107], v3 offset:24576
    v_add_f32 v89, v89, v91
    v_cvt_pk_bf16_f32 v88, v88, v89
    v_smfmac_f32_16x16x64_bf16 v[92:95], v[56:59], a[0:7], v1
    ds_read_b128 v[108:111], v3 offset:25600
    v_add_f32 v100, v100, v102
    v_add_f32 v101, v101, v103
    v_smfmac_f32_16x16x64_bf16 v[92:95], v[60:63], v[240:247], v1
    ds_read_b128 v[112:115], v3 offset:26624
    v_exp_f32 v102, v100
    v_smfmac_f32_16x16x64_bf16 v[92:95], v[64:67], v[224:231], v1
    ds_read_b128 v[116:119], v3 offset:27648
    v_exp_f32 v103, v101
    v_smfmac_f32_16x16x64_bf16 v[92:95], v[68:71], v[208:215], v1
    s_waitcnt vmcnt(6)
    s_cmp_eq_u32 s34, 63
    v_cvt_pk_bf16_f32 v20, v102, v103
    v_swap_b32 v34, v36
    v_swap_b32 v35, v37
    v_mfma_f32_16x16x16_bf16 v[132:135], v[16:17], v[20:21], v[132:135]
    s_cselect_b32 s30, 0, s55
    v_add_f32 v92, v92, v94
    v_add_f32 v93, v93, v95
    v_mfma_f32_16x16x32_bf16 v[136:139], v[32:35], v[128:131], 0
    ds_read_b128 v[120:123], v3 offset:28672
    v_cvt_pk_bf16_f32 v89, v92, v93
    v_mfma_f32_16x16x32_bf16 v[140:143], v[36:39], v[128:131], 0
    ds_read_b128 v[124:127], v3 offset:29696
    v_mov_b32 v23, v20
    s_nop 0
    v_mfma_f32_16x16x16_bf16 v[136:139], v[88:89], v[20:21], v[136:139]
    s_nop 1
    v_mfma_f32_16x16x16_bf16 v[140:143], v[88:89], v[22:23], v[140:143]
    s_nop 0
    v_rcp_f32 v134, v132
    v_subrev_u32 v133, s54, v132
    v_cmp_le_u32 vcc, s30, v133
L_ch_normF0:
    v_mul_f32 v136, v134, v136
    v_mul_f32 v137, v134, v137
    v_mul_f32 v138, v134, v138
    v_mul_f32 v139, v134, v139
    v_mul_f32 v140, v134, v140
    v_mul_f32 v141, v134, v141
    v_mul_f32 v142, v134, v142
    v_mul_f32 v143, v134, v143
    v_cvt_pk_bf16_f32 v136, v136, v140
    v_cvt_pk_bf16_f32 v137, v137, v141
    v_cvt_pk_bf16_f32 v138, v138, v142
    v_cvt_pk_bf16_f32 v139, v139, v143
    ds_write_b128 v2, v[136:139] offset:12288
    s_cbranch_vccnz L_ch_safeF0
    v_smfmac_f32_16x16x64_bf16 v[72:75], v[136:139], v[200:207], v1
    s_add_u32 s34, s34, 1
    s_add_u32 s42, s42, 131072
    v_smfmac_f32_16x16x64_bf16 v[76:79], v[136:139], v[168:175], v1
    s_waitcnt lgkmcnt(0)
    s_barrier
    ds_read_b128 v[140:143], v2 offset:13312
    ds_read_b128 v[96:99], v2 offset:14336
    ds_read_b128 v[100:103], v2 offset:15360
    v_smfmac_f32_16x16x64_bf16 v[80:83], v[136:139], v[152:159], v1
    v_smfmac_f32_16x16x64_bf16 v[84:87], v[136:139], v[144:151], v1
    s_waitcnt lgkmcnt(2)
    v_smfmac_f32_16x16x64_bf16 v[72:75], v[140:143], v[192:199], v1
    ds_read_b128 v[56:59], v3 offset:30720
    s_waitcnt lgkmcnt(2)
    v_smfmac_f32_16x16x64_bf16 v[72:75], v[96:99], v[184:191], v1
    ds_read_b128 v[60:63], v3 offset:31744
    s_waitcnt lgkmcnt(2)
    v_smfmac_f32_16x16x64_bf16 v[72:75], v[100:103], v[176:183], v1
    ds_read_b128 v[64:67], v3 offset:32768
    v_smfmac_f32_16x16x64_bf16 v[76:79], v[140:143], v[160:167], v1
    ds_read_b128 v[68:71], v3 offset:33792
    v_smfmac_f32_16x16x64_bf16 v[76:79], v[96:99], v[40:47], v1
    ds_read_b128 v[128:131], v3 offset:34816
    v_cvt_pk_bf16_f32 v72, v72, v74
    v_cvt_pk_bf16_f32 v73, v73, v75
    v_and_or_b32 v72, v72, -2, s36
    v_smfmac_f32_16x16x64_bf16 v[76:79], v[100:103], v[48:55], v1
    buffer_store_dwordx2 v[72:73], v7, s[8:11], 0 offen offset:0
    v_smfmac_f32_16x16x64_bf16 v[80:83], v[140:143], v[104:111], v1
    ds_read_b128 v[132:135], v3 offset:35840
    v_smfmac_f32_16x16x64_bf16 v[80:83], v[96:99], v[112:119], v1
    v_cvt_pk_bf16_f32 v76, v76, v78
    v_cvt_pk_bf16_f32 v77, v77, v79
    v_and_or_b32 v76, v76, -2, s36
    v_smfmac_f32_16x16x64_bf16 v[80:83], v[100:103], v[120:127], v1
    buffer_store_dwordx2 v[76:77], v7, s[8:11], 0 offen offset:2048
    s_waitcnt lgkmcnt(4)
    v_smfmac_f32_16x16x64_bf16 v[84:87], v[140:143], v[56:63], v1
    s_waitcnt lgkmcnt(2)
    v_smfmac_f32_16x16x64_bf16 v[84:87], v[96:99], v[64:71], v1
    s_waitcnt lgkmcnt(0)
    v_cvt_pk_bf16_f32 v80, v80, v82
    v_cvt_pk_bf16_f32 v81, v81, v83
    v_and_or_b32 v80, v80, -2, s36
    v_smfmac_f32_16x16x64_bf16 v[84:87], v[100:103], v[128:135], v1
    buffer_store_dwordx2 v[80:81], v7, s[8:11], s50 offen offset:0
    ds_read_b128 v[136:139], v2 offset:11264
    s_nop 5
    v_cvt_pk_bf16_f32 v84, v84, v86
    v_cvt_pk_bf16_f32 v85, v85, v87
    v_and_or_b32 v84, v84, -2, s36
    buffer_store_dwordx2 v[84:85], v7, s[8:11], s50 offen offset:2048
    s_barrier
    v_mov_b32 v13, s44
    v_mov_b64 v[72:73], 0
    v_mov_b64 v[74:75], 0
    v_mov_b64 v[76:77], 0
    v_mov_b64 v[78:79], 0
    v_mov_b64 v[80:81], 0
    v_mov_b64 v[82:83], 0
    v_mov_b64 v[92:93], 0
    v_mov_b64 v[94:95], 0
    v_mov_b64 v[96:97], 0
    v_mov_b64 v[98:99], 0
    buffer_load_dwordx4 v[40:43], v2, s[8:11], s39 offen sc1
    buffer_load_dwordx4 v[44:47], v2, s[8:11], s39 offen offset:1024 sc1
    v_mov_b64 v[100:101], 0
    v_mov_b64 v[102:103], 0
    v_mov_b64 v[84:85], 0
    v_mov_b64 v[86:87], 0
    s_nop 15
    s_nop 15
    s_nop 5
    buffer_load_dwordx4 v[48:51], v2, s[8:11], s39 offen sc1
    buffer_load_dwordx4 v[52:55], v2, s[8:11], s39 offen offset:1024 sc1
    ds_read_b64 v[90:91], v10 offset:8192
    ds_read_b128 v[104:107], v3 offset:0
    ds_read_b128 v[108:111], v3 offset:1024
    ds_read_b128 v[112:115], v3 offset:2048
    ds_read_b128 v[116:119], v3 offset:3072
    ds_read_b128 v[120:123], v3 offset:4096
    ds_read_b128 v[124:127], v3 offset:5120
    ds_read_b128 v[128:131], v3 offset:6144
    ds_read_b128 v[132:135], v3 offset:7168
    s_waitcnt lgkmcnt(9)
    s_waitcnt vmcnt(3)
    v_mfma_f32_16x16x32_bf16 v[140:143], v[136:139], v[40:43], 0
    v_bitop3_b32 v70, v40, v42, s36 bitop3:0x7e
    s_waitcnt vmcnt(2)
    v_mfma_f32_16x16x32_bf16 v[140:143], v[136:139], v[44:47], v[140:143]
    v_bitop3_b32 v71, v44, v46, s36 bitop3:0x7e
    v_bitop3_b32 v70, v70, v71, 1 bitop3:0xa8
    v_cmp_ne_u32 vcc, 0, v70
    s_nop 3
    s_cbranch_vccnz L_ch_missaF0
L_ch_okaF0:
    v_add_f32_dpp v140, v140, v140 row_ror:4 row_mask:0xf bank_mask:0xf
    v_add_f32_dpp v141, v141, v141 row_ror:4 row_mask:0xf bank_mask:0xf
    s_nop 0
    v_add_f32_dpp v140, v140, v140 row_ror:8 row_mask:0xf bank_mask:0xf
    v_add_f32_dpp v141, v141, v141 row_ror:8 row_mask:0xf bank_mask:0xf
    v_cvt_pk_bf16_f32 v70, v140, v141
    v_min_u32 v70, -2, v70
    buffer_store_dword v70, v8, s[8:11], s37 offen
    s_nop 3
    buffer_store_dword v13, v21, s[8:11], s5 offen
    ds_read_b128 v[136:139], v3 offset:8192
    ds_read_b128 v[140:143], v3 offset:9216
    s_nop 15
    s_nop 15
    s_nop 9
    buffer_load_dword v32, v12, s[8:11], s4 offen sc1
    buffer_load_dwordx4 v2, s[8:11], s37 offen sc1 lds
    buffer_load_dwordx4 v2, s[8:11], s37 offen offset:1024 sc1 lds
    s_add_u32 s35, s35, 1
    s_and_b32 s36, s35, 1
    s_xor_b32 s36, s36, 1
    s_add_u32 s30, s35, 3
    s_and_b32 s30, s30, 3
    s_lshl_b32 s30, s30, 13
    s_add_u32 s57, s30, s40
    s_xor_b32 s30, s30, 0x4000
    s_add_u32 s38, s30, s40
    s_add_u32 s44, s44, 1
    s_add_u32 s51, s41, 16384
    s_add_u32 s3, s51, 4096
    s_add_u32 s41, s41, 786432
    s_add_u32 s43, s43, 1
    s_waitcnt lgkmcnt(10)
    v_min_u32 v88, -2, v88
    v_min_u32 v89, -2, v89
    v_min_u32 v90, -2, v90
    v_min_u32 v91, -2, v91
    s_nop 12
    buffer_load_dword v33, v12, s[8:11], s4 offen sc1
    buffer_load_dwordx4 v2, s[8:11], s37 offen sc1 lds
    buffer_load_dwordx4 v2, s[8:11], s37 offen offset:1024 sc1 lds
    s_waitcnt lgkmcnt(0)
    s_branch L_ch_stepF0
L_ch_pwaitF0:
    s_mov_b32 s27, 0
L_poll_12:
    buffer_load_dword v14, v11, s[8:11], s46 offen sc1
    s_waitcnt vmcnt(0)
    v_cmp_gt_u32 vcc, s43, v14
    s_cbranch_vccz L_pollok_13
    s_sleep 0
    s_add_u32 s27, s27, 1
    s_cmp_lt_u32 s27, 200000
    s_cbranch_scc1 L_poll_12
    s_branch L_ch_fail
L_pollok_13:
    s_branch L_ch_pokF0
L_ch_missaF0:
    s_mov_b32 s27, 0
L_ch_pollaF0:
    buffer_load_dwordx4 v[40:43], v2, s[8:11], s39 offen sc1
    buffer_load_dwordx4 v[44:47], v2, s[8:11], s39 offen offset:1024 sc1
    s_waitcnt vmcnt(3)
    v_mfma_f32_16x16x32_bf16 v[140:143], v[136:139], v[48:51], 0
    v_bitop3_b32 v70, v48, v50, s36 bitop3:0x7e
    s_waitcnt vmcnt(2)
    v_mfma_f32_16x16x32_bf16 v[140:143], v[136:139], v[52:55], v[140:143]
    v_bitop3_b32 v71, v52, v54, s36 bitop3:0x7e
    v_bitop3_b32 v70, v70, v71, 1 bitop3:0xa8
    v_cmp_ne_u32 vcc, 0, v70
    s_nop 3
    s_cbranch_vccz L_ch_okaF0
    buffer_load_dwordx4 v[48:51], v2, s[8:11], s39 offen sc1
    buffer_load_dwordx4 v[52:55], v2, s[8:11], s39 offen offset:1024 sc1
    s_waitcnt vmcnt(3)
    v_mfma_f32_16x16x32_bf16 v[140:143], v[136:139], v[40:43], 0
    v_bitop3_b32 v70, v40, v42, s36 bitop3:0x7e
    s_waitcnt vmcnt(2)
    v_mfma_f32_16x16x32_bf16 v[140:143], v[136:139], v[44:47], v[140:143]
    v_bitop3_b32 v71, v44, v46, s36 bitop3:0x7e
    v_bitop3_b32 v70, v70, v71, 1 bitop3:0xa8
    v_cmp_ne_u32 vcc, 0, v70
    s_nop 3
    s_cbranch_vccz L_ch_okaF0
    s_add_u32 s27, s27, 1
    s_cmp_lt_u32 s27, 200000
    s_cbranch_scc1 L_ch_pollaF0
    s_branch L_ch_fail
L_ch_hmissF0:
    s_mov_b32 s27, 0
L_ch_hpollF0:
    buffer_load_dword v32, v12, s[8:11], s4 offen sc1
    buffer_load_dwordx4 v2, s[8:11], s37 offen sc1 lds
    buffer_load_dwordx4 v2, s[8:11], s37 offen offset:1024 sc1 lds
    s_waitcnt vmcnt(5)
    v_cmp_gt_u32 vcc, v13, v33
    s_cbranch_vccz L_ch_hokF0
    buffer_load_dword v33, v12, s[8:11], s4 offen sc1
    buffer_load_dwordx4 v2, s[8:11], s37 offen sc1 lds
    buffer_load_dwordx4 v2, s[8:11], s37 offen offset:1024 sc1 lds
    s_waitcnt vmcnt(5)
    v_cmp_gt_u32 vcc, v13, v32
    s_cbranch_vccz L_ch_hokF0
    s_add_u32 s27, s27, 1
    s_cmp_lt_u32 s27, 200000
    s_cbranch_scc1 L_ch_hpollF0
    s_branch L_ch_fail
L_ch_missbF0:
    s_mov_b32 s27, 0
    s_sub_u32 s30, s37, 0
    s_add_u32 s31, s30, 4096
    s_waitcnt lgkmcnt(0)
    ds_read_b128 v[40:43], v2 offset:0
    ds_read_b128 v[44:47], v2 offset:1024
    ds_read_b128 v[48:51], v2 offset:2048
    ds_read_b128 v[52:55], v2 offset:3072
    ds_read_b128 v[56:59], v2 offset:4096
    ds_read_b128 v[60:63], v2 offset:5120
    ds_read_b128 v[64:67], v2 offset:6144
    ds_read_b128 v[68:71], v2 offset:7168
    s_waitcnt lgkmcnt(0)
    ds_read_b128 v[104:107], v3 offset:0
    ds_read_b128 v[108:111], v3 offset:1024
    ds_read_b128 v[112:115], v3 offset:2048
    ds_read_b128 v[116:119], v3 offset:3072
    ds_read_b128 v[120:123], v3 offset:4096
    ds_read_b128 v[124:127], v3 offset:5120
    ds_read_b128 v[128:131], v3 offset:6144
    ds_read_b128 v[132:135], v3 offset:7168
    ds_read_b128 v[136:139], v3 offset:8192
    ds_read_b128 v[140:143], v3 offset:9216
    s_branch L_ch_chkbF0
L_ch_pollbF0:
    buffer_load_dwordx4 v[40:43], v2, s[8:11], s30 offen offset:0 sc1
    buffer_load_dwordx4 v[44:47], v2, s[8:11], s30 offen offset:1024 sc1
    buffer_load_dwordx4 v[48:51], v2, s[8:11], s30 offen offset:2048 sc1
    buffer_load_dwordx4 v[52:55], v2, s[8:11], s30 offen offset:3072 sc1
    buffer_load_dwordx4 v[56:59], v2, s[8:11], s31 offen offset:0 sc1
    buffer_load_dwordx4 v[60:63], v2, s[8:11], s31 offen offset:1024 sc1
    buffer_load_dwordx4 v[64:67], v2, s[8:11], s31 offen offset:2048 sc1
    buffer_load_dwordx4 v[68:71], v2, s[8:11], s31 offen offset:3072 sc1
    s_add_u32 s27, s27, 1
    s_cmp_lt_u32 s27, 200000
    s_cbranch_scc0 L_ch_fail
    s_waitcnt vmcnt(0)
L_ch_chkbF0:
    v_max_u32 v23, v40, v41
    v_max3_u32 v23, v23, v42, v43
    v_max3_u32 v23, v23, v44, v45
    v_max3_u32 v23, v23, v46, v47
    v_max3_u32 v23, v23, v48, v49
    v_max3_u32 v23, v23, v50, v51
    v_max3_u32 v23, v23, v52, v53
    v_max3_u32 v23, v23, v54, v55
    v_max3_u32 v23, v23, v56, v57
    v_max3_u32 v23, v23, v58, v59
    v_max3_u32 v23, v23, v60, v61
    v_max3_u32 v23, v23, v62, v63
    v_max3_u32 v23, v23, v64, v65
    v_max3_u32 v23, v23, v66, v67
    v_max3_u32 v23, v23, v68, v69
    v_max3_u32 v23, v23, v70, v71
    v_cmp_eq_u32 vcc, -1, v23
    s_cbranch_vccnz L_ch_pollbF0
    v_mov_b64 v[72:73], 0
    v_mov_b64 v[74:75], 0
    v_mov_b64 v[76:77], 0
    v_mov_b64 v[78:79], 0
    v_mov_b64 v[80:81], 0
    v_mov_b64 v[82:83], 0
    v_mov_b64 v[84:85], 0
    v_mov_b64 v[86:87], 0
    s_waitcnt lgkmcnt(0)
    s_nop 0
    v_smfmac_f32_16x16x64_bf16 v[72:75], v[40:43], v[104:111], v1
    v_smfmac_f32_16x16x64_bf16 v[76:79], v[40:43], v[112:119], v1
    v_smfmac_f32_16x16x64_bf16 v[72:75], v[44:47], v[120:127], v1
    v_smfmac_f32_16x16x64_bf16 v[76:79], v[44:47], v[128:135], v1
    v_smfmac_f32_16x16x64_bf16 v[72:75], v[48:51], v[136:143], v1
    v_smfmac_f32_16x16x64_bf16 v[76:79], v[48:51], a[248:255], v1
    v_smfmac_f32_16x16x64_bf16 v[72:75], v[52:55], a[240:247], v1
    v_smfmac_f32_16x16x64_bf16 v[76:79], v[52:55], a[232:239], v1
    ds_read_b128 v[104:107], v3 offset:10240
    v_smfmac_f32_16x16x64_bf16 v[72:75], v[56:59], a[224:231], v1
    v_smfmac_f32_16x16x64_bf16 v[72:75], v[60:63], a[208:215], v1
    ds_read_b128 v[108:111], v3 offset:11264
    v_smfmac_f32_16x16x64_bf16 v[72:75], v[64:67], a[192:199], v1
    v_smfmac_f32_16x16x64_bf16 v[72:75], v[68:71], a[176:183], v1
    ds_read_b128 v[112:115], v3 offset:12288
    v_smfmac_f32_16x16x64_bf16 v[76:79], v[56:59], a[216:223], v1
    ds_read_b128 v[116:119], v3 offset:13312
    v_smfmac_f32_16x16x64_bf16 v[76:79], v[60:63], a[200:207], v1
    v_add_f32 v72, v72, v74
    v_smfmac_f32_16x16x64_bf16 v[76:79], v[64:67], a[184:191], v1
    ds_read_b128 v[120:123], v3 offset:14336
    v_add_f32 v73, v73, v75
    v_smfmac_f32_16x16x64_bf16 v[76:79], v[68:71], a[168:175], v1
    v_cmp_u_f32 vcc, v72, v73
    v_smfmac_f32_16x16x64_bf16 v[80:83], v[40:43], a[160:167], v1
    ds_read_b128 v[124:127], v3 offset:15360
    v_mul_f32 v72, s45, v72
    v_mul_f32 v73, s45, v73
    v_smfmac_f32_16x16x64_bf16 v[84:87], v[40:43], a[152:159], v1
    s_branch L_ch_okbF0
L_ch_lastF0:
    ds_read_b64 v[90:91], v10 offset:8192
    s_waitcnt lgkmcnt(0)
    v_min_u32 v88, -2, v88
    v_min_u32 v89, -2, v89
    v_min_u32 v90, -2, v90
    v_min_u32 v91, -2, v91
    buffer_store_dwordx2 v[90:91], v10, s[8:11], s56 offen offset:0 sc1
    buffer_store_dwordx2 v[88:89], v10, s[8:11], s56 offen offset:2048 sc1
    s_sub_u32 s35, s35, 1
    s_waitcnt vmcnt(0) lgkmcnt(0)
    s_barrier
    s_add_u32 s33, s33, 1
    s_cmp_lt_u32 s33, 2
    s_cbranch_scc1 L_ch_layerF0
    s_endpgm
L_ch_safeF0:
    s_cmp_eq_u32 s34, 63
    s_cbranch_scc1 L_ch_lastF0
    v_max3_f32 v133, v96, v97, v100
    v_max_f32 v133, v133, v101
    v_mov_b32 v135, v133
    s_nop 1
    v_permlane16_swap_b32 v133, v135
    s_nop 1
    v_max_f32 v133, v133, v135
    v_mov_b32 v135, v133
    s_nop 1
    v_permlane32_swap_b32 v133, v135
    s_nop 1
    v_max_f32 v133, v133, v135
    ds_write_b32 v2, v133 offset:4096
    s_waitcnt lgkmcnt(0)
    s_barrier
    ds_read_b128 v[128:131], v2 offset:4096
    s_waitcnt lgkmcnt(0)
    v_max3_f32 v133, v128, v129, v130
    v_max_f32 v133, v133, v131
    v_sub_f32 v98, v96, v133
    v_exp_f32 v98, v98
    v_sub_f32 v99, v97, v133
    v_exp_f32 v99, v99
    v_sub_f32 v102, v100, v133
    v_exp_f32 v102, v102
    v_sub_f32 v103, v101, v133
    v_exp_f32 v103, v103
    s_nop 0
    v_cvt_pk_bf16_f32 v98, v98, v99
    v_cvt_pk_bf16_f32 v20, v102, v103
    v_cvt_pk_bf16_f32 v23, v102, v103
    ds_write_b32 v2, v98 offset:10240
    s_waitcnt lgkmcnt(0)
    s_barrier
    ds_read_b128 v[128:131], v2 offset:10240
    s_waitcnt lgkmcnt(0)
    v_mfma_f32_16x16x32_bf16 v[132:135], v[16:19], v[128:131], 0
    v_mfma_f32_16x16x32_bf16 v[136:139], v[32:35], v[128:131], 0
    v_mfma_f32_16x16x32_bf16 v[140:143], v[36:39], v[128:131], 0
    s_nop 7
    v_mfma_f32_16x16x16_bf16 v[132:135], v[16:17], v[20:21], v[132:135]
    v_mfma_f32_16x16x16_bf16 v[136:139], v[88:89], v[20:21], v[136:139]
    v_mfma_f32_16x16x16_bf16 v[140:143], v[88:89], v[22:23], v[140:143]
    s_nop 7
    v_rcp_f32 v134, v132
    s_mov_b64 vcc, 0
    s_branch L_ch_normF0
L_ch_layerF1:
    s_mov_b32 s30, 0
    s_mul_i32 s41, s32, 24576
    s_add_u32 s41, s41, s30
    s_add_u32 s41, s41, 1048576
    s_lshl_b32 s56, s32, 12
    s_add_u32 s56, s56, 61341696
    s_mul_i32 s42, s32, 4096
    s_add_u32 s42, s42, s30
    s_add_u32 s42, s42, 52428800
    s_lshl_b32 s43, s33, 7
    s_add_u32 s43, s43, 1
    s_mov_b32 s34, 0
    s_mov_b32 m0, 2048
    v_bfe_u32 v48, v2, 6, 2
    v_bfe_u32 v49, v2, 4, 1
    v_lshl_add_u32 v48, v48, 1, v49
    v_lshlrev_b32 v48, 10, v48
    v_lshrrev_b32 v49, 8, v2
    v_lshl_add_u32 v48, v49, 7, v48
    v_bfe_u32 v49, v2, 5, 1
    v_lshl_add_u32 v48, v49, 6, v48
    v_add_u32 v48, 4, v48
    buffer_load_dword v40, v48, s[12:15], 0 offen offset:0
    buffer_load_dword v41, v48, s[12:15], 0 offen offset:16
    buffer_load_dword v42, v48, s[12:15], 0 offen offset:32
    buffer_load_dword v43, v48, s[12:15], 0 offen offset:48
    buffer_load_dword v44, v48, s[12:15], 0 offen offset:512
    buffer_load_dword v45, v48, s[12:15], 0 offen offset:528
    buffer_load_dword v46, v48, s[12:15], 0 offen offset:544
    buffer_load_dword v47, v48, s[12:15], 0 offen offset:560
    v_mov_b64 v[72:73], 0
    v_mov_b64 v[74:75], 0
    v_mov_b64 v[76:77], 0
    v_mov_b64 v[78:79], 0
    v_mov_b64 v[80:81], 0
    v_mov_b64 v[82:83], 0
    v_mov_b64 v[84:85], 0
    v_mov_b64 v[86:87], 0
    v_mov_b64 v[88:89], 0
    v_mov_b64 v[90:91], 0
    v_mov_b64 v[92:93], 0
    v_mov_b64 v[94:95], 0
    v_mov_b64 v[96:97], 0
    v_mov_b64 v[98:99], 0
    v_mov_b64 v[100:101], 0
    v_mov_b64 v[102:103], 0
    ds_read_b128 v[104:107], v3 offset:0
    ds_read_b128 v[108:111], v3 offset:1024
    ds_read_b128 v[112:115], v3 offset:2048
    ds_read_b128 v[116:119], v3 offset:3072
    ds_read_b128 v[120:123], v3 offset:4096
    ds_read_b128 v[124:127], v3 offset:5120
    ds_read_b128 v[128:131], v3 offset:6144
    ds_read_b128 v[132:135], v3 offset:7168
    ds_read_b128 v[136:139], v3 offset:8192
    ds_read_b128 v[140:143], v3 offset:9216
    s_waitcnt vmcnt(0)
    v_min_u32 v40, -2, v40
    v_min_u32 v41, -2, v41
    v_min_u32 v42, -2, v42
    v_min_u32 v43, -2, v43
    v_min_u32 v44, -2, v44
    v_min_u32 v45, -2, v45
    v_min_u32 v46, -2, v46
    v_min_u32 v47, -2, v47
    ds_write_b128 v2, v[40:43] offset:2048
    ds_write_b128 v2, v[44:47] offset:3072
    s_mov_b32 s27, 0
L_poll_14:
    buffer_load_dword v14, v11, s[8:11], s46 offen sc1
    s_waitcnt vmcnt(0)
    v_cmp_gt_u32 vcc, s43, v14
    s_cbranch_vccz L_pollok_15
    s_sleep 1
    s_add_u32 s27, s27, 1
    s_cmp_lt_u32 s27, 200000
    s_cbranch_scc1 L_poll_14
    s_branch L_ch_fail
L_pollok_15:
    buffer_load_dwordx4 v[24:27], v9, s[8:11], s41 offen sc1
    buffer_load_dwordx4 v[28:31], v9, s[8:11], s41 offen offset:2048 sc1
    s_add_u32 s35, s35, 1
    s_and_b32 s36, s35, 1
    s_xor_b32 s36, s36, 1
    s_add_u32 s30, s35, 3
    s_and_b32 s30, s30, 3
    s_lshl_b32 s30, s30, 13
    s_add_u32 s57, s30, s40
    s_xor_b32 s30, s30, 0x4000
    s_add_u32 s38, s30, s40
    s_add_u32 s44, s44, 1
    s_add_u32 s51, s41, 17408
    s_add_u32 s3, s51, 4096
    s_add_u32 s41, s41, 786432
    s_add_u32 s43, s43, 1
    v_mov_b32 v32, -1
    s_waitcnt lgkmcnt(0)
    s_branch L_ch_inF1
L_ch_stepF1:
    s_waitcnt vmcnt(5)
    v_cmp_gt_u32 vcc, v13, v32
    s_cbranch_vccnz L_ch_hmissF1
L_ch_hokF1:
    s_waitcnt vmcnt(3)

L_ch_inF1:
    s_barrier
    ds_read_b128 v[40:43], v2 offset:0
    ds_read_b128 v[44:47], v2 offset:1024
    ds_read_b128 v[48:51], v2 offset:2048
    buffer_load_dwordx4 v[32:35], v2, s[8:11], s51 offen sc1
    s_waitcnt lgkmcnt(2)
    v_smfmac_f32_16x16x64_bf16 v[72:75], v[40:43], v[104:111], v1
    ds_read_b128 v[52:55], v2 offset:3072
    v_smfmac_f32_16x16x64_bf16 v[76:79], v[40:43], v[112:119], v1
    ds_read_b128 v[56:59], v2 offset:4096
    s_waitcnt lgkmcnt(3)
    v_smfmac_f32_16x16x64_bf16 v[72:75], v[44:47], v[120:127], v1
    buffer_load_dwordx4 v[36:39], v2, s[8:11], s3 offen sc1
    v_smfmac_f32_16x16x64_bf16 v[76:79], v[44:47], v[128:135], v1
    ds_read_b128 v[60:63], v2 offset:5120
    s_waitcnt lgkmcnt(3)
    v_smfmac_f32_16x16x64_bf16 v[72:75], v[48:51], v[136:143], v1
    ds_read_b128 v[64:67], v2 offset:6144
    v_smfmac_f32_16x16x64_bf16 v[76:79], v[48:51], a[248:255], v1
    s_waitcnt lgkmcnt(3)
    v_smfmac_f32_16x16x64_bf16 v[72:75], v[52:55], a[240:247], v1
    ds_read_b128 v[68:71], v2 offset:7168
    v_smfmac_f32_16x16x64_bf16 v[76:79], v[52:55], a[232:239], v1
    ds_read_b128 v[104:107], v3 offset:10240
    s_waitcnt lgkmcnt(4)
    v_smfmac_f32_16x16x64_bf16 v[72:75], v[56:59], a[224:231], v1
    s_waitcnt lgkmcnt(3)
    v_smfmac_f32_16x16x64_bf16 v[72:75], v[60:63], a[208:215], v1
    ds_read_b128 v[108:111], v3 offset:11264
    s_waitcnt lgkmcnt(3)
    v_smfmac_f32_16x16x64_bf16 v[72:75], v[64:67], a[192:199], v1
    buffer_store_dwordx2 v[88:89], v10, s[8:11], s56 offen offset:2560 sc1
    s_waitcnt lgkmcnt(2)
    v_smfmac_f32_16x16x64_bf16 v[72:75], v[68:71], a[176:183], v1
    ds_read_b128 v[112:115], v3 offset:12288
    v_smfmac_f32_16x16x64_bf16 v[76:79], v[56:59], a[216:223], v1
    ds_read_b128 v[116:119], v3 offset:13312
    v_smfmac_f32_16x16x64_bf16 v[76:79], v[60:63], a[200:207], v1
    v_add_f32 v72, v72, v74
    v_smfmac_f32_16x16x64_bf16 v[76:79], v[64:67], a[184:191], v1
    ds_read_b128 v[120:123], v3 offset:14336
    v_add_f32 v73, v73, v75
    v_smfmac_f32_16x16x64_bf16 v[76:79], v[68:71], a[168:175], v1
    buffer_store_dwordx2 v[90:91], v10, s[8:11], s56 offen offset:512 sc1
    v_cmp_u_f32 vcc, v72, v73
    v_smfmac_f32_16x16x64_bf16 v[80:83], v[40:43], a[160:167], v1
    ds_read_b128 v[124:127], v3 offset:15360
    v_mul_f32 v72, s45, v72
    v_mul_f32 v73, s45, v73
    v_smfmac_f32_16x16x64_bf16 v[84:87], v[40:43], a[152:159], v1
    s_cbranch_vccnz L_ch_missbF1
L_ch_okbF1:
    s_waitcnt lgkmcnt(4)
    v_add_f32 v76, v76, v78
    v_add_f32 v77, v77, v79
    v_smfmac_f32_16x16x64_bf16 v[80:83], v[44:47], v[104:111], v1
    ds_read_b128 v[128:131], v3 offset:16384
    v_mul_f32 v76, s45, v76
    v_mul_f32 v77, s45, v77
    v_smfmac_f32_16x16x64_bf16 v[84:87], v[44:47], a[144:151], v1
    s_waitcnt lgkmcnt(3)
    v_cvt_pk_bf16_f32 v72, v72, v76
    v_cvt_pk_bf16_f32 v73, v73, v77
    v_smfmac_f32_16x16x64_bf16 v[80:83], v[48:51], v[112:119], v1
    ds_write2_b32 v4, v72, v73 offset1:4
    v_smfmac_f32_16x16x64_bf16 v[84:87], v[48:51], a[136:143], v1
    ds_read_b128 v[132:135], v3 offset:17408
    v_mov_b64 v[74:75], 0
    v_smfmac_f32_16x16x64_bf16 v[80:83], v[52:55], a[128:135], v1
    ds_read_b128 v[136:139], v3 offset:18432
    v_mov_b64 v[76:77], 0
    v_smfmac_f32_16x16x64_bf16 v[84:87], v[52:55], a[120:127], v1
    ds_read_b128 v[140:143], v3 offset:19456
    v_mov_b64 v[78:79], 0
    v_smfmac_f32_16x16x64_bf16 v[80:83], v[56:59], a[112:119], v1
    s_waitcnt lgkmcnt(3)
    s_barrier
    v_smfmac_f32_16x16x64_bf16 v[80:83], v[60:63], a[96:103], v1
    ds_read_b128 v[104:107], v6 offset:12288
    v_mov_b64 v[72:73], 0
    v_smfmac_f32_16x16x64_bf16 v[80:83], v[64:67], a[88:95], v1
    ds_read_b128 v[108:111], v6 offset:12864
    v_smfmac_f32_16x16x64_bf16 v[80:83], v[68:71], a[80:87], v1
    ds_read_b128 v[112:115], v6 offset:13440
    v_mov_b64 v[88:89], 0
    v_smfmac_f32_16x16x64_bf16 v[84:87], v[56:59], a[104:111], v1
    ds_read_b128 v[116:119], v6 offset:14016
    v_mov_b64 v[90:91], 0
    v_smfmac_f32_16x16x64_bf16 v[84:87], v[60:63], v[120:127], v1
    s_waitcnt vmcnt(4)
    s_waitcnt lgkmcnt(6)
    v_add_f32 v80, v80, v82
    v_smfmac_f32_16x16x64_bf16 v[84:87], v[64:67], v[128:135], v1
    s_waitcnt lgkmcnt(4)
    v_add_f32 v81, v81, v83
    v_smfmac_f32_16x16x64_bf16 v[84:87], v[68:71], v[136:143], v1
    s_mov_b32 s56, s42
    s_waitcnt lgkmcnt(2)
    v_smfmac_f32_16x16x64_bf16 v[96:99], v[24:27], v[104:111], v1
    s_mov_b32 s37, s57
    s_waitcnt lgkmcnt(0)
    v_smfmac_f32_16x16x64_bf16 v[96:99], v[28:31], v[112:119], v1
    v_add_f32 v84, v84, v86
    v_add_f32 v85, v85, v87
    v_smfmac_f32_16x16x64_bf16 v[88:91], v[40:43], a[72:79], v1
    buffer_load_dwordx4 v[24:27], v9, s[8:11], s41 offen sc1
    v_cvt_pk_bf16_f32 v80, v80, v84
    v_cvt_pk_bf16_f32 v81, v81, v85
    v_smfmac_f32_16x16x64_bf16 v[92:95], v[40:43], a[64:71], v1
    ds_write2_b32 v5, v80, v81 offset1:4
    v_add_f32 v96, v96, v98
    v_add_f32 v97, v97, v99
    v_smfmac_f32_16x16x64_bf16 v[88:91], v[44:47], a[56:63], v1
    buffer_load_dwordx4 v[28:31], v9, s[8:11], s41 offen offset:2048 sc1
    v_exp_f32 v98, v96
    v_exp_f32 v99, v97
    v_mov_b64 v[82:83], 0
    v_cvt_pk_bf16_f32 v98, v98, v99
    v_smfmac_f32_16x16x64_bf16 v[92:95], v[44:47], a[48:55], v1
    ds_write_b32 v2, v98 offset:10244
    v_smfmac_f32_16x16x64_bf16 v[88:91], v[48:51], a[40:47], v1
    buffer_store_dword v15, v8, s[8:11], s38 offen
    v_mov_b64 v[84:85], 0
    v_smfmac_f32_16x16x64_bf16 v[92:95], v[48:51], a[32:39], v1
    ds_read_b128 v[40:43], v3 offset:20480
    v_mov_b64 v[86:87], 0
    v_smfmac_f32_16x16x64_bf16 v[88:91], v[52:55], a[24:31], v1
    ds_read_b128 v[44:47], v3 offset:21504
    v_mov_b64 v[80:81], 0
    v_smfmac_f32_16x16x64_bf16 v[92:95], v[52:55], a[16:23], v1
    s_waitcnt lgkmcnt(2)
    s_barrier
    ds_read_b128 v[120:123], v2 offset:8192
    v_smfmac_f32_16x16x64_bf16 v[88:91], v[56:59], a[8:15], v1
    ds_read_b128 v[124:127], v2 offset:9216
    v_smfmac_f32_16x16x64_bf16 v[88:91], v[60:63], v[248:255], v1
    ds_read_b128 v[128:131], v2 offset:10240
    v_smfmac_f32_16x16x64_bf16 v[88:91], v[64:67], v[232:239], v1
    v_smfmac_f32_16x16x64_bf16 v[88:91], v[68:71], v[216:223], v1
    ds_read_b128 v[48:51], v3 offset:22528
    s_waitcnt lgkmcnt(3)
    v_smfmac_f32_16x16x64_bf16 v[100:103], v[120:123], v[104:111], v1
    ds_read_b128 v[52:55], v3 offset:23552
    s_waitcnt lgkmcnt(3)
    v_smfmac_f32_16x16x64_bf16 v[100:103], v[124:127], v[112:119], v1
    s_waitcnt lgkmcnt(2)
    v_add_f32 v88, v88, v90
    v_mfma_f32_16x16x32_bf16 v[132:135], v[16:19], v[128:131], 0
    ds_read_b128 v[104:107], v3 offset:24576
    v_add_f32 v89, v89, v91
    v_cvt_pk_bf16_f32 v88, v88, v89
    v_smfmac_f32_16x16x64_bf16 v[92:95], v[56:59], a[0:7], v1
    ds_read_b128 v[108:111], v3 offset:25600
    v_add_f32 v100, v100, v102
    v_add_f32 v101, v101, v103
    v_smfmac_f32_16x16x64_bf16 v[92:95], v[60:63], v[240:247], v1
    ds_read_b128 v[112:115], v3 offset:26624
    v_exp_f32 v102, v100
    v_smfmac_f32_16x16x64_bf16 v[92:95], v[64:67], v[224:231], v1
    ds_read_b128 v[116:119], v3 offset:27648
    v_exp_f32 v103, v101
    v_smfmac_f32_16x16x64_bf16 v[92:95], v[68:71], v[208:215], v1
    s_waitcnt vmcnt(5)
    s_cmp_eq_u32 s34, 63
    v_cvt_pk_bf16_f32 v20, v102, v103
    v_swap_b32 v34, v36
    v_swap_b32 v35, v37
    v_mfma_f32_16x16x16_bf16 v[132:135], v[16:17], v[20:21], v[132:135]
    s_cselect_b32 s30, 0, s55
    v_add_f32 v92, v92, v94
    v_add_f32 v93, v93, v95
    v_mfma_f32_16x16x32_bf16 v[136:139], v[32:35], v[128:131], 0
    ds_read_b128 v[120:123], v3 offset:28672
    v_cvt_pk_bf16_f32 v89, v92, v93
    v_mfma_f32_16x16x32_bf16 v[140:143], v[36:39], v[128:131], 0
    ds_read_b128 v[124:127], v3 offset:29696
    v_mov_b32 v23, v20
    s_nop 0
    v_mfma_f32_16x16x16_bf16 v[136:139], v[88:89], v[20:21], v[136:139]
    s_nop 1
    v_mfma_f32_16x16x16_bf16 v[140:143], v[88:89], v[22:23], v[140:143]
    s_nop 0
    v_rcp_f32 v134, v132
    v_subrev_u32 v133, s54, v132
    v_cmp_le_u32 vcc, s30, v133
L_ch_normF1:
    v_mul_f32 v136, v134, v136
    v_mul_f32 v137, v134, v137
    v_mul_f32 v138, v134, v138
    v_mul_f32 v139, v134, v139
    v_mul_f32 v140, v134, v140
    v_mul_f32 v141, v134, v141
    v_mul_f32 v142, v134, v142
    v_mul_f32 v143, v134, v143
    v_cvt_pk_bf16_f32 v136, v136, v140
    v_cvt_pk_bf16_f32 v137, v137, v141
    v_cvt_pk_bf16_f32 v138, v138, v142
    v_cvt_pk_bf16_f32 v139, v139, v143
    ds_write_b128 v2, v[136:139] offset:13312
    s_cbranch_vccnz L_ch_safeF1
    v_smfmac_f32_16x16x64_bf16 v[72:75], v[136:139], v[200:207], v1
    s_add_u32 s34, s34, 1
    s_add_u32 s42, s42, 131072
    v_smfmac_f32_16x16x64_bf16 v[76:79], v[136:139], v[168:175], v1
    s_waitcnt lgkmcnt(0)
    s_barrier
    ds_read_b128 v[140:143], v2 offset:14336
    ds_read_b128 v[96:99], v2 offset:15360
    ds_read_b128 v[100:103], v2 offset:12288
    v_smfmac_f32_16x16x64_bf16 v[80:83], v[136:139], v[152:159], v1
    v_smfmac_f32_16x16x64_bf16 v[84:87], v[136:139], v[144:151], v1
    s_waitcnt lgkmcnt(2)
    v_smfmac_f32_16x16x64_bf16 v[72:75], v[140:143], v[192:199], v1
    ds_read_b128 v[56:59], v3 offset:30720
    s_waitcnt lgkmcnt(2)
    v_smfmac_f32_16x16x64_bf16 v[72:75], v[96:99], v[184:191], v1
    ds_read_b128 v[60:63], v3 offset:31744
    s_waitcnt lgkmcnt(2)
    v_smfmac_f32_16x16x64_bf16 v[72:75], v[100:103], v[176:183], v1
    ds_read_b128 v[64:67], v3 offset:32768
    v_smfmac_f32_16x16x64_bf16 v[76:79], v[140:143], v[160:167], v1
    ds_read_b128 v[68:71], v3 offset:33792
    v_smfmac_f32_16x16x64_bf16 v[76:79], v[96:99], v[40:47], v1
    ds_read_b128 v[128:131], v3 offset:34816
    v_cvt_pk_bf16_f32 v72, v72, v74
    v_cvt_pk_bf16_f32 v73, v73, v75
    v_and_or_b32 v72, v72, -2, s36
    v_smfmac_f32_16x16x64_bf16 v[76:79], v[100:103], v[48:55], v1
    buffer_store_dwordx2 v[72:73], v7, s[8:11], 0 offen offset:0
    v_smfmac_f32_16x16x64_bf16 v[80:83], v[140:143], v[104:111], v1
    ds_read_b128 v[132:135], v3 offset:35840
    v_smfmac_f32_16x16x64_bf16 v[80:83], v[96:99], v[112:119], v1
    v_cvt_pk_bf16_f32 v76, v76, v78
    v_cvt_pk_bf16_f32 v77, v77, v79
    v_and_or_b32 v76, v76, -2, s36
    v_smfmac_f32_16x16x64_bf16 v[80:83], v[100:103], v[120:127], v1
    buffer_store_dwordx2 v[76:77], v7, s[8:11], 0 offen offset:2048
    s_waitcnt lgkmcnt(4)
    v_smfmac_f32_16x16x64_bf16 v[84:87], v[140:143], v[56:63], v1
    s_waitcnt lgkmcnt(2)
    v_smfmac_f32_16x16x64_bf16 v[84:87], v[96:99], v[64:71], v1
    s_waitcnt lgkmcnt(0)
    v_cvt_pk_bf16_f32 v80, v80, v82
    v_cvt_pk_bf16_f32 v81, v81, v83
    v_and_or_b32 v80, v80, -2, s36
    v_smfmac_f32_16x16x64_bf16 v[84:87], v[100:103], v[128:135], v1
    buffer_store_dwordx2 v[80:81], v7, s[8:11], s50 offen offset:0
    ds_read_b128 v[136:139], v2 offset:11264
    s_nop 5
    v_cvt_pk_bf16_f32 v84, v84, v86
    v_cvt_pk_bf16_f32 v85, v85, v87
    v_and_or_b32 v84, v84, -2, s36
    buffer_store_dwordx2 v[84:85], v7, s[8:11], s50 offen offset:2048
    s_barrier
    v_mov_b32 v13, s44
    v_mov_b64 v[72:73], 0
    v_mov_b64 v[74:75], 0
    v_mov_b64 v[76:77], 0
    v_mov_b64 v[78:79], 0
    v_mov_b64 v[80:81], 0
    v_mov_b64 v[82:83], 0
    v_mov_b64 v[92:93], 0
    v_mov_b64 v[94:95], 0
    v_mov_b64 v[96:97], 0
    v_mov_b64 v[98:99], 0
    v_mov_b64 v[100:101], 0
    v_mov_b64 v[102:103], 0
    v_mov_b64 v[84:85], 0
    v_mov_b64 v[86:87], 0
    s_nop 8
    buffer_load_dwordx4 v[40:43], v2, s[8:11], s39 offen sc1
    buffer_load_dwordx4 v[44:47], v2, s[8:11], s39 offen offset:1024 sc1
    s_nop 15
    s_nop 15
    s_nop 7
    buffer_load_dwordx4 v[48:51], v2, s[8:11], s39 offen sc1
    buffer_load_dwordx4 v[52:55], v2, s[8:11], s39 offen offset:1024 sc1
    ds_read_b64 v[90:91], v10 offset:8704
    ds_read_b128 v[104:107], v3 offset:0
    ds_read_b128 v[108:111], v3 offset:1024
    ds_read_b128 v[112:115], v3 offset:2048
    ds_read_b128 v[116:119], v3 offset:3072
    ds_read_b128 v[120:123], v3 offset:4096
    ds_read_b128 v[124:127], v3 offset:5120
    ds_read_b128 v[128:131], v3 offset:6144
    ds_read_b128 v[132:135], v3 offset:7168
    s_waitcnt lgkmcnt(9)
    s_waitcnt vmcnt(3)
    v_mfma_f32_16x16x32_bf16 v[140:143], v[136:139], v[40:43], 0
    v_bitop3_b32 v70, v40, v42, s36 bitop3:0x7e
    s_waitcnt vmcnt(2)
    v_mfma_f32_16x16x32_bf16 v[140:143], v[136:139], v[44:47], v[140:143]
    v_bitop3_b32 v71, v44, v46, s36 bitop3:0x7e
    v_bitop3_b32 v70, v70, v71, 1 bitop3:0xa8
    v_cmp_ne_u32 vcc, 0, v70
    s_nop 3
    s_cbranch_vccnz L_ch_missaF1
L_ch_okaF1:
    v_add_f32_dpp v140, v140, v140 row_ror:4 row_mask:0xf bank_mask:0xf
    v_add_f32_dpp v141, v141, v141 row_ror:4 row_mask:0xf bank_mask:0xf
    s_nop 0
    v_add_f32_dpp v140, v140, v140 row_ror:8 row_mask:0xf bank_mask:0xf
    v_add_f32_dpp v141, v141, v141 row_ror:8 row_mask:0xf bank_mask:0xf
    v_cvt_pk_bf16_f32 v70, v140, v141
    v_min_u32 v70, -2, v70
    buffer_store_dword v70, v8, s[8:11], s37 offen
    s_nop 3
    buffer_store_dword v13, v21, s[8:11], s5 offen
    ds_read_b128 v[136:139], v3 offset:8192
    ds_read_b128 v[140:143], v3 offset:9216
    s_nop 15
    s_nop 15
    s_nop 15
    buffer_load_dword v32, v12, s[8:11], s4 offen sc1
    buffer_load_dwordx4 v2, s[8:11], s37 offen sc1 lds
    buffer_load_dwordx4 v2, s[8:11], s37 offen offset:1024 sc1 lds
    s_add_u32 s35, s35, 1
    s_and_b32 s36, s35, 1
    s_xor_b32 s36, s36, 1
    s_add_u32 s30, s35, 3
    s_and_b32 s30, s30, 3
    s_lshl_b32 s30, s30, 13
    s_add_u32 s57, s30, s40
    s_xor_b32 s30, s30, 0x4000
    s_add_u32 s38, s30, s40
    s_add_u32 s44, s44, 1
    s_add_u32 s51, s41, 17408
    s_add_u32 s3, s51, 4096
    s_add_u32 s41, s41, 786432
    s_add_u32 s43, s43, 1
    s_waitcnt lgkmcnt(10)
    v_min_u32 v88, -2, v88
    v_min_u32 v89, -2, v89
    v_min_u32 v90, -2, v90
    v_min_u32 v91, -2, v91
    s_nop 12
    buffer_load_dword v33, v12, s[8:11], s4 offen sc1
    buffer_load_dwordx4 v2, s[8:11], s37 offen sc1 lds
    buffer_load_dwordx4 v2, s[8:11], s37 offen offset:1024 sc1 lds
    s_waitcnt lgkmcnt(0)
    s_branch L_ch_stepF1
L_ch_missaF1:
    s_mov_b32 s27, 0
L_ch_pollaF1:
    buffer_load_dwordx4 v[40:43], v2, s[8:11], s39 offen sc1
    buffer_load_dwordx4 v[44:47], v2, s[8:11], s39 offen offset:1024 sc1
    s_waitcnt vmcnt(3)
    v_mfma_f32_16x16x32_bf16 v[140:143], v[136:139], v[48:51], 0
    v_bitop3_b32 v70, v48, v50, s36 bitop3:0x7e
    s_waitcnt vmcnt(2)
    v_mfma_f32_16x16x32_bf16 v[140:143], v[136:139], v[52:55], v[140:143]
    v_bitop3_b32 v71, v52, v54, s36 bitop3:0x7e
    v_bitop3_b32 v70, v70, v71, 1 bitop3:0xa8
    v_cmp_ne_u32 vcc, 0, v70
    s_nop 3
    s_cbranch_vccz L_ch_okaF1
    buffer_load_dwordx4 v[48:51], v2, s[8:11], s39 offen sc1
    buffer_load_dwordx4 v[52:55], v2, s[8:11], s39 offen offset:1024 sc1
    s_waitcnt vmcnt(3)
    v_mfma_f32_16x16x32_bf16 v[140:143], v[136:139], v[40:43], 0
    v_bitop3_b32 v70, v40, v42, s36 bitop3:0x7e
    s_waitcnt vmcnt(2)
    v_mfma_f32_16x16x32_bf16 v[140:143], v[136:139], v[44:47], v[140:143]
    v_bitop3_b32 v71, v44, v46, s36 bitop3:0x7e
    v_bitop3_b32 v70, v70, v71, 1 bitop3:0xa8
    v_cmp_ne_u32 vcc, 0, v70
    s_nop 3
    s_cbranch_vccz L_ch_okaF1
    s_add_u32 s27, s27, 1
    s_cmp_lt_u32 s27, 200000
    s_cbranch_scc1 L_ch_pollaF1
    s_branch L_ch_fail
L_ch_hmissF1:
    s_mov_b32 s27, 0
L_ch_hpollF1:
    buffer_load_dword v32, v12, s[8:11], s4 offen sc1
    buffer_load_dwordx4 v2, s[8:11], s37 offen sc1 lds
    buffer_load_dwordx4 v2, s[8:11], s37 offen offset:1024 sc1 lds
    s_waitcnt vmcnt(5)
    v_cmp_gt_u32 vcc, v13, v33
    s_cbranch_vccz L_ch_hokF1
    buffer_load_dword v33, v12, s[8:11], s4 offen sc1
    buffer_load_dwordx4 v2, s[8:11], s37 offen sc1 lds
    buffer_load_dwordx4 v2, s[8:11], s37 offen offset:1024 sc1 lds
    s_waitcnt vmcnt(5)
    v_cmp_gt_u32 vcc, v13, v32
    s_cbranch_vccz L_ch_hokF1
    s_add_u32 s27, s27, 1
    s_cmp_lt_u32 s27, 200000
    s_cbranch_scc1 L_ch_hpollF1
    s_branch L_ch_fail
L_ch_missbF1:
    s_mov_b32 s27, 0
    s_sub_u32 s30, s37, 2048
    s_add_u32 s31, s30, 4096
    s_waitcnt lgkmcnt(0)
    ds_read_b128 v[40:43], v2 offset:0
    ds_read_b128 v[44:47], v2 offset:1024
    ds_read_b128 v[48:51], v2 offset:2048
    ds_read_b128 v[52:55], v2 offset:3072
    ds_read_b128 v[56:59], v2 offset:4096
    ds_read_b128 v[60:63], v2 offset:5120
    ds_read_b128 v[64:67], v2 offset:6144
    ds_read_b128 v[68:71], v2 offset:7168
    s_waitcnt lgkmcnt(0)
    ds_read_b128 v[104:107], v3 offset:0
    ds_read_b128 v[108:111], v3 offset:1024
    ds_read_b128 v[112:115], v3 offset:2048
    ds_read_b128 v[116:119], v3 offset:3072
    ds_read_b128 v[120:123], v3 offset:4096
    ds_read_b128 v[124:127], v3 offset:5120
    ds_read_b128 v[128:131], v3 offset:6144
    ds_read_b128 v[132:135], v3 offset:7168
    ds_read_b128 v[136:139], v3 offset:8192
    ds_read_b128 v[140:143], v3 offset:9216
    s_branch L_ch_chkbF1
L_ch_pollbF1:
    buffer_load_dwordx4 v[40:43], v2, s[8:11], s30 offen offset:0 sc1
    buffer_load_dwordx4 v[44:47], v2, s[8:11], s30 offen offset:1024 sc1
    buffer_load_dwordx4 v[48:51], v2, s[8:11], s30 offen offset:2048 sc1
    buffer_load_dwordx4 v[52:55], v2, s[8:11], s30 offen offset:3072 sc1
    buffer_load_dwordx4 v[56:59], v2, s[8:11], s31 offen offset:0 sc1
    buffer_load_dwordx4 v[60:63], v2, s[8:11], s31 offen offset:1024 sc1
    buffer_load_dwordx4 v[64:67], v2, s[8:11], s31 offen offset:2048 sc1
    buffer_load_dwordx4 v[68:71], v2, s[8:11], s31 offen offset:3072 sc1
    s_add_u32 s27, s27, 1
    s_cmp_lt_u32 s27, 200000
    s_cbranch_scc0 L_ch_fail
    s_waitcnt vmcnt(0)
L_ch_chkbF1:
    v_max_u32 v23, v40, v41
    v_max3_u32 v23, v23, v42, v43
    v_max3_u32 v23, v23, v44, v45
    v_max3_u32 v23, v23, v46, v47
    v_max3_u32 v23, v23, v48, v49
    v_max3_u32 v23, v23, v50, v51
    v_max3_u32 v23, v23, v52, v53
    v_max3_u32 v23, v23, v54, v55
    v_max3_u32 v23, v23, v56, v57
    v_max3_u32 v23, v23, v58, v59
    v_max3_u32 v23, v23, v60, v61
    v_max3_u32 v23, v23, v62, v63
    v_max3_u32 v23, v23, v64, v65
    v_max3_u32 v23, v23, v66, v67
    v_max3_u32 v23, v23, v68, v69
    v_max3_u32 v23, v23, v70, v71
    v_cmp_eq_u32 vcc, -1, v23
    s_cbranch_vccnz L_ch_pollbF1
    v_mov_b64 v[72:73], 0
    v_mov_b64 v[74:75], 0
    v_mov_b64 v[76:77], 0
    v_mov_b64 v[78:79], 0
    v_mov_b64 v[80:81], 0
    v_mov_b64 v[82:83], 0
    v_mov_b64 v[84:85], 0
    v_mov_b64 v[86:87], 0
    s_waitcnt lgkmcnt(0)
    s_nop 0
    v_smfmac_f32_16x16x64_bf16 v[72:75], v[40:43], v[104:111], v1
    v_smfmac_f32_16x16x64_bf16 v[76:79], v[40:43], v[112:119], v1
    v_smfmac_f32_16x16x64_bf16 v[72:75], v[44:47], v[120:127], v1
    v_smfmac_f32_16x16x64_bf16 v[76:79], v[44:47], v[128:135], v1
    v_smfmac_f32_16x16x64_bf16 v[72:75], v[48:51], v[136:143], v1
    v_smfmac_f32_16x16x64_bf16 v[76:79], v[48:51], a[248:255], v1
    v_smfmac_f32_16x16x64_bf16 v[72:75], v[52:55], a[240:247], v1
    v_smfmac_f32_16x16x64_bf16 v[76:79], v[52:55], a[232:239], v1
    ds_read_b128 v[104:107], v3 offset:10240
    v_smfmac_f32_16x16x64_bf16 v[72:75], v[56:59], a[224:231], v1
    v_smfmac_f32_16x16x64_bf16 v[72:75], v[60:63], a[208:215], v1
    ds_read_b128 v[108:111], v3 offset:11264
    v_smfmac_f32_16x16x64_bf16 v[72:75], v[64:67], a[192:199], v1
    v_smfmac_f32_16x16x64_bf16 v[72:75], v[68:71], a[176:183], v1
    ds_read_b128 v[112:115], v3 offset:12288
    v_smfmac_f32_16x16x64_bf16 v[76:79], v[56:59], a[216:223], v1
    ds_read_b128 v[116:119], v3 offset:13312
    v_smfmac_f32_16x16x64_bf16 v[76:79], v[60:63], a[200:207], v1
    v_add_f32 v72, v72, v74
    v_smfmac_f32_16x16x64_bf16 v[76:79], v[64:67], a[184:191], v1
    ds_read_b128 v[120:123], v3 offset:14336
    v_add_f32 v73, v73, v75
    v_smfmac_f32_16x16x64_bf16 v[76:79], v[68:71], a[168:175], v1
    v_cmp_u_f32 vcc, v72, v73
    v_smfmac_f32_16x16x64_bf16 v[80:83], v[40:43], a[160:167], v1
    ds_read_b128 v[124:127], v3 offset:15360
    v_mul_f32 v72, s45, v72
    v_mul_f32 v73, s45, v73
    v_smfmac_f32_16x16x64_bf16 v[84:87], v[40:43], a[152:159], v1
    s_branch L_ch_okbF1
L_ch_lastF1:
    ds_read_b64 v[90:91], v10 offset:8704
    s_waitcnt lgkmcnt(0)
    v_min_u32 v88, -2, v88
    v_min_u32 v89, -2, v89
    v_min_u32 v90, -2, v90
    v_min_u32 v91, -2, v91
    buffer_store_dwordx2 v[90:91], v10, s[8:11], s56 offen offset:512 sc1
    buffer_store_dwordx2 v[88:89], v10, s[8:11], s56 offen offset:2560 sc1
    s_sub_u32 s35, s35, 1
    s_waitcnt vmcnt(0) lgkmcnt(0)
    s_barrier
    s_add_u32 s33, s33, 1
    s_cmp_lt_u32 s33, 2
    s_cbranch_scc1 L_ch_layerF1
    s_endpgm
L_ch_safeF1:
    s_cmp_eq_u32 s34, 63
    s_cbranch_scc1 L_ch_lastF1
    v_max3_f32 v133, v96, v97, v100
    v_max_f32 v133, v133, v101
    v_mov_b32 v135, v133
    s_nop 1
    v_permlane16_swap_b32 v133, v135
    s_nop 1
    v_max_f32 v133, v133, v135
    v_mov_b32 v135, v133
    s_nop 1
    v_permlane32_swap_b32 v133, v135
    s_nop 1
    v_max_f32 v133, v133, v135
    ds_write_b32 v2, v133 offset:4100
    s_waitcnt lgkmcnt(0)
    s_barrier
    ds_read_b128 v[128:131], v2 offset:4096
    s_waitcnt lgkmcnt(0)
    v_max3_f32 v133, v128, v129, v130
    v_max_f32 v133, v133, v131
    v_sub_f32 v98, v96, v133
    v_exp_f32 v98, v98
    v_sub_f32 v99, v97, v133
    v_exp_f32 v99, v99
    v_sub_f32 v102, v100, v133
    v_exp_f32 v102, v102
    v_sub_f32 v103, v101, v133
    v_exp_f32 v103, v103
    s_nop 0
    v_cvt_pk_bf16_f32 v98, v98, v99
    v_cvt_pk_bf16_f32 v20, v102, v103
    v_cvt_pk_bf16_f32 v23, v102, v103
    ds_write_b32 v2, v98 offset:10244
    s_waitcnt lgkmcnt(0)
    s_barrier
    ds_read_b128 v[128:131], v2 offset:10240
    s_waitcnt lgkmcnt(0)
    v_mfma_f32_16x16x32_bf16 v[132:135], v[16:19], v[128:131], 0
    v_mfma_f32_16x16x32_bf16 v[136:139], v[32:35], v[128:131], 0
    v_mfma_f32_16x16x32_bf16 v[140:143], v[36:39], v[128:131], 0
    s_nop 7
    v_mfma_f32_16x16x16_bf16 v[132:135], v[16:17], v[20:21], v[132:135]
    v_mfma_f32_16x16x16_bf16 v[136:139], v[88:89], v[20:21], v[136:139]
    v_mfma_f32_16x16x16_bf16 v[140:143], v[88:89], v[22:23], v[140:143]
    s_nop 7
    v_rcp_f32 v134, v132
    s_mov_b64 vcc, 0
    s_branch L_ch_normF1
L_ch_layerF2:
    s_mov_b32 s30, 0
    s_mul_i32 s41, s32, 24576
    s_add_u32 s41, s41, s30
    s_add_u32 s41, s41, 1048576
    s_lshl_b32 s56, s32, 12
    s_add_u32 s56, s56, 61341696
    s_mul_i32 s42, s32, 4096
    s_add_u32 s42, s42, s30
    s_add_u32 s42, s42, 52428800
    s_lshl_b32 s43, s33, 7
    s_add_u32 s43, s43, 1
    s_mov_b32 s34, 0
    s_mov_b32 m0, 4096
    v_bfe_u32 v48, v2, 6, 2
    v_bfe_u32 v49, v2, 4, 1
    v_lshl_add_u32 v48, v48, 1, v49
    v_lshlrev_b32 v48, 10, v48
    v_lshrrev_b32 v49, 8, v2
    v_lshl_add_u32 v48, v49, 7, v48
    v_bfe_u32 v49, v2, 5, 1
    v_lshl_add_u32 v48, v49, 6, v48
    v_add_u32 v48, 8, v48
    buffer_load_dword v40, v48, s[12:15], 0 offen offset:0
    buffer_load_dword v41, v48, s[12:15], 0 offen offset:16
    buffer_load_dword v42, v48, s[12:15], 0 offen offset:32
    buffer_load_dword v43, v48, s[12:15], 0 offen offset:48
    buffer_load_dword v44, v48, s[12:15], 0 offen offset:512
    buffer_load_dword v45, v48, s[12:15], 0 offen offset:528
    buffer_load_dword v46, v48, s[12:15], 0 offen offset:544
    buffer_load_dword v47, v48, s[12:15], 0 offen offset:560
    v_mov_b64 v[72:73], 0
    v_mov_b64 v[74:75], 0
    v_mov_b64 v[76:77], 0
    v_mov_b64 v[78:79], 0
    v_mov_b64 v[80:81], 0
    v_mov_b64 v[82:83], 0
    v_mov_b64 v[84:85], 0
    v_mov_b64 v[86:87], 0
    v_mov_b64 v[88:89], 0
    v_mov_b64 v[90:91], 0
    v_mov_b64 v[92:93], 0
    v_mov_b64 v[94:95], 0
    v_mov_b64 v[96:97], 0
    v_mov_b64 v[98:99], 0
    v_mov_b64 v[100:101], 0
    v_mov_b64 v[102:103], 0
    ds_read_b128 v[104:107], v3 offset:0
    ds_read_b128 v[108:111], v3 offset:1024
    ds_read_b128 v[112:115], v3 offset:2048
    ds_read_b128 v[116:119], v3 offset:3072
    ds_read_b128 v[120:123], v3 offset:4096
    ds_read_b128 v[124:127], v3 offset:5120
    ds_read_b128 v[128:131], v3 offset:6144
    ds_read_b128 v[132:135], v3 offset:7168
    ds_read_b128 v[136:139], v3 offset:8192
    ds_read_b128 v[140:143], v3 offset:9216
    s_waitcnt vmcnt(0)
    v_min_u32 v40, -2, v40
    v_min_u32 v41, -2, v41
    v_min_u32 v42, -2, v42
    v_min_u32 v43, -2, v43
    v_min_u32 v44, -2, v44
    v_min_u32 v45, -2, v45
    v_min_u32 v46, -2, v46
    v_min_u32 v47, -2, v47
    ds_write_b128 v2, v[40:43] offset:4096
    ds_write_b128 v2, v[44:47] offset:5120
    s_mov_b32 s27, 0
L_poll_16:
    buffer_load_dword v14, v11, s[8:11], s46 offen sc1
    s_waitcnt vmcnt(0)
    v_cmp_gt_u32 vcc, s43, v14
    s_cbranch_vccz L_pollok_17
    s_sleep 1
    s_add_u32 s27, s27, 1
    s_cmp_lt_u32 s27, 200000
    s_cbranch_scc1 L_poll_16
    s_branch L_ch_fail
L_pollok_17:
    buffer_load_dwordx4 v[24:27], v9, s[8:11], s41 offen sc1
    buffer_load_dwordx4 v[28:31], v9, s[8:11], s41 offen offset:2048 sc1
    s_add_u32 s35, s35, 1
    s_and_b32 s36, s35, 1
    s_xor_b32 s36, s36, 1
    s_add_u32 s30, s35, 3
    s_and_b32 s30, s30, 3
    s_lshl_b32 s30, s30, 13
    s_add_u32 s57, s30, s40
    s_xor_b32 s30, s30, 0x4000
    s_add_u32 s38, s30, s40
    s_add_u32 s44, s44, 1
    s_add_u32 s51, s41, 18432
    s_add_u32 s3, s51, 4096
    s_add_u32 s41, s41, 786432
    s_add_u32 s43, s43, 1
    v_mov_b32 v32, -1
    s_waitcnt lgkmcnt(0)
    s_branch L_ch_inF2
L_ch_stepF2:
    s_waitcnt vmcnt(5)
    v_cmp_gt_u32 vcc, v13, v32
    s_cbranch_vccnz L_ch_hmissF2
L_ch_hokF2:
    s_waitcnt vmcnt(3)

L_ch_inF2:
    s_barrier
    ds_read_b128 v[40:43], v2 offset:0
    ds_read_b128 v[44:47], v2 offset:1024
    ds_read_b128 v[48:51], v2 offset:2048
    buffer_load_dwordx4 v[32:35], v2, s[8:11], s51 offen sc1
    s_waitcnt lgkmcnt(2)
    v_smfmac_f32_16x16x64_bf16 v[72:75], v[40:43], v[104:111], v1
    ds_read_b128 v[52:55], v2 offset:3072
    v_smfmac_f32_16x16x64_bf16 v[76:79], v[40:43], v[112:119], v1
    ds_read_b128 v[56:59], v2 offset:4096
    s_waitcnt lgkmcnt(3)
    v_smfmac_f32_16x16x64_bf16 v[72:75], v[44:47], v[120:127], v1
    buffer_load_dwordx4 v[36:39], v2, s[8:11], s3 offen sc1
    v_smfmac_f32_16x16x64_bf16 v[76:79], v[44:47], v[128:135], v1
    ds_read_b128 v[60:63], v2 offset:5120
    s_waitcnt lgkmcnt(3)
    v_smfmac_f32_16x16x64_bf16 v[72:75], v[48:51], v[136:143], v1
    ds_read_b128 v[64:67], v2 offset:6144
    v_smfmac_f32_16x16x64_bf16 v[76:79], v[48:51], a[248:255], v1
    s_waitcnt lgkmcnt(3)
    v_smfmac_f32_16x16x64_bf16 v[72:75], v[52:55], a[240:247], v1
    ds_read_b128 v[68:71], v2 offset:7168
    v_smfmac_f32_16x16x64_bf16 v[76:79], v[52:55], a[232:239], v1
    ds_read_b128 v[104:107], v3 offset:10240
    s_waitcnt lgkmcnt(4)
    v_smfmac_f32_16x16x64_bf16 v[72:75], v[56:59], a[224:231], v1
    buffer_store_dwordx2 v[88:89], v10, s[8:11], s56 offen offset:3072 sc1
    s_waitcnt lgkmcnt(3)
    v_smfmac_f32_16x16x64_bf16 v[72:75], v[60:63], a[208:215], v1
    ds_read_b128 v[108:111], v3 offset:11264
    s_waitcnt lgkmcnt(3)
    v_smfmac_f32_16x16x64_bf16 v[72:75], v[64:67], a[192:199], v1
    s_waitcnt lgkmcnt(2)
    v_smfmac_f32_16x16x64_bf16 v[72:75], v[68:71], a[176:183], v1
    ds_read_b128 v[112:115], v3 offset:12288
    v_smfmac_f32_16x16x64_bf16 v[76:79], v[56:59], a[216:223], v1
    ds_read_b128 v[116:119], v3 offset:13312
    v_smfmac_f32_16x16x64_bf16 v[76:79], v[60:63], a[200:207], v1
    buffer_store_dwordx2 v[90:91], v10, s[8:11], s56 offen offset:1024 sc1
    v_add_f32 v72, v72, v74
    v_smfmac_f32_16x16x64_bf16 v[76:79], v[64:67], a[184:191], v1
    ds_read_b128 v[120:123], v3 offset:14336
    v_add_f32 v73, v73, v75
    v_smfmac_f32_16x16x64_bf16 v[76:79], v[68:71], a[168:175], v1
    v_cmp_u_f32 vcc, v72, v73
    v_smfmac_f32_16x16x64_bf16 v[80:83], v[40:43], a[160:167], v1
    ds_read_b128 v[124:127], v3 offset:15360
    v_mul_f32 v72, s45, v72
    v_mul_f32 v73, s45, v73
    v_smfmac_f32_16x16x64_bf16 v[84:87], v[40:43], a[152:159], v1
    s_cbranch_vccnz L_ch_missbF2
L_ch_okbF2:
    s_waitcnt lgkmcnt(4)
    v_add_f32 v76, v76, v78
    v_add_f32 v77, v77, v79
    v_smfmac_f32_16x16x64_bf16 v[80:83], v[44:47], v[104:111], v1
    ds_read_b128 v[128:131], v3 offset:16384
    v_mul_f32 v76, s45, v76
    v_mul_f32 v77, s45, v77
    v_smfmac_f32_16x16x64_bf16 v[84:87], v[44:47], a[144:151], v1
    s_waitcnt lgkmcnt(3)
    v_cvt_pk_bf16_f32 v72, v72, v76
    v_cvt_pk_bf16_f32 v73, v73, v77
    v_smfmac_f32_16x16x64_bf16 v[80:83], v[48:51], v[112:119], v1
    ds_write2_b32 v4, v72, v73 offset1:4
    v_smfmac_f32_16x16x64_bf16 v[84:87], v[48:51], a[136:143], v1
    ds_read_b128 v[132:135], v3 offset:17408
    v_mov_b64 v[74:75], 0
    v_smfmac_f32_16x16x64_bf16 v[80:83], v[52:55], a[128:135], v1
    ds_read_b128 v[136:139], v3 offset:18432
    v_mov_b64 v[76:77], 0
    v_smfmac_f32_16x16x64_bf16 v[84:87], v[52:55], a[120:127], v1
    ds_read_b128 v[140:143], v3 offset:19456
    v_mov_b64 v[78:79], 0
    v_smfmac_f32_16x16x64_bf16 v[80:83], v[56:59], a[112:119], v1
    s_waitcnt lgkmcnt(3)
    s_barrier
    v_smfmac_f32_16x16x64_bf16 v[80:83], v[60:63], a[96:103], v1
    ds_read_b128 v[104:107], v6 offset:12288
    v_mov_b64 v[72:73], 0
    v_smfmac_f32_16x16x64_bf16 v[80:83], v[64:67], a[88:95], v1
    ds_read_b128 v[108:111], v6 offset:12864
    v_smfmac_f32_16x16x64_bf16 v[80:83], v[68:71], a[80:87], v1
    ds_read_b128 v[112:115], v6 offset:13440
    v_mov_b64 v[88:89], 0
    v_smfmac_f32_16x16x64_bf16 v[84:87], v[56:59], a[104:111], v1
    ds_read_b128 v[116:119], v6 offset:14016
    v_mov_b64 v[90:91], 0
    v_smfmac_f32_16x16x64_bf16 v[84:87], v[60:63], v[120:127], v1
    s_waitcnt vmcnt(4)
    s_waitcnt lgkmcnt(6)
    v_add_f32 v80, v80, v82
    v_smfmac_f32_16x16x64_bf16 v[84:87], v[64:67], v[128:135], v1
    s_waitcnt lgkmcnt(4)
    v_add_f32 v81, v81, v83
    v_smfmac_f32_16x16x64_bf16 v[84:87], v[68:71], v[136:143], v1
    s_mov_b32 s56, s42
    s_waitcnt lgkmcnt(2)
    v_smfmac_f32_16x16x64_bf16 v[96:99], v[24:27], v[104:111], v1
    s_mov_b32 s37, s57
    s_waitcnt lgkmcnt(0)
    v_smfmac_f32_16x16x64_bf16 v[96:99], v[28:31], v[112:119], v1
    v_add_f32 v84, v84, v86
    v_add_f32 v85, v85, v87
    v_smfmac_f32_16x16x64_bf16 v[88:91], v[40:43], a[72:79], v1
    buffer_load_dwordx4 v[24:27], v9, s[8:11], s41 offen sc1
    v_cvt_pk_bf16_f32 v80, v80, v84
    v_cvt_pk_bf16_f32 v81, v81, v85
    v_smfmac_f32_16x16x64_bf16 v[92:95], v[40:43], a[64:71], v1
    ds_write2_b32 v5, v80, v81 offset1:4
    v_add_f32 v96, v96, v98
    v_add_f32 v97, v97, v99
    v_smfmac_f32_16x16x64_bf16 v[88:91], v[44:47], a[56:63], v1
    buffer_load_dwordx4 v[28:31], v9, s[8:11], s41 offen offset:2048 sc1
    v_exp_f32 v98, v96
    v_exp_f32 v99, v97
    v_mov_b64 v[82:83], 0
    v_cvt_pk_bf16_f32 v98, v98, v99
    v_smfmac_f32_16x16x64_bf16 v[92:95], v[44:47], a[48:55], v1
    ds_write_b32 v2, v98 offset:10248
    v_smfmac_f32_16x16x64_bf16 v[88:91], v[48:51], a[40:47], v1
    buffer_store_dword v15, v8, s[8:11], s38 offen
    v_mov_b64 v[84:85], 0
    v_smfmac_f32_16x16x64_bf16 v[92:95], v[48:51], a[32:39], v1
    ds_read_b128 v[40:43], v3 offset:20480
    v_mov_b64 v[86:87], 0
    v_smfmac_f32_16x16x64_bf16 v[88:91], v[52:55], a[24:31], v1
    ds_read_b128 v[44:47], v3 offset:21504
    v_mov_b64 v[80:81], 0
    v_smfmac_f32_16x16x64_bf16 v[92:95], v[52:55], a[16:23], v1
    s_waitcnt lgkmcnt(2)
    s_barrier
    ds_read_b128 v[120:123], v2 offset:8192
    v_smfmac_f32_16x16x64_bf16 v[88:91], v[56:59], a[8:15], v1
    ds_read_b128 v[124:127], v2 offset:9216
    v_smfmac_f32_16x16x64_bf16 v[88:91], v[60:63], v[248:255], v1
    ds_read_b128 v[128:131], v2 offset:10240
    v_smfmac_f32_16x16x64_bf16 v[88:91], v[64:67], v[232:239], v1
    v_smfmac_f32_16x16x64_bf16 v[88:91], v[68:71], v[216:223], v1
    ds_read_b128 v[48:51], v3 offset:22528
    s_waitcnt lgkmcnt(3)
    v_smfmac_f32_16x16x64_bf16 v[100:103], v[120:123], v[104:111], v1
    ds_read_b128 v[52:55], v3 offset:23552
    s_waitcnt lgkmcnt(3)
    v_smfmac_f32_16x16x64_bf16 v[100:103], v[124:127], v[112:119], v1
    s_waitcnt lgkmcnt(2)
    v_add_f32 v88, v88, v90
    v_mfma_f32_16x16x32_bf16 v[132:135], v[16:19], v[128:131], 0
    ds_read_b128 v[104:107], v3 offset:24576
    v_add_f32 v89, v89, v91
    v_cvt_pk_bf16_f32 v88, v88, v89
    v_smfmac_f32_16x16x64_bf16 v[92:95], v[56:59], a[0:7], v1
    ds_read_b128 v[108:111], v3 offset:25600
    v_add_f32 v100, v100, v102
    v_add_f32 v101, v101, v103
    v_smfmac_f32_16x16x64_bf16 v[92:95], v[60:63], v[240:247], v1
    ds_read_b128 v[112:115], v3 offset:26624
    v_exp_f32 v102, v100
    v_smfmac_f32_16x16x64_bf16 v[92:95], v[64:67], v[224:231], v1
    ds_read_b128 v[116:119], v3 offset:27648
    v_exp_f32 v103, v101
    v_smfmac_f32_16x16x64_bf16 v[92:95], v[68:71], v[208:215], v1
    s_waitcnt vmcnt(5)
    s_cmp_eq_u32 s34, 63
    v_cvt_pk_bf16_f32 v20, v102, v103
    v_swap_b32 v34, v36
    v_swap_b32 v35, v37
    v_mfma_f32_16x16x16_bf16 v[132:135], v[16:17], v[20:21], v[132:135]
    s_cselect_b32 s30, 0, s55
    v_add_f32 v92, v92, v94
    v_add_f32 v93, v93, v95
    v_mfma_f32_16x16x32_bf16 v[136:139], v[32:35], v[128:131], 0
    ds_read_b128 v[120:123], v3 offset:28672
    v_cvt_pk_bf16_f32 v89, v92, v93
    v_mfma_f32_16x16x32_bf16 v[140:143], v[36:39], v[128:131], 0
    ds_read_b128 v[124:127], v3 offset:29696
    v_mov_b32 v23, v20
    s_nop 0
    v_mfma_f32_16x16x16_bf16 v[136:139], v[88:89], v[20:21], v[136:139]
    s_nop 1
    v_mfma_f32_16x16x16_bf16 v[140:143], v[88:89], v[22:23], v[140:143]
    s_nop 0
    v_rcp_f32 v134, v132
    v_subrev_u32 v133, s54, v132
    v_cmp_le_u32 vcc, s30, v133
L_ch_normF2:
    v_mul_f32 v136, v134, v136
    v_mul_f32 v137, v134, v137
    v_mul_f32 v138, v134, v138
    v_mul_f32 v139, v134, v139
    v_mul_f32 v140, v134, v140
    v_mul_f32 v141, v134, v141
    v_mul_f32 v142, v134, v142
    v_mul_f32 v143, v134, v143
    v_cvt_pk_bf16_f32 v136, v136, v140
    v_cvt_pk_bf16_f32 v137, v137, v141
    v_cvt_pk_bf16_f32 v138, v138, v142
    v_cvt_pk_bf16_f32 v139, v139, v143
    ds_write_b128 v2, v[136:139] offset:14336
    s_cbranch_vccnz L_ch_safeF2
    v_smfmac_f32_16x16x64_bf16 v[72:75], v[136:139], v[200:207], v1
    s_add_u32 s34, s34, 1
    s_add_u32 s42, s42, 131072
    v_smfmac_f32_16x16x64_bf16 v[76:79], v[136:139], v[168:175], v1
    s_waitcnt lgkmcnt(0)
    s_barrier
    ds_read_b128 v[140:143], v2 offset:15360
    ds_read_b128 v[96:99], v2 offset:12288
    ds_read_b128 v[100:103], v2 offset:13312
    v_smfmac_f32_16x16x64_bf16 v[80:83], v[136:139], v[152:159], v1
    v_smfmac_f32_16x16x64_bf16 v[84:87], v[136:139], v[144:151], v1
    s_waitcnt lgkmcnt(2)
    v_smfmac_f32_16x16x64_bf16 v[72:75], v[140:143], v[192:199], v1
    ds_read_b128 v[56:59], v3 offset:30720
    s_waitcnt lgkmcnt(2)
    v_smfmac_f32_16x16x64_bf16 v[72:75], v[96:99], v[184:191], v1
    ds_read_b128 v[60:63], v3 offset:31744
    s_waitcnt lgkmcnt(2)
    v_smfmac_f32_16x16x64_bf16 v[72:75], v[100:103], v[176:183], v1
    ds_read_b128 v[64:67], v3 offset:32768
    v_smfmac_f32_16x16x64_bf16 v[76:79], v[140:143], v[160:167], v1
    ds_read_b128 v[68:71], v3 offset:33792
    v_smfmac_f32_16x16x64_bf16 v[76:79], v[96:99], v[40:47], v1
    ds_read_b128 v[128:131], v3 offset:34816
    v_cvt_pk_bf16_f32 v72, v72, v74
    v_cvt_pk_bf16_f32 v73, v73, v75
    v_and_or_b32 v72, v72, -2, s36
    v_smfmac_f32_16x16x64_bf16 v[76:79], v[100:103], v[48:55], v1
    buffer_store_dwordx2 v[72:73], v7, s[8:11], 0 offen offset:0
    v_smfmac_f32_16x16x64_bf16 v[80:83], v[140:143], v[104:111], v1
    ds_read_b128 v[132:135], v3 offset:35840
    v_smfmac_f32_16x16x64_bf16 v[80:83], v[96:99], v[112:119], v1
    v_cvt_pk_bf16_f32 v76, v76, v78
    v_cvt_pk_bf16_f32 v77, v77, v79
    v_and_or_b32 v76, v76, -2, s36
    v_smfmac_f32_16x16x64_bf16 v[80:83], v[100:103], v[120:127], v1
    buffer_store_dwordx2 v[76:77], v7, s[8:11], 0 offen offset:2048
    s_waitcnt lgkmcnt(4)
    v_smfmac_f32_16x16x64_bf16 v[84:87], v[140:143], v[56:63], v1
    s_waitcnt lgkmcnt(2)
    v_smfmac_f32_16x16x64_bf16 v[84:87], v[96:99], v[64:71], v1
    s_waitcnt lgkmcnt(0)
    v_cvt_pk_bf16_f32 v80, v80, v82
    v_cvt_pk_bf16_f32 v81, v81, v83
    v_and_or_b32 v80, v80, -2, s36
    v_smfmac_f32_16x16x64_bf16 v[84:87], v[100:103], v[128:135], v1
    buffer_store_dwordx2 v[80:81], v7, s[8:11], s50 offen offset:0
    ds_read_b128 v[136:139], v2 offset:11264
    s_nop 5
    v_cvt_pk_bf16_f32 v84, v84, v86
    v_cvt_pk_bf16_f32 v85, v85, v87
    v_and_or_b32 v84, v84, -2, s36
    buffer_store_dwordx2 v[84:85], v7, s[8:11], s50 offen offset:2048
    s_barrier
    v_mov_b32 v13, s44
    v_mov_b64 v[72:73], 0
    v_mov_b64 v[74:75], 0
    v_mov_b64 v[76:77], 0
    v_mov_b64 v[78:79], 0
    v_mov_b64 v[80:81], 0
    v_mov_b64 v[82:83], 0
    v_mov_b64 v[92:93], 0
    v_mov_b64 v[94:95], 0
    v_mov_b64 v[96:97], 0
    v_mov_b64 v[98:99], 0
    v_mov_b64 v[100:101], 0
    v_mov_b64 v[102:103], 0
    v_mov_b64 v[84:85], 0
    v_mov_b64 v[86:87], 0
    s_nop 15
    s_nop 5
    buffer_load_dwordx4 v[40:43], v2, s[8:11], s39 offen sc1
    buffer_load_dwordx4 v[44:47], v2, s[8:11], s39 offen offset:1024 sc1
    s_nop 15
    s_nop 15
    s_nop 5
    buffer_load_dwordx4 v[48:51], v2, s[8:11], s39 offen sc1
    buffer_load_dwordx4 v[52:55], v2, s[8:11], s39 offen offset:1024 sc1
    ds_read_b64 v[90:91], v10 offset:9216
    ds_read_b128 v[104:107], v3 offset:0
    ds_read_b128 v[108:111], v3 offset:1024
    ds_read_b128 v[112:115], v3 offset:2048
    ds_read_b128 v[116:119], v3 offset:3072
    ds_read_b128 v[120:123], v3 offset:4096
    ds_read_b128 v[124:127], v3 offset:5120
    ds_read_b128 v[128:131], v3 offset:6144
    ds_read_b128 v[132:135], v3 offset:7168
    s_waitcnt lgkmcnt(9)
    s_waitcnt vmcnt(3)
    v_mfma_f32_16x16x32_bf16 v[140:143], v[136:139], v[40:43], 0
    v_bitop3_b32 v70, v40, v42, s36 bitop3:0x7e
    s_waitcnt vmcnt(2)
    v_mfma_f32_16x16x32_bf16 v[140:143], v[136:139], v[44:47], v[140:143]
    v_bitop3_b32 v71, v44, v46, s36 bitop3:0x7e
    v_bitop3_b32 v70, v70, v71, 1 bitop3:0xa8
    v_cmp_ne_u32 vcc, 0, v70
    s_nop 3
    s_cbranch_vccnz L_ch_missaF2
L_ch_okaF2:
    v_add_f32_dpp v140, v140, v140 row_ror:4 row_mask:0xf bank_mask:0xf
    v_add_f32_dpp v141, v141, v141 row_ror:4 row_mask:0xf bank_mask:0xf
    s_nop 0
    v_add_f32_dpp v140, v140, v140 row_ror:8 row_mask:0xf bank_mask:0xf
    v_add_f32_dpp v141, v141, v141 row_ror:8 row_mask:0xf bank_mask:0xf
    v_cvt_pk_bf16_f32 v70, v140, v141
    v_min_u32 v70, -2, v70
    buffer_store_dword v70, v8, s[8:11], s37 offen
    s_nop 3
    buffer_store_dword v13, v21, s[8:11], s5 offen
    ds_read_b128 v[136:139], v3 offset:8192
    ds_read_b128 v[140:143], v3 offset:9216
    s_nop 15
    s_nop 15
    s_nop 9
    buffer_load_dword v32, v12, s[8:11], s4 offen sc1
    buffer_load_dwordx4 v2, s[8:11], s37 offen sc1 lds
    buffer_load_dwordx4 v2, s[8:11], s37 offen offset:1024 sc1 lds
    s_add_u32 s35, s35, 1
    s_and_b32 s36, s35, 1
    s_xor_b32 s36, s36, 1
    s_add_u32 s30, s35, 3
    s_and_b32 s30, s30, 3
    s_lshl_b32 s30, s30, 13
    s_add_u32 s57, s30, s40
    s_xor_b32 s30, s30, 0x4000
    s_add_u32 s38, s30, s40
    s_add_u32 s44, s44, 1
    s_add_u32 s51, s41, 18432
    s_add_u32 s3, s51, 4096
    s_add_u32 s41, s41, 786432
    s_add_u32 s43, s43, 1
    s_waitcnt lgkmcnt(10)
    v_min_u32 v88, -2, v88
    v_min_u32 v89, -2, v89
    v_min_u32 v90, -2, v90
    v_min_u32 v91, -2, v91
    s_nop 15
    s_nop 0
    buffer_load_dword v33, v12, s[8:11], s4 offen sc1
    buffer_load_dwordx4 v2, s[8:11], s37 offen sc1 lds
    buffer_load_dwordx4 v2, s[8:11], s37 offen offset:1024 sc1 lds
    s_waitcnt lgkmcnt(0)
    s_branch L_ch_stepF2
L_ch_missaF2:
    s_mov_b32 s27, 0
L_ch_pollaF2:
    buffer_load_dwordx4 v[40:43], v2, s[8:11], s39 offen sc1
    buffer_load_dwordx4 v[44:47], v2, s[8:11], s39 offen offset:1024 sc1
    s_waitcnt vmcnt(3)
    v_mfma_f32_16x16x32_bf16 v[140:143], v[136:139], v[48:51], 0
    v_bitop3_b32 v70, v48, v50, s36 bitop3:0x7e
    s_waitcnt vmcnt(2)
    v_mfma_f32_16x16x32_bf16 v[140:143], v[136:139], v[52:55], v[140:143]
    v_bitop3_b32 v71, v52, v54, s36 bitop3:0x7e
    v_bitop3_b32 v70, v70, v71, 1 bitop3:0xa8
    v_cmp_ne_u32 vcc, 0, v70
    s_nop 3
    s_cbranch_vccz L_ch_okaF2
    buffer_load_dwordx4 v[48:51], v2, s[8:11], s39 offen sc1
    buffer_load_dwordx4 v[52:55], v2, s[8:11], s39 offen offset:1024 sc1
    s_waitcnt vmcnt(3)
    v_mfma_f32_16x16x32_bf16 v[140:143], v[136:139], v[40:43], 0
    v_bitop3_b32 v70, v40, v42, s36 bitop3:0x7e
    s_waitcnt vmcnt(2)
    v_mfma_f32_16x16x32_bf16 v[140:143], v[136:139], v[44:47], v[140:143]
    v_bitop3_b32 v71, v44, v46, s36 bitop3:0x7e
    v_bitop3_b32 v70, v70, v71, 1 bitop3:0xa8
    v_cmp_ne_u32 vcc, 0, v70
    s_nop 3
    s_cbranch_vccz L_ch_okaF2
    s_add_u32 s27, s27, 1
    s_cmp_lt_u32 s27, 200000
    s_cbranch_scc1 L_ch_pollaF2
    s_branch L_ch_fail
L_ch_hmissF2:
    s_mov_b32 s27, 0
L_ch_hpollF2:
    buffer_load_dword v32, v12, s[8:11], s4 offen sc1
    buffer_load_dwordx4 v2, s[8:11], s37 offen sc1 lds
    buffer_load_dwordx4 v2, s[8:11], s37 offen offset:1024 sc1 lds
    s_waitcnt vmcnt(5)
    v_cmp_gt_u32 vcc, v13, v33
    s_cbranch_vccz L_ch_hokF2
    buffer_load_dword v33, v12, s[8:11], s4 offen sc1
    buffer_load_dwordx4 v2, s[8:11], s37 offen sc1 lds
    buffer_load_dwordx4 v2, s[8:11], s37 offen offset:1024 sc1 lds
    s_waitcnt vmcnt(5)
    v_cmp_gt_u32 vcc, v13, v32
    s_cbranch_vccz L_ch_hokF2
    s_add_u32 s27, s27, 1
    s_cmp_lt_u32 s27, 200000
    s_cbranch_scc1 L_ch_hpollF2
    s_branch L_ch_fail
L_ch_missbF2:
    s_mov_b32 s27, 0
    s_sub_u32 s30, s37, 4096
    s_add_u32 s31, s30, 4096
    s_waitcnt lgkmcnt(0)
    ds_read_b128 v[40:43], v2 offset:0
    ds_read_b128 v[44:47], v2 offset:1024
    ds_read_b128 v[48:51], v2 offset:2048
    ds_read_b128 v[52:55], v2 offset:3072
    ds_read_b128 v[56:59], v2 offset:4096
    ds_read_b128 v[60:63], v2 offset:5120
    ds_read_b128 v[64:67], v2 offset:6144
    ds_read_b128 v[68:71], v2 offset:7168
    s_waitcnt lgkmcnt(0)
    ds_read_b128 v[104:107], v3 offset:0
    ds_read_b128 v[108:111], v3 offset:1024
    ds_read_b128 v[112:115], v3 offset:2048
    ds_read_b128 v[116:119], v3 offset:3072
    ds_read_b128 v[120:123], v3 offset:4096
    ds_read_b128 v[124:127], v3 offset:5120
    ds_read_b128 v[128:131], v3 offset:6144
    ds_read_b128 v[132:135], v3 offset:7168
    ds_read_b128 v[136:139], v3 offset:8192
    ds_read_b128 v[140:143], v3 offset:9216
    s_branch L_ch_chkbF2
L_ch_pollbF2:
    buffer_load_dwordx4 v[40:43], v2, s[8:11], s30 offen offset:0 sc1
    buffer_load_dwordx4 v[44:47], v2, s[8:11], s30 offen offset:1024 sc1
    buffer_load_dwordx4 v[48:51], v2, s[8:11], s30 offen offset:2048 sc1
    buffer_load_dwordx4 v[52:55], v2, s[8:11], s30 offen offset:3072 sc1
    buffer_load_dwordx4 v[56:59], v2, s[8:11], s31 offen offset:0 sc1
    buffer_load_dwordx4 v[60:63], v2, s[8:11], s31 offen offset:1024 sc1
    buffer_load_dwordx4 v[64:67], v2, s[8:11], s31 offen offset:2048 sc1
    buffer_load_dwordx4 v[68:71], v2, s[8:11], s31 offen offset:3072 sc1
    s_add_u32 s27, s27, 1
    s_cmp_lt_u32 s27, 200000
    s_cbranch_scc0 L_ch_fail
    s_waitcnt vmcnt(0)
L_ch_chkbF2:
    v_max_u32 v23, v40, v41
    v_max3_u32 v23, v23, v42, v43
    v_max3_u32 v23, v23, v44, v45
    v_max3_u32 v23, v23, v46, v47
    v_max3_u32 v23, v23, v48, v49
    v_max3_u32 v23, v23, v50, v51
    v_max3_u32 v23, v23, v52, v53
    v_max3_u32 v23, v23, v54, v55
    v_max3_u32 v23, v23, v56, v57
    v_max3_u32 v23, v23, v58, v59
    v_max3_u32 v23, v23, v60, v61
    v_max3_u32 v23, v23, v62, v63
    v_max3_u32 v23, v23, v64, v65
    v_max3_u32 v23, v23, v66, v67
    v_max3_u32 v23, v23, v68, v69
    v_max3_u32 v23, v23, v70, v71
    v_cmp_eq_u32 vcc, -1, v23
    s_cbranch_vccnz L_ch_pollbF2
    v_mov_b64 v[72:73], 0
    v_mov_b64 v[74:75], 0
    v_mov_b64 v[76:77], 0
    v_mov_b64 v[78:79], 0
    v_mov_b64 v[80:81], 0
    v_mov_b64 v[82:83], 0
    v_mov_b64 v[84:85], 0
    v_mov_b64 v[86:87], 0
    s_waitcnt lgkmcnt(0)
    s_nop 0
    v_smfmac_f32_16x16x64_bf16 v[72:75], v[40:43], v[104:111], v1
    v_smfmac_f32_16x16x64_bf16 v[76:79], v[40:43], v[112:119], v1
    v_smfmac_f32_16x16x64_bf16 v[72:75], v[44:47], v[120:127], v1
    v_smfmac_f32_16x16x64_bf16 v[76:79], v[44:47], v[128:135], v1
    v_smfmac_f32_16x16x64_bf16 v[72:75], v[48:51], v[136:143], v1
    v_smfmac_f32_16x16x64_bf16 v[76:79], v[48:51], a[248:255], v1
    v_smfmac_f32_16x16x64_bf16 v[72:75], v[52:55], a[240:247], v1
    v_smfmac_f32_16x16x64_bf16 v[76:79], v[52:55], a[232:239], v1
    ds_read_b128 v[104:107], v3 offset:10240
    v_smfmac_f32_16x16x64_bf16 v[72:75], v[56:59], a[224:231], v1
    v_smfmac_f32_16x16x64_bf16 v[72:75], v[60:63], a[208:215], v1
    ds_read_b128 v[108:111], v3 offset:11264
    v_smfmac_f32_16x16x64_bf16 v[72:75], v[64:67], a[192:199], v1
    v_smfmac_f32_16x16x64_bf16 v[72:75], v[68:71], a[176:183], v1
    ds_read_b128 v[112:115], v3 offset:12288
    v_smfmac_f32_16x16x64_bf16 v[76:79], v[56:59], a[216:223], v1
    ds_read_b128 v[116:119], v3 offset:13312
    v_smfmac_f32_16x16x64_bf16 v[76:79], v[60:63], a[200:207], v1
    v_add_f32 v72, v72, v74
    v_smfmac_f32_16x16x64_bf16 v[76:79], v[64:67], a[184:191], v1
    ds_read_b128 v[120:123], v3 offset:14336
    v_add_f32 v73, v73, v75
    v_smfmac_f32_16x16x64_bf16 v[76:79], v[68:71], a[168:175], v1
    v_cmp_u_f32 vcc, v72, v73
    v_smfmac_f32_16x16x64_bf16 v[80:83], v[40:43], a[160:167], v1
    ds_read_b128 v[124:127], v3 offset:15360
    v_mul_f32 v72, s45, v72
    v_mul_f32 v73, s45, v73
    v_smfmac_f32_16x16x64_bf16 v[84:87], v[40:43], a[152:159], v1
    s_branch L_ch_okbF2
L_ch_lastF2:
    ds_read_b64 v[90:91], v10 offset:9216
    s_waitcnt lgkmcnt(0)
    v_min_u32 v88, -2, v88
    v_min_u32 v89, -2, v89
    v_min_u32 v90, -2, v90
    v_min_u32 v91, -2, v91
    buffer_store_dwordx2 v[90:91], v10, s[8:11], s56 offen offset:1024 sc1
    buffer_store_dwordx2 v[88:89], v10, s[8:11], s56 offen offset:3072 sc1
    s_sub_u32 s35, s35, 1
    s_waitcnt vmcnt(0) lgkmcnt(0)
    s_barrier
    s_add_u32 s33, s33, 1
    s_cmp_lt_u32 s33, 2
    s_cbranch_scc1 L_ch_layerF2
    s_endpgm
L_ch_safeF2:
    s_cmp_eq_u32 s34, 63
    s_cbranch_scc1 L_ch_lastF2
    v_max3_f32 v133, v96, v97, v100
    v_max_f32 v133, v133, v101
    v_mov_b32 v135, v133
    s_nop 1
    v_permlane16_swap_b32 v133, v135
    s_nop 1
    v_max_f32 v133, v133, v135
    v_mov_b32 v135, v133
    s_nop 1
    v_permlane32_swap_b32 v133, v135
    s_nop 1
    v_max_f32 v133, v133, v135
    ds_write_b32 v2, v133 offset:4104
    s_waitcnt lgkmcnt(0)
    s_barrier
    ds_read_b128 v[128:131], v2 offset:4096
    s_waitcnt lgkmcnt(0)
    v_max3_f32 v133, v128, v129, v130
    v_max_f32 v133, v133, v131
    v_sub_f32 v98, v96, v133
    v_exp_f32 v98, v98
    v_sub_f32 v99, v97, v133
    v_exp_f32 v99, v99
    v_sub_f32 v102, v100, v133
    v_exp_f32 v102, v102
    v_sub_f32 v103, v101, v133
    v_exp_f32 v103, v103
    s_nop 0
    v_cvt_pk_bf16_f32 v98, v98, v99
    v_cvt_pk_bf16_f32 v20, v102, v103
    v_cvt_pk_bf16_f32 v23, v102, v103
    ds_write_b32 v2, v98 offset:10248
    s_waitcnt lgkmcnt(0)
    s_barrier
    ds_read_b128 v[128:131], v2 offset:10240
    s_waitcnt lgkmcnt(0)
    v_mfma_f32_16x16x32_bf16 v[132:135], v[16:19], v[128:131], 0
    v_mfma_f32_16x16x32_bf16 v[136:139], v[32:35], v[128:131], 0
    v_mfma_f32_16x16x32_bf16 v[140:143], v[36:39], v[128:131], 0
    s_nop 7
    v_mfma_f32_16x16x16_bf16 v[132:135], v[16:17], v[20:21], v[132:135]
    v_mfma_f32_16x16x16_bf16 v[136:139], v[88:89], v[20:21], v[136:139]
    v_mfma_f32_16x16x16_bf16 v[140:143], v[88:89], v[22:23], v[140:143]
    s_nop 7
    v_rcp_f32 v134, v132
    s_mov_b64 vcc, 0
    s_branch L_ch_normF2
L_ch_layerF3:
    s_mov_b32 s30, 0
    s_mul_i32 s41, s32, 24576
    s_add_u32 s41, s41, s30
    s_add_u32 s41, s41, 1048576
    s_lshl_b32 s56, s32, 12
    s_add_u32 s56, s56, 61341696
    s_mul_i32 s42, s32, 4096
    s_add_u32 s42, s42, s30
    s_add_u32 s42, s42, 52428800
    s_lshl_b32 s43, s33, 7
    s_add_u32 s43, s43, 1
    s_mov_b32 s34, 0
    s_mov_b32 m0, 6144
    v_bfe_u32 v48, v2, 6, 2
    v_bfe_u32 v49, v2, 4, 1
    v_lshl_add_u32 v48, v48, 1, v49
    v_lshlrev_b32 v48, 10, v48
    v_lshrrev_b32 v49, 8, v2
    v_lshl_add_u32 v48, v49, 7, v48
    v_bfe_u32 v49, v2, 5, 1
    v_lshl_add_u32 v48, v49, 6, v48
    v_add_u32 v48, 12, v48
    buffer_load_dword v40, v48, s[12:15], 0 offen offset:0
    buffer_load_dword v41, v48, s[12:15], 0 offen offset:16
    buffer_load_dword v42, v48, s[12:15], 0 offen offset:32
    buffer_load_dword v43, v48, s[12:15], 0 offen offset:48
    buffer_load_dword v44, v48, s[12:15], 0 offen offset:512
    buffer_load_dword v45, v48, s[12:15], 0 offen offset:528
    buffer_load_dword v46, v48, s[12:15], 0 offen offset:544
    buffer_load_dword v47, v48, s[12:15], 0 offen offset:560
    v_mov_b64 v[72:73], 0
    v_mov_b64 v[74:75], 0
    v_mov_b64 v[76:77], 0
    v_mov_b64 v[78:79], 0
    v_mov_b64 v[80:81], 0
    v_mov_b64 v[82:83], 0
    v_mov_b64 v[84:85], 0
    v_mov_b64 v[86:87], 0
    v_mov_b64 v[88:89], 0
    v_mov_b64 v[90:91], 0
    v_mov_b64 v[92:93], 0
    v_mov_b64 v[94:95], 0
    v_mov_b64 v[96:97], 0
    v_mov_b64 v[98:99], 0
    v_mov_b64 v[100:101], 0
    v_mov_b64 v[102:103], 0
    ds_read_b128 v[104:107], v3 offset:0
    ds_read_b128 v[108:111], v3 offset:1024
    ds_read_b128 v[112:115], v3 offset:2048
    ds_read_b128 v[116:119], v3 offset:3072
    ds_read_b128 v[120:123], v3 offset:4096
    ds_read_b128 v[124:127], v3 offset:5120
    ds_read_b128 v[128:131], v3 offset:6144
    ds_read_b128 v[132:135], v3 offset:7168
    ds_read_b128 v[136:139], v3 offset:8192
    ds_read_b128 v[140:143], v3 offset:9216
    s_waitcnt vmcnt(0)
    v_min_u32 v40, -2, v40
    v_min_u32 v41, -2, v41
    v_min_u32 v42, -2, v42
    v_min_u32 v43, -2, v43
    v_min_u32 v44, -2, v44
    v_min_u32 v45, -2, v45
    v_min_u32 v46, -2, v46
    v_min_u32 v47, -2, v47
    ds_write_b128 v2, v[40:43] offset:6144
    ds_write_b128 v2, v[44:47] offset:7168
    s_mov_b32 s27, 0
L_poll_18:
    buffer_load_dword v14, v11, s[8:11], s46 offen sc1
    s_waitcnt vmcnt(0)
    v_cmp_gt_u32 vcc, s43, v14
    s_cbranch_vccz L_pollok_19
    s_sleep 1
    s_add_u32 s27, s27, 1
    s_cmp_lt_u32 s27, 200000
    s_cbranch_scc1 L_poll_18
    s_branch L_ch_fail
L_pollok_19:
    buffer_load_dwordx4 v[24:27], v9, s[8:11], s41 offen sc1
    buffer_load_dwordx4 v[28:31], v9, s[8:11], s41 offen offset:2048 sc1
    s_add_u32 s35, s35, 1
    s_and_b32 s36, s35, 1
    s_xor_b32 s36, s36, 1
    s_add_u32 s30, s35, 3
    s_and_b32 s30, s30, 3
    s_lshl_b32 s30, s30, 13
    s_add_u32 s57, s30, s40
    s_xor_b32 s30, s30, 0x4000
    s_add_u32 s38, s30, s40
    s_add_u32 s44, s44, 1
    s_add_u32 s51, s41, 19456
    s_add_u32 s3, s51, 4096
    s_add_u32 s41, s41, 786432
    s_add_u32 s43, s43, 1
    v_mov_b32 v32, -1
    s_waitcnt lgkmcnt(0)
    s_branch L_ch_inF3
L_ch_stepF3:
    s_waitcnt vmcnt(5)
    v_cmp_gt_u32 vcc, v13, v32
    s_cbranch_vccnz L_ch_hmissF3
L_ch_hokF3:
    s_waitcnt vmcnt(3)

L_ch_inF3:
    s_barrier
    ds_read_b128 v[40:43], v2 offset:0
    ds_read_b128 v[44:47], v2 offset:1024
    ds_read_b128 v[48:51], v2 offset:2048
    buffer_load_dwordx4 v[32:35], v2, s[8:11], s51 offen sc1
    s_waitcnt lgkmcnt(2)
    v_smfmac_f32_16x16x64_bf16 v[72:75], v[40:43], v[104:111], v1
    ds_read_b128 v[52:55], v2 offset:3072
    v_smfmac_f32_16x16x64_bf16 v[76:79], v[40:43], v[112:119], v1
    ds_read_b128 v[56:59], v2 offset:4096
    s_waitcnt lgkmcnt(3)
    v_smfmac_f32_16x16x64_bf16 v[72:75], v[44:47], v[120:127], v1
    buffer_load_dwordx4 v[36:39], v2, s[8:11], s3 offen sc1
    v_smfmac_f32_16x16x64_bf16 v[76:79], v[44:47], v[128:135], v1
    ds_read_b128 v[60:63], v2 offset:5120
    s_waitcnt lgkmcnt(3)
    v_smfmac_f32_16x16x64_bf16 v[72:75], v[48:51], v[136:143], v1
    ds_read_b128 v[64:67], v2 offset:6144
    v_smfmac_f32_16x16x64_bf16 v[76:79], v[48:51], a[248:255], v1
    s_waitcnt lgkmcnt(3)
    v_smfmac_f32_16x16x64_bf16 v[72:75], v[52:55], a[240:247], v1
    ds_read_b128 v[68:71], v2 offset:7168
    v_smfmac_f32_16x16x64_bf16 v[76:79], v[52:55], a[232:239], v1
    ds_read_b128 v[104:107], v3 offset:10240
    s_waitcnt lgkmcnt(4)
    v_smfmac_f32_16x16x64_bf16 v[72:75], v[56:59], a[224:231], v1
    s_waitcnt lgkmcnt(3)
    v_smfmac_f32_16x16x64_bf16 v[72:75], v[60:63], a[208:215], v1
    ds_read_b128 v[108:111], v3 offset:11264
    s_waitcnt lgkmcnt(3)
    v_smfmac_f32_16x16x64_bf16 v[72:75], v[64:67], a[192:199], v1
    buffer_store_dwordx2 v[88:89], v10, s[8:11], s56 offen offset:3584 sc1
    s_waitcnt lgkmcnt(2)
    v_smfmac_f32_16x16x64_bf16 v[72:75], v[68:71], a[176:183], v1
    ds_read_b128 v[112:115], v3 offset:12288
    v_smfmac_f32_16x16x64_bf16 v[76:79], v[56:59], a[216:223], v1
    ds_read_b128 v[116:119], v3 offset:13312
    v_smfmac_f32_16x16x64_bf16 v[76:79], v[60:63], a[200:207], v1
    v_add_f32 v72, v72, v74
    v_smfmac_f32_16x16x64_bf16 v[76:79], v[64:67], a[184:191], v1
    ds_read_b128 v[120:123], v3 offset:14336
    v_add_f32 v73, v73, v75
    v_smfmac_f32_16x16x64_bf16 v[76:79], v[68:71], a[168:175], v1
    buffer_store_dwordx2 v[90:91], v10, s[8:11], s56 offen offset:1536 sc1
    v_cmp_u_f32 vcc, v72, v73
    v_smfmac_f32_16x16x64_bf16 v[80:83], v[40:43], a[160:167], v1
    ds_read_b128 v[124:127], v3 offset:15360
    v_mul_f32 v72, s45, v72
    v_mul_f32 v73, s45, v73
    v_smfmac_f32_16x16x64_bf16 v[84:87], v[40:43], a[152:159], v1
    s_cbranch_vccnz L_ch_missbF3
L_ch_okbF3:
    s_waitcnt lgkmcnt(4)
    v_add_f32 v76, v76, v78
    v_add_f32 v77, v77, v79
    v_smfmac_f32_16x16x64_bf16 v[80:83], v[44:47], v[104:111], v1
    ds_read_b128 v[128:131], v3 offset:16384
    v_mul_f32 v76, s45, v76
    v_mul_f32 v77, s45, v77
    v_smfmac_f32_16x16x64_bf16 v[84:87], v[44:47], a[144:151], v1
    s_waitcnt lgkmcnt(3)
    v_cvt_pk_bf16_f32 v72, v72, v76
    v_cvt_pk_bf16_f32 v73, v73, v77
    v_smfmac_f32_16x16x64_bf16 v[80:83], v[48:51], v[112:119], v1
    ds_write2_b32 v4, v72, v73 offset1:4
    v_smfmac_f32_16x16x64_bf16 v[84:87], v[48:51], a[136:143], v1
    ds_read_b128 v[132:135], v3 offset:17408
    v_mov_b64 v[74:75], 0
    v_smfmac_f32_16x16x64_bf16 v[80:83], v[52:55], a[128:135], v1
    ds_read_b128 v[136:139], v3 offset:18432
    v_mov_b64 v[76:77], 0
    v_smfmac_f32_16x16x64_bf16 v[84:87], v[52:55], a[120:127], v1
    ds_read_b128 v[140:143], v3 offset:19456
    v_mov_b64 v[78:79], 0
    v_smfmac_f32_16x16x64_bf16 v[80:83], v[56:59], a[112:119], v1
    s_waitcnt lgkmcnt(3)
    s_barrier
    v_smfmac_f32_16x16x64_bf16 v[80:83], v[60:63], a[96:103], v1
    ds_read_b128 v[104:107], v6 offset:12288
    v_mov_b64 v[72:73], 0
    v_smfmac_f32_16x16x64_bf16 v[80:83], v[64:67], a[88:95], v1
    ds_read_b128 v[108:111], v6 offset:12864
    v_smfmac_f32_16x16x64_bf16 v[80:83], v[68:71], a[80:87], v1
    ds_read_b128 v[112:115], v6 offset:13440
    v_mov_b64 v[88:89], 0
    v_smfmac_f32_16x16x64_bf16 v[84:87], v[56:59], a[104:111], v1
    ds_read_b128 v[116:119], v6 offset:14016
    v_mov_b64 v[90:91], 0
    v_smfmac_f32_16x16x64_bf16 v[84:87], v[60:63], v[120:127], v1
    s_waitcnt vmcnt(4)
    s_waitcnt lgkmcnt(6)
    v_add_f32 v80, v80, v82
    v_smfmac_f32_16x16x64_bf16 v[84:87], v[64:67], v[128:135], v1
    s_waitcnt lgkmcnt(4)
    v_add_f32 v81, v81, v83
    v_smfmac_f32_16x16x64_bf16 v[84:87], v[68:71], v[136:143], v1
    s_mov_b32 s56, s42
    s_waitcnt lgkmcnt(2)
    v_smfmac_f32_16x16x64_bf16 v[96:99], v[24:27], v[104:111], v1
    s_mov_b32 s37, s57
    s_waitcnt lgkmcnt(0)
    v_smfmac_f32_16x16x64_bf16 v[96:99], v[28:31], v[112:119], v1
    v_add_f32 v84, v84, v86
    v_add_f32 v85, v85, v87
    v_smfmac_f32_16x16x64_bf16 v[88:91], v[40:43], a[72:79], v1
    buffer_load_dwordx4 v[24:27], v9, s[8:11], s41 offen sc1
    v_cvt_pk_bf16_f32 v80, v80, v84
    v_cvt_pk_bf16_f32 v81, v81, v85
    v_smfmac_f32_16x16x64_bf16 v[92:95], v[40:43], a[64:71], v1
    ds_write2_b32 v5, v80, v81 offset1:4
    v_add_f32 v96, v96, v98
    v_add_f32 v97, v97, v99
    v_smfmac_f32_16x16x64_bf16 v[88:91], v[44:47], a[56:63], v1
    buffer_load_dwordx4 v[28:31], v9, s[8:11], s41 offen offset:2048 sc1
    v_exp_f32 v98, v96
    v_exp_f32 v99, v97
    v_mov_b64 v[82:83], 0
    v_cvt_pk_bf16_f32 v98, v98, v99
    v_smfmac_f32_16x16x64_bf16 v[92:95], v[44:47], a[48:55], v1
    ds_write_b32 v2, v98 offset:10252
    v_smfmac_f32_16x16x64_bf16 v[88:91], v[48:51], a[40:47], v1
    buffer_store_dword v15, v8, s[8:11], s38 offen
    v_mov_b64 v[84:85], 0
    v_smfmac_f32_16x16x64_bf16 v[92:95], v[48:51], a[32:39], v1
    ds_read_b128 v[40:43], v3 offset:20480
    v_mov_b64 v[86:87], 0
    v_smfmac_f32_16x16x64_bf16 v[88:91], v[52:55], a[24:31], v1
    ds_read_b128 v[44:47], v3 offset:21504
    v_mov_b64 v[80:81], 0
    v_smfmac_f32_16x16x64_bf16 v[92:95], v[52:55], a[16:23], v1
    s_waitcnt lgkmcnt(2)
    s_barrier
    ds_read_b128 v[120:123], v2 offset:8192
    v_smfmac_f32_16x16x64_bf16 v[88:91], v[56:59], a[8:15], v1
    ds_read_b128 v[124:127], v2 offset:9216
    v_smfmac_f32_16x16x64_bf16 v[88:91], v[60:63], v[248:255], v1
    ds_read_b128 v[128:131], v2 offset:10240
    v_smfmac_f32_16x16x64_bf16 v[88:91], v[64:67], v[232:239], v1
    v_smfmac_f32_16x16x64_bf16 v[88:91], v[68:71], v[216:223], v1
    ds_read_b128 v[48:51], v3 offset:22528
    s_waitcnt lgkmcnt(3)
    v_smfmac_f32_16x16x64_bf16 v[100:103], v[120:123], v[104:111], v1
    ds_read_b128 v[52:55], v3 offset:23552
    s_waitcnt lgkmcnt(3)
    v_smfmac_f32_16x16x64_bf16 v[100:103], v[124:127], v[112:119], v1
    s_waitcnt lgkmcnt(2)
    v_add_f32 v88, v88, v90
    v_mfma_f32_16x16x32_bf16 v[132:135], v[16:19], v[128:131], 0
    ds_read_b128 v[104:107], v3 offset:24576
    v_add_f32 v89, v89, v91
    v_cvt_pk_bf16_f32 v88, v88, v89
    v_smfmac_f32_16x16x64_bf16 v[92:95], v[56:59], a[0:7], v1
    ds_read_b128 v[108:111], v3 offset:25600
    v_add_f32 v100, v100, v102
    v_add_f32 v101, v101, v103
    v_smfmac_f32_16x16x64_bf16 v[92:95], v[60:63], v[240:247], v1
    ds_read_b128 v[112:115], v3 offset:26624
    v_exp_f32 v102, v100
    v_smfmac_f32_16x16x64_bf16 v[92:95], v[64:67], v[224:231], v1
    ds_read_b128 v[116:119], v3 offset:27648
    v_exp_f32 v103, v101
    v_smfmac_f32_16x16x64_bf16 v[92:95], v[68:71], v[208:215], v1
    s_waitcnt vmcnt(5)
    s_cmp_eq_u32 s34, 63
    v_cvt_pk_bf16_f32 v20, v102, v103
    v_swap_b32 v34, v36
    v_swap_b32 v35, v37
    v_mfma_f32_16x16x16_bf16 v[132:135], v[16:17], v[20:21], v[132:135]
    s_cselect_b32 s30, 0, s55
    v_add_f32 v92, v92, v94
    v_add_f32 v93, v93, v95
    v_mfma_f32_16x16x32_bf16 v[136:139], v[32:35], v[128:131], 0
    ds_read_b128 v[120:123], v3 offset:28672
    v_cvt_pk_bf16_f32 v89, v92, v93
    v_mfma_f32_16x16x32_bf16 v[140:143], v[36:39], v[128:131], 0
    ds_read_b128 v[124:127], v3 offset:29696
    v_mov_b32 v23, v20
    s_nop 0
    v_mfma_f32_16x16x16_bf16 v[136:139], v[88:89], v[20:21], v[136:139]
    s_nop 1
    v_mfma_f32_16x16x16_bf16 v[140:143], v[88:89], v[22:23], v[140:143]
    s_nop 0
    v_rcp_f32 v134, v132
    v_subrev_u32 v133, s54, v132
    v_cmp_le_u32 vcc, s30, v133
L_ch_normF3:
    v_mul_f32 v136, v134, v136
    v_mul_f32 v137, v134, v137
    v_mul_f32 v138, v134, v138
    v_mul_f32 v139, v134, v139
    v_mul_f32 v140, v134, v140
    v_mul_f32 v141, v134, v141
    v_mul_f32 v142, v134, v142
    v_mul_f32 v143, v134, v143
    v_cvt_pk_bf16_f32 v136, v136, v140
    v_cvt_pk_bf16_f32 v137, v137, v141
    v_cvt_pk_bf16_f32 v138, v138, v142
    v_cvt_pk_bf16_f32 v139, v139, v143
    ds_write_b128 v2, v[136:139] offset:15360
    s_cbranch_vccnz L_ch_safeF3
    v_smfmac_f32_16x16x64_bf16 v[72:75], v[136:139], v[200:207], v1
    s_add_u32 s34, s34, 1
    s_add_u32 s42, s42, 131072
    v_smfmac_f32_16x16x64_bf16 v[76:79], v[136:139], v[168:175], v1
    s_waitcnt lgkmcnt(0)
    s_barrier
    ds_read_b128 v[140:143], v2 offset:12288
    ds_read_b128 v[96:99], v2 offset:13312
    ds_read_b128 v[100:103], v2 offset:14336
    v_smfmac_f32_16x16x64_bf16 v[80:83], v[136:139], v[152:159], v1
    v_smfmac_f32_16x16x64_bf16 v[84:87], v[136:139], v[144:151], v1
    s_waitcnt lgkmcnt(2)
    v_smfmac_f32_16x16x64_bf16 v[72:75], v[140:143], v[192:199], v1
    ds_read_b128 v[56:59], v3 offset:30720
    s_waitcnt lgkmcnt(2)
    v_smfmac_f32_16x16x64_bf16 v[72:75], v[96:99], v[184:191], v1
    ds_read_b128 v[60:63], v3 offset:31744
    s_waitcnt lgkmcnt(2)
    v_smfmac_f32_16x16x64_bf16 v[72:75], v[100:103], v[176:183], v1
    ds_read_b128 v[64:67], v3 offset:32768
    v_smfmac_f32_16x16x64_bf16 v[76:79], v[140:143], v[160:167], v1
    ds_read_b128 v[68:71], v3 offset:33792
    v_smfmac_f32_16x16x64_bf16 v[76:79], v[96:99], v[40:47], v1
    ds_read_b128 v[128:131], v3 offset:34816
    v_cvt_pk_bf16_f32 v72, v72, v74
    v_cvt_pk_bf16_f32 v73, v73, v75
    v_and_or_b32 v72, v72, -2, s36
    v_smfmac_f32_16x16x64_bf16 v[76:79], v[100:103], v[48:55], v1
    buffer_store_dwordx2 v[72:73], v7, s[8:11], 0 offen offset:0
    v_smfmac_f32_16x16x64_bf16 v[80:83], v[140:143], v[104:111], v1
    ds_read_b128 v[132:135], v3 offset:35840
    v_smfmac_f32_16x16x64_bf16 v[80:83], v[96:99], v[112:119], v1
    v_cvt_pk_bf16_f32 v76, v76, v78
    v_cvt_pk_bf16_f32 v77, v77, v79
    v_and_or_b32 v76, v76, -2, s36
    v_smfmac_f32_16x16x64_bf16 v[80:83], v[100:103], v[120:127], v1
    buffer_store_dwordx2 v[76:77], v7, s[8:11], 0 offen offset:2048
    s_waitcnt lgkmcnt(4)
    v_smfmac_f32_16x16x64_bf16 v[84:87], v[140:143], v[56:63], v1
    s_waitcnt lgkmcnt(2)
    v_smfmac_f32_16x16x64_bf16 v[84:87], v[96:99], v[64:71], v1
    s_waitcnt lgkmcnt(0)
    v_cvt_pk_bf16_f32 v80, v80, v82
    v_cvt_pk_bf16_f32 v81, v81, v83
    v_and_or_b32 v80, v80, -2, s36
    v_smfmac_f32_16x16x64_bf16 v[84:87], v[100:103], v[128:135], v1
    buffer_store_dwordx2 v[80:81], v7, s[8:11], s50 offen offset:0
    ds_read_b128 v[136:139], v2 offset:11264
    s_nop 5
    v_cvt_pk_bf16_f32 v84, v84, v86
    v_cvt_pk_bf16_f32 v85, v85, v87
    v_and_or_b32 v84, v84, -2, s36
    buffer_store_dwordx2 v[84:85], v7, s[8:11], s50 offen offset:2048
    s_barrier
    v_mov_b32 v13, s44
    v_mov_b64 v[72:73], 0
    v_mov_b64 v[74:75], 0
    v_mov_b64 v[76:77], 0
    v_mov_b64 v[78:79], 0
    v_mov_b64 v[80:81], 0
    v_mov_b64 v[82:83], 0
    v_mov_b64 v[92:93], 0
    v_mov_b64 v[94:95], 0
    v_mov_b64 v[96:97], 0
    v_mov_b64 v[98:99], 0
    v_mov_b64 v[100:101], 0
    v_mov_b64 v[102:103], 0
    v_mov_b64 v[84:85], 0
    v_mov_b64 v[86:87], 0
    s_nop 15
    s_nop 15
    s_nop 2
    buffer_load_dwordx4 v[40:43], v2, s[8:11], s39 offen sc1
    buffer_load_dwordx4 v[44:47], v2, s[8:11], s39 offen offset:1024 sc1
    s_nop 15
    s_nop 15
    s_nop 3
    buffer_load_dwordx4 v[48:51], v2, s[8:11], s39 offen sc1
    buffer_load_dwordx4 v[52:55], v2, s[8:11], s39 offen offset:1024 sc1
    ds_read_b64 v[90:91], v10 offset:9728
    ds_read_b128 v[104:107], v3 offset:0
    ds_read_b128 v[108:111], v3 offset:1024
    ds_read_b128 v[112:115], v3 offset:2048
    ds_read_b128 v[116:119], v3 offset:3072
    ds_read_b128 v[120:123], v3 offset:4096
    ds_read_b128 v[124:127], v3 offset:5120
    ds_read_b128 v[128:131], v3 offset:6144
    ds_read_b128 v[132:135], v3 offset:7168
    s_waitcnt lgkmcnt(9)
    s_waitcnt vmcnt(3)
    v_mfma_f32_16x16x32_bf16 v[140:143], v[136:139], v[40:43], 0
    v_bitop3_b32 v70, v40, v42, s36 bitop3:0x7e
    s_waitcnt vmcnt(2)
    v_mfma_f32_16x16x32_bf16 v[140:143], v[136:139], v[44:47], v[140:143]
    v_bitop3_b32 v71, v44, v46, s36 bitop3:0x7e
    v_bitop3_b32 v70, v70, v71, 1 bitop3:0xa8
    v_cmp_ne_u32 vcc, 0, v70
    s_nop 3
    s_cbranch_vccnz L_ch_missaF3
L_ch_okaF3:
    v_add_f32_dpp v140, v140, v140 row_ror:4 row_mask:0xf bank_mask:0xf
    v_add_f32_dpp v141, v141, v141 row_ror:4 row_mask:0xf bank_mask:0xf
    s_nop 0
    v_add_f32_dpp v140, v140, v140 row_ror:8 row_mask:0xf bank_mask:0xf
    v_add_f32_dpp v141, v141, v141 row_ror:8 row_mask:0xf bank_mask:0xf
    v_cvt_pk_bf16_f32 v70, v140, v141
    v_min_u32 v70, -2, v70
    buffer_store_dword v70, v8, s[8:11], s37 offen
    s_nop 3
    buffer_store_dword v13, v21, s[8:11], s5 offen
    ds_read_b128 v[136:139], v3 offset:8192
    ds_read_b128 v[140:143], v3 offset:9216
    s_nop 15
    s_nop 15
    s_nop 4
    buffer_load_dword v32, v12, s[8:11], s4 offen sc1
    buffer_load_dwordx4 v2, s[8:11], s37 offen sc1 lds
    buffer_load_dwordx4 v2, s[8:11], s37 offen offset:1024 sc1 lds
    s_add_u32 s35, s35, 1
    s_and_b32 s36, s35, 1
    s_xor_b32 s36, s36, 1
    s_add_u32 s30, s35, 3
    s_and_b32 s30, s30, 3
    s_lshl_b32 s30, s30, 13
    s_add_u32 s57, s30, s40
    s_xor_b32 s30, s30, 0x4000
    s_add_u32 s38, s30, s40
    s_add_u32 s44, s44, 1
    s_add_u32 s51, s41, 19456
    s_add_u32 s3, s51, 4096
    s_add_u32 s41, s41, 786432
    s_add_u32 s43, s43, 1
    s_waitcnt lgkmcnt(10)
    v_min_u32 v88, -2, v88
    v_min_u32 v89, -2, v89
    v_min_u32 v90, -2, v90
    v_min_u32 v91, -2, v91
    s_nop 8
    buffer_load_dword v33, v12, s[8:11], s4 offen sc1
    buffer_load_dwordx4 v2, s[8:11], s37 offen sc1 lds
    buffer_load_dwordx4 v2, s[8:11], s37 offen offset:1024 sc1 lds
    s_waitcnt lgkmcnt(0)
    s_branch L_ch_stepF3
L_ch_missaF3:
    s_mov_b32 s27, 0
L_ch_pollaF3:
    buffer_load_dwordx4 v[40:43], v2, s[8:11], s39 offen sc1
    buffer_load_dwordx4 v[44:47], v2, s[8:11], s39 offen offset:1024 sc1
    s_waitcnt vmcnt(3)
    v_mfma_f32_16x16x32_bf16 v[140:143], v[136:139], v[48:51], 0
    v_bitop3_b32 v70, v48, v50, s36 bitop3:0x7e
    s_waitcnt vmcnt(2)
    v_mfma_f32_16x16x32_bf16 v[140:143], v[136:139], v[52:55], v[140:143]
    v_bitop3_b32 v71, v52, v54, s36 bitop3:0x7e
    v_bitop3_b32 v70, v70, v71, 1 bitop3:0xa8
    v_cmp_ne_u32 vcc, 0, v70
    s_nop 3
    s_cbranch_vccz L_ch_okaF3
    buffer_load_dwordx4 v[48:51], v2, s[8:11], s39 offen sc1
    buffer_load_dwordx4 v[52:55], v2, s[8:11], s39 offen offset:1024 sc1
    s_waitcnt vmcnt(3)
    v_mfma_f32_16x16x32_bf16 v[140:143], v[136:139], v[40:43], 0
    v_bitop3_b32 v70, v40, v42, s36 bitop3:0x7e
    s_waitcnt vmcnt(2)
    v_mfma_f32_16x16x32_bf16 v[140:143], v[136:139], v[44:47], v[140:143]
    v_bitop3_b32 v71, v44, v46, s36 bitop3:0x7e
    v_bitop3_b32 v70, v70, v71, 1 bitop3:0xa8
    v_cmp_ne_u32 vcc, 0, v70
    s_nop 3
    s_cbranch_vccz L_ch_okaF3
    s_add_u32 s27, s27, 1
    s_cmp_lt_u32 s27, 200000
    s_cbranch_scc1 L_ch_pollaF3
    s_branch L_ch_fail
L_ch_hmissF3:
    s_mov_b32 s27, 0
L_ch_hpollF3:
    buffer_load_dword v32, v12, s[8:11], s4 offen sc1
    buffer_load_dwordx4 v2, s[8:11], s37 offen sc1 lds
    buffer_load_dwordx4 v2, s[8:11], s37 offen offset:1024 sc1 lds
    s_waitcnt vmcnt(5)
    v_cmp_gt_u32 vcc, v13, v33
    s_cbranch_vccz L_ch_hokF3
    buffer_load_dword v33, v12, s[8:11], s4 offen sc1
    buffer_load_dwordx4 v2, s[8:11], s37 offen sc1 lds
    buffer_load_dwordx4 v2, s[8:11], s37 offen offset:1024 sc1 lds
    s_waitcnt vmcnt(5)
    v_cmp_gt_u32 vcc, v13, v32
    s_cbranch_vccz L_ch_hokF3
    s_add_u32 s27, s27, 1
    s_cmp_lt_u32 s27, 200000
    s_cbranch_scc1 L_ch_hpollF3
    s_branch L_ch_fail
L_ch_missbF3:
    s_mov_b32 s27, 0
    s_sub_u32 s30, s37, 6144
    s_add_u32 s31, s30, 4096
    s_waitcnt lgkmcnt(0)
    ds_read_b128 v[40:43], v2 offset:0
    ds_read_b128 v[44:47], v2 offset:1024
    ds_read_b128 v[48:51], v2 offset:2048
    ds_read_b128 v[52:55], v2 offset:3072
    ds_read_b128 v[56:59], v2 offset:4096
    ds_read_b128 v[60:63], v2 offset:5120
    ds_read_b128 v[64:67], v2 offset:6144
    ds_read_b128 v[68:71], v2 offset:7168
    s_waitcnt lgkmcnt(0)
    ds_read_b128 v[104:107], v3 offset:0
    ds_read_b128 v[108:111], v3 offset:1024
    ds_read_b128 v[112:115], v3 offset:2048
    ds_read_b128 v[116:119], v3 offset:3072
    ds_read_b128 v[120:123], v3 offset:4096
    ds_read_b128 v[124:127], v3 offset:5120
    ds_read_b128 v[128:131], v3 offset:6144
    ds_read_b128 v[132:135], v3 offset:7168
    ds_read_b128 v[136:139], v3 offset:8192
    ds_read_b128 v[140:143], v3 offset:9216
    s_branch L_ch_chkbF3
L_ch_pollbF3:
    buffer_load_dwordx4 v[40:43], v2, s[8:11], s30 offen offset:0 sc1
    buffer_load_dwordx4 v[44:47], v2, s[8:11], s30 offen offset:1024 sc1
    buffer_load_dwordx4 v[48:51], v2, s[8:11], s30 offen offset:2048 sc1
    buffer_load_dwordx4 v[52:55], v2, s[8:11], s30 offen offset:3072 sc1
    buffer_load_dwordx4 v[56:59], v2, s[8:11], s31 offen offset:0 sc1
    buffer_load_dwordx4 v[60:63], v2, s[8:11], s31 offen offset:1024 sc1
    buffer_load_dwordx4 v[64:67], v2, s[8:11], s31 offen offset:2048 sc1
    buffer_load_dwordx4 v[68:71], v2, s[8:11], s31 offen offset:3072 sc1
    s_add_u32 s27, s27, 1
    s_cmp_lt_u32 s27, 200000
    s_cbranch_scc0 L_ch_fail
    s_waitcnt vmcnt(0)
L_ch_chkbF3:
    v_max_u32 v23, v40, v41
    v_max3_u32 v23, v23, v42, v43
    v_max3_u32 v23, v23, v44, v45
    v_max3_u32 v23, v23, v46, v47
    v_max3_u32 v23, v23, v48, v49
    v_max3_u32 v23, v23, v50, v51
    v_max3_u32 v23, v23, v52, v53
    v_max3_u32 v23, v23, v54, v55
    v_max3_u32 v23, v23, v56, v57
    v_max3_u32 v23, v23, v58, v59
    v_max3_u32 v23, v23, v60, v61
    v_max3_u32 v23, v23, v62, v63
    v_max3_u32 v23, v23, v64, v65
    v_max3_u32 v23, v23, v66, v67
    v_max3_u32 v23, v23, v68, v69
    v_max3_u32 v23, v23, v70, v71
    v_cmp_eq_u32 vcc, -1, v23
    s_cbranch_vccnz L_ch_pollbF3
    v_mov_b64 v[72:73], 0
    v_mov_b64 v[74:75], 0
    v_mov_b64 v[76:77], 0
    v_mov_b64 v[78:79], 0
    v_mov_b64 v[80:81], 0
    v_mov_b64 v[82:83], 0
    v_mov_b64 v[84:85], 0
    v_mov_b64 v[86:87], 0
    s_waitcnt lgkmcnt(0)
    s_nop 0
    v_smfmac_f32_16x16x64_bf16 v[72:75], v[40:43], v[104:111], v1
    v_smfmac_f32_16x16x64_bf16 v[76:79], v[40:43], v[112:119], v1
    v_smfmac_f32_16x16x64_bf16 v[72:75], v[44:47], v[120:127], v1
    v_smfmac_f32_16x16x64_bf16 v[76:79], v[44:47], v[128:135], v1
    v_smfmac_f32_16x16x64_bf16 v[72:75], v[48:51], v[136:143], v1
    v_smfmac_f32_16x16x64_bf16 v[76:79], v[48:51], a[248:255], v1
    v_smfmac_f32_16x16x64_bf16 v[72:75], v[52:55], a[240:247], v1
    v_smfmac_f32_16x16x64_bf16 v[76:79], v[52:55], a[232:239], v1
    ds_read_b128 v[104:107], v3 offset:10240
    v_smfmac_f32_16x16x64_bf16 v[72:75], v[56:59], a[224:231], v1
    v_smfmac_f32_16x16x64_bf16 v[72:75], v[60:63], a[208:215], v1
    ds_read_b128 v[108:111], v3 offset:11264
    v_smfmac_f32_16x16x64_bf16 v[72:75], v[64:67], a[192:199], v1
    v_smfmac_f32_16x16x64_bf16 v[72:75], v[68:71], a[176:183], v1
    ds_read_b128 v[112:115], v3 offset:12288
    v_smfmac_f32_16x16x64_bf16 v[76:79], v[56:59], a[216:223], v1
    ds_read_b128 v[116:119], v3 offset:13312
    v_smfmac_f32_16x16x64_bf16 v[76:79], v[60:63], a[200:207], v1
    v_add_f32 v72, v72, v74
    v_smfmac_f32_16x16x64_bf16 v[76:79], v[64:67], a[184:191], v1
    ds_read_b128 v[120:123], v3 offset:14336
    v_add_f32 v73, v73, v75
    v_smfmac_f32_16x16x64_bf16 v[76:79], v[68:71], a[168:175], v1
    v_cmp_u_f32 vcc, v72, v73
    v_smfmac_f32_16x16x64_bf16 v[80:83], v[40:43], a[160:167], v1
    ds_read_b128 v[124:127], v3 offset:15360
    v_mul_f32 v72, s45, v72
    v_mul_f32 v73, s45, v73
    v_smfmac_f32_16x16x64_bf16 v[84:87], v[40:43], a[152:159], v1
    s_branch L_ch_okbF3
L_ch_lastF3:
    ds_read_b64 v[90:91], v10 offset:9728
    s_waitcnt lgkmcnt(0)
    v_min_u32 v88, -2, v88
    v_min_u32 v89, -2, v89
    v_min_u32 v90, -2, v90
    v_min_u32 v91, -2, v91
    buffer_store_dwordx2 v[90:91], v10, s[8:11], s56 offen offset:1536 sc1
    buffer_store_dwordx2 v[88:89], v10, s[8:11], s56 offen offset:3584 sc1
    s_sub_u32 s35, s35, 1
    s_waitcnt vmcnt(0) lgkmcnt(0)
    s_barrier
    s_add_u32 s33, s33, 1
    s_cmp_lt_u32 s33, 2
    s_cbranch_scc1 L_ch_layerF3
    s_endpgm
L_ch_safeF3:
    s_cmp_eq_u32 s34, 63
    s_cbranch_scc1 L_ch_lastF3
    v_max3_f32 v133, v96, v97, v100
    v_max_f32 v133, v133, v101
    v_mov_b32 v135, v133
    s_nop 1
    v_permlane16_swap_b32 v133, v135
    s_nop 1
    v_max_f32 v133, v133, v135
    v_mov_b32 v135, v133
    s_nop 1
    v_permlane32_swap_b32 v133, v135
    s_nop 1
    v_max_f32 v133, v133, v135
    ds_write_b32 v2, v133 offset:4108
    s_waitcnt lgkmcnt(0)
    s_barrier
    ds_read_b128 v[128:131], v2 offset:4096
    s_waitcnt lgkmcnt(0)
    v_max3_f32 v133, v128, v129, v130
    v_max_f32 v133, v133, v131
    v_sub_f32 v98, v96, v133
    v_exp_f32 v98, v98
    v_sub_f32 v99, v97, v133
    v_exp_f32 v99, v99
    v_sub_f32 v102, v100, v133
    v_exp_f32 v102, v102
    v_sub_f32 v103, v101, v133
    v_exp_f32 v103, v103
    s_nop 0
    v_cvt_pk_bf16_f32 v98, v98, v99
    v_cvt_pk_bf16_f32 v20, v102, v103
    v_cvt_pk_bf16_f32 v23, v102, v103
    ds_write_b32 v2, v98 offset:10252
    s_waitcnt lgkmcnt(0)
    s_barrier
    ds_read_b128 v[128:131], v2 offset:10240
    s_waitcnt lgkmcnt(0)
    v_mfma_f32_16x16x32_bf16 v[132:135], v[16:19], v[128:131], 0
    v_mfma_f32_16x16x32_bf16 v[136:139], v[32:35], v[128:131], 0
    v_mfma_f32_16x16x32_bf16 v[140:143], v[36:39], v[128:131], 0
    s_nop 7
    v_mfma_f32_16x16x16_bf16 v[132:135], v[16:17], v[20:21], v[132:135]
    v_mfma_f32_16x16x16_bf16 v[136:139], v[88:89], v[20:21], v[136:139]
    v_mfma_f32_16x16x16_bf16 v[140:143], v[88:89], v[22:23], v[140:143]
    s_nop 7
    v_rcp_f32 v134, v132
    s_mov_b64 vcc, 0
    s_branch L_ch_normF3
L_ch_fail:
    s_endpgm
L_ch_initS:
    s_cmp_eq_u32 s24, 0
    s_cbranch_scc1 L_ch_layerS0
    s_cmp_eq_u32 s24, 1
    s_cbranch_scc1 L_ch_layerS1
    s_cmp_eq_u32 s24, 2
    s_cbranch_scc1 L_ch_layerS2
    s_branch L_ch_layerS3
L_ch_layerS0:
    s_mov_b32 s30, 0
    s_mul_i32 s41, s32, 24576
    s_add_u32 s41, s41, s30
    s_add_u32 s41, s41, 1048576
    s_lshl_b32 s56, s32, 12
    s_add_u32 s56, s56, 61341696
    s_mul_i32 s42, s32, 4096
    s_add_u32 s42, s42, s30
    s_add_u32 s42, s42, 52428800
    s_lshl_b32 s43, s33, 7
    s_add_u32 s43, s43, 1
    s_mov_b32 s34, 0
    s_mov_b32 m0, 0
    v_bfe_u32 v48, v2, 6, 2
    v_bfe_u32 v49, v2, 4, 1
    v_lshl_add_u32 v48, v48, 1, v49
    v_lshlrev_b32 v48, 10, v48
    v_lshrrev_b32 v49, 8, v2
    v_lshl_add_u32 v48, v49, 7, v48
    v_bfe_u32 v49, v2, 5, 1
    v_lshl_add_u32 v48, v49, 6, v48
    v_add_u32 v48, 0, v48
    buffer_load_dword v40, v48, s[12:15], 0 offen offset:0
    buffer_load_dword v41, v48, s[12:15], 0 offen offset:16
    buffer_load_dword v42, v48, s[12:15], 0 offen offset:32
    buffer_load_dword v43, v48, s[12:15], 0 offen offset:48
    buffer_load_dword v44, v48, s[12:15], 0 offen offset:512
    buffer_load_dword v45, v48, s[12:15], 0 offen offset:528
    buffer_load_dword v46, v48, s[12:15], 0 offen offset:544
    buffer_load_dword v47, v48, s[12:15], 0 offen offset:560
    v_mov_b64 v[72:73], 0
    v_mov_b64 v[74:75], 0
    v_mov_b64 v[76:77], 0
    v_mov_b64 v[78:79], 0
    v_mov_b64 v[80:81], 0
    v_mov_b64 v[82:83], 0
    v_mov_b64 v[84:85], 0
    v_mov_b64 v[86:87], 0
    v_mov_b64 v[88:89], 0
    v_mov_b64 v[90:91], 0
    v_mov_b64 v[92:93], 0
    v_mov_b64 v[94:95], 0
    v_mov_b64 v[96:97], 0
    v_mov_b64 v[98:99], 0
    v_mov_b64 v[100:101], 0
    v_mov_b64 v[102:103], 0
    ds_read_b128 v[104:107], v3 offset:0
    ds_read_b128 v[108:111], v3 offset:1024
    ds_read_b128 v[112:115], v3 offset:2048
    ds_read_b128 v[116:119], v3 offset:3072
    ds_read_b128 v[120:123], v3 offset:4096
    ds_read_b128 v[124:127], v3 offset:5120
    ds_read_b128 v[128:131], v3 offset:6144
    ds_read_b128 v[132:135], v3 offset:7168
    ds_read_b128 v[136:139], v3 offset:8192
    ds_read_b128 v[140:143], v3 offset:9216
    s_waitcnt vmcnt(0)
    v_min_u32 v40, -2, v40
    v_min_u32 v41, -2, v41
    v_min_u32 v42, -2, v42
    v_min_u32 v43, -2, v43
    v_min_u32 v44, -2, v44
    v_min_u32 v45, -2, v45
    v_min_u32 v46, -2, v46
    v_min_u32 v47, -2, v47
    ds_write_b128 v2, v[40:43] offset:0
    ds_write_b128 v2, v[44:47] offset:1024
    s_mov_b32 s27, 0
L_poll_20:
    buffer_load_dword v14, v11, s[8:11], s46 offen sc1
    s_waitcnt vmcnt(0)
    v_cmp_gt_u32 vcc, s43, v14
    s_cbranch_vccz L_pollok_21
    s_sleep 1
    s_add_u32 s27, s27, 1
    s_cmp_lt_u32 s27, 200000
    s_cbranch_scc1 L_poll_20
    s_branch L_ch_fail
L_pollok_21:
    buffer_load_dwordx4 v[24:27], v9, s[8:11], s41 offen sc1
    buffer_load_dwordx4 v[28:31], v9, s[8:11], s41 offen offset:2048 sc1
    s_add_u32 s35, s35, 1
    s_and_b32 s36, s35, 1
    s_xor_b32 s36, s36, 1
    s_add_u32 s30, s35, 3
    s_and_b32 s30, s30, 3
    s_lshl_b32 s30, s30, 13
    s_add_u32 s57, s30, s40
    s_xor_b32 s30, s30, 0x4000
    s_add_u32 s38, s30, s40
    s_add_u32 s44, s44, 1
    s_add_u32 s51, s41, 16384
    s_add_u32 s3, s51, 4096
    s_add_u32 s41, s41, 786432
    s_add_u32 s43, s43, 1
    v_mov_b32 v32, -1
    s_waitcnt lgkmcnt(0)
    s_branch L_ch_inS0
L_ch_stepS0:
    s_waitcnt vmcnt(5)
    v_cmp_gt_u32 vcc, v13, v32
    s_cbranch_vccnz L_ch_hmissS0
L_ch_hokS0:
    s_waitcnt vmcnt(3)

L_ch_inS0:
    s_barrier
    ds_read_b128 v[40:43], v2 offset:0
    ds_read_b128 v[44:47], v2 offset:1024
    ds_read_b128 v[48:51], v2 offset:2048
    buffer_load_dwordx4 v[32:35], v2, s[8:11], s51 offen sc1
    s_waitcnt lgkmcnt(2)
    v_smfmac_f32_16x16x64_bf16 v[72:75], v[40:43], v[104:111], v1
    ds_read_b128 v[52:55], v2 offset:3072
    v_smfmac_f32_16x16x64_bf16 v[76:79], v[40:43], v[112:119], v1
    ds_read_b128 v[56:59], v2 offset:4096
    s_waitcnt lgkmcnt(3)
    v_smfmac_f32_16x16x64_bf16 v[72:75], v[44:47], v[120:127], v1
    buffer_load_dwordx4 v[36:39], v2, s[8:11], s3 offen sc1
    v_smfmac_f32_16x16x64_bf16 v[76:79], v[44:47], v[128:135], v1
    ds_read_b128 v[60:63], v2 offset:5120
    s_waitcnt lgkmcnt(3)
    v_smfmac_f32_16x16x64_bf16 v[72:75], v[48:51], v[136:143], v1
    ds_read_b128 v[64:67], v2 offset:6144
    v_cmp_gt_u32 s[20:21], s43, v14
    v_smfmac_f32_16x16x64_bf16 v[76:79], v[48:51], a[248:255], v1
    s_waitcnt lgkmcnt(3)
    v_smfmac_f32_16x16x64_bf16 v[72:75], v[52:55], a[240:247], v1
    ds_read_b128 v[68:71], v2 offset:7168
    v_smfmac_f32_16x16x64_bf16 v[76:79], v[52:55], a[232:239], v1
    ds_read_b128 v[104:107], v3 offset:10240
    s_waitcnt lgkmcnt(4)
    v_smfmac_f32_16x16x64_bf16 v[72:75], v[56:59], a[224:231], v1
    buffer_store_dwordx2 v[88:89], v10, s[8:11], s56 offen offset:2048 sc1
    s_cmp_lg_u64 s[20:21], 0
    s_waitcnt lgkmcnt(3)
    v_smfmac_f32_16x16x64_bf16 v[72:75], v[60:63], a[208:215], v1
    ds_read_b128 v[108:111], v3 offset:11264
    s_waitcnt lgkmcnt(3)
    v_smfmac_f32_16x16x64_bf16 v[72:75], v[64:67], a[192:199], v1
    s_cbranch_scc1 L_ch_pwaitS0
L_ch_pokS0:
    s_waitcnt lgkmcnt(2)
    v_smfmac_f32_16x16x64_bf16 v[72:75], v[68:71], a[176:183], v1
    ds_read_b128 v[112:115], v3 offset:12288
    v_smfmac_f32_16x16x64_bf16 v[76:79], v[56:59], a[216:223], v1
    ds_read_b128 v[116:119], v3 offset:13312
    v_smfmac_f32_16x16x64_bf16 v[76:79], v[60:63], a[200:207], v1
    buffer_store_dwordx2 v[90:91], v10, s[8:11], s56 offen offset:0 sc1
    v_add_f32 v72, v72, v74
    v_smfmac_f32_16x16x64_bf16 v[76:79], v[64:67], a[184:191], v1
    ds_read_b128 v[120:123], v3 offset:14336
    v_add_f32 v73, v73, v75
    v_smfmac_f32_16x16x64_bf16 v[76:79], v[68:71], a[168:175], v1
    v_cmp_u_f32 vcc, v72, v73
    v_smfmac_f32_16x16x64_bf16 v[80:83], v[40:43], a[160:167], v1
    ds_read_b128 v[124:127], v3 offset:15360
    v_mul_f32 v72, s45, v72
    v_mul_f32 v73, s45, v73
    v_smfmac_f32_16x16x64_bf16 v[84:87], v[40:43], a[152:159], v1
    s_cbranch_vccnz L_ch_missbS0
L_ch_okbS0:
    s_waitcnt lgkmcnt(4)
    v_add_f32 v76, v76, v78
    v_add_f32 v77, v77, v79
    v_smfmac_f32_16x16x64_bf16 v[80:83], v[44:47], v[104:111], v1
    ds_read_b128 v[128:131], v3 offset:16384
    v_mul_f32 v76, s45, v76
    v_mul_f32 v77, s45, v77
    v_smfmac_f32_16x16x64_bf16 v[84:87], v[44:47], a[144:151], v1
    s_waitcnt lgkmcnt(3)
    v_cvt_pk_bf16_f32 v72, v72, v76
    v_cvt_pk_bf16_f32 v73, v73, v77
    v_smfmac_f32_16x16x64_bf16 v[80:83], v[48:51], v[112:119], v1
    ds_write2_b32 v4, v72, v73 offset1:4
    v_smfmac_f32_16x16x64_bf16 v[84:87], v[48:51], a[136:143], v1
    ds_read_b128 v[132:135], v3 offset:17408
    v_mov_b64 v[74:75], 0
    v_smfmac_f32_16x16x64_bf16 v[80:83], v[52:55], a[128:135], v1
    ds_read_b128 v[136:139], v3 offset:18432
    v_mov_b64 v[76:77], 0
    v_smfmac_f32_16x16x64_bf16 v[84:87], v[52:55], a[120:127], v1
    ds_read_b128 v[140:143], v3 offset:19456
    v_mov_b64 v[78:79], 0
    v_smfmac_f32_16x16x64_bf16 v[80:83], v[56:59], a[112:119], v1
    s_waitcnt lgkmcnt(3)
    s_barrier
    v_smfmac_f32_16x16x64_bf16 v[80:83], v[60:63], a[96:103], v1
    ds_read_b128 v[104:107], v6 offset:12288
    v_mov_b64 v[72:73], 0
    v_smfmac_f32_16x16x64_bf16 v[80:83], v[64:67], a[88:95], v1
    ds_read_b128 v[108:111], v6 offset:12864
    v_smfmac_f32_16x16x64_bf16 v[80:83], v[68:71], a[80:87], v1
    ds_read_b128 v[112:115], v6 offset:13440
    v_mov_b64 v[88:89], 0
    v_smfmac_f32_16x16x64_bf16 v[84:87], v[56:59], a[104:111], v1
    ds_read_b128 v[116:119], v6 offset:14016
    v_mov_b64 v[90:91], 0
    v_smfmac_f32_16x16x64_bf16 v[84:87], v[60:63], v[120:127], v1
    s_waitcnt vmcnt(4)
    s_waitcnt lgkmcnt(6)
    v_add_f32 v80, v80, v82
    v_smfmac_f32_16x16x64_bf16 v[84:87], v[64:67], v[128:135], v1
    s_waitcnt lgkmcnt(4)
    v_add_f32 v81, v81, v83
    v_smfmac_f32_16x16x64_bf16 v[84:87], v[68:71], v[136:143], v1
    buffer_load_dword v14, v11, s[8:11], s46 offen sc1
    s_mov_b32 s56, s42
    s_waitcnt lgkmcnt(2)
    v_smfmac_f32_16x16x64_bf16 v[96:99], v[24:27], v[104:111], v1
    s_mov_b32 s37, s57
    s_waitcnt lgkmcnt(0)
    v_smfmac_f32_16x16x64_bf16 v[96:99], v[28:31], v[112:119], v1
    v_add_f32 v84, v84, v86
    v_add_f32 v85, v85, v87
    v_smfmac_f32_16x16x64_bf16 v[88:91], v[40:43], a[72:79], v1
    buffer_load_dwordx4 v[24:27], v9, s[8:11], s41 offen sc1
    v_cvt_pk_bf16_f32 v80, v80, v84
    v_cvt_pk_bf16_f32 v81, v81, v85
    v_smfmac_f32_16x16x64_bf16 v[92:95], v[40:43], a[64:71], v1
    ds_write2_b32 v5, v80, v81 offset1:4
    v_add_f32 v96, v96, v98
    v_add_f32 v97, v97, v99
    v_smfmac_f32_16x16x64_bf16 v[88:91], v[44:47], a[56:63], v1
    buffer_load_dwordx4 v[28:31], v9, s[8:11], s41 offen offset:2048 sc1
    v_exp_f32 v98, v96
    v_exp_f32 v99, v97
    v_mov_b64 v[82:83], 0
    v_cvt_pk_bf16_f32 v98, v98, v99
    v_smfmac_f32_16x16x64_bf16 v[92:95], v[44:47], a[48:55], v1
    ds_write_b32 v2, v98 offset:10240
    v_smfmac_f32_16x16x64_bf16 v[88:91], v[48:51], a[40:47], v1
    buffer_store_dword v15, v8, s[8:11], s38 offen sc1
    v_mov_b64 v[84:85], 0
    v_smfmac_f32_16x16x64_bf16 v[92:95], v[48:51], a[32:39], v1
    ds_read_b128 v[40:43], v3 offset:20480
    v_mov_b64 v[86:87], 0
    v_smfmac_f32_16x16x64_bf16 v[88:91], v[52:55], a[24:31], v1
    ds_read_b128 v[44:47], v3 offset:21504
    v_mov_b64 v[80:81], 0
    v_smfmac_f32_16x16x64_bf16 v[92:95], v[52:55], a[16:23], v1
    s_waitcnt lgkmcnt(2)
    s_barrier
    ds_read_b128 v[120:123], v2 offset:8192
    v_smfmac_f32_16x16x64_bf16 v[88:91], v[56:59], a[8:15], v1
    ds_read_b128 v[124:127], v2 offset:9216
    v_smfmac_f32_16x16x64_bf16 v[88:91], v[60:63], v[248:255], v1
    ds_read_b128 v[128:131], v2 offset:10240
    v_smfmac_f32_16x16x64_bf16 v[88:91], v[64:67], v[232:239], v1
    v_smfmac_f32_16x16x64_bf16 v[88:91], v[68:71], v[216:223], v1
    ds_read_b128 v[48:51], v3 offset:22528
    s_waitcnt lgkmcnt(3)
    v_smfmac_f32_16x16x64_bf16 v[100:103], v[120:123], v[104:111], v1
    ds_read_b128 v[52:55], v3 offset:23552
    s_waitcnt lgkmcnt(3)
    v_smfmac_f32_16x16x64_bf16 v[100:103], v[124:127], v[112:119], v1
    s_waitcnt lgkmcnt(2)
    v_add_f32 v88, v88, v90
    v_mfma_f32_16x16x32_bf16 v[132:135], v[16:19], v[128:131], 0
    ds_read_b128 v[104:107], v3 offset:24576
    v_add_f32 v89, v89, v91
    v_cvt_pk_bf16_f32 v88, v88, v89
    v_smfmac_f32_16x16x64_bf16 v[92:95], v[56:59], a[0:7], v1
    ds_read_b128 v[108:111], v3 offset:25600
    v_add_f32 v100, v100, v102
    v_add_f32 v101, v101, v103
    v_smfmac_f32_16x16x64_bf16 v[92:95], v[60:63], v[240:247], v1
    ds_read_b128 v[112:115], v3 offset:26624
    v_exp_f32 v102, v100
    v_smfmac_f32_16x16x64_bf16 v[92:95], v[64:67], v[224:231], v1
    ds_read_b128 v[116:119], v3 offset:27648
    v_exp_f32 v103, v101
    v_smfmac_f32_16x16x64_bf16 v[92:95], v[68:71], v[208:215], v1
    s_waitcnt vmcnt(6)
    s_cmp_eq_u32 s34, 63
    v_cvt_pk_bf16_f32 v20, v102, v103
    v_swap_b32 v34, v36
    v_swap_b32 v35, v37
    v_mfma_f32_16x16x16_bf16 v[132:135], v[16:17], v[20:21], v[132:135]
    s_cselect_b32 s30, 0, s55
    v_add_f32 v92, v92, v94
    v_add_f32 v93, v93, v95
    v_mfma_f32_16x16x32_bf16 v[136:139], v[32:35], v[128:131], 0
    ds_read_b128 v[120:123], v3 offset:28672
    v_cvt_pk_bf16_f32 v89, v92, v93
    v_mfma_f32_16x16x32_bf16 v[140:143], v[36:39], v[128:131], 0
    ds_read_b128 v[124:127], v3 offset:29696
    v_mov_b32 v23, v20
    s_nop 0
    v_mfma_f32_16x16x16_bf16 v[136:139], v[88:89], v[20:21], v[136:139]
    s_nop 1
    v_mfma_f32_16x16x16_bf16 v[140:143], v[88:89], v[22:23], v[140:143]
    s_nop 0
    v_rcp_f32 v134, v132
    v_subrev_u32 v133, s54, v132
    v_cmp_le_u32 vcc, s30, v133
L_ch_normS0:
    v_mul_f32 v136, v134, v136
    v_mul_f32 v137, v134, v137
    v_mul_f32 v138, v134, v138
    v_mul_f32 v139, v134, v139
    v_mul_f32 v140, v134, v140
    v_mul_f32 v141, v134, v141
    v_mul_f32 v142, v134, v142
    v_mul_f32 v143, v134, v143
    v_cvt_pk_bf16_f32 v136, v136, v140
    v_cvt_pk_bf16_f32 v137, v137, v141
    v_cvt_pk_bf16_f32 v138, v138, v142
    v_cvt_pk_bf16_f32 v139, v139, v143
    ds_write_b128 v2, v[136:139] offset:12288
    s_cbranch_vccnz L_ch_safeS0
    v_smfmac_f32_16x16x64_bf16 v[72:75], v[136:139], v[200:207], v1
    s_add_u32 s34, s34, 1
    s_add_u32 s42, s42, 131072
    v_smfmac_f32_16x16x64_bf16 v[76:79], v[136:139], v[168:175], v1
    s_waitcnt lgkmcnt(0)
    s_barrier
    ds_read_b128 v[140:143], v2 offset:13312
    ds_read_b128 v[96:99], v2 offset:14336
    ds_read_b128 v[100:103], v2 offset:15360
    v_smfmac_f32_16x16x64_bf16 v[80:83], v[136:139], v[152:159], v1
    v_smfmac_f32_16x16x64_bf16 v[84:87], v[136:139], v[144:151], v1
    s_waitcnt lgkmcnt(2)
    v_smfmac_f32_16x16x64_bf16 v[72:75], v[140:143], v[192:199], v1
    ds_read_b128 v[56:59], v3 offset:30720
    s_waitcnt lgkmcnt(2)
    v_smfmac_f32_16x16x64_bf16 v[72:75], v[96:99], v[184:191], v1
    ds_read_b128 v[60:63], v3 offset:31744
    s_waitcnt lgkmcnt(2)
    v_smfmac_f32_16x16x64_bf16 v[72:75], v[100:103], v[176:183], v1
    ds_read_b128 v[64:67], v3 offset:32768
    v_smfmac_f32_16x16x64_bf16 v[76:79], v[140:143], v[160:167], v1
    ds_read_b128 v[68:71], v3 offset:33792
    v_smfmac_f32_16x16x64_bf16 v[76:79], v[96:99], v[40:47], v1
    ds_read_b128 v[128:131], v3 offset:34816
    v_cvt_pk_bf16_f32 v72, v72, v74
    v_cvt_pk_bf16_f32 v73, v73, v75
    v_and_or_b32 v72, v72, -2, s36
    v_smfmac_f32_16x16x64_bf16 v[76:79], v[100:103], v[48:55], v1
    buffer_store_dwordx2 v[72:73], v7, s[8:11], 0 offen offset:0 sc1
    v_smfmac_f32_16x16x64_bf16 v[80:83], v[140:143], v[104:111], v1
    ds_read_b128 v[132:135], v3 offset:35840
    v_smfmac_f32_16x16x64_bf16 v[80:83], v[96:99], v[112:119], v1
    v_cvt_pk_bf16_f32 v76, v76, v78
    v_cvt_pk_bf16_f32 v77, v77, v79
    v_and_or_b32 v76, v76, -2, s36
    v_smfmac_f32_16x16x64_bf16 v[80:83], v[100:103], v[120:127], v1
    buffer_store_dwordx2 v[76:77], v7, s[8:11], 0 offen offset:2048 sc1
    s_waitcnt lgkmcnt(4)
    v_smfmac_f32_16x16x64_bf16 v[84:87], v[140:143], v[56:63], v1
    s_waitcnt lgkmcnt(2)
    v_smfmac_f32_16x16x64_bf16 v[84:87], v[96:99], v[64:71], v1
    s_waitcnt lgkmcnt(0)
    v_cvt_pk_bf16_f32 v80, v80, v82
    v_cvt_pk_bf16_f32 v81, v81, v83
    v_and_or_b32 v80, v80, -2, s36
    v_smfmac_f32_16x16x64_bf16 v[84:87], v[100:103], v[128:135], v1
    buffer_store_dwordx2 v[80:81], v7, s[8:11], s50 offen offset:0 sc1
    ds_read_b128 v[136:139], v2 offset:11264
    s_nop 5
    v_cvt_pk_bf16_f32 v84, v84, v86
    v_cvt_pk_bf16_f32 v85, v85, v87
    v_and_or_b32 v84, v84, -2, s36
    buffer_store_dwordx2 v[84:85], v7, s[8:11], s50 offen offset:2048 sc1
    s_barrier
    v_mov_b32 v13, s44
    v_mov_b64 v[72:73], 0
    v_mov_b64 v[74:75], 0
    v_mov_b64 v[76:77], 0
    v_mov_b64 v[78:79], 0
    v_mov_b64 v[80:81], 0
    v_mov_b64 v[82:83], 0
    v_mov_b64 v[92:93], 0
    v_mov_b64 v[94:95], 0
    v_mov_b64 v[96:97], 0
    v_mov_b64 v[98:99], 0
    buffer_load_dwordx4 v[40:43], v2, s[8:11], s39 offen sc1
    buffer_load_dwordx4 v[44:47], v2, s[8:11], s39 offen offset:1024 sc1
    v_mov_b64 v[100:101], 0
    v_mov_b64 v[102:103], 0
    v_mov_b64 v[84:85], 0
    v_mov_b64 v[86:87], 0
    s_nop 15
    s_nop 15
    s_nop 5
    buffer_load_dwordx4 v[48:51], v2, s[8:11], s39 offen sc1
    buffer_load_dwordx4 v[52:55], v2, s[8:11], s39 offen offset:1024 sc1
    ds_read_b64 v[90:91], v10 offset:8192
    ds_read_b128 v[104:107], v3 offset:0
    ds_read_b128 v[108:111], v3 offset:1024
    ds_read_b128 v[112:115], v3 offset:2048
    ds_read_b128 v[116:119], v3 offset:3072
    ds_read_b128 v[120:123], v3 offset:4096
    ds_read_b128 v[124:127], v3 offset:5120
    ds_read_b128 v[128:131], v3 offset:6144
    ds_read_b128 v[132:135], v3 offset:7168
    s_waitcnt lgkmcnt(9)
    s_waitcnt vmcnt(3)
    v_mfma_f32_16x16x32_bf16 v[140:143], v[136:139], v[40:43], 0
    v_bitop3_b32 v70, v40, v42, s36 bitop3:0x7e
    s_waitcnt vmcnt(2)
    v_mfma_f32_16x16x32_bf16 v[140:143], v[136:139], v[44:47], v[140:143]
    v_bitop3_b32 v71, v44, v46, s36 bitop3:0x7e
    v_bitop3_b32 v70, v70, v71, 1 bitop3:0xa8
    v_cmp_ne_u32 vcc, 0, v70
    s_nop 3
    s_cbranch_vccnz L_ch_missaS0
L_ch_okaS0:
    v_add_f32_dpp v140, v140, v140 row_ror:4 row_mask:0xf bank_mask:0xf
    v_add_f32_dpp v141, v141, v141 row_ror:4 row_mask:0xf bank_mask:0xf
    s_nop 0
    v_add_f32_dpp v140, v140, v140 row_ror:8 row_mask:0xf bank_mask:0xf
    v_add_f32_dpp v141, v141, v141 row_ror:8 row_mask:0xf bank_mask:0xf
    v_cvt_pk_bf16_f32 v70, v140, v141
    v_min_u32 v70, -2, v70
    buffer_store_dword v70, v8, s[8:11], s37 offen sc1
    s_nop 3
    buffer_store_dword v13, v21, s[8:11], s5 offen sc1
    ds_read_b128 v[136:139], v3 offset:8192
    ds_read_b128 v[140:143], v3 offset:9216
    s_nop 15
    s_nop 15
    s_nop 9
    buffer_load_dword v32, v12, s[8:11], s4 offen sc1
    buffer_load_dwordx4 v2, s[8:11], s37 offen sc1 lds
    buffer_load_dwordx4 v2, s[8:11], s37 offen offset:1024 sc1 lds
    s_add_u32 s35, s35, 1
    s_and_b32 s36, s35, 1
    s_xor_b32 s36, s36, 1
    s_add_u32 s30, s35, 3
    s_and_b32 s30, s30, 3
    s_lshl_b32 s30, s30, 13
    s_add_u32 s57, s30, s40
    s_xor_b32 s30, s30, 0x4000
    s_add_u32 s38, s30, s40
    s_add_u32 s44, s44, 1
    s_add_u32 s51, s41, 16384
    s_add_u32 s3, s51, 4096
    s_add_u32 s41, s41, 786432
    s_add_u32 s43, s43, 1
    s_waitcnt lgkmcnt(10)
    v_min_u32 v88, -2, v88
    v_min_u32 v89, -2, v89
    v_min_u32 v90, -2, v90
    v_min_u32 v91, -2, v91
    s_nop 12
    buffer_load_dword v33, v12, s[8:11], s4 offen sc1
    buffer_load_dwordx4 v2, s[8:11], s37 offen sc1 lds
    buffer_load_dwordx4 v2, s[8:11], s37 offen offset:1024 sc1 lds
    s_waitcnt lgkmcnt(0)
    s_branch L_ch_stepS0
L_ch_pwaitS0:
    s_mov_b32 s27, 0
L_poll_22:
    buffer_load_dword v14, v11, s[8:11], s46 offen sc1
    s_waitcnt vmcnt(0)
    v_cmp_gt_u32 vcc, s43, v14
    s_cbranch_vccz L_pollok_23
    s_sleep 0
    s_add_u32 s27, s27, 1
    s_cmp_lt_u32 s27, 200000
    s_cbranch_scc1 L_poll_22
    s_branch L_ch_fail
L_pollok_23:
    s_branch L_ch_pokS0
L_ch_missaS0:
    s_mov_b32 s27, 0
L_ch_pollaS0:
    buffer_load_dwordx4 v[40:43], v2, s[8:11], s39 offen sc1
    buffer_load_dwordx4 v[44:47], v2, s[8:11], s39 offen offset:1024 sc1
    s_waitcnt vmcnt(3)
    v_mfma_f32_16x16x32_bf16 v[140:143], v[136:139], v[48:51], 0
    v_bitop3_b32 v70, v48, v50, s36 bitop3:0x7e
    s_waitcnt vmcnt(2)
    v_mfma_f32_16x16x32_bf16 v[140:143], v[136:139], v[52:55], v[140:143]
    v_bitop3_b32 v71, v52, v54, s36 bitop3:0x7e
    v_bitop3_b32 v70, v70, v71, 1 bitop3:0xa8
    v_cmp_ne_u32 vcc, 0, v70
    s_nop 3
    s_cbranch_vccz L_ch_okaS0
    buffer_load_dwordx4 v[48:51], v2, s[8:11], s39 offen sc1
    buffer_load_dwordx4 v[52:55], v2, s[8:11], s39 offen offset:1024 sc1
    s_waitcnt vmcnt(3)
    v_mfma_f32_16x16x32_bf16 v[140:143], v[136:139], v[40:43], 0
    v_bitop3_b32 v70, v40, v42, s36 bitop3:0x7e
    s_waitcnt vmcnt(2)
    v_mfma_f32_16x16x32_bf16 v[140:143], v[136:139], v[44:47], v[140:143]
    v_bitop3_b32 v71, v44, v46, s36 bitop3:0x7e
    v_bitop3_b32 v70, v70, v71, 1 bitop3:0xa8
    v_cmp_ne_u32 vcc, 0, v70
    s_nop 3
    s_cbranch_vccz L_ch_okaS0
    s_add_u32 s27, s27, 1
    s_cmp_lt_u32 s27, 200000
    s_cbranch_scc1 L_ch_pollaS0
    s_branch L_ch_fail
L_ch_hmissS0:
    s_mov_b32 s27, 0
L_ch_hpollS0:
    buffer_load_dword v32, v12, s[8:11], s4 offen sc1
    buffer_load_dwordx4 v2, s[8:11], s37 offen sc1 lds
    buffer_load_dwordx4 v2, s[8:11], s37 offen offset:1024 sc1 lds
    s_waitcnt vmcnt(5)
    v_cmp_gt_u32 vcc, v13, v33
    s_cbranch_vccz L_ch_hokS0
    buffer_load_dword v33, v12, s[8:11], s4 offen sc1
    buffer_load_dwordx4 v2, s[8:11], s37 offen sc1 lds
    buffer_load_dwordx4 v2, s[8:11], s37 offen offset:1024 sc1 lds
    s_waitcnt vmcnt(5)
    v_cmp_gt_u32 vcc, v13, v32
    s_cbranch_vccz L_ch_hokS0
    s_add_u32 s27, s27, 1
    s_cmp_lt_u32 s27, 200000
    s_cbranch_scc1 L_ch_hpollS0
    s_branch L_ch_fail
L_ch_missbS0:
    s_mov_b32 s27, 0
    s_sub_u32 s30, s37, 0
    s_add_u32 s31, s30, 4096
    s_waitcnt lgkmcnt(0)
    ds_read_b128 v[40:43], v2 offset:0
    ds_read_b128 v[44:47], v2 offset:1024
    ds_read_b128 v[48:51], v2 offset:2048
    ds_read_b128 v[52:55], v2 offset:3072
    ds_read_b128 v[56:59], v2 offset:4096
    ds_read_b128 v[60:63], v2 offset:5120
    ds_read_b128 v[64:67], v2 offset:6144
    ds_read_b128 v[68:71], v2 offset:7168
    s_waitcnt lgkmcnt(0)
    ds_read_b128 v[104:107], v3 offset:0
    ds_read_b128 v[108:111], v3 offset:1024
    ds_read_b128 v[112:115], v3 offset:2048
    ds_read_b128 v[116:119], v3 offset:3072
    ds_read_b128 v[120:123], v3 offset:4096
    ds_read_b128 v[124:127], v3 offset:5120
    ds_read_b128 v[128:131], v3 offset:6144
    ds_read_b128 v[132:135], v3 offset:7168
    ds_read_b128 v[136:139], v3 offset:8192
    ds_read_b128 v[140:143], v3 offset:9216
    s_branch L_ch_chkbS0
L_ch_pollbS0:
    buffer_load_dwordx4 v[40:43], v2, s[8:11], s30 offen offset:0 sc1
    buffer_load_dwordx4 v[44:47], v2, s[8:11], s30 offen offset:1024 sc1
    buffer_load_dwordx4 v[48:51], v2, s[8:11], s30 offen offset:2048 sc1
    buffer_load_dwordx4 v[52:55], v2, s[8:11], s30 offen offset:3072 sc1
    buffer_load_dwordx4 v[56:59], v2, s[8:11], s31 offen offset:0 sc1
    buffer_load_dwordx4 v[60:63], v2, s[8:11], s31 offen offset:1024 sc1
    buffer_load_dwordx4 v[64:67], v2, s[8:11], s31 offen offset:2048 sc1
    buffer_load_dwordx4 v[68:71], v2, s[8:11], s31 offen offset:3072 sc1
    s_add_u32 s27, s27, 1
    s_cmp_lt_u32 s27, 200000
    s_cbranch_scc0 L_ch_fail
    s_waitcnt vmcnt(0)
L_ch_chkbS0:
    v_max_u32 v23, v40, v41
    v_max3_u32 v23, v23, v42, v43
    v_max3_u32 v23, v23, v44, v45
    v_max3_u32 v23, v23, v46, v47
    v_max3_u32 v23, v23, v48, v49
    v_max3_u32 v23, v23, v50, v51
    v_max3_u32 v23, v23, v52, v53
    v_max3_u32 v23, v23, v54, v55
    v_max3_u32 v23, v23, v56, v57
    v_max3_u32 v23, v23, v58, v59
    v_max3_u32 v23, v23, v60, v61
    v_max3_u32 v23, v23, v62, v63
    v_max3_u32 v23, v23, v64, v65
    v_max3_u32 v23, v23, v66, v67
    v_max3_u32 v23, v23, v68, v69
    v_max3_u32 v23, v23, v70, v71
    v_cmp_eq_u32 vcc, -1, v23
    s_cbranch_vccnz L_ch_pollbS0
    v_mov_b64 v[72:73], 0
    v_mov_b64 v[74:75], 0
    v_mov_b64 v[76:77], 0
    v_mov_b64 v[78:79], 0
    v_mov_b64 v[80:81], 0
    v_mov_b64 v[82:83], 0
    v_mov_b64 v[84:85], 0
    v_mov_b64 v[86:87], 0
    s_waitcnt lgkmcnt(0)
    s_nop 0
    v_smfmac_f32_16x16x64_bf16 v[72:75], v[40:43], v[104:111], v1
    v_smfmac_f32_16x16x64_bf16 v[76:79], v[40:43], v[112:119], v1
    v_smfmac_f32_16x16x64_bf16 v[72:75], v[44:47], v[120:127], v1
    v_smfmac_f32_16x16x64_bf16 v[76:79], v[44:47], v[128:135], v1
    v_smfmac_f32_16x16x64_bf16 v[72:75], v[48:51], v[136:143], v1
    v_smfmac_f32_16x16x64_bf16 v[76:79], v[48:51], a[248:255], v1
    v_smfmac_f32_16x16x64_bf16 v[72:75], v[52:55], a[240:247], v1
    v_smfmac_f32_16x16x64_bf16 v[76:79], v[52:55], a[232:239], v1
    ds_read_b128 v[104:107], v3 offset:10240
    v_smfmac_f32_16x16x64_bf16 v[72:75], v[56:59], a[224:231], v1
    v_smfmac_f32_16x16x64_bf16 v[72:75], v[60:63], a[208:215], v1
    ds_read_b128 v[108:111], v3 offset:11264
    v_smfmac_f32_16x16x64_bf16 v[72:75], v[64:67], a[192:199], v1
    v_smfmac_f32_16x16x64_bf16 v[72:75], v[68:71], a[176:183], v1
    ds_read_b128 v[112:115], v3 offset:12288
    v_smfmac_f32_16x16x64_bf16 v[76:79], v[56:59], a[216:223], v1
    ds_read_b128 v[116:119], v3 offset:13312
    v_smfmac_f32_16x16x64_bf16 v[76:79], v[60:63], a[200:207], v1
    v_add_f32 v72, v72, v74
    v_smfmac_f32_16x16x64_bf16 v[76:79], v[64:67], a[184:191], v1
    ds_read_b128 v[120:123], v3 offset:14336
    v_add_f32 v73, v73, v75
    v_smfmac_f32_16x16x64_bf16 v[76:79], v[68:71], a[168:175], v1
    v_cmp_u_f32 vcc, v72, v73
    v_smfmac_f32_16x16x64_bf16 v[80:83], v[40:43], a[160:167], v1
    ds_read_b128 v[124:127], v3 offset:15360
    v_mul_f32 v72, s45, v72
    v_mul_f32 v73, s45, v73
    v_smfmac_f32_16x16x64_bf16 v[84:87], v[40:43], a[152:159], v1
    s_branch L_ch_okbS0
L_ch_lastS0:
    ds_read_b64 v[90:91], v10 offset:8192
    s_waitcnt lgkmcnt(0)
    v_min_u32 v88, -2, v88
    v_min_u32 v89, -2, v89
    v_min_u32 v90, -2, v90
    v_min_u32 v91, -2, v91
    buffer_store_dwordx2 v[90:91], v10, s[8:11], s56 offen offset:0 sc1
    buffer_store_dwordx2 v[88:89], v10, s[8:11], s56 offen offset:2048 sc1
    s_sub_u32 s35, s35, 1
    s_waitcnt vmcnt(0) lgkmcnt(0)
    s_barrier
    s_add_u32 s33, s33, 1
    s_cmp_lt_u32 s33, 2
    s_cbranch_scc1 L_ch_layerS0
    s_endpgm
L_ch_safeS0:
    s_cmp_eq_u32 s34, 63
    s_cbranch_scc1 L_ch_lastS0
    v_max3_f32 v133, v96, v97, v100
    v_max_f32 v133, v133, v101
    v_mov_b32 v135, v133
    s_nop 1
    v_permlane16_swap_b32 v133, v135
    s_nop 1
    v_max_f32 v133, v133, v135
    v_mov_b32 v135, v133
    s_nop 1
    v_permlane32_swap_b32 v133, v135
    s_nop 1
    v_max_f32 v133, v133, v135
    ds_write_b32 v2, v133 offset:4096
    s_waitcnt lgkmcnt(0)
    s_barrier
    ds_read_b128 v[128:131], v2 offset:4096
    s_waitcnt lgkmcnt(0)
    v_max3_f32 v133, v128, v129, v130
    v_max_f32 v133, v133, v131
    v_sub_f32 v98, v96, v133
    v_exp_f32 v98, v98
    v_sub_f32 v99, v97, v133
    v_exp_f32 v99, v99
    v_sub_f32 v102, v100, v133
    v_exp_f32 v102, v102
    v_sub_f32 v103, v101, v133
    v_exp_f32 v103, v103
    s_nop 0
    v_cvt_pk_bf16_f32 v98, v98, v99
    v_cvt_pk_bf16_f32 v20, v102, v103
    v_cvt_pk_bf16_f32 v23, v102, v103
    ds_write_b32 v2, v98 offset:10240
    s_waitcnt lgkmcnt(0)
    s_barrier
    ds_read_b128 v[128:131], v2 offset:10240
    s_waitcnt lgkmcnt(0)
    v_mfma_f32_16x16x32_bf16 v[132:135], v[16:19], v[128:131], 0
    v_mfma_f32_16x16x32_bf16 v[136:139], v[32:35], v[128:131], 0
    v_mfma_f32_16x16x32_bf16 v[140:143], v[36:39], v[128:131], 0
    s_nop 7
    v_mfma_f32_16x16x16_bf16 v[132:135], v[16:17], v[20:21], v[132:135]
    v_mfma_f32_16x16x16_bf16 v[136:139], v[88:89], v[20:21], v[136:139]
    v_mfma_f32_16x16x16_bf16 v[140:143], v[88:89], v[22:23], v[140:143]
    s_nop 7
    v_rcp_f32 v134, v132
    s_mov_b64 vcc, 0
    s_branch L_ch_normS0
L_ch_layerS1:
    s_mov_b32 s30, 0
    s_mul_i32 s41, s32, 24576
    s_add_u32 s41, s41, s30
    s_add_u32 s41, s41, 1048576
    s_lshl_b32 s56, s32, 12
    s_add_u32 s56, s56, 61341696
    s_mul_i32 s42, s32, 4096
    s_add_u32 s42, s42, s30
    s_add_u32 s42, s42, 52428800
    s_lshl_b32 s43, s33, 7
    s_add_u32 s43, s43, 1
    s_mov_b32 s34, 0
    s_mov_b32 m0, 2048
    v_bfe_u32 v48, v2, 6, 2
    v_bfe_u32 v49, v2, 4, 1
    v_lshl_add_u32 v48, v48, 1, v49
    v_lshlrev_b32 v48, 10, v48
    v_lshrrev_b32 v49, 8, v2
    v_lshl_add_u32 v48, v49, 7, v48
    v_bfe_u32 v49, v2, 5, 1
    v_lshl_add_u32 v48, v49, 6, v48
    v_add_u32 v48, 4, v48
    buffer_load_dword v40, v48, s[12:15], 0 offen offset:0
    buffer_load_dword v41, v48, s[12:15], 0 offen offset:16
    buffer_load_dword v42, v48, s[12:15], 0 offen offset:32
    buffer_load_dword v43, v48, s[12:15], 0 offen offset:48
    buffer_load_dword v44, v48, s[12:15], 0 offen offset:512
    buffer_load_dword v45, v48, s[12:15], 0 offen offset:528
    buffer_load_dword v46, v48, s[12:15], 0 offen offset:544
    buffer_load_dword v47, v48, s[12:15], 0 offen offset:560
    v_mov_b64 v[72:73], 0
    v_mov_b64 v[74:75], 0
    v_mov_b64 v[76:77], 0
    v_mov_b64 v[78:79], 0
    v_mov_b64 v[80:81], 0
    v_mov_b64 v[82:83], 0
    v_mov_b64 v[84:85], 0
    v_mov_b64 v[86:87], 0
    v_mov_b64 v[88:89], 0
    v_mov_b64 v[90:91], 0
    v_mov_b64 v[92:93], 0
    v_mov_b64 v[94:95], 0
    v_mov_b64 v[96:97], 0
    v_mov_b64 v[98:99], 0
    v_mov_b64 v[100:101], 0
    v_mov_b64 v[102:103], 0
    ds_read_b128 v[104:107], v3 offset:0
    ds_read_b128 v[108:111], v3 offset:1024
    ds_read_b128 v[112:115], v3 offset:2048
    ds_read_b128 v[116:119], v3 offset:3072
    ds_read_b128 v[120:123], v3 offset:4096
    ds_read_b128 v[124:127], v3 offset:5120
    ds_read_b128 v[128:131], v3 offset:6144
    ds_read_b128 v[132:135], v3 offset:7168
    ds_read_b128 v[136:139], v3 offset:8192
    ds_read_b128 v[140:143], v3 offset:9216
    s_waitcnt vmcnt(0)
    v_min_u32 v40, -2, v40
    v_min_u32 v41, -2, v41
    v_min_u32 v42, -2, v42
    v_min_u32 v43, -2, v43
    v_min_u32 v44, -2, v44
    v_min_u32 v45, -2, v45
    v_min_u32 v46, -2, v46
    v_min_u32 v47, -2, v47
    ds_write_b128 v2, v[40:43] offset:2048
    ds_write_b128 v2, v[44:47] offset:3072
    s_mov_b32 s27, 0
L_poll_24:
    buffer_load_dword v14, v11, s[8:11], s46 offen sc1
    s_waitcnt vmcnt(0)
    v_cmp_gt_u32 vcc, s43, v14
    s_cbranch_vccz L_pollok_25
    s_sleep 1
    s_add_u32 s27, s27, 1
    s_cmp_lt_u32 s27, 200000
    s_cbranch_scc1 L_poll_24
    s_branch L_ch_fail
L_pollok_25:
    buffer_load_dwordx4 v[24:27], v9, s[8:11], s41 offen sc1
    buffer_load_dwordx4 v[28:31], v9, s[8:11], s41 offen offset:2048 sc1
    s_add_u32 s35, s35, 1
    s_and_b32 s36, s35, 1
    s_xor_b32 s36, s36, 1
    s_add_u32 s30, s35, 3
    s_and_b32 s30, s30, 3
    s_lshl_b32 s30, s30, 13
    s_add_u32 s57, s30, s40
    s_xor_b32 s30, s30, 0x4000
    s_add_u32 s38, s30, s40
    s_add_u32 s44, s44, 1
    s_add_u32 s51, s41, 17408
    s_add_u32 s3, s51, 4096
    s_add_u32 s41, s41, 786432
    s_add_u32 s43, s43, 1
    v_mov_b32 v32, -1
    s_waitcnt lgkmcnt(0)
    s_branch L_ch_inS1
L_ch_stepS1:
    s_waitcnt vmcnt(5)
    v_cmp_gt_u32 vcc, v13, v32
    s_cbranch_vccnz L_ch_hmissS1
L_ch_hokS1:
    s_waitcnt vmcnt(3)

L_ch_inS1:
    s_barrier
    ds_read_b128 v[40:43], v2 offset:0
    ds_read_b128 v[44:47], v2 offset:1024
    ds_read_b128 v[48:51], v2 offset:2048
    buffer_load_dwordx4 v[32:35], v2, s[8:11], s51 offen sc1
    s_waitcnt lgkmcnt(2)
    v_smfmac_f32_16x16x64_bf16 v[72:75], v[40:43], v[104:111], v1
    ds_read_b128 v[52:55], v2 offset:3072
    v_smfmac_f32_16x16x64_bf16 v[76:79], v[40:43], v[112:119], v1
    ds_read_b128 v[56:59], v2 offset:4096
    s_waitcnt lgkmcnt(3)
    v_smfmac_f32_16x16x64_bf16 v[72:75], v[44:47], v[120:127], v1
    buffer_load_dwordx4 v[36:39], v2, s[8:11], s3 offen sc1
    v_smfmac_f32_16x16x64_bf16 v[76:79], v[44:47], v[128:135], v1
    ds_read_b128 v[60:63], v2 offset:5120
    s_waitcnt lgkmcnt(3)
    v_smfmac_f32_16x16x64_bf16 v[72:75], v[48:51], v[136:143], v1
    ds_read_b128 v[64:67], v2 offset:6144
    v_smfmac_f32_16x16x64_bf16 v[76:79], v[48:51], a[248:255], v1
    s_waitcnt lgkmcnt(3)
    v_smfmac_f32_16x16x64_bf16 v[72:75], v[52:55], a[240:247], v1
    ds_read_b128 v[68:71], v2 offset:7168
    v_smfmac_f32_16x16x64_bf16 v[76:79], v[52:55], a[232:239], v1
    ds_read_b128 v[104:107], v3 offset:10240
    s_waitcnt lgkmcnt(4)
    v_smfmac_f32_16x16x64_bf16 v[72:75], v[56:59], a[224:231], v1
    s_waitcnt lgkmcnt(3)
    v_smfmac_f32_16x16x64_bf16 v[72:75], v[60:63], a[208:215], v1
    ds_read_b128 v[108:111], v3 offset:11264
    s_waitcnt lgkmcnt(3)
    v_smfmac_f32_16x16x64_bf16 v[72:75], v[64:67], a[192:199], v1
    buffer_store_dwordx2 v[88:89], v10, s[8:11], s56 offen offset:2560 sc1
    s_waitcnt lgkmcnt(2)
    v_smfmac_f32_16x16x64_bf16 v[72:75], v[68:71], a[176:183], v1
    ds_read_b128 v[112:115], v3 offset:12288
    v_smfmac_f32_16x16x64_bf16 v[76:79], v[56:59], a[216:223], v1
    ds_read_b128 v[116:119], v3 offset:13312
    v_smfmac_f32_16x16x64_bf16 v[76:79], v[60:63], a[200:207], v1
    v_add_f32 v72, v72, v74
    v_smfmac_f32_16x16x64_bf16 v[76:79], v[64:67], a[184:191], v1
    ds_read_b128 v[120:123], v3 offset:14336
    v_add_f32 v73, v73, v75
    v_smfmac_f32_16x16x64_bf16 v[76:79], v[68:71], a[168:175], v1
    buffer_store_dwordx2 v[90:91], v10, s[8:11], s56 offen offset:512 sc1
    v_cmp_u_f32 vcc, v72, v73
    v_smfmac_f32_16x16x64_bf16 v[80:83], v[40:43], a[160:167], v1
    ds_read_b128 v[124:127], v3 offset:15360
    v_mul_f32 v72, s45, v72
    v_mul_f32 v73, s45, v73
    v_smfmac_f32_16x16x64_bf16 v[84:87], v[40:43], a[152:159], v1
    s_cbranch_vccnz L_ch_missbS1
L_ch_okbS1:
    s_waitcnt lgkmcnt(4)
    v_add_f32 v76, v76, v78
    v_add_f32 v77, v77, v79
    v_smfmac_f32_16x16x64_bf16 v[80:83], v[44:47], v[104:111], v1
    ds_read_b128 v[128:131], v3 offset:16384
    v_mul_f32 v76, s45, v76
    v_mul_f32 v77, s45, v77
    v_smfmac_f32_16x16x64_bf16 v[84:87], v[44:47], a[144:151], v1
    s_waitcnt lgkmcnt(3)
    v_cvt_pk_bf16_f32 v72, v72, v76
    v_cvt_pk_bf16_f32 v73, v73, v77
    v_smfmac_f32_16x16x64_bf16 v[80:83], v[48:51], v[112:119], v1
    ds_write2_b32 v4, v72, v73 offset1:4
    v_smfmac_f32_16x16x64_bf16 v[84:87], v[48:51], a[136:143], v1
    ds_read_b128 v[132:135], v3 offset:17408
    v_mov_b64 v[74:75], 0
    v_smfmac_f32_16x16x64_bf16 v[80:83], v[52:55], a[128:135], v1
    ds_read_b128 v[136:139], v3 offset:18432
    v_mov_b64 v[76:77], 0
    v_smfmac_f32_16x16x64_bf16 v[84:87], v[52:55], a[120:127], v1
    ds_read_b128 v[140:143], v3 offset:19456
    v_mov_b64 v[78:79], 0
    v_smfmac_f32_16x16x64_bf16 v[80:83], v[56:59], a[112:119], v1
    s_waitcnt lgkmcnt(3)
    s_barrier
    v_smfmac_f32_16x16x64_bf16 v[80:83], v[60:63], a[96:103], v1
    ds_read_b128 v[104:107], v6 offset:12288
    v_mov_b64 v[72:73], 0
    v_smfmac_f32_16x16x64_bf16 v[80:83], v[64:67], a[88:95], v1
    ds_read_b128 v[108:111], v6 offset:12864
    v_smfmac_f32_16x16x64_bf16 v[80:83], v[68:71], a[80:87], v1
    ds_read_b128 v[112:115], v6 offset:13440
    v_mov_b64 v[88:89], 0
    v_smfmac_f32_16x16x64_bf16 v[84:87], v[56:59], a[104:111], v1
    ds_read_b128 v[116:119], v6 offset:14016
    v_mov_b64 v[90:91], 0
    v_smfmac_f32_16x16x64_bf16 v[84:87], v[60:63], v[120:127], v1
    s_waitcnt vmcnt(4)
    s_waitcnt lgkmcnt(6)
    v_add_f32 v80, v80, v82
    v_smfmac_f32_16x16x64_bf16 v[84:87], v[64:67], v[128:135], v1
    s_waitcnt lgkmcnt(4)
    v_add_f32 v81, v81, v83
    v_smfmac_f32_16x16x64_bf16 v[84:87], v[68:71], v[136:143], v1
    s_mov_b32 s56, s42
    s_waitcnt lgkmcnt(2)
    v_smfmac_f32_16x16x64_bf16 v[96:99], v[24:27], v[104:111], v1
    s_mov_b32 s37, s57
    s_waitcnt lgkmcnt(0)
    v_smfmac_f32_16x16x64_bf16 v[96:99], v[28:31], v[112:119], v1
    v_add_f32 v84, v84, v86
    v_add_f32 v85, v85, v87
    v_smfmac_f32_16x16x64_bf16 v[88:91], v[40:43], a[72:79], v1
    buffer_load_dwordx4 v[24:27], v9, s[8:11], s41 offen sc1
    v_cvt_pk_bf16_f32 v80, v80, v84
    v_cvt_pk_bf16_f32 v81, v81, v85
    v_smfmac_f32_16x16x64_bf16 v[92:95], v[40:43], a[64:71], v1
    ds_write2_b32 v5, v80, v81 offset1:4
    v_add_f32 v96, v96, v98
    v_add_f32 v97, v97, v99
    v_smfmac_f32_16x16x64_bf16 v[88:91], v[44:47], a[56:63], v1
    buffer_load_dwordx4 v[28:31], v9, s[8:11], s41 offen offset:2048 sc1
    v_exp_f32 v98, v96
    v_exp_f32 v99, v97
    v_mov_b64 v[82:83], 0
    v_cvt_pk_bf16_f32 v98, v98, v99
    v_smfmac_f32_16x16x64_bf16 v[92:95], v[44:47], a[48:55], v1
    ds_write_b32 v2, v98 offset:10244
    v_smfmac_f32_16x16x64_bf16 v[88:91], v[48:51], a[40:47], v1
    buffer_store_dword v15, v8, s[8:11], s38 offen sc1
    v_mov_b64 v[84:85], 0
    v_smfmac_f32_16x16x64_bf16 v[92:95], v[48:51], a[32:39], v1
    ds_read_b128 v[40:43], v3 offset:20480
    v_mov_b64 v[86:87], 0
    v_smfmac_f32_16x16x64_bf16 v[88:91], v[52:55], a[24:31], v1
    ds_read_b128 v[44:47], v3 offset:21504
    v_mov_b64 v[80:81], 0
    v_smfmac_f32_16x16x64_bf16 v[92:95], v[52:55], a[16:23], v1
    s_waitcnt lgkmcnt(2)
    s_barrier
    ds_read_b128 v[120:123], v2 offset:8192
    v_smfmac_f32_16x16x64_bf16 v[88:91], v[56:59], a[8:15], v1
    ds_read_b128 v[124:127], v2 offset:9216
    v_smfmac_f32_16x16x64_bf16 v[88:91], v[60:63], v[248:255], v1
    ds_read_b128 v[128:131], v2 offset:10240
    v_smfmac_f32_16x16x64_bf16 v[88:91], v[64:67], v[232:239], v1
    v_smfmac_f32_16x16x64_bf16 v[88:91], v[68:71], v[216:223], v1
    ds_read_b128 v[48:51], v3 offset:22528
    s_waitcnt lgkmcnt(3)
    v_smfmac_f32_16x16x64_bf16 v[100:103], v[120:123], v[104:111], v1
    ds_read_b128 v[52:55], v3 offset:23552
    s_waitcnt lgkmcnt(3)
    v_smfmac_f32_16x16x64_bf16 v[100:103], v[124:127], v[112:119], v1
    s_waitcnt lgkmcnt(2)
    v_add_f32 v88, v88, v90
    v_mfma_f32_16x16x32_bf16 v[132:135], v[16:19], v[128:131], 0
    ds_read_b128 v[104:107], v3 offset:24576
    v_add_f32 v89, v89, v91
    v_cvt_pk_bf16_f32 v88, v88, v89
    v_smfmac_f32_16x16x64_bf16 v[92:95], v[56:59], a[0:7], v1
    ds_read_b128 v[108:111], v3 offset:25600
    v_add_f32 v100, v100, v102
    v_add_f32 v101, v101, v103
    v_smfmac_f32_16x16x64_bf16 v[92:95], v[60:63], v[240:247], v1
    ds_read_b128 v[112:115], v3 offset:26624
    v_exp_f32 v102, v100
    v_smfmac_f32_16x16x64_bf16 v[92:95], v[64:67], v[224:231], v1
    ds_read_b128 v[116:119], v3 offset:27648
    v_exp_f32 v103, v101
    v_smfmac_f32_16x16x64_bf16 v[92:95], v[68:71], v[208:215], v1
    s_waitcnt vmcnt(5)
    s_cmp_eq_u32 s34, 63
    v_cvt_pk_bf16_f32 v20, v102, v103
    v_swap_b32 v34, v36
    v_swap_b32 v35, v37
    v_mfma_f32_16x16x16_bf16 v[132:135], v[16:17], v[20:21], v[132:135]
    s_cselect_b32 s30, 0, s55
    v_add_f32 v92, v92, v94
    v_add_f32 v93, v93, v95
    v_mfma_f32_16x16x32_bf16 v[136:139], v[32:35], v[128:131], 0
    ds_read_b128 v[120:123], v3 offset:28672
    v_cvt_pk_bf16_f32 v89, v92, v93
    v_mfma_f32_16x16x32_bf16 v[140:143], v[36:39], v[128:131], 0
    ds_read_b128 v[124:127], v3 offset:29696
    v_mov_b32 v23, v20
    s_nop 0
    v_mfma_f32_16x16x16_bf16 v[136:139], v[88:89], v[20:21], v[136:139]
    s_nop 1
    v_mfma_f32_16x16x16_bf16 v[140:143], v[88:89], v[22:23], v[140:143]
    s_nop 0
    v_rcp_f32 v134, v132
    v_subrev_u32 v133, s54, v132
    v_cmp_le_u32 vcc, s30, v133
L_ch_normS1:
    v_mul_f32 v136, v134, v136
    v_mul_f32 v137, v134, v137
    v_mul_f32 v138, v134, v138
    v_mul_f32 v139, v134, v139
    v_mul_f32 v140, v134, v140
    v_mul_f32 v141, v134, v141
    v_mul_f32 v142, v134, v142
    v_mul_f32 v143, v134, v143
    v_cvt_pk_bf16_f32 v136, v136, v140
    v_cvt_pk_bf16_f32 v137, v137, v141
    v_cvt_pk_bf16_f32 v138, v138, v142
    v_cvt_pk_bf16_f32 v139, v139, v143
    ds_write_b128 v2, v[136:139] offset:13312
    s_cbranch_vccnz L_ch_safeS1
    v_smfmac_f32_16x16x64_bf16 v[72:75], v[136:139], v[200:207], v1
    s_add_u32 s34, s34, 1
    s_add_u32 s42, s42, 131072
    v_smfmac_f32_16x16x64_bf16 v[76:79], v[136:139], v[168:175], v1
    s_waitcnt lgkmcnt(0)
    s_barrier
    ds_read_b128 v[140:143], v2 offset:14336
    ds_read_b128 v[96:99], v2 offset:15360
    ds_read_b128 v[100:103], v2 offset:12288
    v_smfmac_f32_16x16x64_bf16 v[80:83], v[136:139], v[152:159], v1
    v_smfmac_f32_16x16x64_bf16 v[84:87], v[136:139], v[144:151], v1
    s_waitcnt lgkmcnt(2)
    v_smfmac_f32_16x16x64_bf16 v[72:75], v[140:143], v[192:199], v1
    ds_read_b128 v[56:59], v3 offset:30720
    s_waitcnt lgkmcnt(2)
    v_smfmac_f32_16x16x64_bf16 v[72:75], v[96:99], v[184:191], v1
    ds_read_b128 v[60:63], v3 offset:31744
    s_waitcnt lgkmcnt(2)
    v_smfmac_f32_16x16x64_bf16 v[72:75], v[100:103], v[176:183], v1
    ds_read_b128 v[64:67], v3 offset:32768
    v_smfmac_f32_16x16x64_bf16 v[76:79], v[140:143], v[160:167], v1
    ds_read_b128 v[68:71], v3 offset:33792
    v_smfmac_f32_16x16x64_bf16 v[76:79], v[96:99], v[40:47], v1
    ds_read_b128 v[128:131], v3 offset:34816
    v_cvt_pk_bf16_f32 v72, v72, v74
    v_cvt_pk_bf16_f32 v73, v73, v75
    v_and_or_b32 v72, v72, -2, s36
    v_smfmac_f32_16x16x64_bf16 v[76:79], v[100:103], v[48:55], v1
    buffer_store_dwordx2 v[72:73], v7, s[8:11], 0 offen offset:0 sc1
    v_smfmac_f32_16x16x64_bf16 v[80:83], v[140:143], v[104:111], v1
    ds_read_b128 v[132:135], v3 offset:35840
    v_smfmac_f32_16x16x64_bf16 v[80:83], v[96:99], v[112:119], v1
    v_cvt_pk_bf16_f32 v76, v76, v78
    v_cvt_pk_bf16_f32 v77, v77, v79
    v_and_or_b32 v76, v76, -2, s36
    v_smfmac_f32_16x16x64_bf16 v[80:83], v[100:103], v[120:127], v1
    buffer_store_dwordx2 v[76:77], v7, s[8:11], 0 offen offset:2048 sc1
    s_waitcnt lgkmcnt(4)
    v_smfmac_f32_16x16x64_bf16 v[84:87], v[140:143], v[56:63], v1
    s_waitcnt lgkmcnt(2)
    v_smfmac_f32_16x16x64_bf16 v[84:87], v[96:99], v[64:71], v1
    s_waitcnt lgkmcnt(0)
    v_cvt_pk_bf16_f32 v80, v80, v82
    v_cvt_pk_bf16_f32 v81, v81, v83
    v_and_or_b32 v80, v80, -2, s36
    v_smfmac_f32_16x16x64_bf16 v[84:87], v[100:103], v[128:135], v1
    buffer_store_dwordx2 v[80:81], v7, s[8:11], s50 offen offset:0 sc1
    ds_read_b128 v[136:139], v2 offset:11264
    s_nop 5
    v_cvt_pk_bf16_f32 v84, v84, v86
    v_cvt_pk_bf16_f32 v85, v85, v87
    v_and_or_b32 v84, v84, -2, s36
    buffer_store_dwordx2 v[84:85], v7, s[8:11], s50 offen offset:2048 sc1
    s_barrier
    v_mov_b32 v13, s44
    v_mov_b64 v[72:73], 0
    v_mov_b64 v[74:75], 0
    v_mov_b64 v[76:77], 0
    v_mov_b64 v[78:79], 0
    v_mov_b64 v[80:81], 0
    v_mov_b64 v[82:83], 0
    v_mov_b64 v[92:93], 0
    v_mov_b64 v[94:95], 0
    v_mov_b64 v[96:97], 0
    v_mov_b64 v[98:99], 0
    v_mov_b64 v[100:101], 0
    v_mov_b64 v[102:103], 0
    v_mov_b64 v[84:85], 0
    v_mov_b64 v[86:87], 0
    s_nop 8
    buffer_load_dwordx4 v[40:43], v2, s[8:11], s39 offen sc1
    buffer_load_dwordx4 v[44:47], v2, s[8:11], s39 offen offset:1024 sc1
    s_nop 15
    s_nop 15
    s_nop 7
    buffer_load_dwordx4 v[48:51], v2, s[8:11], s39 offen sc1
    buffer_load_dwordx4 v[52:55], v2, s[8:11], s39 offen offset:1024 sc1
    ds_read_b64 v[90:91], v10 offset:8704
    ds_read_b128 v[104:107], v3 offset:0
    ds_read_b128 v[108:111], v3 offset:1024
    ds_read_b128 v[112:115], v3 offset:2048
    ds_read_b128 v[116:119], v3 offset:3072
    ds_read_b128 v[120:123], v3 offset:4096
    ds_read_b128 v[124:127], v3 offset:5120
    ds_read_b128 v[128:131], v3 offset:6144
    ds_read_b128 v[132:135], v3 offset:7168
    s_waitcnt lgkmcnt(9)
    s_waitcnt vmcnt(3)
    v_mfma_f32_16x16x32_bf16 v[140:143], v[136:139], v[40:43], 0
    v_bitop3_b32 v70, v40, v42, s36 bitop3:0x7e
    s_waitcnt vmcnt(2)
    v_mfma_f32_16x16x32_bf16 v[140:143], v[136:139], v[44:47], v[140:143]
    v_bitop3_b32 v71, v44, v46, s36 bitop3:0x7e
    v_bitop3_b32 v70, v70, v71, 1 bitop3:0xa8
    v_cmp_ne_u32 vcc, 0, v70
    s_nop 3
    s_cbranch_vccnz L_ch_missaS1
L_ch_okaS1:
    v_add_f32_dpp v140, v140, v140 row_ror:4 row_mask:0xf bank_mask:0xf
    v_add_f32_dpp v141, v141, v141 row_ror:4 row_mask:0xf bank_mask:0xf
    s_nop 0
    v_add_f32_dpp v140, v140, v140 row_ror:8 row_mask:0xf bank_mask:0xf
    v_add_f32_dpp v141, v141, v141 row_ror:8 row_mask:0xf bank_mask:0xf
    v_cvt_pk_bf16_f32 v70, v140, v141
    v_min_u32 v70, -2, v70
    buffer_store_dword v70, v8, s[8:11], s37 offen sc1
    s_nop 3
    buffer_store_dword v13, v21, s[8:11], s5 offen sc1
    ds_read_b128 v[136:139], v3 offset:8192
    ds_read_b128 v[140:143], v3 offset:9216
    s_nop 15
    s_nop 15
    s_nop 15
    buffer_load_dword v32, v12, s[8:11], s4 offen sc1
    buffer_load_dwordx4 v2, s[8:11], s37 offen sc1 lds
    buffer_load_dwordx4 v2, s[8:11], s37 offen offset:1024 sc1 lds
    s_add_u32 s35, s35, 1
    s_and_b32 s36, s35, 1
    s_xor_b32 s36, s36, 1
    s_add_u32 s30, s35, 3
    s_and_b32 s30, s30, 3
    s_lshl_b32 s30, s30, 13
    s_add_u32 s57, s30, s40
    s_xor_b32 s30, s30, 0x4000
    s_add_u32 s38, s30, s40
    s_add_u32 s44, s44, 1
    s_add_u32 s51, s41, 17408
    s_add_u32 s3, s51, 4096
    s_add_u32 s41, s41, 786432
    s_add_u32 s43, s43, 1
    s_waitcnt lgkmcnt(10)
    v_min_u32 v88, -2, v88
    v_min_u32 v89, -2, v89
    v_min_u32 v90, -2, v90
    v_min_u32 v91, -2, v91
    s_nop 12
    buffer_load_dword v33, v12, s[8:11], s4 offen sc1
    buffer_load_dwordx4 v2, s[8:11], s37 offen sc1 lds
    buffer_load_dwordx4 v2, s[8:11], s37 offen offset:1024 sc1 lds
    s_waitcnt lgkmcnt(0)
    s_branch L_ch_stepS1
L_ch_missaS1:
    s_mov_b32 s27, 0
L_ch_pollaS1:
    buffer_load_dwordx4 v[40:43], v2, s[8:11], s39 offen sc1
    buffer_load_dwordx4 v[44:47], v2, s[8:11], s39 offen offset:1024 sc1
    s_waitcnt vmcnt(3)
    v_mfma_f32_16x16x32_bf16 v[140:143], v[136:139], v[48:51], 0
    v_bitop3_b32 v70, v48, v50, s36 bitop3:0x7e
    s_waitcnt vmcnt(2)
    v_mfma_f32_16x16x32_bf16 v[140:143], v[136:139], v[52:55], v[140:143]
    v_bitop3_b32 v71, v52, v54, s36 bitop3:0x7e
    v_bitop3_b32 v70, v70, v71, 1 bitop3:0xa8
    v_cmp_ne_u32 vcc, 0, v70
    s_nop 3
    s_cbranch_vccz L_ch_okaS1
    buffer_load_dwordx4 v[48:51], v2, s[8:11], s39 offen sc1
    buffer_load_dwordx4 v[52:55], v2, s[8:11], s39 offen offset:1024 sc1
    s_waitcnt vmcnt(3)
    v_mfma_f32_16x16x32_bf16 v[140:143], v[136:139], v[40:43], 0
    v_bitop3_b32 v70, v40, v42, s36 bitop3:0x7e
    s_waitcnt vmcnt(2)
    v_mfma_f32_16x16x32_bf16 v[140:143], v[136:139], v[44:47], v[140:143]
    v_bitop3_b32 v71, v44, v46, s36 bitop3:0x7e
    v_bitop3_b32 v70, v70, v71, 1 bitop3:0xa8
    v_cmp_ne_u32 vcc, 0, v70
    s_nop 3
    s_cbranch_vccz L_ch_okaS1
    s_add_u32 s27, s27, 1
    s_cmp_lt_u32 s27, 200000
    s_cbranch_scc1 L_ch_pollaS1
    s_branch L_ch_fail
L_ch_hmissS1:
    s_mov_b32 s27, 0
L_ch_hpollS1:
    buffer_load_dword v32, v12, s[8:11], s4 offen sc1
    buffer_load_dwordx4 v2, s[8:11], s37 offen sc1 lds
    buffer_load_dwordx4 v2, s[8:11], s37 offen offset:1024 sc1 lds
    s_waitcnt vmcnt(5)
    v_cmp_gt_u32 vcc, v13, v33
    s_cbranch_vccz L_ch_hokS1
    buffer_load_dword v33, v12, s[8:11], s4 offen sc1
    buffer_load_dwordx4 v2, s[8:11], s37 offen sc1 lds
    buffer_load_dwordx4 v2, s[8:11], s37 offen offset:1024 sc1 lds
    s_waitcnt vmcnt(5)
    v_cmp_gt_u32 vcc, v13, v32
    s_cbranch_vccz L_ch_hokS1
    s_add_u32 s27, s27, 1
    s_cmp_lt_u32 s27, 200000
    s_cbranch_scc1 L_ch_hpollS1
    s_branch L_ch_fail
L_ch_missbS1:
    s_mov_b32 s27, 0
    s_sub_u32 s30, s37, 2048
    s_add_u32 s31, s30, 4096
    s_waitcnt lgkmcnt(0)
    ds_read_b128 v[40:43], v2 offset:0
    ds_read_b128 v[44:47], v2 offset:1024
    ds_read_b128 v[48:51], v2 offset:2048
    ds_read_b128 v[52:55], v2 offset:3072
    ds_read_b128 v[56:59], v2 offset:4096
    ds_read_b128 v[60:63], v2 offset:5120
    ds_read_b128 v[64:67], v2 offset:6144
    ds_read_b128 v[68:71], v2 offset:7168
    s_waitcnt lgkmcnt(0)
    ds_read_b128 v[104:107], v3 offset:0
    ds_read_b128 v[108:111], v3 offset:1024
    ds_read_b128 v[112:115], v3 offset:2048
    ds_read_b128 v[116:119], v3 offset:3072
    ds_read_b128 v[120:123], v3 offset:4096
    ds_read_b128 v[124:127], v3 offset:5120
    ds_read_b128 v[128:131], v3 offset:6144
    ds_read_b128 v[132:135], v3 offset:7168
    ds_read_b128 v[136:139], v3 offset:8192
    ds_read_b128 v[140:143], v3 offset:9216
    s_branch L_ch_chkbS1
L_ch_pollbS1:
    buffer_load_dwordx4 v[40:43], v2, s[8:11], s30 offen offset:0 sc1
    buffer_load_dwordx4 v[44:47], v2, s[8:11], s30 offen offset:1024 sc1
    buffer_load_dwordx4 v[48:51], v2, s[8:11], s30 offen offset:2048 sc1
    buffer_load_dwordx4 v[52:55], v2, s[8:11], s30 offen offset:3072 sc1
    buffer_load_dwordx4 v[56:59], v2, s[8:11], s31 offen offset:0 sc1
    buffer_load_dwordx4 v[60:63], v2, s[8:11], s31 offen offset:1024 sc1
    buffer_load_dwordx4 v[64:67], v2, s[8:11], s31 offen offset:2048 sc1
    buffer_load_dwordx4 v[68:71], v2, s[8:11], s31 offen offset:3072 sc1
    s_add_u32 s27, s27, 1
    s_cmp_lt_u32 s27, 200000
    s_cbranch_scc0 L_ch_fail
    s_waitcnt vmcnt(0)
L_ch_chkbS1:
    v_max_u32 v23, v40, v41
    v_max3_u32 v23, v23, v42, v43
    v_max3_u32 v23, v23, v44, v45
    v_max3_u32 v23, v23, v46, v47
    v_max3_u32 v23, v23, v48, v49
    v_max3_u32 v23, v23, v50, v51
    v_max3_u32 v23, v23, v52, v53
    v_max3_u32 v23, v23, v54, v55
    v_max3_u32 v23, v23, v56, v57
    v_max3_u32 v23, v23, v58, v59
    v_max3_u32 v23, v23, v60, v61
    v_max3_u32 v23, v23, v62, v63
    v_max3_u32 v23, v23, v64, v65
    v_max3_u32 v23, v23, v66, v67
    v_max3_u32 v23, v23, v68, v69
    v_max3_u32 v23, v23, v70, v71
    v_cmp_eq_u32 vcc, -1, v23
    s_cbranch_vccnz L_ch_pollbS1
    v_mov_b64 v[72:73], 0
    v_mov_b64 v[74:75], 0
    v_mov_b64 v[76:77], 0
    v_mov_b64 v[78:79], 0
    v_mov_b64 v[80:81], 0
    v_mov_b64 v[82:83], 0
    v_mov_b64 v[84:85], 0
    v_mov_b64 v[86:87], 0
    s_waitcnt lgkmcnt(0)
    s_nop 0
    v_smfmac_f32_16x16x64_bf16 v[72:75], v[40:43], v[104:111], v1
    v_smfmac_f32_16x16x64_bf16 v[76:79], v[40:43], v[112:119], v1
    v_smfmac_f32_16x16x64_bf16 v[72:75], v[44:47], v[120:127], v1
    v_smfmac_f32_16x16x64_bf16 v[76:79], v[44:47], v[128:135], v1
    v_smfmac_f32_16x16x64_bf16 v[72:75], v[48:51], v[136:143], v1
    v_smfmac_f32_16x16x64_bf16 v[76:79], v[48:51], a[248:255], v1
    v_smfmac_f32_16x16x64_bf16 v[72:75], v[52:55], a[240:247], v1
    v_smfmac_f32_16x16x64_bf16 v[76:79], v[52:55], a[232:239], v1
    ds_read_b128 v[104:107], v3 offset:10240
    v_smfmac_f32_16x16x64_bf16 v[72:75], v[56:59], a[224:231], v1
    v_smfmac_f32_16x16x64_bf16 v[72:75], v[60:63], a[208:215], v1
    ds_read_b128 v[108:111], v3 offset:11264
    v_smfmac_f32_16x16x64_bf16 v[72:75], v[64:67], a[192:199], v1
    v_smfmac_f32_16x16x64_bf16 v[72:75], v[68:71], a[176:183], v1
    ds_read_b128 v[112:115], v3 offset:12288
    v_smfmac_f32_16x16x64_bf16 v[76:79], v[56:59], a[216:223], v1
    ds_read_b128 v[116:119], v3 offset:13312
    v_smfmac_f32_16x16x64_bf16 v[76:79], v[60:63], a[200:207], v1
    v_add_f32 v72, v72, v74
    v_smfmac_f32_16x16x64_bf16 v[76:79], v[64:67], a[184:191], v1
    ds_read_b128 v[120:123], v3 offset:14336
    v_add_f32 v73, v73, v75
    v_smfmac_f32_16x16x64_bf16 v[76:79], v[68:71], a[168:175], v1
    v_cmp_u_f32 vcc, v72, v73
    v_smfmac_f32_16x16x64_bf16 v[80:83], v[40:43], a[160:167], v1
    ds_read_b128 v[124:127], v3 offset:15360
    v_mul_f32 v72, s45, v72
    v_mul_f32 v73, s45, v73
    v_smfmac_f32_16x16x64_bf16 v[84:87], v[40:43], a[152:159], v1
    s_branch L_ch_okbS1
L_ch_lastS1:
    ds_read_b64 v[90:91], v10 offset:8704
    s_waitcnt lgkmcnt(0)
    v_min_u32 v88, -2, v88
    v_min_u32 v89, -2, v89
    v_min_u32 v90, -2, v90
    v_min_u32 v91, -2, v91
    buffer_store_dwordx2 v[90:91], v10, s[8:11], s56 offen offset:512 sc1
    buffer_store_dwordx2 v[88:89], v10, s[8:11], s56 offen offset:2560 sc1
    s_sub_u32 s35, s35, 1
    s_waitcnt vmcnt(0) lgkmcnt(0)
    s_barrier
    s_add_u32 s33, s33, 1
    s_cmp_lt_u32 s33, 2
    s_cbranch_scc1 L_ch_layerS1
    s_endpgm
L_ch_safeS1:
    s_cmp_eq_u32 s34, 63
    s_cbranch_scc1 L_ch_lastS1
    v_max3_f32 v133, v96, v97, v100
    v_max_f32 v133, v133, v101
    v_mov_b32 v135, v133
    s_nop 1
    v_permlane16_swap_b32 v133, v135
    s_nop 1
    v_max_f32 v133, v133, v135
    v_mov_b32 v135, v133
    s_nop 1
    v_permlane32_swap_b32 v133, v135
    s_nop 1
    v_max_f32 v133, v133, v135
    ds_write_b32 v2, v133 offset:4100
    s_waitcnt lgkmcnt(0)
    s_barrier
    ds_read_b128 v[128:131], v2 offset:4096
    s_waitcnt lgkmcnt(0)
    v_max3_f32 v133, v128, v129, v130
    v_max_f32 v133, v133, v131
    v_sub_f32 v98, v96, v133
    v_exp_f32 v98, v98
    v_sub_f32 v99, v97, v133
    v_exp_f32 v99, v99
    v_sub_f32 v102, v100, v133
    v_exp_f32 v102, v102
    v_sub_f32 v103, v101, v133
    v_exp_f32 v103, v103
    s_nop 0
    v_cvt_pk_bf16_f32 v98, v98, v99
    v_cvt_pk_bf16_f32 v20, v102, v103
    v_cvt_pk_bf16_f32 v23, v102, v103
    ds_write_b32 v2, v98 offset:10244
    s_waitcnt lgkmcnt(0)
    s_barrier
    ds_read_b128 v[128:131], v2 offset:10240
    s_waitcnt lgkmcnt(0)
    v_mfma_f32_16x16x32_bf16 v[132:135], v[16:19], v[128:131], 0
    v_mfma_f32_16x16x32_bf16 v[136:139], v[32:35], v[128:131], 0
    v_mfma_f32_16x16x32_bf16 v[140:143], v[36:39], v[128:131], 0
    s_nop 7
    v_mfma_f32_16x16x16_bf16 v[132:135], v[16:17], v[20:21], v[132:135]
    v_mfma_f32_16x16x16_bf16 v[136:139], v[88:89], v[20:21], v[136:139]
    v_mfma_f32_16x16x16_bf16 v[140:143], v[88:89], v[22:23], v[140:143]
    s_nop 7
    v_rcp_f32 v134, v132
    s_mov_b64 vcc, 0
    s_branch L_ch_normS1
L_ch_layerS2:
    s_mov_b32 s30, 0
    s_mul_i32 s41, s32, 24576
    s_add_u32 s41, s41, s30
    s_add_u32 s41, s41, 1048576
    s_lshl_b32 s56, s32, 12
    s_add_u32 s56, s56, 61341696
    s_mul_i32 s42, s32, 4096
    s_add_u32 s42, s42, s30
    s_add_u32 s42, s42, 52428800
    s_lshl_b32 s43, s33, 7
    s_add_u32 s43, s43, 1
    s_mov_b32 s34, 0
    s_mov_b32 m0, 4096
    v_bfe_u32 v48, v2, 6, 2
    v_bfe_u32 v49, v2, 4, 1
    v_lshl_add_u32 v48, v48, 1, v49
    v_lshlrev_b32 v48, 10, v48
    v_lshrrev_b32 v49, 8, v2
    v_lshl_add_u32 v48, v49, 7, v48
    v_bfe_u32 v49, v2, 5, 1
    v_lshl_add_u32 v48, v49, 6, v48
    v_add_u32 v48, 8, v48
    buffer_load_dword v40, v48, s[12:15], 0 offen offset:0
    buffer_load_dword v41, v48, s[12:15], 0 offen offset:16
    buffer_load_dword v42, v48, s[12:15], 0 offen offset:32
    buffer_load_dword v43, v48, s[12:15], 0 offen offset:48
    buffer_load_dword v44, v48, s[12:15], 0 offen offset:512
    buffer_load_dword v45, v48, s[12:15], 0 offen offset:528
    buffer_load_dword v46, v48, s[12:15], 0 offen offset:544
    buffer_load_dword v47, v48, s[12:15], 0 offen offset:560
    v_mov_b64 v[72:73], 0
    v_mov_b64 v[74:75], 0
    v_mov_b64 v[76:77], 0
    v_mov_b64 v[78:79], 0
    v_mov_b64 v[80:81], 0
    v_mov_b64 v[82:83], 0
    v_mov_b64 v[84:85], 0
    v_mov_b64 v[86:87], 0
    v_mov_b64 v[88:89], 0
    v_mov_b64 v[90:91], 0
    v_mov_b64 v[92:93], 0
    v_mov_b64 v[94:95], 0
    v_mov_b64 v[96:97], 0
    v_mov_b64 v[98:99], 0
    v_mov_b64 v[100:101], 0
    v_mov_b64 v[102:103], 0
    ds_read_b128 v[104:107], v3 offset:0
    ds_read_b128 v[108:111], v3 offset:1024
    ds_read_b128 v[112:115], v3 offset:2048
    ds_read_b128 v[116:119], v3 offset:3072
    ds_read_b128 v[120:123], v3 offset:4096
    ds_read_b128 v[124:127], v3 offset:5120
    ds_read_b128 v[128:131], v3 offset:6144
    ds_read_b128 v[132:135], v3 offset:7168
    ds_read_b128 v[136:139], v3 offset:8192
    ds_read_b128 v[140:143], v3 offset:9216
    s_waitcnt vmcnt(0)
    v_min_u32 v40, -2, v40
    v_min_u32 v41, -2, v41
    v_min_u32 v42, -2, v42
    v_min_u32 v43, -2, v43
    v_min_u32 v44, -2, v44
    v_min_u32 v45, -2, v45
    v_min_u32 v46, -2, v46
    v_min_u32 v47, -2, v47
    ds_write_b128 v2, v[40:43] offset:4096
    ds_write_b128 v2, v[44:47] offset:5120
    s_mov_b32 s27, 0
L_poll_26:
    buffer_load_dword v14, v11, s[8:11], s46 offen sc1
    s_waitcnt vmcnt(0)
    v_cmp_gt_u32 vcc, s43, v14
    s_cbranch_vccz L_pollok_27
    s_sleep 1
    s_add_u32 s27, s27, 1
    s_cmp_lt_u32 s27, 200000
    s_cbranch_scc1 L_poll_26
    s_branch L_ch_fail
L_pollok_27:
    buffer_load_dwordx4 v[24:27], v9, s[8:11], s41 offen sc1
    buffer_load_dwordx4 v[28:31], v9, s[8:11], s41 offen offset:2048 sc1
    s_add_u32 s35, s35, 1
    s_and_b32 s36, s35, 1
    s_xor_b32 s36, s36, 1
    s_add_u32 s30, s35, 3
    s_and_b32 s30, s30, 3
    s_lshl_b32 s30, s30, 13
    s_add_u32 s57, s30, s40
    s_xor_b32 s30, s30, 0x4000
    s_add_u32 s38, s30, s40
    s_add_u32 s44, s44, 1
    s_add_u32 s51, s41, 18432
    s_add_u32 s3, s51, 4096
    s_add_u32 s41, s41, 786432
    s_add_u32 s43, s43, 1
    v_mov_b32 v32, -1
    s_waitcnt lgkmcnt(0)
    s_branch L_ch_inS2
L_ch_stepS2:
    s_waitcnt vmcnt(5)
    v_cmp_gt_u32 vcc, v13, v32
    s_cbranch_vccnz L_ch_hmissS2
L_ch_hokS2:
    s_waitcnt vmcnt(3)

L_ch_inS2:
    s_barrier
    ds_read_b128 v[40:43], v2 offset:0
    ds_read_b128 v[44:47], v2 offset:1024
    ds_read_b128 v[48:51], v2 offset:2048
    buffer_load_dwordx4 v[32:35], v2, s[8:11], s51 offen sc1
    s_waitcnt lgkmcnt(2)
    v_smfmac_f32_16x16x64_bf16 v[72:75], v[40:43], v[104:111], v1
    ds_read_b128 v[52:55], v2 offset:3072
    v_smfmac_f32_16x16x64_bf16 v[76:79], v[40:43], v[112:119], v1
    ds_read_b128 v[56:59], v2 offset:4096
    s_waitcnt lgkmcnt(3)
    v_smfmac_f32_16x16x64_bf16 v[72:75], v[44:47], v[120:127], v1
    buffer_load_dwordx4 v[36:39], v2, s[8:11], s3 offen sc1
    v_smfmac_f32_16x16x64_bf16 v[76:79], v[44:47], v[128:135], v1
    ds_read_b128 v[60:63], v2 offset:5120
    s_waitcnt lgkmcnt(3)
    v_smfmac_f32_16x16x64_bf16 v[72:75], v[48:51], v[136:143], v1
    ds_read_b128 v[64:67], v2 offset:6144
    v_smfmac_f32_16x16x64_bf16 v[76:79], v[48:51], a[248:255], v1
    s_waitcnt lgkmcnt(3)
    v_smfmac_f32_16x16x64_bf16 v[72:75], v[52:55], a[240:247], v1
    ds_read_b128 v[68:71], v2 offset:7168
    v_smfmac_f32_16x16x64_bf16 v[76:79], v[52:55], a[232:239], v1
    ds_read_b128 v[104:107], v3 offset:10240
    s_waitcnt lgkmcnt(4)
    v_smfmac_f32_16x16x64_bf16 v[72:75], v[56:59], a[224:231], v1
    buffer_store_dwordx2 v[88:89], v10, s[8:11], s56 offen offset:3072 sc1
    s_waitcnt lgkmcnt(3)
    v_smfmac_f32_16x16x64_bf16 v[72:75], v[60:63], a[208:215], v1
    ds_read_b128 v[108:111], v3 offset:11264
    s_waitcnt lgkmcnt(3)
    v_smfmac_f32_16x16x64_bf16 v[72:75], v[64:67], a[192:199], v1
    s_waitcnt lgkmcnt(2)
    v_smfmac_f32_16x16x64_bf16 v[72:75], v[68:71], a[176:183], v1
    ds_read_b128 v[112:115], v3 offset:12288
    v_smfmac_f32_16x16x64_bf16 v[76:79], v[56:59], a[216:223], v1
    ds_read_b128 v[116:119], v3 offset:13312
    v_smfmac_f32_16x16x64_bf16 v[76:79], v[60:63], a[200:207], v1
    buffer_store_dwordx2 v[90:91], v10, s[8:11], s56 offen offset:1024 sc1
    v_add_f32 v72, v72, v74
    v_smfmac_f32_16x16x64_bf16 v[76:79], v[64:67], a[184:191], v1
    ds_read_b128 v[120:123], v3 offset:14336
    v_add_f32 v73, v73, v75
    v_smfmac_f32_16x16x64_bf16 v[76:79], v[68:71], a[168:175], v1
    v_cmp_u_f32 vcc, v72, v73
    v_smfmac_f32_16x16x64_bf16 v[80:83], v[40:43], a[160:167], v1
    ds_read_b128 v[124:127], v3 offset:15360
    v_mul_f32 v72, s45, v72
    v_mul_f32 v73, s45, v73
    v_smfmac_f32_16x16x64_bf16 v[84:87], v[40:43], a[152:159], v1
    s_cbranch_vccnz L_ch_missbS2
L_ch_okbS2:
    s_waitcnt lgkmcnt(4)
    v_add_f32 v76, v76, v78
    v_add_f32 v77, v77, v79
    v_smfmac_f32_16x16x64_bf16 v[80:83], v[44:47], v[104:111], v1
    ds_read_b128 v[128:131], v3 offset:16384
    v_mul_f32 v76, s45, v76
    v_mul_f32 v77, s45, v77
    v_smfmac_f32_16x16x64_bf16 v[84:87], v[44:47], a[144:151], v1
    s_waitcnt lgkmcnt(3)
    v_cvt_pk_bf16_f32 v72, v72, v76
    v_cvt_pk_bf16_f32 v73, v73, v77
    v_smfmac_f32_16x16x64_bf16 v[80:83], v[48:51], v[112:119], v1
    ds_write2_b32 v4, v72, v73 offset1:4
    v_smfmac_f32_16x16x64_bf16 v[84:87], v[48:51], a[136:143], v1
    ds_read_b128 v[132:135], v3 offset:17408
    v_mov_b64 v[74:75], 0
    v_smfmac_f32_16x16x64_bf16 v[80:83], v[52:55], a[128:135], v1
    ds_read_b128 v[136:139], v3 offset:18432
    v_mov_b64 v[76:77], 0
    v_smfmac_f32_16x16x64_bf16 v[84:87], v[52:55], a[120:127], v1
    ds_read_b128 v[140:143], v3 offset:19456
    v_mov_b64 v[78:79], 0
    v_smfmac_f32_16x16x64_bf16 v[80:83], v[56:59], a[112:119], v1
    s_waitcnt lgkmcnt(3)
    s_barrier
    v_smfmac_f32_16x16x64_bf16 v[80:83], v[60:63], a[96:103], v1
    ds_read_b128 v[104:107], v6 offset:12288
    v_mov_b64 v[72:73], 0
    v_smfmac_f32_16x16x64_bf16 v[80:83], v[64:67], a[88:95], v1
    ds_read_b128 v[108:111], v6 offset:12864
    v_smfmac_f32_16x16x64_bf16 v[80:83], v[68:71], a[80:87], v1
    ds_read_b128 v[112:115], v6 offset:13440
    v_mov_b64 v[88:89], 0
    v_smfmac_f32_16x16x64_bf16 v[84:87], v[56:59], a[104:111], v1
    ds_read_b128 v[116:119], v6 offset:14016
    v_mov_b64 v[90:91], 0
    v_smfmac_f32_16x16x64_bf16 v[84:87], v[60:63], v[120:127], v1
    s_waitcnt vmcnt(4)
    s_waitcnt lgkmcnt(6)
    v_add_f32 v80, v80, v82
    v_smfmac_f32_16x16x64_bf16 v[84:87], v[64:67], v[128:135], v1
    s_waitcnt lgkmcnt(4)
    v_add_f32 v81, v81, v83
    v_smfmac_f32_16x16x64_bf16 v[84:87], v[68:71], v[136:143], v1
    s_mov_b32 s56, s42
    s_waitcnt lgkmcnt(2)
    v_smfmac_f32_16x16x64_bf16 v[96:99], v[24:27], v[104:111], v1
    s_mov_b32 s37, s57
    s_waitcnt lgkmcnt(0)
    v_smfmac_f32_16x16x64_bf16 v[96:99], v[28:31], v[112:119], v1
    v_add_f32 v84, v84, v86
    v_add_f32 v85, v85, v87
    v_smfmac_f32_16x16x64_bf16 v[88:91], v[40:43], a[72:79], v1
    buffer_load_dwordx4 v[24:27], v9, s[8:11], s41 offen sc1
    v_cvt_pk_bf16_f32 v80, v80, v84
    v_cvt_pk_bf16_f32 v81, v81, v85
    v_smfmac_f32_16x16x64_bf16 v[92:95], v[40:43], a[64:71], v1
    ds_write2_b32 v5, v80, v81 offset1:4
    v_add_f32 v96, v96, v98
    v_add_f32 v97, v97, v99
    v_smfmac_f32_16x16x64_bf16 v[88:91], v[44:47], a[56:63], v1
    buffer_load_dwordx4 v[28:31], v9, s[8:11], s41 offen offset:2048 sc1
    v_exp_f32 v98, v96
    v_exp_f32 v99, v97
    v_mov_b64 v[82:83], 0
    v_cvt_pk_bf16_f32 v98, v98, v99
    v_smfmac_f32_16x16x64_bf16 v[92:95], v[44:47], a[48:55], v1
    ds_write_b32 v2, v98 offset:10248
    v_smfmac_f32_16x16x64_bf16 v[88:91], v[48:51], a[40:47], v1
    buffer_store_dword v15, v8, s[8:11], s38 offen sc1
    v_mov_b64 v[84:85], 0
    v_smfmac_f32_16x16x64_bf16 v[92:95], v[48:51], a[32:39], v1
    ds_read_b128 v[40:43], v3 offset:20480
    v_mov_b64 v[86:87], 0
    v_smfmac_f32_16x16x64_bf16 v[88:91], v[52:55], a[24:31], v1
    ds_read_b128 v[44:47], v3 offset:21504
    v_mov_b64 v[80:81], 0
    v_smfmac_f32_16x16x64_bf16 v[92:95], v[52:55], a[16:23], v1
    s_waitcnt lgkmcnt(2)
    s_barrier
    ds_read_b128 v[120:123], v2 offset:8192
    v_smfmac_f32_16x16x64_bf16 v[88:91], v[56:59], a[8:15], v1
    ds_read_b128 v[124:127], v2 offset:9216
    v_smfmac_f32_16x16x64_bf16 v[88:91], v[60:63], v[248:255], v1
    ds_read_b128 v[128:131], v2 offset:10240
    v_smfmac_f32_16x16x64_bf16 v[88:91], v[64:67], v[232:239], v1
    v_smfmac_f32_16x16x64_bf16 v[88:91], v[68:71], v[216:223], v1
    ds_read_b128 v[48:51], v3 offset:22528
    s_waitcnt lgkmcnt(3)
    v_smfmac_f32_16x16x64_bf16 v[100:103], v[120:123], v[104:111], v1
    ds_read_b128 v[52:55], v3 offset:23552
    s_waitcnt lgkmcnt(3)
    v_smfmac_f32_16x16x64_bf16 v[100:103], v[124:127], v[112:119], v1
    s_waitcnt lgkmcnt(2)
    v_add_f32 v88, v88, v90
    v_mfma_f32_16x16x32_bf16 v[132:135], v[16:19], v[128:131], 0
    ds_read_b128 v[104:107], v3 offset:24576
    v_add_f32 v89, v89, v91
    v_cvt_pk_bf16_f32 v88, v88, v89
    v_smfmac_f32_16x16x64_bf16 v[92:95], v[56:59], a[0:7], v1
    ds_read_b128 v[108:111], v3 offset:25600
    v_add_f32 v100, v100, v102
    v_add_f32 v101, v101, v103
    v_smfmac_f32_16x16x64_bf16 v[92:95], v[60:63], v[240:247], v1
    ds_read_b128 v[112:115], v3 offset:26624
    v_exp_f32 v102, v100
    v_smfmac_f32_16x16x64_bf16 v[92:95], v[64:67], v[224:231], v1
    ds_read_b128 v[116:119], v3 offset:27648
    v_exp_f32 v103, v101
    v_smfmac_f32_16x16x64_bf16 v[92:95], v[68:71], v[208:215], v1
    s_waitcnt vmcnt(5)
    s_cmp_eq_u32 s34, 63
    v_cvt_pk_bf16_f32 v20, v102, v103
    v_swap_b32 v34, v36
    v_swap_b32 v35, v37
    v_mfma_f32_16x16x16_bf16 v[132:135], v[16:17], v[20:21], v[132:135]
    s_cselect_b32 s30, 0, s55
    v_add_f32 v92, v92, v94
    v_add_f32 v93, v93, v95
    v_mfma_f32_16x16x32_bf16 v[136:139], v[32:35], v[128:131], 0
    ds_read_b128 v[120:123], v3 offset:28672
    v_cvt_pk_bf16_f32 v89, v92, v93
    v_mfma_f32_16x16x32_bf16 v[140:143], v[36:39], v[128:131], 0
    ds_read_b128 v[124:127], v3 offset:29696
    v_mov_b32 v23, v20
    s_nop 0
    v_mfma_f32_16x16x16_bf16 v[136:139], v[88:89], v[20:21], v[136:139]
    s_nop 1
    v_mfma_f32_16x16x16_bf16 v[140:143], v[88:89], v[22:23], v[140:143]
    s_nop 0
    v_rcp_f32 v134, v132
    v_subrev_u32 v133, s54, v132
    v_cmp_le_u32 vcc, s30, v133
L_ch_normS2:
    v_mul_f32 v136, v134, v136
    v_mul_f32 v137, v134, v137
    v_mul_f32 v138, v134, v138
    v_mul_f32 v139, v134, v139
    v_mul_f32 v140, v134, v140
    v_mul_f32 v141, v134, v141
    v_mul_f32 v142, v134, v142
    v_mul_f32 v143, v134, v143
    v_cvt_pk_bf16_f32 v136, v136, v140
    v_cvt_pk_bf16_f32 v137, v137, v141
    v_cvt_pk_bf16_f32 v138, v138, v142
    v_cvt_pk_bf16_f32 v139, v139, v143
    ds_write_b128 v2, v[136:139] offset:14336
    s_cbranch_vccnz L_ch_safeS2
    v_smfmac_f32_16x16x64_bf16 v[72:75], v[136:139], v[200:207], v1
    s_add_u32 s34, s34, 1
    s_add_u32 s42, s42, 131072
    v_smfmac_f32_16x16x64_bf16 v[76:79], v[136:139], v[168:175], v1
    s_waitcnt lgkmcnt(0)
    s_barrier
    ds_read_b128 v[140:143], v2 offset:15360
    ds_read_b128 v[96:99], v2 offset:12288
    ds_read_b128 v[100:103], v2 offset:13312
    v_smfmac_f32_16x16x64_bf16 v[80:83], v[136:139], v[152:159], v1
    v_smfmac_f32_16x16x64_bf16 v[84:87], v[136:139], v[144:151], v1
    s_waitcnt lgkmcnt(2)
    v_smfmac_f32_16x16x64_bf16 v[72:75], v[140:143], v[192:199], v1
    ds_read_b128 v[56:59], v3 offset:30720
    s_waitcnt lgkmcnt(2)
    v_smfmac_f32_16x16x64_bf16 v[72:75], v[96:99], v[184:191], v1
    ds_read_b128 v[60:63], v3 offset:31744
    s_waitcnt lgkmcnt(2)
    v_smfmac_f32_16x16x64_bf16 v[72:75], v[100:103], v[176:183], v1
    ds_read_b128 v[64:67], v3 offset:32768
    v_smfmac_f32_16x16x64_bf16 v[76:79], v[140:143], v[160:167], v1
    ds_read_b128 v[68:71], v3 offset:33792
    v_smfmac_f32_16x16x64_bf16 v[76:79], v[96:99], v[40:47], v1
    ds_read_b128 v[128:131], v3 offset:34816
    v_cvt_pk_bf16_f32 v72, v72, v74
    v_cvt_pk_bf16_f32 v73, v73, v75
    v_and_or_b32 v72, v72, -2, s36
    v_smfmac_f32_16x16x64_bf16 v[76:79], v[100:103], v[48:55], v1
    buffer_store_dwordx2 v[72:73], v7, s[8:11], 0 offen offset:0 sc1
    v_smfmac_f32_16x16x64_bf16 v[80:83], v[140:143], v[104:111], v1
    ds_read_b128 v[132:135], v3 offset:35840
    v_smfmac_f32_16x16x64_bf16 v[80:83], v[96:99], v[112:119], v1
    v_cvt_pk_bf16_f32 v76, v76, v78
    v_cvt_pk_bf16_f32 v77, v77, v79
    v_and_or_b32 v76, v76, -2, s36
    v_smfmac_f32_16x16x64_bf16 v[80:83], v[100:103], v[120:127], v1
    buffer_store_dwordx2 v[76:77], v7, s[8:11], 0 offen offset:2048 sc1
    s_waitcnt lgkmcnt(4)
    v_smfmac_f32_16x16x64_bf16 v[84:87], v[140:143], v[56:63], v1
    s_waitcnt lgkmcnt(2)
    v_smfmac_f32_16x16x64_bf16 v[84:87], v[96:99], v[64:71], v1
    s_waitcnt lgkmcnt(0)
    v_cvt_pk_bf16_f32 v80, v80, v82
    v_cvt_pk_bf16_f32 v81, v81, v83
    v_and_or_b32 v80, v80, -2, s36
    v_smfmac_f32_16x16x64_bf16 v[84:87], v[100:103], v[128:135], v1
    buffer_store_dwordx2 v[80:81], v7, s[8:11], s50 offen offset:0 sc1
    ds_read_b128 v[136:139], v2 offset:11264
    s_nop 5
    v_cvt_pk_bf16_f32 v84, v84, v86
    v_cvt_pk_bf16_f32 v85, v85, v87
    v_and_or_b32 v84, v84, -2, s36
    buffer_store_dwordx2 v[84:85], v7, s[8:11], s50 offen offset:2048 sc1
    s_barrier
    v_mov_b32 v13, s44
    v_mov_b64 v[72:73], 0
    v_mov_b64 v[74:75], 0
    v_mov_b64 v[76:77], 0
    v_mov_b64 v[78:79], 0
    v_mov_b64 v[80:81], 0
    v_mov_b64 v[82:83], 0
    v_mov_b64 v[92:93], 0
    v_mov_b64 v[94:95], 0
    v_mov_b64 v[96:97], 0
    v_mov_b64 v[98:99], 0
    v_mov_b64 v[100:101], 0
    v_mov_b64 v[102:103], 0
    v_mov_b64 v[84:85], 0
    v_mov_b64 v[86:87], 0
    s_nop 15
    s_nop 5
    buffer_load_dwordx4 v[40:43], v2, s[8:11], s39 offen sc1
    buffer_load_dwordx4 v[44:47], v2, s[8:11], s39 offen offset:1024 sc1
    s_nop 15
    s_nop 15
    s_nop 5
    buffer_load_dwordx4 v[48:51], v2, s[8:11], s39 offen sc1
    buffer_load_dwordx4 v[52:55], v2, s[8:11], s39 offen offset:1024 sc1
    ds_read_b64 v[90:91], v10 offset:9216
    ds_read_b128 v[104:107], v3 offset:0
    ds_read_b128 v[108:111], v3 offset:1024
    ds_read_b128 v[112:115], v3 offset:2048
    ds_read_b128 v[116:119], v3 offset:3072
    ds_read_b128 v[120:123], v3 offset:4096
    ds_read_b128 v[124:127], v3 offset:5120
    ds_read_b128 v[128:131], v3 offset:6144
    ds_read_b128 v[132:135], v3 offset:7168
    s_waitcnt lgkmcnt(9)
    s_waitcnt vmcnt(3)
    v_mfma_f32_16x16x32_bf16 v[140:143], v[136:139], v[40:43], 0
    v_bitop3_b32 v70, v40, v42, s36 bitop3:0x7e
    s_waitcnt vmcnt(2)
    v_mfma_f32_16x16x32_bf16 v[140:143], v[136:139], v[44:47], v[140:143]
    v_bitop3_b32 v71, v44, v46, s36 bitop3:0x7e
    v_bitop3_b32 v70, v70, v71, 1 bitop3:0xa8
    v_cmp_ne_u32 vcc, 0, v70
    s_nop 3
    s_cbranch_vccnz L_ch_missaS2
L_ch_okaS2:
    v_add_f32_dpp v140, v140, v140 row_ror:4 row_mask:0xf bank_mask:0xf
    v_add_f32_dpp v141, v141, v141 row_ror:4 row_mask:0xf bank_mask:0xf
    s_nop 0
    v_add_f32_dpp v140, v140, v140 row_ror:8 row_mask:0xf bank_mask:0xf
    v_add_f32_dpp v141, v141, v141 row_ror:8 row_mask:0xf bank_mask:0xf
    v_cvt_pk_bf16_f32 v70, v140, v141
    v_min_u32 v70, -2, v70
    buffer_store_dword v70, v8, s[8:11], s37 offen sc1
    s_nop 3
    buffer_store_dword v13, v21, s[8:11], s5 offen sc1
    ds_read_b128 v[136:139], v3 offset:8192
    ds_read_b128 v[140:143], v3 offset:9216
    s_nop 15
    s_nop 15
    s_nop 9
    buffer_load_dword v32, v12, s[8:11], s4 offen sc1
    buffer_load_dwordx4 v2, s[8:11], s37 offen sc1 lds
    buffer_load_dwordx4 v2, s[8:11], s37 offen offset:1024 sc1 lds
    s_add_u32 s35, s35, 1
    s_and_b32 s36, s35, 1
    s_xor_b32 s36, s36, 1
    s_add_u32 s30, s35, 3
    s_and_b32 s30, s30, 3
    s_lshl_b32 s30, s30, 13
    s_add_u32 s57, s30, s40
    s_xor_b32 s30, s30, 0x4000
    s_add_u32 s38, s30, s40
    s_add_u32 s44, s44, 1
    s_add_u32 s51, s41, 18432
    s_add_u32 s3, s51, 4096
    s_add_u32 s41, s41, 786432
    s_add_u32 s43, s43, 1
    s_waitcnt lgkmcnt(10)
    v_min_u32 v88, -2, v88
    v_min_u32 v89, -2, v89
    v_min_u32 v90, -2, v90
    v_min_u32 v91, -2, v91
    s_nop 15
    s_nop 0
    buffer_load_dword v33, v12, s[8:11], s4 offen sc1
    buffer_load_dwordx4 v2, s[8:11], s37 offen sc1 lds
    buffer_load_dwordx4 v2, s[8:11], s37 offen offset:1024 sc1 lds
    s_waitcnt lgkmcnt(0)
    s_branch L_ch_stepS2
L_ch_missaS2:
    s_mov_b32 s27, 0
L_ch_pollaS2:
    buffer_load_dwordx4 v[40:43], v2, s[8:11], s39 offen sc1
    buffer_load_dwordx4 v[44:47], v2, s[8:11], s39 offen offset:1024 sc1
    s_waitcnt vmcnt(3)
    v_mfma_f32_16x16x32_bf16 v[140:143], v[136:139], v[48:51], 0
    v_bitop3_b32 v70, v48, v50, s36 bitop3:0x7e
    s_waitcnt vmcnt(2)
    v_mfma_f32_16x16x32_bf16 v[140:143], v[136:139], v[52:55], v[140:143]
    v_bitop3_b32 v71, v52, v54, s36 bitop3:0x7e
    v_bitop3_b32 v70, v70, v71, 1 bitop3:0xa8
    v_cmp_ne_u32 vcc, 0, v70
    s_nop 3
    s_cbranch_vccz L_ch_okaS2
    buffer_load_dwordx4 v[48:51], v2, s[8:11], s39 offen sc1
    buffer_load_dwordx4 v[52:55], v2, s[8:11], s39 offen offset:1024 sc1
    s_waitcnt vmcnt(3)
    v_mfma_f32_16x16x32_bf16 v[140:143], v[136:139], v[40:43], 0
    v_bitop3_b32 v70, v40, v42, s36 bitop3:0x7e
    s_waitcnt vmcnt(2)
    v_mfma_f32_16x16x32_bf16 v[140:143], v[136:139], v[44:47], v[140:143]
    v_bitop3_b32 v71, v44, v46, s36 bitop3:0x7e
    v_bitop3_b32 v70, v70, v71, 1 bitop3:0xa8
    v_cmp_ne_u32 vcc, 0, v70
    s_nop 3
    s_cbranch_vccz L_ch_okaS2
    s_add_u32 s27, s27, 1
    s_cmp_lt_u32 s27, 200000
    s_cbranch_scc1 L_ch_pollaS2
    s_branch L_ch_fail
L_ch_hmissS2:
    s_mov_b32 s27, 0
L_ch_hpollS2:
    buffer_load_dword v32, v12, s[8:11], s4 offen sc1
    buffer_load_dwordx4 v2, s[8:11], s37 offen sc1 lds
    buffer_load_dwordx4 v2, s[8:11], s37 offen offset:1024 sc1 lds
    s_waitcnt vmcnt(5)
    v_cmp_gt_u32 vcc, v13, v33
    s_cbranch_vccz L_ch_hokS2
    buffer_load_dword v33, v12, s[8:11], s4 offen sc1
    buffer_load_dwordx4 v2, s[8:11], s37 offen sc1 lds
    buffer_load_dwordx4 v2, s[8:11], s37 offen offset:1024 sc1 lds
    s_waitcnt vmcnt(5)
    v_cmp_gt_u32 vcc, v13, v32
    s_cbranch_vccz L_ch_hokS2
    s_add_u32 s27, s27, 1
    s_cmp_lt_u32 s27, 200000
    s_cbranch_scc1 L_ch_hpollS2
    s_branch L_ch_fail
L_ch_missbS2:
    s_mov_b32 s27, 0
    s_sub_u32 s30, s37, 4096
    s_add_u32 s31, s30, 4096
    s_waitcnt lgkmcnt(0)
    ds_read_b128 v[40:43], v2 offset:0
    ds_read_b128 v[44:47], v2 offset:1024
    ds_read_b128 v[48:51], v2 offset:2048
    ds_read_b128 v[52:55], v2 offset:3072
    ds_read_b128 v[56:59], v2 offset:4096
    ds_read_b128 v[60:63], v2 offset:5120
    ds_read_b128 v[64:67], v2 offset:6144
    ds_read_b128 v[68:71], v2 offset:7168
    s_waitcnt lgkmcnt(0)
    ds_read_b128 v[104:107], v3 offset:0
    ds_read_b128 v[108:111], v3 offset:1024
    ds_read_b128 v[112:115], v3 offset:2048
    ds_read_b128 v[116:119], v3 offset:3072
    ds_read_b128 v[120:123], v3 offset:4096
    ds_read_b128 v[124:127], v3 offset:5120
    ds_read_b128 v[128:131], v3 offset:6144
    ds_read_b128 v[132:135], v3 offset:7168
    ds_read_b128 v[136:139], v3 offset:8192
    ds_read_b128 v[140:143], v3 offset:9216
    s_branch L_ch_chkbS2
L_ch_pollbS2:
    buffer_load_dwordx4 v[40:43], v2, s[8:11], s30 offen offset:0 sc1
    buffer_load_dwordx4 v[44:47], v2, s[8:11], s30 offen offset:1024 sc1
    buffer_load_dwordx4 v[48:51], v2, s[8:11], s30 offen offset:2048 sc1
    buffer_load_dwordx4 v[52:55], v2, s[8:11], s30 offen offset:3072 sc1
    buffer_load_dwordx4 v[56:59], v2, s[8:11], s31 offen offset:0 sc1
    buffer_load_dwordx4 v[60:63], v2, s[8:11], s31 offen offset:1024 sc1
    buffer_load_dwordx4 v[64:67], v2, s[8:11], s31 offen offset:2048 sc1
    buffer_load_dwordx4 v[68:71], v2, s[8:11], s31 offen offset:3072 sc1
    s_add_u32 s27, s27, 1
    s_cmp_lt_u32 s27, 200000
    s_cbranch_scc0 L_ch_fail
    s_waitcnt vmcnt(0)
L_ch_chkbS2:
    v_max_u32 v23, v40, v41
    v_max3_u32 v23, v23, v42, v43
    v_max3_u32 v23, v23, v44, v45
    v_max3_u32 v23, v23, v46, v47
    v_max3_u32 v23, v23, v48, v49
    v_max3_u32 v23, v23, v50, v51
    v_max3_u32 v23, v23, v52, v53
    v_max3_u32 v23, v23, v54, v55
    v_max3_u32 v23, v23, v56, v57
    v_max3_u32 v23, v23, v58, v59
    v_max3_u32 v23, v23, v60, v61
    v_max3_u32 v23, v23, v62, v63
    v_max3_u32 v23, v23, v64, v65
    v_max3_u32 v23, v23, v66, v67
    v_max3_u32 v23, v23, v68, v69
    v_max3_u32 v23, v23, v70, v71
    v_cmp_eq_u32 vcc, -1, v23
    s_cbranch_vccnz L_ch_pollbS2
    v_mov_b64 v[72:73], 0
    v_mov_b64 v[74:75], 0
    v_mov_b64 v[76:77], 0
    v_mov_b64 v[78:79], 0
    v_mov_b64 v[80:81], 0
    v_mov_b64 v[82:83], 0
    v_mov_b64 v[84:85], 0
    v_mov_b64 v[86:87], 0
    s_waitcnt lgkmcnt(0)
    s_nop 0
    v_smfmac_f32_16x16x64_bf16 v[72:75], v[40:43], v[104:111], v1
    v_smfmac_f32_16x16x64_bf16 v[76:79], v[40:43], v[112:119], v1
    v_smfmac_f32_16x16x64_bf16 v[72:75], v[44:47], v[120:127], v1
    v_smfmac_f32_16x16x64_bf16 v[76:79], v[44:47], v[128:135], v1
    v_smfmac_f32_16x16x64_bf16 v[72:75], v[48:51], v[136:143], v1
    v_smfmac_f32_16x16x64_bf16 v[76:79], v[48:51], a[248:255], v1
    v_smfmac_f32_16x16x64_bf16 v[72:75], v[52:55], a[240:247], v1
    v_smfmac_f32_16x16x64_bf16 v[76:79], v[52:55], a[232:239], v1
    ds_read_b128 v[104:107], v3 offset:10240
    v_smfmac_f32_16x16x64_bf16 v[72:75], v[56:59], a[224:231], v1
    v_smfmac_f32_16x16x64_bf16 v[72:75], v[60:63], a[208:215], v1
    ds_read_b128 v[108:111], v3 offset:11264
    v_smfmac_f32_16x16x64_bf16 v[72:75], v[64:67], a[192:199], v1
    v_smfmac_f32_16x16x64_bf16 v[72:75], v[68:71], a[176:183], v1
    ds_read_b128 v[112:115], v3 offset:12288
    v_smfmac_f32_16x16x64_bf16 v[76:79], v[56:59], a[216:223], v1
    ds_read_b128 v[116:119], v3 offset:13312
    v_smfmac_f32_16x16x64_bf16 v[76:79], v[60:63], a[200:207], v1
    v_add_f32 v72, v72, v74
    v_smfmac_f32_16x16x64_bf16 v[76:79], v[64:67], a[184:191], v1
    ds_read_b128 v[120:123], v3 offset:14336
    v_add_f32 v73, v73, v75
    v_smfmac_f32_16x16x64_bf16 v[76:79], v[68:71], a[168:175], v1
    v_cmp_u_f32 vcc, v72, v73
    v_smfmac_f32_16x16x64_bf16 v[80:83], v[40:43], a[160:167], v1
    ds_read_b128 v[124:127], v3 offset:15360
    v_mul_f32 v72, s45, v72
    v_mul_f32 v73, s45, v73
    v_smfmac_f32_16x16x64_bf16 v[84:87], v[40:43], a[152:159], v1
    s_branch L_ch_okbS2
L_ch_lastS2:
    ds_read_b64 v[90:91], v10 offset:9216
    s_waitcnt lgkmcnt(0)
    v_min_u32 v88, -2, v88
    v_min_u32 v89, -2, v89
    v_min_u32 v90, -2, v90
    v_min_u32 v91, -2, v91
    buffer_store_dwordx2 v[90:91], v10, s[8:11], s56 offen offset:1024 sc1
    buffer_store_dwordx2 v[88:89], v10, s[8:11], s56 offen offset:3072 sc1
    s_sub_u32 s35, s35, 1
    s_waitcnt vmcnt(0) lgkmcnt(0)
    s_barrier
    s_add_u32 s33, s33, 1
    s_cmp_lt_u32 s33, 2
    s_cbranch_scc1 L_ch_layerS2
    s_endpgm
L_ch_safeS2:
    s_cmp_eq_u32 s34, 63
    s_cbranch_scc1 L_ch_lastS2
    v_max3_f32 v133, v96, v97, v100
    v_max_f32 v133, v133, v101
    v_mov_b32 v135, v133
    s_nop 1
    v_permlane16_swap_b32 v133, v135
    s_nop 1
    v_max_f32 v133, v133, v135
    v_mov_b32 v135, v133
    s_nop 1
    v_permlane32_swap_b32 v133, v135
    s_nop 1
    v_max_f32 v133, v133, v135
    ds_write_b32 v2, v133 offset:4104
    s_waitcnt lgkmcnt(0)
    s_barrier
    ds_read_b128 v[128:131], v2 offset:4096
    s_waitcnt lgkmcnt(0)
    v_max3_f32 v133, v128, v129, v130
    v_max_f32 v133, v133, v131
    v_sub_f32 v98, v96, v133
    v_exp_f32 v98, v98
    v_sub_f32 v99, v97, v133
    v_exp_f32 v99, v99
    v_sub_f32 v102, v100, v133
    v_exp_f32 v102, v102
    v_sub_f32 v103, v101, v133
    v_exp_f32 v103, v103
    s_nop 0
    v_cvt_pk_bf16_f32 v98, v98, v99
    v_cvt_pk_bf16_f32 v20, v102, v103
    v_cvt_pk_bf16_f32 v23, v102, v103
    ds_write_b32 v2, v98 offset:10248
    s_waitcnt lgkmcnt(0)
    s_barrier
    ds_read_b128 v[128:131], v2 offset:10240
    s_waitcnt lgkmcnt(0)
    v_mfma_f32_16x16x32_bf16 v[132:135], v[16:19], v[128:131], 0
    v_mfma_f32_16x16x32_bf16 v[136:139], v[32:35], v[128:131], 0
    v_mfma_f32_16x16x32_bf16 v[140:143], v[36:39], v[128:131], 0
    s_nop 7
    v_mfma_f32_16x16x16_bf16 v[132:135], v[16:17], v[20:21], v[132:135]
    v_mfma_f32_16x16x16_bf16 v[136:139], v[88:89], v[20:21], v[136:139]
    v_mfma_f32_16x16x16_bf16 v[140:143], v[88:89], v[22:23], v[140:143]
    s_nop 7
    v_rcp_f32 v134, v132
    s_mov_b64 vcc, 0
    s_branch L_ch_normS2
L_ch_layerS3:
    s_mov_b32 s30, 0
    s_mul_i32 s41, s32, 24576
    s_add_u32 s41, s41, s30
    s_add_u32 s41, s41, 1048576
    s_lshl_b32 s56, s32, 12
    s_add_u32 s56, s56, 61341696
    s_mul_i32 s42, s32, 4096
    s_add_u32 s42, s42, s30
    s_add_u32 s42, s42, 52428800
    s_lshl_b32 s43, s33, 7
    s_add_u32 s43, s43, 1
    s_mov_b32 s34, 0
    s_mov_b32 m0, 6144
    v_bfe_u32 v48, v2, 6, 2
    v_bfe_u32 v49, v2, 4, 1
    v_lshl_add_u32 v48, v48, 1, v49
    v_lshlrev_b32 v48, 10, v48
    v_lshrrev_b32 v49, 8, v2
    v_lshl_add_u32 v48, v49, 7, v48
    v_bfe_u32 v49, v2, 5, 1
    v_lshl_add_u32 v48, v49, 6, v48
    v_add_u32 v48, 12, v48
    buffer_load_dword v40, v48, s[12:15], 0 offen offset:0
    buffer_load_dword v41, v48, s[12:15], 0 offen offset:16
    buffer_load_dword v42, v48, s[12:15], 0 offen offset:32
    buffer_load_dword v43, v48, s[12:15], 0 offen offset:48
    buffer_load_dword v44, v48, s[12:15], 0 offen offset:512
    buffer_load_dword v45, v48, s[12:15], 0 offen offset:528
    buffer_load_dword v46, v48, s[12:15], 0 offen offset:544
    buffer_load_dword v47, v48, s[12:15], 0 offen offset:560
    v_mov_b64 v[72:73], 0
    v_mov_b64 v[74:75], 0
    v_mov_b64 v[76:77], 0
    v_mov_b64 v[78:79], 0
    v_mov_b64 v[80:81], 0
    v_mov_b64 v[82:83], 0
    v_mov_b64 v[84:85], 0
    v_mov_b64 v[86:87], 0
    v_mov_b64 v[88:89], 0
    v_mov_b64 v[90:91], 0
    v_mov_b64 v[92:93], 0
    v_mov_b64 v[94:95], 0
    v_mov_b64 v[96:97], 0
    v_mov_b64 v[98:99], 0
    v_mov_b64 v[100:101], 0
    v_mov_b64 v[102:103], 0
    ds_read_b128 v[104:107], v3 offset:0
    ds_read_b128 v[108:111], v3 offset:1024
    ds_read_b128 v[112:115], v3 offset:2048
    ds_read_b128 v[116:119], v3 offset:3072
    ds_read_b128 v[120:123], v3 offset:4096
    ds_read_b128 v[124:127], v3 offset:5120
    ds_read_b128 v[128:131], v3 offset:6144
    ds_read_b128 v[132:135], v3 offset:7168
    ds_read_b128 v[136:139], v3 offset:8192
    ds_read_b128 v[140:143], v3 offset:9216
    s_waitcnt vmcnt(0)
    v_min_u32 v40, -2, v40
    v_min_u32 v41, -2, v41
    v_min_u32 v42, -2, v42
    v_min_u32 v43, -2, v43
    v_min_u32 v44, -2, v44
    v_min_u32 v45, -2, v45
    v_min_u32 v46, -2, v46
    v_min_u32 v47, -2, v47
    ds_write_b128 v2, v[40:43] offset:6144
    ds_write_b128 v2, v[44:47] offset:7168
    s_mov_b32 s27, 0
L_poll_28:
    buffer_load_dword v14, v11, s[8:11], s46 offen sc1
    s_waitcnt vmcnt(0)
    v_cmp_gt_u32 vcc, s43, v14
    s_cbranch_vccz L_pollok_29
    s_sleep 1
    s_add_u32 s27, s27, 1
    s_cmp_lt_u32 s27, 200000
    s_cbranch_scc1 L_poll_28
    s_branch L_ch_fail
L_pollok_29:
    buffer_load_dwordx4 v[24:27], v9, s[8:11], s41 offen sc1
    buffer_load_dwordx4 v[28:31], v9, s[8:11], s41 offen offset:2048 sc1
    s_add_u32 s35, s35, 1
    s_and_b32 s36, s35, 1
    s_xor_b32 s36, s36, 1
    s_add_u32 s30, s35, 3
    s_and_b32 s30, s30, 3
    s_lshl_b32 s30, s30, 13
    s_add_u32 s57, s30, s40
    s_xor_b32 s30, s30, 0x4000
    s_add_u32 s38, s30, s40
    s_add_u32 s44, s44, 1
    s_add_u32 s51, s41, 19456
    s_add_u32 s3, s51, 4096
    s_add_u32 s41, s41, 786432
    s_add_u32 s43, s43, 1
    v_mov_b32 v32, -1
    s_waitcnt lgkmcnt(0)
    s_branch L_ch_inS3
L_ch_stepS3:
    s_waitcnt vmcnt(5)
    v_cmp_gt_u32 vcc, v13, v32
    s_cbranch_vccnz L_ch_hmissS3
L_ch_hokS3:
    s_waitcnt vmcnt(3)

L_ch_inS3:
    s_barrier
    ds_read_b128 v[40:43], v2 offset:0
    ds_read_b128 v[44:47], v2 offset:1024
    ds_read_b128 v[48:51], v2 offset:2048
    buffer_load_dwordx4 v[32:35], v2, s[8:11], s51 offen sc1
    s_waitcnt lgkmcnt(2)
    v_smfmac_f32_16x16x64_bf16 v[72:75], v[40:43], v[104:111], v1
    ds_read_b128 v[52:55], v2 offset:3072
    v_smfmac_f32_16x16x64_bf16 v[76:79], v[40:43], v[112:119], v1
    ds_read_b128 v[56:59], v2 offset:4096
    s_waitcnt lgkmcnt(3)
    v_smfmac_f32_16x16x64_bf16 v[72:75], v[44:47], v[120:127], v1
    buffer_load_dwordx4 v[36:39], v2, s[8:11], s3 offen sc1
    v_smfmac_f32_16x16x64_bf16 v[76:79], v[44:47], v[128:135], v1
    ds_read_b128 v[60:63], v2 offset:5120
    s_waitcnt lgkmcnt(3)
    v_smfmac_f32_16x16x64_bf16 v[72:75], v[48:51], v[136:143], v1
    ds_read_b128 v[64:67], v2 offset:6144
    v_smfmac_f32_16x16x64_bf16 v[76:79], v[48:51], a[248:255], v1
    s_waitcnt lgkmcnt(3)
    v_smfmac_f32_16x16x64_bf16 v[72:75], v[52:55], a[240:247], v1
    ds_read_b128 v[68:71], v2 offset:7168
    v_smfmac_f32_16x16x64_bf16 v[76:79], v[52:55], a[232:239], v1
    ds_read_b128 v[104:107], v3 offset:10240
    s_waitcnt lgkmcnt(4)
    v_smfmac_f32_16x16x64_bf16 v[72:75], v[56:59], a[224:231], v1
    s_waitcnt lgkmcnt(3)
    v_smfmac_f32_16x16x64_bf16 v[72:75], v[60:63], a[208:215], v1
    ds_read_b128 v[108:111], v3 offset:11264
    s_waitcnt lgkmcnt(3)
    v_smfmac_f32_16x16x64_bf16 v[72:75], v[64:67], a[192:199], v1
    buffer_store_dwordx2 v[88:89], v10, s[8:11], s56 offen offset:3584 sc1
    s_waitcnt lgkmcnt(2)
    v_smfmac_f32_16x16x64_bf16 v[72:75], v[68:71], a[176:183], v1
    ds_read_b128 v[112:115], v3 offset:12288
    v_smfmac_f32_16x16x64_bf16 v[76:79], v[56:59], a[216:223], v1
    ds_read_b128 v[116:119], v3 offset:13312
    v_smfmac_f32_16x16x64_bf16 v[76:79], v[60:63], a[200:207], v1
    v_add_f32 v72, v72, v74
    v_smfmac_f32_16x16x64_bf16 v[76:79], v[64:67], a[184:191], v1
    ds_read_b128 v[120:123], v3 offset:14336
    v_add_f32 v73, v73, v75
    v_smfmac_f32_16x16x64_bf16 v[76:79], v[68:71], a[168:175], v1
    buffer_store_dwordx2 v[90:91], v10, s[8:11], s56 offen offset:1536 sc1
    v_cmp_u_f32 vcc, v72, v73
    v_smfmac_f32_16x16x64_bf16 v[80:83], v[40:43], a[160:167], v1
    ds_read_b128 v[124:127], v3 offset:15360
    v_mul_f32 v72, s45, v72
    v_mul_f32 v73, s45, v73
    v_smfmac_f32_16x16x64_bf16 v[84:87], v[40:43], a[152:159], v1
    s_cbranch_vccnz L_ch_missbS3
L_ch_okbS3:
    s_waitcnt lgkmcnt(4)
    v_add_f32 v76, v76, v78
    v_add_f32 v77, v77, v79
    v_smfmac_f32_16x16x64_bf16 v[80:83], v[44:47], v[104:111], v1
    ds_read_b128 v[128:131], v3 offset:16384
    v_mul_f32 v76, s45, v76
    v_mul_f32 v77, s45, v77
    v_smfmac_f32_16x16x64_bf16 v[84:87], v[44:47], a[144:151], v1
    s_waitcnt lgkmcnt(3)
    v_cvt_pk_bf16_f32 v72, v72, v76
    v_cvt_pk_bf16_f32 v73, v73, v77
    v_smfmac_f32_16x16x64_bf16 v[80:83], v[48:51], v[112:119], v1
    ds_write2_b32 v4, v72, v73 offset1:4
    v_smfmac_f32_16x16x64_bf16 v[84:87], v[48:51], a[136:143], v1
    ds_read_b128 v[132:135], v3 offset:17408
    v_mov_b64 v[74:75], 0
    v_smfmac_f32_16x16x64_bf16 v[80:83], v[52:55], a[128:135], v1
    ds_read_b128 v[136:139], v3 offset:18432
    v_mov_b64 v[76:77], 0
    v_smfmac_f32_16x16x64_bf16 v[84:87], v[52:55], a[120:127], v1
    ds_read_b128 v[140:143], v3 offset:19456
    v_mov_b64 v[78:79], 0
    v_smfmac_f32_16x16x64_bf16 v[80:83], v[56:59], a[112:119], v1
    s_waitcnt lgkmcnt(3)
    s_barrier
    v_smfmac_f32_16x16x64_bf16 v[80:83], v[60:63], a[96:103], v1
    ds_read_b128 v[104:107], v6 offset:12288
    v_mov_b64 v[72:73], 0
    v_smfmac_f32_16x16x64_bf16 v[80:83], v[64:67], a[88:95], v1
    ds_read_b128 v[108:111], v6 offset:12864
    v_smfmac_f32_16x16x64_bf16 v[80:83], v[68:71], a[80:87], v1
    ds_read_b128 v[112:115], v6 offset:13440
    v_mov_b64 v[88:89], 0
    v_smfmac_f32_16x16x64_bf16 v[84:87], v[56:59], a[104:111], v1
    ds_read_b128 v[116:119], v6 offset:14016
    v_mov_b64 v[90:91], 0
    v_smfmac_f32_16x16x64_bf16 v[84:87], v[60:63], v[120:127], v1
    s_waitcnt vmcnt(4)
    s_waitcnt lgkmcnt(6)
    v_add_f32 v80, v80, v82
    v_smfmac_f32_16x16x64_bf16 v[84:87], v[64:67], v[128:135], v1
    s_waitcnt lgkmcnt(4)
    v_add_f32 v81, v81, v83
    v_smfmac_f32_16x16x64_bf16 v[84:87], v[68:71], v[136:143], v1
    s_mov_b32 s56, s42
    s_waitcnt lgkmcnt(2)
    v_smfmac_f32_16x16x64_bf16 v[96:99], v[24:27], v[104:111], v1
    s_mov_b32 s37, s57
    s_waitcnt lgkmcnt(0)
    v_smfmac_f32_16x16x64_bf16 v[96:99], v[28:31], v[112:119], v1
    v_add_f32 v84, v84, v86
    v_add_f32 v85, v85, v87
    v_smfmac_f32_16x16x64_bf16 v[88:91], v[40:43], a[72:79], v1
    buffer_load_dwordx4 v[24:27], v9, s[8:11], s41 offen sc1
    v_cvt_pk_bf16_f32 v80, v80, v84
    v_cvt_pk_bf16_f32 v81, v81, v85
    v_smfmac_f32_16x16x64_bf16 v[92:95], v[40:43], a[64:71], v1
    ds_write2_b32 v5, v80, v81 offset1:4
    v_add_f32 v96, v96, v98
    v_add_f32 v97, v97, v99
    v_smfmac_f32_16x16x64_bf16 v[88:91], v[44:47], a[56:63], v1
    buffer_load_dwordx4 v[28:31], v9, s[8:11], s41 offen offset:2048 sc1
    v_exp_f32 v98, v96
    v_exp_f32 v99, v97
    v_mov_b64 v[82:83], 0
    v_cvt_pk_bf16_f32 v98, v98, v99
    v_smfmac_f32_16x16x64_bf16 v[92:95], v[44:47], a[48:55], v1
    ds_write_b32 v2, v98 offset:10252
    v_smfmac_f32_16x16x64_bf16 v[88:91], v[48:51], a[40:47], v1
    buffer_store_dword v15, v8, s[8:11], s38 offen sc1
    v_mov_b64 v[84:85], 0
    v_smfmac_f32_16x16x64_bf16 v[92:95], v[48:51], a[32:39], v1
    ds_read_b128 v[40:43], v3 offset:20480
    v_mov_b64 v[86:87], 0
    v_smfmac_f32_16x16x64_bf16 v[88:91], v[52:55], a[24:31], v1
    ds_read_b128 v[44:47], v3 offset:21504
    v_mov_b64 v[80:81], 0
    v_smfmac_f32_16x16x64_bf16 v[92:95], v[52:55], a[16:23], v1
    s_waitcnt lgkmcnt(2)
    s_barrier
    ds_read_b128 v[120:123], v2 offset:8192
    v_smfmac_f32_16x16x64_bf16 v[88:91], v[56:59], a[8:15], v1
    ds_read_b128 v[124:127], v2 offset:9216
    v_smfmac_f32_16x16x64_bf16 v[88:91], v[60:63], v[248:255], v1
    ds_read_b128 v[128:131], v2 offset:10240
    v_smfmac_f32_16x16x64_bf16 v[88:91], v[64:67], v[232:239], v1
    v_smfmac_f32_16x16x64_bf16 v[88:91], v[68:71], v[216:223], v1
    ds_read_b128 v[48:51], v3 offset:22528
    s_waitcnt lgkmcnt(3)
    v_smfmac_f32_16x16x64_bf16 v[100:103], v[120:123], v[104:111], v1
    ds_read_b128 v[52:55], v3 offset:23552
    s_waitcnt lgkmcnt(3)
    v_smfmac_f32_16x16x64_bf16 v[100:103], v[124:127], v[112:119], v1
    s_waitcnt lgkmcnt(2)
    v_add_f32 v88, v88, v90
    v_mfma_f32_16x16x32_bf16 v[132:135], v[16:19], v[128:131], 0
    ds_read_b128 v[104:107], v3 offset:24576
    v_add_f32 v89, v89, v91
    v_cvt_pk_bf16_f32 v88, v88, v89
    v_smfmac_f32_16x16x64_bf16 v[92:95], v[56:59], a[0:7], v1
    ds_read_b128 v[108:111], v3 offset:25600
    v_add_f32 v100, v100, v102
    v_add_f32 v101, v101, v103
    v_smfmac_f32_16x16x64_bf16 v[92:95], v[60:63], v[240:247], v1
    ds_read_b128 v[112:115], v3 offset:26624
    v_exp_f32 v102, v100
    v_smfmac_f32_16x16x64_bf16 v[92:95], v[64:67], v[224:231], v1
    ds_read_b128 v[116:119], v3 offset:27648
    v_exp_f32 v103, v101
    v_smfmac_f32_16x16x64_bf16 v[92:95], v[68:71], v[208:215], v1
    s_waitcnt vmcnt(5)
    s_cmp_eq_u32 s34, 63
    v_cvt_pk_bf16_f32 v20, v102, v103
    v_swap_b32 v34, v36
    v_swap_b32 v35, v37
    v_mfma_f32_16x16x16_bf16 v[132:135], v[16:17], v[20:21], v[132:135]
    s_cselect_b32 s30, 0, s55
    v_add_f32 v92, v92, v94
    v_add_f32 v93, v93, v95
    v_mfma_f32_16x16x32_bf16 v[136:139], v[32:35], v[128:131], 0
    ds_read_b128 v[120:123], v3 offset:28672
    v_cvt_pk_bf16_f32 v89, v92, v93
    v_mfma_f32_16x16x32_bf16 v[140:143], v[36:39], v[128:131], 0
    ds_read_b128 v[124:127], v3 offset:29696
    v_mov_b32 v23, v20
    s_nop 0
    v_mfma_f32_16x16x16_bf16 v[136:139], v[88:89], v[20:21], v[136:139]
    s_nop 1
    v_mfma_f32_16x16x16_bf16 v[140:143], v[88:89], v[22:23], v[140:143]
    s_nop 0
    v_rcp_f32 v134, v132
    v_subrev_u32 v133, s54, v132
    v_cmp_le_u32 vcc, s30, v133
L_ch_normS3:
    v_mul_f32 v136, v134, v136
    v_mul_f32 v137, v134, v137
    v_mul_f32 v138, v134, v138
    v_mul_f32 v139, v134, v139
    v_mul_f32 v140, v134, v140
    v_mul_f32 v141, v134, v141
    v_mul_f32 v142, v134, v142
    v_mul_f32 v143, v134, v143
    v_cvt_pk_bf16_f32 v136, v136, v140
    v_cvt_pk_bf16_f32 v137, v137, v141
    v_cvt_pk_bf16_f32 v138, v138, v142
    v_cvt_pk_bf16_f32 v139, v139, v143
    ds_write_b128 v2, v[136:139] offset:15360
    s_cbranch_vccnz L_ch_safeS3
    v_smfmac_f32_16x16x64_bf16 v[72:75], v[136:139], v[200:207], v1
    s_add_u32 s34, s34, 1
    s_add_u32 s42, s42, 131072
    v_smfmac_f32_16x16x64_bf16 v[76:79], v[136:139], v[168:175], v1
    s_waitcnt lgkmcnt(0)
    s_barrier
    ds_read_b128 v[140:143], v2 offset:12288
    ds_read_b128 v[96:99], v2 offset:13312
    ds_read_b128 v[100:103], v2 offset:14336
    v_smfmac_f32_16x16x64_bf16 v[80:83], v[136:139], v[152:159], v1
    v_smfmac_f32_16x16x64_bf16 v[84:87], v[136:139], v[144:151], v1
    s_waitcnt lgkmcnt(2)
    v_smfmac_f32_16x16x64_bf16 v[72:75], v[140:143], v[192:199], v1
    ds_read_b128 v[56:59], v3 offset:30720
    s_waitcnt lgkmcnt(2)
    v_smfmac_f32_16x16x64_bf16 v[72:75], v[96:99], v[184:191], v1
    ds_read_b128 v[60:63], v3 offset:31744
    s_waitcnt lgkmcnt(2)
    v_smfmac_f32_16x16x64_bf16 v[72:75], v[100:103], v[176:183], v1
    ds_read_b128 v[64:67], v3 offset:32768
    v_smfmac_f32_16x16x64_bf16 v[76:79], v[140:143], v[160:167], v1
    ds_read_b128 v[68:71], v3 offset:33792
    v_smfmac_f32_16x16x64_bf16 v[76:79], v[96:99], v[40:47], v1
    ds_read_b128 v[128:131], v3 offset:34816
    v_cvt_pk_bf16_f32 v72, v72, v74
    v_cvt_pk_bf16_f32 v73, v73, v75
    v_and_or_b32 v72, v72, -2, s36
    v_smfmac_f32_16x16x64_bf16 v[76:79], v[100:103], v[48:55], v1
    buffer_store_dwordx2 v[72:73], v7, s[8:11], 0 offen offset:0 sc1
    v_smfmac_f32_16x16x64_bf16 v[80:83], v[140:143], v[104:111], v1
    ds_read_b128 v[132:135], v3 offset:35840
    v_smfmac_f32_16x16x64_bf16 v[80:83], v[96:99], v[112:119], v1
    v_cvt_pk_bf16_f32 v76, v76, v78
    v_cvt_pk_bf16_f32 v77, v77, v79
    v_and_or_b32 v76, v76, -2, s36
    v_smfmac_f32_16x16x64_bf16 v[80:83], v[100:103], v[120:127], v1
    buffer_store_dwordx2 v[76:77], v7, s[8:11], 0 offen offset:2048 sc1
    s_waitcnt lgkmcnt(4)
    v_smfmac_f32_16x16x64_bf16 v[84:87], v[140:143], v[56:63], v1
    s_waitcnt lgkmcnt(2)
    v_smfmac_f32_16x16x64_bf16 v[84:87], v[96:99], v[64:71], v1
    s_waitcnt lgkmcnt(0)
    v_cvt_pk_bf16_f32 v80, v80, v82
    v_cvt_pk_bf16_f32 v81, v81, v83
    v_and_or_b32 v80, v80, -2, s36
    v_smfmac_f32_16x16x64_bf16 v[84:87], v[100:103], v[128:135], v1
    buffer_store_dwordx2 v[80:81], v7, s[8:11], s50 offen offset:0 sc1
    ds_read_b128 v[136:139], v2 offset:11264
    s_nop 5
    v_cvt_pk_bf16_f32 v84, v84, v86
    v_cvt_pk_bf16_f32 v85, v85, v87
    v_and_or_b32 v84, v84, -2, s36
    buffer_store_dwordx2 v[84:85], v7, s[8:11], s50 offen offset:2048 sc1
    s_barrier
    v_mov_b32 v13, s44
    v_mov_b64 v[72:73], 0
    v_mov_b64 v[74:75], 0
    v_mov_b64 v[76:77], 0
    v_mov_b64 v[78:79], 0
    v_mov_b64 v[80:81], 0
    v_mov_b64 v[82:83], 0
    v_mov_b64 v[92:93], 0
    v_mov_b64 v[94:95], 0
    v_mov_b64 v[96:97], 0
    v_mov_b64 v[98:99], 0
    v_mov_b64 v[100:101], 0
    v_mov_b64 v[102:103], 0
    v_mov_b64 v[84:85], 0
    v_mov_b64 v[86:87], 0
    s_nop 15
    s_nop 15
    s_nop 2
    buffer_load_dwordx4 v[40:43], v2, s[8:11], s39 offen sc1
    buffer_load_dwordx4 v[44:47], v2, s[8:11], s39 offen offset:1024 sc1
    s_nop 15
    s_nop 15
    s_nop 3
    buffer_load_dwordx4 v[48:51], v2, s[8:11], s39 offen sc1
    buffer_load_dwordx4 v[52:55], v2, s[8:11], s39 offen offset:1024 sc1
    ds_read_b64 v[90:91], v10 offset:9728
    ds_read_b128 v[104:107], v3 offset:0
    ds_read_b128 v[108:111], v3 offset:1024
    ds_read_b128 v[112:115], v3 offset:2048
    ds_read_b128 v[116:119], v3 offset:3072
    ds_read_b128 v[120:123], v3 offset:4096
    ds_read_b128 v[124:127], v3 offset:5120
    ds_read_b128 v[128:131], v3 offset:6144
    ds_read_b128 v[132:135], v3 offset:7168
    s_waitcnt lgkmcnt(9)
    s_waitcnt vmcnt(3)
    v_mfma_f32_16x16x32_bf16 v[140:143], v[136:139], v[40:43], 0
    v_bitop3_b32 v70, v40, v42, s36 bitop3:0x7e
    s_waitcnt vmcnt(2)
    v_mfma_f32_16x16x32_bf16 v[140:143], v[136:139], v[44:47], v[140:143]
    v_bitop3_b32 v71, v44, v46, s36 bitop3:0x7e
    v_bitop3_b32 v70, v70, v71, 1 bitop3:0xa8
    v_cmp_ne_u32 vcc, 0, v70
    s_nop 3
    s_cbranch_vccnz L_ch_missaS3
L_ch_okaS3:
    v_add_f32_dpp v140, v140, v140 row_ror:4 row_mask:0xf bank_mask:0xf
    v_add_f32_dpp v141, v141, v141 row_ror:4 row_mask:0xf bank_mask:0xf
    s_nop 0
    v_add_f32_dpp v140, v140, v140 row_ror:8 row_mask:0xf bank_mask:0xf
    v_add_f32_dpp v141, v141, v141 row_ror:8 row_mask:0xf bank_mask:0xf
    v_cvt_pk_bf16_f32 v70, v140, v141
    v_min_u32 v70, -2, v70
    buffer_store_dword v70, v8, s[8:11], s37 offen sc1
    s_nop 3
    buffer_store_dword v13, v21, s[8:11], s5 offen sc1
    ds_read_b128 v[136:139], v3 offset:8192
    ds_read_b128 v[140:143], v3 offset:9216
    s_nop 15
    s_nop 15
    s_nop 4
    buffer_load_dword v32, v12, s[8:11], s4 offen sc1
    buffer_load_dwordx4 v2, s[8:11], s37 offen sc1 lds
    buffer_load_dwordx4 v2, s[8:11], s37 offen offset:1024 sc1 lds
    s_add_u32 s35, s35, 1
    s_and_b32 s36, s35, 1
    s_xor_b32 s36, s36, 1
    s_add_u32 s30, s35, 3
    s_and_b32 s30, s30, 3
    s_lshl_b32 s30, s30, 13
    s_add_u32 s57, s30, s40
    s_xor_b32 s30, s30, 0x4000
    s_add_u32 s38, s30, s40
    s_add_u32 s44, s44, 1
    s_add_u32 s51, s41, 19456
    s_add_u32 s3, s51, 4096
    s_add_u32 s41, s41, 786432
    s_add_u32 s43, s43, 1
    s_waitcnt lgkmcnt(10)
    v_min_u32 v88, -2, v88
    v_min_u32 v89, -2, v89
    v_min_u32 v90, -2, v90
    v_min_u32 v91, -2, v91
    s_nop 8
    buffer_load_dword v33, v12, s[8:11], s4 offen sc1
    buffer_load_dwordx4 v2, s[8:11], s37 offen sc1 lds
    buffer_load_dwordx4 v2, s[8:11], s37 offen offset:1024 sc1 lds
    s_waitcnt lgkmcnt(0)
    s_branch L_ch_stepS3
L_ch_missaS3:
    s_mov_b32 s27, 0
L_ch_pollaS3:
    buffer_load_dwordx4 v[40:43], v2, s[8:11], s39 offen sc1
    buffer_load_dwordx4 v[44:47], v2, s[8:11], s39 offen offset:1024 sc1
    s_waitcnt vmcnt(3)
    v_mfma_f32_16x16x32_bf16 v[140:143], v[136:139], v[48:51], 0
    v_bitop3_b32 v70, v48, v50, s36 bitop3:0x7e
    s_waitcnt vmcnt(2)
    v_mfma_f32_16x16x32_bf16 v[140:143], v[136:139], v[52:55], v[140:143]
    v_bitop3_b32 v71, v52, v54, s36 bitop3:0x7e
    v_bitop3_b32 v70, v70, v71, 1 bitop3:0xa8
    v_cmp_ne_u32 vcc, 0, v70
    s_nop 3
    s_cbranch_vccz L_ch_okaS3
    buffer_load_dwordx4 v[48:51], v2, s[8:11], s39 offen sc1
    buffer_load_dwordx4 v[52:55], v2, s[8:11], s39 offen offset:1024 sc1
    s_waitcnt vmcnt(3)
    v_mfma_f32_16x16x32_bf16 v[140:143], v[136:139], v[40:43], 0
    v_bitop3_b32 v70, v40, v42, s36 bitop3:0x7e
    s_waitcnt vmcnt(2)
    v_mfma_f32_16x16x32_bf16 v[140:143], v[136:139], v[44:47], v[140:143]
    v_bitop3_b32 v71, v44, v46, s36 bitop3:0x7e
    v_bitop3_b32 v70, v70, v71, 1 bitop3:0xa8
    v_cmp_ne_u32 vcc, 0, v70
    s_nop 3
    s_cbranch_vccz L_ch_okaS3
    s_add_u32 s27, s27, 1
    s_cmp_lt_u32 s27, 200000
    s_cbranch_scc1 L_ch_pollaS3
    s_branch L_ch_fail
L_ch_hmissS3:
    s_mov_b32 s27, 0
L_ch_hpollS3:
    buffer_load_dword v32, v12, s[8:11], s4 offen sc1
    buffer_load_dwordx4 v2, s[8:11], s37 offen sc1 lds
    buffer_load_dwordx4 v2, s[8:11], s37 offen offset:1024 sc1 lds
    s_waitcnt vmcnt(5)
    v_cmp_gt_u32 vcc, v13, v33
    s_cbranch_vccz L_ch_hokS3
    buffer_load_dword v33, v12, s[8:11], s4 offen sc1
    buffer_load_dwordx4 v2, s[8:11], s37 offen sc1 lds
    buffer_load_dwordx4 v2, s[8:11], s37 offen offset:1024 sc1 lds
    s_waitcnt vmcnt(5)
    v_cmp_gt_u32 vcc, v13, v32
    s_cbranch_vccz L_ch_hokS3
    s_add_u32 s27, s27, 1
    s_cmp_lt_u32 s27, 200000
    s_cbranch_scc1 L_ch_hpollS3
    s_branch L_ch_fail
L_ch_missbS3:
    s_mov_b32 s27, 0
    s_sub_u32 s30, s37, 6144
    s_add_u32 s31, s30, 4096
    s_waitcnt lgkmcnt(0)
    ds_read_b128 v[40:43], v2 offset:0
    ds_read_b128 v[44:47], v2 offset:1024
    ds_read_b128 v[48:51], v2 offset:2048
    ds_read_b128 v[52:55], v2 offset:3072
    ds_read_b128 v[56:59], v2 offset:4096
    ds_read_b128 v[60:63], v2 offset:5120
    ds_read_b128 v[64:67], v2 offset:6144
    ds_read_b128 v[68:71], v2 offset:7168
    s_waitcnt lgkmcnt(0)
    ds_read_b128 v[104:107], v3 offset:0
    ds_read_b128 v[108:111], v3 offset:1024
    ds_read_b128 v[112:115], v3 offset:2048
    ds_read_b128 v[116:119], v3 offset:3072
    ds_read_b128 v[120:123], v3 offset:4096
    ds_read_b128 v[124:127], v3 offset:5120
    ds_read_b128 v[128:131], v3 offset:6144
    ds_read_b128 v[132:135], v3 offset:7168
    ds_read_b128 v[136:139], v3 offset:8192
    ds_read_b128 v[140:143], v3 offset:9216
    s_branch L_ch_chkbS3
L_ch_pollbS3:
    buffer_load_dwordx4 v[40:43], v2, s[8:11], s30 offen offset:0 sc1
    buffer_load_dwordx4 v[44:47], v2, s[8:11], s30 offen offset:1024 sc1
    buffer_load_dwordx4 v[48:51], v2, s[8:11], s30 offen offset:2048 sc1
    buffer_load_dwordx4 v[52:55], v2, s[8:11], s30 offen offset:3072 sc1
    buffer_load_dwordx4 v[56:59], v2, s[8:11], s31 offen offset:0 sc1
    buffer_load_dwordx4 v[60:63], v2, s[8:11], s31 offen offset:1024 sc1
    buffer_load_dwordx4 v[64:67], v2, s[8:11], s31 offen offset:2048 sc1
    buffer_load_dwordx4 v[68:71], v2, s[8:11], s31 offen offset:3072 sc1
    s_add_u32 s27, s27, 1
    s_cmp_lt_u32 s27, 200000
    s_cbranch_scc0 L_ch_fail
    s_waitcnt vmcnt(0)
L_ch_chkbS3:
    v_max_u32 v23, v40, v41
    v_max3_u32 v23, v23, v42, v43
    v_max3_u32 v23, v23, v44, v45
    v_max3_u32 v23, v23, v46, v47
    v_max3_u32 v23, v23, v48, v49
    v_max3_u32 v23, v23, v50, v51
    v_max3_u32 v23, v23, v52, v53
    v_max3_u32 v23, v23, v54, v55
    v_max3_u32 v23, v23, v56, v57
    v_max3_u32 v23, v23, v58, v59
    v_max3_u32 v23, v23, v60, v61
    v_max3_u32 v23, v23, v62, v63
    v_max3_u32 v23, v23, v64, v65
    v_max3_u32 v23, v23, v66, v67
    v_max3_u32 v23, v23, v68, v69
    v_max3_u32 v23, v23, v70, v71
    v_cmp_eq_u32 vcc, -1, v23
    s_cbranch_vccnz L_ch_pollbS3
    v_mov_b64 v[72:73], 0
    v_mov_b64 v[74:75], 0
    v_mov_b64 v[76:77], 0
    v_mov_b64 v[78:79], 0
    v_mov_b64 v[80:81], 0
    v_mov_b64 v[82:83], 0
    v_mov_b64 v[84:85], 0
    v_mov_b64 v[86:87], 0
    s_waitcnt lgkmcnt(0)
    s_nop 0
    v_smfmac_f32_16x16x64_bf16 v[72:75], v[40:43], v[104:111], v1
    v_smfmac_f32_16x16x64_bf16 v[76:79], v[40:43], v[112:119], v1
    v_smfmac_f32_16x16x64_bf16 v[72:75], v[44:47], v[120:127], v1
    v_smfmac_f32_16x16x64_bf16 v[76:79], v[44:47], v[128:135], v1
    v_smfmac_f32_16x16x64_bf16 v[72:75], v[48:51], v[136:143], v1
    v_smfmac_f32_16x16x64_bf16 v[76:79], v[48:51], a[248:255], v1
    v_smfmac_f32_16x16x64_bf16 v[72:75], v[52:55], a[240:247], v1
    v_smfmac_f32_16x16x64_bf16 v[76:79], v[52:55], a[232:239], v1
    ds_read_b128 v[104:107], v3 offset:10240
    v_smfmac_f32_16x16x64_bf16 v[72:75], v[56:59], a[224:231], v1
    v_smfmac_f32_16x16x64_bf16 v[72:75], v[60:63], a[208:215], v1
    ds_read_b128 v[108:111], v3 offset:11264
    v_smfmac_f32_16x16x64_bf16 v[72:75], v[64:67], a[192:199], v1
    v_smfmac_f32_16x16x64_bf16 v[72:75], v[68:71], a[176:183], v1
    ds_read_b128 v[112:115], v3 offset:12288
    v_smfmac_f32_16x16x64_bf16 v[76:79], v[56:59], a[216:223], v1
    ds_read_b128 v[116:119], v3 offset:13312
    v_smfmac_f32_16x16x64_bf16 v[76:79], v[60:63], a[200:207], v1
    v_add_f32 v72, v72, v74
    v_smfmac_f32_16x16x64_bf16 v[76:79], v[64:67], a[184:191], v1
    ds_read_b128 v[120:123], v3 offset:14336
    v_add_f32 v73, v73, v75
    v_smfmac_f32_16x16x64_bf16 v[76:79], v[68:71], a[168:175], v1
    v_cmp_u_f32 vcc, v72, v73
    v_smfmac_f32_16x16x64_bf16 v[80:83], v[40:43], a[160:167], v1
    ds_read_b128 v[124:127], v3 offset:15360
    v_mul_f32 v72, s45, v72
    v_mul_f32 v73, s45, v73
    v_smfmac_f32_16x16x64_bf16 v[84:87], v[40:43], a[152:159], v1
    s_branch L_ch_okbS3
L_ch_lastS3:
    ds_read_b64 v[90:91], v10 offset:9728
    s_waitcnt lgkmcnt(0)
    v_min_u32 v88, -2, v88
    v_min_u32 v89, -2, v89
    v_min_u32 v90, -2, v90
    v_min_u32 v91, -2, v91
    buffer_store_dwordx2 v[90:91], v10, s[8:11], s56 offen offset:1536 sc1
    buffer_store_dwordx2 v[88:89], v10, s[8:11], s56 offen offset:3584 sc1
    s_sub_u32 s35, s35, 1
    s_waitcnt vmcnt(0) lgkmcnt(0)
    s_barrier
    s_add_u32 s33, s33, 1
    s_cmp_lt_u32 s33, 2
    s_cbranch_scc1 L_ch_layerS3
    s_endpgm
L_ch_safeS3:
    s_cmp_eq_u32 s34, 63
    s_cbranch_scc1 L_ch_lastS3
    v_max3_f32 v133, v96, v97, v100
    v_max_f32 v133, v133, v101
    v_mov_b32 v135, v133
    s_nop 1
    v_permlane16_swap_b32 v133, v135
    s_nop 1
    v_max_f32 v133, v133, v135
    v_mov_b32 v135, v133
    s_nop 1
    v_permlane32_swap_b32 v133, v135
    s_nop 1
    v_max_f32 v133, v133, v135
    ds_write_b32 v2, v133 offset:4108
    s_waitcnt lgkmcnt(0)
    s_barrier
    ds_read_b128 v[128:131], v2 offset:4096
    s_waitcnt lgkmcnt(0)
    v_max3_f32 v133, v128, v129, v130
    v_max_f32 v133, v133, v131
    v_sub_f32 v98, v96, v133
    v_exp_f32 v98, v98
    v_sub_f32 v99, v97, v133
    v_exp_f32 v99, v99
    v_sub_f32 v102, v100, v133
    v_exp_f32 v102, v102
    v_sub_f32 v103, v101, v133
    v_exp_f32 v103, v103
    s_nop 0
    v_cvt_pk_bf16_f32 v98, v98, v99
    v_cvt_pk_bf16_f32 v20, v102, v103
    v_cvt_pk_bf16_f32 v23, v102, v103
    ds_write_b32 v2, v98 offset:10252
    s_waitcnt lgkmcnt(0)
    s_barrier
    ds_read_b128 v[128:131], v2 offset:10240
    s_waitcnt lgkmcnt(0)
    v_mfma_f32_16x16x32_bf16 v[132:135], v[16:19], v[128:131], 0
    v_mfma_f32_16x16x32_bf16 v[136:139], v[32:35], v[128:131], 0
    v_mfma_f32_16x16x32_bf16 v[140:143], v[36:39], v[128:131], 0
    s_nop 7
    v_mfma_f32_16x16x16_bf16 v[132:135], v[16:17], v[20:21], v[132:135]
    v_mfma_f32_16x16x16_bf16 v[136:139], v[88:89], v[20:21], v[136:139]
    v_mfma_f32_16x16x16_bf16 v[140:143], v[88:89], v[22:23], v[140:143]
    s_nop 7
    v_rcp_f32 v134, v132
    s_mov_b64 vcc, 0
    s_branch L_ch_normS3
L_role_p:
    s_lshr_b32 s30, s25, 5
    s_sub_u32 s30, s30, 1
    s_lshl_b32 s30, s30, 3
    s_bfe_u32 s31, s25, 0x30001
    s_add_u32 s32, s30, s31
    s_and_b32 s33, s25, 1
    v_lshlrev_b32 v1, 4, v0
    v_lshrrev_b32 v14, 4, v0
    v_and_b32 v15, 15, v0
    v_lshlrev_b32 v12, 16, v14
    v_lshl_add_u32 v12, v15, 2, v12
    s_lshl_b32 s30, s32, 8
    s_lshl_b32 s31, s24, 6
    s_add_u32 s30, s30, s31
    v_add_u32 v12, s30, v12
    v_add_u32 v13, 0x2000, v12
    v_sub_u32 v16, 0, v14
    v_xor_b32 v16, v16, v0
    v_and_b32 v16, 3, v16
    v_lshrrev_b32 v17, 2, v0
    v_lshlrev_b32 v2, 10, v17
    v_lshl_add_u32 v2, v16, 4, v2
    s_lshl_b32 s30, s24, 8
    v_add_u32 v2, s30, v2
    v_sub_u32 v16, 0, v17
    v_xor_b32 v16, v16, v14
    v_and_b32 v16, 3, v16
    v_lshlrev_b32 v124, 6, v15
    v_lshl_add_u32 v124, v16, 4, v124
    s_load_dwordx2 s[16:17], s[0:1], 24
    s_load_dwordx2 s[84:85], s[0:1], 32
    s_load_dwordx2 s[88:89], s[0:1], 16
    s_waitcnt lgkmcnt(0)
    s_mov_b32 s18, 4194304
    s_mov_b32 s19, 0x20000
    s_mov_b32 s86, 4194304
    s_mov_b32 s87, 0x20000
    s_mov_b32 s90, 4194304
    s_mov_b32 s91, 0x20000
    s_lshl_b32 s92, s32, 8
    v_lshrrev_b32 v16, 5, v0
    v_mul_u32_u24 v12, 16, v16
    v_bfe_u32 v16, v0, 4, 1
    v_mul_u32_u24 v16, 8, v16
    v_add_u32 v12, v12, v16
    s_lshr_b32 s30, s24, 1
    s_mul_i32 s30, s30, 32
    s_and_b32 s31, s24, 1
    s_mul_i32 s31, s31, 4
    s_add_u32 s30, s30, s31
    v_add_u32 v12, s30, v12
    v_lshlrev_b32 v12, 13, v12
    v_and_b32 v16, 15, v0
    v_lshl_add_u32 v12, v16, 4, v12
    v_add_u32 v12, s92, v12
    v_lshrrev_b32 v13, 4, v0
    v_lshlrev_b32 v13, 8, v13
    v_lshl_add_u32 v13, v16, 2, v13
    s_lshl_b32 s30, s24, 6
    s_add_u32 s30, s30, 0
    v_add_u32 v13, s30, v13
    v_add_u32 v14, 0x10000, v13
    s_lshl_b32 s31, s24, 12
    s_add_u32 m0, s31, 0
    s_mov_b32 s30, 0
    buffer_load_dwordx4 v12, s[16:19], s30 offen lds
    s_add_u32 m0, s31, 1024
    s_mov_b32 s30, 8192
    buffer_load_dwordx4 v12, s[16:19], s30 offen lds
    s_add_u32 m0, s31, 2048
    s_mov_b32 s30, 16384
    buffer_load_dwordx4 v12, s[16:19], s30 offen lds
    s_add_u32 m0, s31, 3072
    s_mov_b32 s30, 24576
    buffer_load_dwordx4 v12, s[16:19], s30 offen lds
    s_add_u32 m0, s31, 16384
    s_mov_b32 s30, 524288
    buffer_load_dwordx4 v12, s[16:19], s30 offen lds
    s_add_u32 m0, s31, 17408
    s_mov_b32 s30, 532480
    buffer_load_dwordx4 v12, s[16:19], s30 offen lds
    s_add_u32 m0, s31, 18432
    s_mov_b32 s30, 540672
    buffer_load_dwordx4 v12, s[16:19], s30 offen lds
    s_add_u32 m0, s31, 19456
    s_mov_b32 s30, 548864
    buffer_load_dwordx4 v12, s[16:19], s30 offen lds
    s_add_u32 m0, s31, 32768
    s_mov_b32 s30, 1048576
    buffer_load_dwordx4 v12, s[16:19], s30 offen lds
    s_add_u32 m0, s31, 33792
    s_mov_b32 s30, 1056768
    buffer_load_dwordx4 v12, s[16:19], s30 offen lds
    s_add_u32 m0, s31, 34816
    s_mov_b32 s30, 1064960
    buffer_load_dwordx4 v12, s[16:19], s30 offen lds
    s_add_u32 m0, s31, 35840
    s_mov_b32 s30, 1073152
    buffer_load_dwordx4 v12, s[16:19], s30 offen lds
    s_add_u32 m0, s31, 49152
    s_mov_b32 s30, 1572864
    buffer_load_dwordx4 v12, s[16:19], s30 offen lds
    s_add_u32 m0, s31, 50176
    s_mov_b32 s30, 1581056
    buffer_load_dwordx4 v12, s[16:19], s30 offen lds
    s_add_u32 m0, s31, 51200
    s_mov_b32 s30, 1589248
    buffer_load_dwordx4 v12, s[16:19], s30 offen lds
    s_add_u32 m0, s31, 52224
    s_mov_b32 s30, 1597440
    buffer_load_dwordx4 v12, s[16:19], s30 offen lds
    s_add_u32 m0, s31, 65536
    s_mov_b32 s30, 2097152
    buffer_load_dwordx4 v12, s[16:19], s30 offen lds
    s_add_u32 m0, s31, 66560
    s_mov_b32 s30, 2105344
    buffer_load_dwordx4 v12, s[16:19], s30 offen lds
    s_add_u32 m0, s31, 67584
    s_mov_b32 s30, 2113536
    buffer_load_dwordx4 v12, s[16:19], s30 offen lds
    s_add_u32 m0, s31, 68608
    s_mov_b32 s30, 2121728
    buffer_load_dwordx4 v12, s[16:19], s30 offen lds
    s_add_u32 m0, s31, 81920
    s_mov_b32 s30, 2621440
    buffer_load_dwordx4 v12, s[16:19], s30 offen lds
    s_add_u32 m0, s31, 82944
    s_mov_b32 s30, 2629632
    buffer_load_dwordx4 v12, s[16:19], s30 offen lds
    s_add_u32 m0, s31, 83968
    s_mov_b32 s30, 2637824
    buffer_load_dwordx4 v12, s[16:19], s30 offen lds
    s_add_u32 m0, s31, 84992
    s_mov_b32 s30, 2646016
    buffer_load_dwordx4 v12, s[16:19], s30 offen lds
    s_waitcnt vmcnt(20)
    s_barrier
    ds_read2st64_b32 v[16:17], v13 offset0:0 offset1:4
    ds_read2st64_b32 v[18:19], v13 offset0:8 offset1:12
    ds_read2st64_b32 v[20:21], v13 offset0:16 offset1:20
    ds_read2st64_b32 v[22:23], v13 offset0:24 offset1:28
    ds_read2st64_b32 v[24:25], v13 offset0:32 offset1:36
    ds_read2st64_b32 v[26:27], v13 offset0:40 offset1:44
    ds_read2st64_b32 v[28:29], v13 offset0:48 offset1:52
    ds_read2st64_b32 v[30:31], v13 offset0:56 offset1:60
    s_add_u32 m0, s31, 98304
    s_mov_b32 s30, 3145728
    buffer_load_dwordx4 v12, s[16:19], s30 offen lds
    s_add_u32 m0, s31, 99328
    s_mov_b32 s30, 3153920
    buffer_load_dwordx4 v12, s[16:19], s30 offen lds
    s_add_u32 m0, s31, 100352
    s_mov_b32 s30, 3162112
    buffer_load_dwordx4 v12, s[16:19], s30 offen lds
    s_add_u32 m0, s31, 101376
    s_mov_b32 s30, 3170304
    buffer_load_dwordx4 v12, s[16:19], s30 offen lds
    s_waitcnt lgkmcnt(6)
    v_perm_b32 v32, v17, v16, s28
    v_accvgpr_write_b32 a0, v32
    v_perm_b32 v33, v17, v16, s29
    v_accvgpr_write_b32 a4, v33
    v_perm_b32 v32, v19, v18, s28
    v_accvgpr_write_b32 a1, v32
    v_perm_b32 v33, v19, v18, s29
    v_accvgpr_write_b32 a5, v33
    s_waitcnt lgkmcnt(4)
    v_perm_b32 v32, v21, v20, s28
    v_accvgpr_write_b32 a2, v32
    v_perm_b32 v33, v21, v20, s29
    v_accvgpr_write_b32 a6, v33
    v_perm_b32 v32, v23, v22, s28
    v_accvgpr_write_b32 a3, v32
    v_perm_b32 v33, v23, v22, s29
    v_accvgpr_write_b32 a7, v33
    s_waitcnt lgkmcnt(2)
    v_perm_b32 v32, v25, v24, s28
    v_accvgpr_write_b32 a8, v32
    v_perm_b32 v33, v25, v24, s29
    v_accvgpr_write_b32 a12, v33
    v_perm_b32 v32, v27, v26, s28
    v_accvgpr_write_b32 a9, v32
    v_perm_b32 v33, v27, v26, s29
    v_accvgpr_write_b32 a13, v33
    s_waitcnt lgkmcnt(0)
    v_perm_b32 v32, v29, v28, s28
    v_accvgpr_write_b32 a10, v32
    v_perm_b32 v33, v29, v28, s29
    v_accvgpr_write_b32 a14, v33
    v_perm_b32 v32, v31, v30, s28
    v_accvgpr_write_b32 a11, v32
    v_perm_b32 v33, v31, v30, s29
    v_accvgpr_write_b32 a15, v33
    s_waitcnt vmcnt(20)
    s_barrier
    ds_read2st64_b32 v[16:17], v13 offset0:64 offset1:68
    ds_read2st64_b32 v[18:19], v13 offset0:72 offset1:76
    ds_read2st64_b32 v[20:21], v13 offset0:80 offset1:84
    ds_read2st64_b32 v[22:23], v13 offset0:88 offset1:92
    ds_read2st64_b32 v[24:25], v13 offset0:96 offset1:100
    ds_read2st64_b32 v[26:27], v13 offset0:104 offset1:108
    ds_read2st64_b32 v[28:29], v13 offset0:112 offset1:116
    ds_read2st64_b32 v[30:31], v13 offset0:120 offset1:124
    s_add_u32 m0, s31, 114688
    s_mov_b32 s30, 3670016
    buffer_load_dwordx4 v12, s[16:19], s30 offen lds
    s_add_u32 m0, s31, 115712
    s_mov_b32 s30, 3678208
    buffer_load_dwordx4 v12, s[16:19], s30 offen lds
    s_add_u32 m0, s31, 116736
    s_mov_b32 s30, 3686400
    buffer_load_dwordx4 v12, s[16:19], s30 offen lds
    s_add_u32 m0, s31, 117760
    s_mov_b32 s30, 3694592
    buffer_load_dwordx4 v12, s[16:19], s30 offen lds
    s_waitcnt lgkmcnt(6)
    v_perm_b32 v32, v17, v16, s28
    v_accvgpr_write_b32 a16, v32
    v_perm_b32 v33, v17, v16, s29
    v_accvgpr_write_b32 a20, v33
    v_perm_b32 v32, v19, v18, s28
    v_accvgpr_write_b32 a17, v32
    v_perm_b32 v33, v19, v18, s29
    v_accvgpr_write_b32 a21, v33
    s_waitcnt lgkmcnt(4)
    v_perm_b32 v32, v21, v20, s28
    v_accvgpr_write_b32 a18, v32
    v_perm_b32 v33, v21, v20, s29
    v_accvgpr_write_b32 a22, v33
    v_perm_b32 v32, v23, v22, s28
    v_accvgpr_write_b32 a19, v32
    v_perm_b32 v33, v23, v22, s29
    v_accvgpr_write_b32 a23, v33
    s_waitcnt lgkmcnt(2)
    v_perm_b32 v32, v25, v24, s28
    v_accvgpr_write_b32 a24, v32
    v_perm_b32 v33, v25, v24, s29
    v_accvgpr_write_b32 a28, v33
    v_perm_b32 v32, v27, v26, s28
    v_accvgpr_write_b32 a25, v32
    v_perm_b32 v33, v27, v26, s29
    v_accvgpr_write_b32 a29, v33
    s_waitcnt lgkmcnt(0)
    v_perm_b32 v32, v29, v28, s28
    v_accvgpr_write_b32 a26, v32
    v_perm_b32 v33, v29, v28, s29
    v_accvgpr_write_b32 a30, v33
    v_perm_b32 v32, v31, v30, s28
    v_accvgpr_write_b32 a27, v32
    v_perm_b32 v33, v31, v30, s29
    v_accvgpr_write_b32 a31, v33
    s_waitcnt vmcnt(20)
    s_barrier
    ds_read2st64_b32 v[16:17], v13 offset0:128 offset1:132
    ds_read2st64_b32 v[18:19], v13 offset0:136 offset1:140
    ds_read2st64_b32 v[20:21], v13 offset0:144 offset1:148
    ds_read2st64_b32 v[22:23], v13 offset0:152 offset1:156
    ds_read2st64_b32 v[24:25], v13 offset0:160 offset1:164
    ds_read2st64_b32 v[26:27], v13 offset0:168 offset1:172
    ds_read2st64_b32 v[28:29], v13 offset0:176 offset1:180
    ds_read2st64_b32 v[30:31], v13 offset0:184 offset1:188
    s_add_u32 m0, s31, 0
    s_mov_b32 s30, 0
    buffer_load_dwordx4 v12, s[84:87], s30 offen lds
    s_add_u32 m0, s31, 1024
    s_mov_b32 s30, 8192
    buffer_load_dwordx4 v12, s[84:87], s30 offen lds
    s_add_u32 m0, s31, 2048
    s_mov_b32 s30, 16384
    buffer_load_dwordx4 v12, s[84:87], s30 offen lds
    s_add_u32 m0, s31, 3072
    s_mov_b32 s30, 24576
    buffer_load_dwordx4 v12, s[84:87], s30 offen lds
    s_waitcnt lgkmcnt(6)
    v_perm_b32 v32, v17, v16, s28
    v_accvgpr_write_b32 a32, v32
    v_perm_b32 v33, v17, v16, s29
    v_accvgpr_write_b32 a36, v33
    v_perm_b32 v32, v19, v18, s28
    v_accvgpr_write_b32 a33, v32
    v_perm_b32 v33, v19, v18, s29
    v_accvgpr_write_b32 a37, v33
    s_waitcnt lgkmcnt(4)
    v_perm_b32 v32, v21, v20, s28
    v_accvgpr_write_b32 a34, v32
    v_perm_b32 v33, v21, v20, s29
    v_accvgpr_write_b32 a38, v33
    v_perm_b32 v32, v23, v22, s28
    v_accvgpr_write_b32 a35, v32
    v_perm_b32 v33, v23, v22, s29
    v_accvgpr_write_b32 a39, v33
    s_waitcnt lgkmcnt(2)
    v_perm_b32 v32, v25, v24, s28
    v_accvgpr_write_b32 a40, v32
    v_perm_b32 v33, v25, v24, s29
    v_accvgpr_write_b32 a44, v33
    v_perm_b32 v32, v27, v26, s28
    v_accvgpr_write_b32 a41, v32
    v_perm_b32 v33, v27, v26, s29
    v_accvgpr_write_b32 a45, v33
    s_waitcnt lgkmcnt(0)
    v_perm_b32 v32, v29, v28, s28
    v_accvgpr_write_b32 a42, v32
    v_perm_b32 v33, v29, v28, s29
    v_accvgpr_write_b32 a46, v33
    v_perm_b32 v32, v31, v30, s28
    v_accvgpr_write_b32 a43, v32
    v_perm_b32 v33, v31, v30, s29
    v_accvgpr_write_b32 a47, v33
    s_waitcnt vmcnt(20)
    s_barrier
    ds_read2st64_b32 v[16:17], v13 offset0:192 offset1:196
    ds_read2st64_b32 v[18:19], v13 offset0:200 offset1:204
    ds_read2st64_b32 v[20:21], v13 offset0:208 offset1:212
    ds_read2st64_b32 v[22:23], v13 offset0:216 offset1:220
    ds_read2st64_b32 v[24:25], v13 offset0:224 offset1:228
    ds_read2st64_b32 v[26:27], v13 offset0:232 offset1:236
    ds_read2st64_b32 v[28:29], v13 offset0:240 offset1:244
    ds_read2st64_b32 v[30:31], v13 offset0:248 offset1:252
    s_add_u32 m0, s31, 16384
    s_mov_b32 s30, 524288
    buffer_load_dwordx4 v12, s[84:87], s30 offen lds
    s_add_u32 m0, s31, 17408
    s_mov_b32 s30, 532480
    buffer_load_dwordx4 v12, s[84:87], s30 offen lds
    s_add_u32 m0, s31, 18432
    s_mov_b32 s30, 540672
    buffer_load_dwordx4 v12, s[84:87], s30 offen lds
    s_add_u32 m0, s31, 19456
    s_mov_b32 s30, 548864
    buffer_load_dwordx4 v12, s[84:87], s30 offen lds
    s_waitcnt lgkmcnt(6)
    v_perm_b32 v32, v17, v16, s28
    v_accvgpr_write_b32 a48, v32
    v_perm_b32 v33, v17, v16, s29
    v_accvgpr_write_b32 a52, v33
    v_perm_b32 v32, v19, v18, s28
    v_accvgpr_write_b32 a49, v32
    v_perm_b32 v33, v19, v18, s29
    v_accvgpr_write_b32 a53, v33
    s_waitcnt lgkmcnt(4)
    v_perm_b32 v32, v21, v20, s28
    v_accvgpr_write_b32 a50, v32
    v_perm_b32 v33, v21, v20, s29
    v_accvgpr_write_b32 a54, v33
    v_perm_b32 v32, v23, v22, s28
    v_accvgpr_write_b32 a51, v32
    v_perm_b32 v33, v23, v22, s29
    v_accvgpr_write_b32 a55, v33
    s_waitcnt lgkmcnt(2)
    v_perm_b32 v32, v25, v24, s28
    v_accvgpr_write_b32 a56, v32
    v_perm_b32 v33, v25, v24, s29
    v_accvgpr_write_b32 a60, v33
    v_perm_b32 v32, v27, v26, s28
    v_accvgpr_write_b32 a57, v32
    v_perm_b32 v33, v27, v26, s29
    v_accvgpr_write_b32 a61, v33
    s_waitcnt lgkmcnt(0)
    v_perm_b32 v32, v29, v28, s28
    v_accvgpr_write_b32 a58, v32
    v_perm_b32 v33, v29, v28, s29
    v_accvgpr_write_b32 a62, v33
    v_perm_b32 v32, v31, v30, s28
    v_accvgpr_write_b32 a59, v32
    v_perm_b32 v33, v31, v30, s29
    v_accvgpr_write_b32 a63, v33
    s_waitcnt vmcnt(20)
    s_barrier
    ds_read2st64_b32 v[16:17], v14 offset0:0 offset1:4
    ds_read2st64_b32 v[18:19], v14 offset0:8 offset1:12
    ds_read2st64_b32 v[20:21], v14 offset0:16 offset1:20
    ds_read2st64_b32 v[22:23], v14 offset0:24 offset1:28
    ds_read2st64_b32 v[24:25], v14 offset0:32 offset1:36
    ds_read2st64_b32 v[26:27], v14 offset0:40 offset1:44
    ds_read2st64_b32 v[28:29], v14 offset0:48 offset1:52
    ds_read2st64_b32 v[30:31], v14 offset0:56 offset1:60
    s_add_u32 m0, s31, 32768
    s_mov_b32 s30, 1048576
    buffer_load_dwordx4 v12, s[84:87], s30 offen lds
    s_add_u32 m0, s31, 33792
    s_mov_b32 s30, 1056768
    buffer_load_dwordx4 v12, s[84:87], s30 offen lds
    s_add_u32 m0, s31, 34816
    s_mov_b32 s30, 1064960
    buffer_load_dwordx4 v12, s[84:87], s30 offen lds
    s_add_u32 m0, s31, 35840
    s_mov_b32 s30, 1073152
    buffer_load_dwordx4 v12, s[84:87], s30 offen lds
    s_waitcnt lgkmcnt(6)
    v_perm_b32 v32, v17, v16, s28
    v_accvgpr_write_b32 a64, v32
    v_perm_b32 v33, v17, v16, s29
    v_accvgpr_write_b32 a68, v33
    v_perm_b32 v32, v19, v18, s28
    v_accvgpr_write_b32 a65, v32
    v_perm_b32 v33, v19, v18, s29
    v_accvgpr_write_b32 a69, v33
    s_waitcnt lgkmcnt(4)
    v_perm_b32 v32, v21, v20, s28
    v_accvgpr_write_b32 a66, v32
    v_perm_b32 v33, v21, v20, s29
    v_accvgpr_write_b32 a70, v33
    v_perm_b32 v32, v23, v22, s28
    v_accvgpr_write_b32 a67, v32
    v_perm_b32 v33, v23, v22, s29
    v_accvgpr_write_b32 a71, v33
    s_waitcnt lgkmcnt(2)
    v_perm_b32 v32, v25, v24, s28
    v_accvgpr_write_b32 a72, v32
    v_perm_b32 v33, v25, v24, s29
    v_accvgpr_write_b32 a76, v33
    v_perm_b32 v32, v27, v26, s28
    v_accvgpr_write_b32 a73, v32
    v_perm_b32 v33, v27, v26, s29
    v_accvgpr_write_b32 a77, v33
    s_waitcnt lgkmcnt(0)
    v_perm_b32 v32, v29, v28, s28
    v_accvgpr_write_b32 a74, v32
    v_perm_b32 v33, v29, v28, s29
    v_accvgpr_write_b32 a78, v33
    v_perm_b32 v32, v31, v30, s28
    v_accvgpr_write_b32 a75, v32
    v_perm_b32 v33, v31, v30, s29
    v_accvgpr_write_b32 a79, v33
    s_waitcnt vmcnt(20)
    s_barrier
    ds_read2st64_b32 v[16:17], v14 offset0:64 offset1:68
    ds_read2st64_b32 v[18:19], v14 offset0:72 offset1:76
    ds_read2st64_b32 v[20:21], v14 offset0:80 offset1:84
    ds_read2st64_b32 v[22:23], v14 offset0:88 offset1:92
    ds_read2st64_b32 v[24:25], v14 offset0:96 offset1:100
    ds_read2st64_b32 v[26:27], v14 offset0:104 offset1:108
    ds_read2st64_b32 v[28:29], v14 offset0:112 offset1:116
    ds_read2st64_b32 v[30:31], v14 offset0:120 offset1:124
    s_add_u32 m0, s31, 49152
    s_mov_b32 s30, 1572864
    buffer_load_dwordx4 v12, s[84:87], s30 offen lds
    s_add_u32 m0, s31, 50176
    s_mov_b32 s30, 1581056
    buffer_load_dwordx4 v12, s[84:87], s30 offen lds
    s_add_u32 m0, s31, 51200
    s_mov_b32 s30, 1589248
    buffer_load_dwordx4 v12, s[84:87], s30 offen lds
    s_add_u32 m0, s31, 52224
    s_mov_b32 s30, 1597440
    buffer_load_dwordx4 v12, s[84:87], s30 offen lds
    s_waitcnt lgkmcnt(6)
    v_perm_b32 v32, v17, v16, s28
    v_accvgpr_write_b32 a80, v32
    v_perm_b32 v33, v17, v16, s29
    v_accvgpr_write_b32 a84, v33
    v_perm_b32 v32, v19, v18, s28
    v_accvgpr_write_b32 a81, v32
    v_perm_b32 v33, v19, v18, s29
    v_accvgpr_write_b32 a85, v33
    s_waitcnt lgkmcnt(4)
    v_perm_b32 v32, v21, v20, s28
    v_accvgpr_write_b32 a82, v32
    v_perm_b32 v33, v21, v20, s29
    v_accvgpr_write_b32 a86, v33
    v_perm_b32 v32, v23, v22, s28
    v_accvgpr_write_b32 a83, v32
    v_perm_b32 v33, v23, v22, s29
    v_accvgpr_write_b32 a87, v33
    s_waitcnt lgkmcnt(2)
    v_perm_b32 v32, v25, v24, s28
    v_accvgpr_write_b32 a88, v32
    v_perm_b32 v33, v25, v24, s29
    v_accvgpr_write_b32 a92, v33
    v_perm_b32 v32, v27, v26, s28
    v_accvgpr_write_b32 a89, v32
    v_perm_b32 v33, v27, v26, s29
    v_accvgpr_write_b32 a93, v33
    s_waitcnt lgkmcnt(0)
    v_perm_b32 v32, v29, v28, s28
    v_accvgpr_write_b32 a90, v32
    v_perm_b32 v33, v29, v28, s29
    v_accvgpr_write_b32 a94, v33
    v_perm_b32 v32, v31, v30, s28
    v_accvgpr_write_b32 a91, v32
    v_perm_b32 v33, v31, v30, s29
    v_accvgpr_write_b32 a95, v33
    s_waitcnt vmcnt(20)
    s_barrier
    ds_read2st64_b32 v[16:17], v14 offset0:128 offset1:132
    ds_read2st64_b32 v[18:19], v14 offset0:136 offset1:140
    ds_read2st64_b32 v[20:21], v14 offset0:144 offset1:148
    ds_read2st64_b32 v[22:23], v14 offset0:152 offset1:156
    ds_read2st64_b32 v[24:25], v14 offset0:160 offset1:164
    ds_read2st64_b32 v[26:27], v14 offset0:168 offset1:172
    ds_read2st64_b32 v[28:29], v14 offset0:176 offset1:180
    ds_read2st64_b32 v[30:31], v14 offset0:184 offset1:188
    s_add_u32 m0, s31, 65536
    s_mov_b32 s30, 2097152
    buffer_load_dwordx4 v12, s[84:87], s30 offen lds
    s_add_u32 m0, s31, 66560
    s_mov_b32 s30, 2105344
    buffer_load_dwordx4 v12, s[84:87], s30 offen lds
    s_add_u32 m0, s31, 67584
    s_mov_b32 s30, 2113536
    buffer_load_dwordx4 v12, s[84:87], s30 offen lds
    s_add_u32 m0, s31, 68608
    s_mov_b32 s30, 2121728
    buffer_load_dwordx4 v12, s[84:87], s30 offen lds
    s_waitcnt lgkmcnt(6)
    v_perm_b32 v32, v17, v16, s28
    v_accvgpr_write_b32 a96, v32
    v_perm_b32 v33, v17, v16, s29
    v_accvgpr_write_b32 a100, v33
    v_perm_b32 v32, v19, v18, s28
    v_accvgpr_write_b32 a97, v32
    v_perm_b32 v33, v19, v18, s29
    v_accvgpr_write_b32 a101, v33
    s_waitcnt lgkmcnt(4)
    v_perm_b32 v32, v21, v20, s28
    v_accvgpr_write_b32 a98, v32
    v_perm_b32 v33, v21, v20, s29
    v_accvgpr_write_b32 a102, v33
    v_perm_b32 v32, v23, v22, s28
    v_accvgpr_write_b32 a99, v32
    v_perm_b32 v33, v23, v22, s29
    v_accvgpr_write_b32 a103, v33
    s_waitcnt lgkmcnt(2)
    v_perm_b32 v32, v25, v24, s28
    v_accvgpr_write_b32 a104, v32
    v_perm_b32 v33, v25, v24, s29
    v_accvgpr_write_b32 a108, v33
    v_perm_b32 v32, v27, v26, s28
    v_accvgpr_write_b32 a105, v32
    v_perm_b32 v33, v27, v26, s29
    v_accvgpr_write_b32 a109, v33
    s_waitcnt lgkmcnt(0)
    v_perm_b32 v32, v29, v28, s28
    v_accvgpr_write_b32 a106, v32
    v_perm_b32 v33, v29, v28, s29
    v_accvgpr_write_b32 a110, v33
    v_perm_b32 v32, v31, v30, s28
    v_accvgpr_write_b32 a107, v32
    v_perm_b32 v33, v31, v30, s29
    v_accvgpr_write_b32 a111, v33
    s_waitcnt vmcnt(20)
    s_barrier
    ds_read2st64_b32 v[16:17], v14 offset0:192 offset1:196
    ds_read2st64_b32 v[18:19], v14 offset0:200 offset1:204
    ds_read2st64_b32 v[20:21], v14 offset0:208 offset1:212
    ds_read2st64_b32 v[22:23], v14 offset0:216 offset1:220
    ds_read2st64_b32 v[24:25], v14 offset0:224 offset1:228
    ds_read2st64_b32 v[26:27], v14 offset0:232 offset1:236
    ds_read2st64_b32 v[28:29], v14 offset0:240 offset1:244
    ds_read2st64_b32 v[30:31], v14 offset0:248 offset1:252
    s_add_u32 m0, s31, 81920
    s_mov_b32 s30, 2621440
    buffer_load_dwordx4 v12, s[84:87], s30 offen lds
    s_add_u32 m0, s31, 82944
    s_mov_b32 s30, 2629632
    buffer_load_dwordx4 v12, s[84:87], s30 offen lds
    s_add_u32 m0, s31, 83968
    s_mov_b32 s30, 2637824
    buffer_load_dwordx4 v12, s[84:87], s30 offen lds
    s_add_u32 m0, s31, 84992
    s_mov_b32 s30, 2646016
    buffer_load_dwordx4 v12, s[84:87], s30 offen lds
    s_waitcnt lgkmcnt(6)
    v_perm_b32 v32, v17, v16, s28
    v_accvgpr_write_b32 a112, v32
    v_perm_b32 v33, v17, v16, s29
    v_accvgpr_write_b32 a116, v33
    v_perm_b32 v32, v19, v18, s28
    v_accvgpr_write_b32 a113, v32
    v_perm_b32 v33, v19, v18, s29
    v_accvgpr_write_b32 a117, v33
    s_waitcnt lgkmcnt(4)
    v_perm_b32 v32, v21, v20, s28
    v_accvgpr_write_b32 a114, v32
    v_perm_b32 v33, v21, v20, s29
    v_accvgpr_write_b32 a118, v33
    v_perm_b32 v32, v23, v22, s28
    v_accvgpr_write_b32 a115, v32
    v_perm_b32 v33, v23, v22, s29
    v_accvgpr_write_b32 a119, v33
    s_waitcnt lgkmcnt(2)
    v_perm_b32 v32, v25, v24, s28
    v_accvgpr_write_b32 a120, v32
    v_perm_b32 v33, v25, v24, s29
    v_accvgpr_write_b32 a124, v33
    v_perm_b32 v32, v27, v26, s28
    v_accvgpr_write_b32 a121, v32
    v_perm_b32 v33, v27, v26, s29
    v_accvgpr_write_b32 a125, v33
    s_waitcnt lgkmcnt(0)
    v_perm_b32 v32, v29, v28, s28
    v_accvgpr_write_b32 a122, v32
    v_perm_b32 v33, v29, v28, s29
    v_accvgpr_write_b32 a126, v33
    v_perm_b32 v32, v31, v30, s28
    v_accvgpr_write_b32 a123, v32
    v_perm_b32 v33, v31, v30, s29
    v_accvgpr_write_b32 a127, v33
    s_waitcnt vmcnt(20)
    s_barrier
    ds_read2st64_b32 v[16:17], v13 offset0:0 offset1:4
    ds_read2st64_b32 v[18:19], v13 offset0:8 offset1:12
    ds_read2st64_b32 v[20:21], v13 offset0:16 offset1:20
    ds_read2st64_b32 v[22:23], v13 offset0:24 offset1:28
    ds_read2st64_b32 v[24:25], v13 offset0:32 offset1:36
    ds_read2st64_b32 v[26:27], v13 offset0:40 offset1:44
    ds_read2st64_b32 v[28:29], v13 offset0:48 offset1:52
    ds_read2st64_b32 v[30:31], v13 offset0:56 offset1:60
    s_add_u32 m0, s31, 98304
    s_mov_b32 s30, 3145728
    buffer_load_dwordx4 v12, s[84:87], s30 offen lds
    s_add_u32 m0, s31, 99328
    s_mov_b32 s30, 3153920
    buffer_load_dwordx4 v12, s[84:87], s30 offen lds
    s_add_u32 m0, s31, 100352
    s_mov_b32 s30, 3162112
    buffer_load_dwordx4 v12, s[84:87], s30 offen lds
    s_add_u32 m0, s31, 101376
    s_mov_b32 s30, 3170304
    buffer_load_dwordx4 v12, s[84:87], s30 offen lds
    s_waitcnt lgkmcnt(6)
    v_perm_b32 v32, v17, v16, s28
    v_accvgpr_write_b32 a128, v32
    v_perm_b32 v33, v17, v16, s29
    v_accvgpr_write_b32 a132, v33
    v_perm_b32 v32, v19, v18, s28
    v_accvgpr_write_b32 a129, v32
    v_perm_b32 v33, v19, v18, s29
    v_accvgpr_write_b32 a133, v33
    s_waitcnt lgkmcnt(4)
    v_perm_b32 v32, v21, v20, s28
    v_accvgpr_write_b32 a130, v32
    v_perm_b32 v33, v21, v20, s29
    v_accvgpr_write_b32 a134, v33
    v_perm_b32 v32, v23, v22, s28
    v_accvgpr_write_b32 a131, v32
    v_perm_b32 v33, v23, v22, s29
    v_accvgpr_write_b32 a135, v33
    s_waitcnt lgkmcnt(2)
    v_perm_b32 v32, v25, v24, s28
    v_accvgpr_write_b32 a136, v32
    v_perm_b32 v33, v25, v24, s29
    v_accvgpr_write_b32 a140, v33
    v_perm_b32 v32, v27, v26, s28
    v_accvgpr_write_b32 a137, v32
    v_perm_b32 v33, v27, v26, s29
    v_accvgpr_write_b32 a141, v33
    s_waitcnt lgkmcnt(0)
    v_perm_b32 v32, v29, v28, s28
    v_accvgpr_write_b32 a138, v32
    v_perm_b32 v33, v29, v28, s29
    v_accvgpr_write_b32 a142, v33
    v_perm_b32 v32, v31, v30, s28
    v_accvgpr_write_b32 a139, v32
    v_perm_b32 v33, v31, v30, s29
    v_accvgpr_write_b32 a143, v33
    s_waitcnt vmcnt(20)
    s_barrier
    ds_read2st64_b32 v[16:17], v13 offset0:64 offset1:68
    ds_read2st64_b32 v[18:19], v13 offset0:72 offset1:76
    ds_read2st64_b32 v[20:21], v13 offset0:80 offset1:84
    ds_read2st64_b32 v[22:23], v13 offset0:88 offset1:92
    ds_read2st64_b32 v[24:25], v13 offset0:96 offset1:100
    ds_read2st64_b32 v[26:27], v13 offset0:104 offset1:108
    ds_read2st64_b32 v[28:29], v13 offset0:112 offset1:116
    ds_read2st64_b32 v[30:31], v13 offset0:120 offset1:124
    s_add_u32 m0, s31, 114688
    s_mov_b32 s30, 3670016
    buffer_load_dwordx4 v12, s[84:87], s30 offen lds
    s_add_u32 m0, s31, 115712
    s_mov_b32 s30, 3678208
    buffer_load_dwordx4 v12, s[84:87], s30 offen lds
    s_add_u32 m0, s31, 116736
    s_mov_b32 s30, 3686400
    buffer_load_dwordx4 v12, s[84:87], s30 offen lds
    s_add_u32 m0, s31, 117760
    s_mov_b32 s30, 3694592
    buffer_load_dwordx4 v12, s[84:87], s30 offen lds
    s_waitcnt lgkmcnt(6)
    v_perm_b32 v32, v17, v16, s28
    v_accvgpr_write_b32 a144, v32
    v_perm_b32 v33, v17, v16, s29
    v_accvgpr_write_b32 a148, v33
    v_perm_b32 v32, v19, v18, s28
    v_accvgpr_write_b32 a145, v32
    v_perm_b32 v33, v19, v18, s29
    v_accvgpr_write_b32 a149, v33
    s_waitcnt lgkmcnt(4)
    v_perm_b32 v32, v21, v20, s28
    v_accvgpr_write_b32 a146, v32
    v_perm_b32 v33, v21, v20, s29
    v_accvgpr_write_b32 a150, v33
    v_perm_b32 v32, v23, v22, s28
    v_accvgpr_write_b32 a147, v32
    v_perm_b32 v33, v23, v22, s29
    v_accvgpr_write_b32 a151, v33
    s_waitcnt lgkmcnt(2)
    v_perm_b32 v32, v25, v24, s28
    v_accvgpr_write_b32 a152, v32
    v_perm_b32 v33, v25, v24, s29
    v_accvgpr_write_b32 a156, v33
    v_perm_b32 v32, v27, v26, s28
    v_accvgpr_write_b32 a153, v32
    v_perm_b32 v33, v27, v26, s29
    v_accvgpr_write_b32 a157, v33
    s_waitcnt lgkmcnt(0)
    v_perm_b32 v32, v29, v28, s28
    v_accvgpr_write_b32 a154, v32
    v_perm_b32 v33, v29, v28, s29
    v_accvgpr_write_b32 a158, v33
    v_perm_b32 v32, v31, v30, s28
    v_accvgpr_write_b32 a155, v32
    v_perm_b32 v33, v31, v30, s29
    v_accvgpr_write_b32 a159, v33
    s_waitcnt vmcnt(20)
    s_barrier
    ds_read2st64_b32 v[16:17], v13 offset0:128 offset1:132
    ds_read2st64_b32 v[18:19], v13 offset0:136 offset1:140
    ds_read2st64_b32 v[20:21], v13 offset0:144 offset1:148
    ds_read2st64_b32 v[22:23], v13 offset0:152 offset1:156
    ds_read2st64_b32 v[24:25], v13 offset0:160 offset1:164
    ds_read2st64_b32 v[26:27], v13 offset0:168 offset1:172
    ds_read2st64_b32 v[28:29], v13 offset0:176 offset1:180
    ds_read2st64_b32 v[30:31], v13 offset0:184 offset1:188
    s_add_u32 m0, s31, 0
    s_mov_b32 s30, 0
    buffer_load_dwordx4 v12, s[88:91], s30 offen lds
    s_add_u32 m0, s31, 1024
    s_mov_b32 s30, 8192
    buffer_load_dwordx4 v12, s[88:91], s30 offen lds
    s_add_u32 m0, s31, 2048
    s_mov_b32 s30, 16384
    buffer_load_dwordx4 v12, s[88:91], s30 offen lds
    s_add_u32 m0, s31, 3072
    s_mov_b32 s30, 24576
    buffer_load_dwordx4 v12, s[88:91], s30 offen lds
    s_waitcnt lgkmcnt(6)
    v_perm_b32 v32, v17, v16, s28
    v_accvgpr_write_b32 a160, v32
    v_perm_b32 v33, v17, v16, s29
    v_accvgpr_write_b32 a164, v33
    v_perm_b32 v32, v19, v18, s28
    v_accvgpr_write_b32 a161, v32
    v_perm_b32 v33, v19, v18, s29
    v_accvgpr_write_b32 a165, v33
    s_waitcnt lgkmcnt(4)
    v_perm_b32 v32, v21, v20, s28
    v_accvgpr_write_b32 a162, v32
    v_perm_b32 v33, v21, v20, s29
    v_accvgpr_write_b32 a166, v33
    v_perm_b32 v32, v23, v22, s28
    v_accvgpr_write_b32 a163, v32
    v_perm_b32 v33, v23, v22, s29
    v_accvgpr_write_b32 a167, v33
    s_waitcnt lgkmcnt(2)
    v_perm_b32 v32, v25, v24, s28
    v_accvgpr_write_b32 a168, v32
    v_perm_b32 v33, v25, v24, s29
    v_accvgpr_write_b32 a172, v33
    v_perm_b32 v32, v27, v26, s28
    v_accvgpr_write_b32 a169, v32
    v_perm_b32 v33, v27, v26, s29
    v_accvgpr_write_b32 a173, v33
    s_waitcnt lgkmcnt(0)
    v_perm_b32 v32, v29, v28, s28
    v_accvgpr_write_b32 a170, v32
    v_perm_b32 v33, v29, v28, s29
    v_accvgpr_write_b32 a174, v33
    v_perm_b32 v32, v31, v30, s28
    v_accvgpr_write_b32 a171, v32
    v_perm_b32 v33, v31, v30, s29
    v_accvgpr_write_b32 a175, v33
    s_waitcnt vmcnt(20)
    s_barrier
    ds_read2st64_b32 v[16:17], v13 offset0:192 offset1:196
    ds_read2st64_b32 v[18:19], v13 offset0:200 offset1:204
    ds_read2st64_b32 v[20:21], v13 offset0:208 offset1:212
    ds_read2st64_b32 v[22:23], v13 offset0:216 offset1:220
    ds_read2st64_b32 v[24:25], v13 offset0:224 offset1:228
    ds_read2st64_b32 v[26:27], v13 offset0:232 offset1:236
    ds_read2st64_b32 v[28:29], v13 offset0:240 offset1:244
    ds_read2st64_b32 v[30:31], v13 offset0:248 offset1:252
    s_add_u32 m0, s31, 16384
    s_mov_b32 s30, 524288
    buffer_load_dwordx4 v12, s[88:91], s30 offen lds
    s_add_u32 m0, s31, 17408
    s_mov_b32 s30, 532480
    buffer_load_dwordx4 v12, s[88:91], s30 offen lds
    s_add_u32 m0, s31, 18432
    s_mov_b32 s30, 540672
    buffer_load_dwordx4 v12, s[88:91], s30 offen lds
    s_add_u32 m0, s31, 19456
    s_mov_b32 s30, 548864
    buffer_load_dwordx4 v12, s[88:91], s30 offen lds
    s_waitcnt lgkmcnt(6)
    v_perm_b32 v32, v17, v16, s28
    v_accvgpr_write_b32 a176, v32
    v_perm_b32 v33, v17, v16, s29
    v_accvgpr_write_b32 a180, v33
    v_perm_b32 v32, v19, v18, s28
    v_accvgpr_write_b32 a177, v32
    v_perm_b32 v33, v19, v18, s29
    v_accvgpr_write_b32 a181, v33
    s_waitcnt lgkmcnt(4)
    v_perm_b32 v32, v21, v20, s28
    v_accvgpr_write_b32 a178, v32
    v_perm_b32 v33, v21, v20, s29
    v_accvgpr_write_b32 a182, v33
    v_perm_b32 v32, v23, v22, s28
    v_accvgpr_write_b32 a179, v32
    v_perm_b32 v33, v23, v22, s29
    v_accvgpr_write_b32 a183, v33
    s_waitcnt lgkmcnt(2)
    v_perm_b32 v32, v25, v24, s28
    v_accvgpr_write_b32 a184, v32
    v_perm_b32 v33, v25, v24, s29
    v_accvgpr_write_b32 a188, v33
    v_perm_b32 v32, v27, v26, s28
    v_accvgpr_write_b32 a185, v32
    v_perm_b32 v33, v27, v26, s29
    v_accvgpr_write_b32 a189, v33
    s_waitcnt lgkmcnt(0)
    v_perm_b32 v32, v29, v28, s28
    v_accvgpr_write_b32 a186, v32
    v_perm_b32 v33, v29, v28, s29
    v_accvgpr_write_b32 a190, v33
    v_perm_b32 v32, v31, v30, s28
    v_accvgpr_write_b32 a187, v32
    v_perm_b32 v33, v31, v30, s29
    v_accvgpr_write_b32 a191, v33
    s_waitcnt vmcnt(20)
    s_barrier
    ds_read2st64_b32 v[16:17], v14 offset0:0 offset1:4
    ds_read2st64_b32 v[18:19], v14 offset0:8 offset1:12
    ds_read2st64_b32 v[20:21], v14 offset0:16 offset1:20
    ds_read2st64_b32 v[22:23], v14 offset0:24 offset1:28
    ds_read2st64_b32 v[24:25], v14 offset0:32 offset1:36
    ds_read2st64_b32 v[26:27], v14 offset0:40 offset1:44
    ds_read2st64_b32 v[28:29], v14 offset0:48 offset1:52
    ds_read2st64_b32 v[30:31], v14 offset0:56 offset1:60
    s_add_u32 m0, s31, 32768
    s_mov_b32 s30, 1048576
    buffer_load_dwordx4 v12, s[88:91], s30 offen lds
    s_add_u32 m0, s31, 33792
    s_mov_b32 s30, 1056768
    buffer_load_dwordx4 v12, s[88:91], s30 offen lds
    s_add_u32 m0, s31, 34816
    s_mov_b32 s30, 1064960
    buffer_load_dwordx4 v12, s[88:91], s30 offen lds
    s_add_u32 m0, s31, 35840
    s_mov_b32 s30, 1073152
    buffer_load_dwordx4 v12, s[88:91], s30 offen lds
    s_waitcnt lgkmcnt(6)
    v_perm_b32 v32, v17, v16, s28
    v_accvgpr_write_b32 a192, v32
    v_perm_b32 v33, v17, v16, s29
    v_accvgpr_write_b32 a196, v33
    v_perm_b32 v32, v19, v18, s28
    v_accvgpr_write_b32 a193, v32
    v_perm_b32 v33, v19, v18, s29
    v_accvgpr_write_b32 a197, v33
    s_waitcnt lgkmcnt(4)
    v_perm_b32 v32, v21, v20, s28
    v_accvgpr_write_b32 a194, v32
    v_perm_b32 v33, v21, v20, s29
    v_accvgpr_write_b32 a198, v33
    v_perm_b32 v32, v23, v22, s28
    v_accvgpr_write_b32 a195, v32
    v_perm_b32 v33, v23, v22, s29
    v_accvgpr_write_b32 a199, v33
    s_waitcnt lgkmcnt(2)
    v_perm_b32 v32, v25, v24, s28
    v_accvgpr_write_b32 a200, v32
    v_perm_b32 v33, v25, v24, s29
    v_accvgpr_write_b32 a204, v33
    v_perm_b32 v32, v27, v26, s28
    v_accvgpr_write_b32 a201, v32
    v_perm_b32 v33, v27, v26, s29
    v_accvgpr_write_b32 a205, v33
    s_waitcnt lgkmcnt(0)
    v_perm_b32 v32, v29, v28, s28
    v_accvgpr_write_b32 a202, v32
    v_perm_b32 v33, v29, v28, s29
    v_accvgpr_write_b32 a206, v33
    v_perm_b32 v32, v31, v30, s28
    v_accvgpr_write_b32 a203, v32
    v_perm_b32 v33, v31, v30, s29
    v_accvgpr_write_b32 a207, v33
    s_waitcnt vmcnt(20)
    s_barrier
    ds_read2st64_b32 v[16:17], v14 offset0:64 offset1:68
    ds_read2st64_b32 v[18:19], v14 offset0:72 offset1:76
    ds_read2st64_b32 v[20:21], v14 offset0:80 offset1:84
    ds_read2st64_b32 v[22:23], v14 offset0:88 offset1:92
    ds_read2st64_b32 v[24:25], v14 offset0:96 offset1:100
    ds_read2st64_b32 v[26:27], v14 offset0:104 offset1:108
    ds_read2st64_b32 v[28:29], v14 offset0:112 offset1:116
    ds_read2st64_b32 v[30:31], v14 offset0:120 offset1:124
    s_add_u32 m0, s31, 49152
    s_mov_b32 s30, 1572864
    buffer_load_dwordx4 v12, s[88:91], s30 offen lds
    s_add_u32 m0, s31, 50176
    s_mov_b32 s30, 1581056
    buffer_load_dwordx4 v12, s[88:91], s30 offen lds
    s_add_u32 m0, s31, 51200
    s_mov_b32 s30, 1589248
    buffer_load_dwordx4 v12, s[88:91], s30 offen lds
    s_add_u32 m0, s31, 52224
    s_mov_b32 s30, 1597440
    buffer_load_dwordx4 v12, s[88:91], s30 offen lds
    s_waitcnt lgkmcnt(6)
    v_perm_b32 v32, v17, v16, s28
    v_accvgpr_write_b32 a208, v32
    v_perm_b32 v33, v17, v16, s29
    v_accvgpr_write_b32 a212, v33
    v_perm_b32 v32, v19, v18, s28
    v_accvgpr_write_b32 a209, v32
    v_perm_b32 v33, v19, v18, s29
    v_accvgpr_write_b32 a213, v33
    s_waitcnt lgkmcnt(4)
    v_perm_b32 v32, v21, v20, s28
    v_accvgpr_write_b32 a210, v32
    v_perm_b32 v33, v21, v20, s29
    v_accvgpr_write_b32 a214, v33
    v_perm_b32 v32, v23, v22, s28
    v_accvgpr_write_b32 a211, v32
    v_perm_b32 v33, v23, v22, s29
    v_accvgpr_write_b32 a215, v33
    s_waitcnt lgkmcnt(2)
    v_perm_b32 v32, v25, v24, s28
    v_accvgpr_write_b32 a216, v32
    v_perm_b32 v33, v25, v24, s29
    v_accvgpr_write_b32 a220, v33
    v_perm_b32 v32, v27, v26, s28
    v_accvgpr_write_b32 a217, v32
    v_perm_b32 v33, v27, v26, s29
    v_accvgpr_write_b32 a221, v33
    s_waitcnt lgkmcnt(0)
    v_perm_b32 v32, v29, v28, s28
    v_accvgpr_write_b32 a218, v32
    v_perm_b32 v33, v29, v28, s29
    v_accvgpr_write_b32 a222, v33
    v_perm_b32 v32, v31, v30, s28
    v_accvgpr_write_b32 a219, v32
    v_perm_b32 v33, v31, v30, s29
    v_accvgpr_write_b32 a223, v33
    s_waitcnt vmcnt(20)
    s_barrier
    ds_read2st64_b32 v[16:17], v14 offset0:128 offset1:132
    ds_read2st64_b32 v[18:19], v14 offset0:136 offset1:140
    ds_read2st64_b32 v[20:21], v14 offset0:144 offset1:148
    ds_read2st64_b32 v[22:23], v14 offset0:152 offset1:156
    ds_read2st64_b32 v[24:25], v14 offset0:160 offset1:164
    ds_read2st64_b32 v[26:27], v14 offset0:168 offset1:172
    ds_read2st64_b32 v[28:29], v14 offset0:176 offset1:180
    ds_read2st64_b32 v[30:31], v14 offset0:184 offset1:188
    s_add_u32 m0, s31, 65536
    s_mov_b32 s30, 2097152
    buffer_load_dwordx4 v12, s[88:91], s30 offen lds
    s_add_u32 m0, s31, 66560
    s_mov_b32 s30, 2105344
    buffer_load_dwordx4 v12, s[88:91], s30 offen lds
    s_add_u32 m0, s31, 67584
    s_mov_b32 s30, 2113536
    buffer_load_dwordx4 v12, s[88:91], s30 offen lds
    s_add_u32 m0, s31, 68608
    s_mov_b32 s30, 2121728
    buffer_load_dwordx4 v12, s[88:91], s30 offen lds
    s_waitcnt lgkmcnt(6)
    v_perm_b32 v32, v17, v16, s28
    v_accvgpr_write_b32 a224, v32
    v_perm_b32 v33, v17, v16, s29
    v_accvgpr_write_b32 a228, v33
    v_perm_b32 v32, v19, v18, s28
    v_accvgpr_write_b32 a225, v32
    v_perm_b32 v33, v19, v18, s29
    v_accvgpr_write_b32 a229, v33
    s_waitcnt lgkmcnt(4)
    v_perm_b32 v32, v21, v20, s28
    v_accvgpr_write_b32 a226, v32
    v_perm_b32 v33, v21, v20, s29
    v_accvgpr_write_b32 a230, v33
    v_perm_b32 v32, v23, v22, s28
    v_accvgpr_write_b32 a227, v32
    v_perm_b32 v33, v23, v22, s29
    v_accvgpr_write_b32 a231, v33
    s_waitcnt lgkmcnt(2)
    v_perm_b32 v32, v25, v24, s28
    v_accvgpr_write_b32 a232, v32
    v_perm_b32 v33, v25, v24, s29
    v_accvgpr_write_b32 a236, v33
    v_perm_b32 v32, v27, v26, s28
    v_accvgpr_write_b32 a233, v32
    v_perm_b32 v33, v27, v26, s29
    v_accvgpr_write_b32 a237, v33
    s_waitcnt lgkmcnt(0)
    v_perm_b32 v32, v29, v28, s28
    v_accvgpr_write_b32 a234, v32
    v_perm_b32 v33, v29, v28, s29
    v_accvgpr_write_b32 a238, v33
    v_perm_b32 v32, v31, v30, s28
    v_accvgpr_write_b32 a235, v32
    v_perm_b32 v33, v31, v30, s29
    v_accvgpr_write_b32 a239, v33
    s_waitcnt vmcnt(20)
    s_barrier
    ds_read2st64_b32 v[16:17], v14 offset0:192 offset1:196
    ds_read2st64_b32 v[18:19], v14 offset0:200 offset1:204
    ds_read2st64_b32 v[20:21], v14 offset0:208 offset1:212
    ds_read2st64_b32 v[22:23], v14 offset0:216 offset1:220
    ds_read2st64_b32 v[24:25], v14 offset0:224 offset1:228
    ds_read2st64_b32 v[26:27], v14 offset0:232 offset1:236
    ds_read2st64_b32 v[28:29], v14 offset0:240 offset1:244
    ds_read2st64_b32 v[30:31], v14 offset0:248 offset1:252
    s_add_u32 m0, s31, 81920
    s_mov_b32 s30, 2621440
    buffer_load_dwordx4 v12, s[88:91], s30 offen lds
    s_add_u32 m0, s31, 82944
    s_mov_b32 s30, 2629632
    buffer_load_dwordx4 v12, s[88:91], s30 offen lds
    s_add_u32 m0, s31, 83968
    s_mov_b32 s30, 2637824
    buffer_load_dwordx4 v12, s[88:91], s30 offen lds
    s_add_u32 m0, s31, 84992
    s_mov_b32 s30, 2646016
    buffer_load_dwordx4 v12, s[88:91], s30 offen lds
    s_waitcnt lgkmcnt(6)
    v_perm_b32 v32, v17, v16, s28
    v_accvgpr_write_b32 a240, v32
    v_perm_b32 v33, v17, v16, s29
    v_accvgpr_write_b32 a244, v33
    v_perm_b32 v32, v19, v18, s28
    v_accvgpr_write_b32 a241, v32
    v_perm_b32 v33, v19, v18, s29
    v_accvgpr_write_b32 a245, v33
    s_waitcnt lgkmcnt(4)
    v_perm_b32 v32, v21, v20, s28
    v_accvgpr_write_b32 a242, v32
    v_perm_b32 v33, v21, v20, s29
    v_accvgpr_write_b32 a246, v33
    v_perm_b32 v32, v23, v22, s28
    v_accvgpr_write_b32 a243, v32
    v_perm_b32 v33, v23, v22, s29
    v_accvgpr_write_b32 a247, v33
    s_waitcnt lgkmcnt(2)
    v_perm_b32 v32, v25, v24, s28
    v_accvgpr_write_b32 a248, v32
    v_perm_b32 v33, v25, v24, s29
    v_accvgpr_write_b32 a252, v33
    v_perm_b32 v32, v27, v26, s28
    v_accvgpr_write_b32 a249, v32
    v_perm_b32 v33, v27, v26, s29
    v_accvgpr_write_b32 a253, v33
    s_waitcnt lgkmcnt(0)
    v_perm_b32 v32, v29, v28, s28
    v_accvgpr_write_b32 a250, v32
    v_perm_b32 v33, v29, v28, s29
    v_accvgpr_write_b32 a254, v33
    v_perm_b32 v32, v31, v30, s28
    v_accvgpr_write_b32 a251, v32
    v_perm_b32 v33, v31, v30, s29
    v_accvgpr_write_b32 a255, v33
    s_waitcnt vmcnt(20)
    s_barrier
    ds_read2st64_b32 v[16:17], v13 offset0:0 offset1:4
    ds_read2st64_b32 v[18:19], v13 offset0:8 offset1:12
    ds_read2st64_b32 v[20:21], v13 offset0:16 offset1:20
    ds_read2st64_b32 v[22:23], v13 offset0:24 offset1:28
    ds_read2st64_b32 v[24:25], v13 offset0:32 offset1:36
    ds_read2st64_b32 v[26:27], v13 offset0:40 offset1:44
    ds_read2st64_b32 v[28:29], v13 offset0:48 offset1:52
    ds_read2st64_b32 v[30:31], v13 offset0:56 offset1:60
    s_add_u32 m0, s31, 98304
    s_mov_b32 s30, 3145728
    buffer_load_dwordx4 v12, s[88:91], s30 offen lds
    s_add_u32 m0, s31, 99328
    s_mov_b32 s30, 3153920
    buffer_load_dwordx4 v12, s[88:91], s30 offen lds
    s_add_u32 m0, s31, 100352
    s_mov_b32 s30, 3162112
    buffer_load_dwordx4 v12, s[88:91], s30 offen lds
    s_add_u32 m0, s31, 101376
    s_mov_b32 s30, 3170304
    buffer_load_dwordx4 v12, s[88:91], s30 offen lds
    s_waitcnt lgkmcnt(6)
    v_perm_b32 v128, v17, v16, s28
    v_perm_b32 v132, v17, v16, s29
    v_perm_b32 v129, v19, v18, s28
    v_perm_b32 v133, v19, v18, s29
    s_waitcnt lgkmcnt(4)
    v_perm_b32 v130, v21, v20, s28
    v_perm_b32 v134, v21, v20, s29
    v_perm_b32 v131, v23, v22, s28
    v_perm_b32 v135, v23, v22, s29
    s_waitcnt lgkmcnt(2)
    v_perm_b32 v136, v25, v24, s28
    v_perm_b32 v140, v25, v24, s29
    v_perm_b32 v137, v27, v26, s28
    v_perm_b32 v141, v27, v26, s29
    s_waitcnt lgkmcnt(0)
    v_perm_b32 v138, v29, v28, s28
    v_perm_b32 v142, v29, v28, s29
    v_perm_b32 v139, v31, v30, s28
    v_perm_b32 v143, v31, v30, s29
    s_waitcnt vmcnt(20)
    s_barrier
    ds_read2st64_b32 v[16:17], v13 offset0:64 offset1:68
    ds_read2st64_b32 v[18:19], v13 offset0:72 offset1:76
    ds_read2st64_b32 v[20:21], v13 offset0:80 offset1:84
    ds_read2st64_b32 v[22:23], v13 offset0:88 offset1:92
    ds_read2st64_b32 v[24:25], v13 offset0:96 offset1:100
    ds_read2st64_b32 v[26:27], v13 offset0:104 offset1:108
    ds_read2st64_b32 v[28:29], v13 offset0:112 offset1:116
    ds_read2st64_b32 v[30:31], v13 offset0:120 offset1:124
    s_add_u32 m0, s31, 114688
    s_mov_b32 s30, 3670016
    buffer_load_dwordx4 v12, s[88:91], s30 offen lds
    s_add_u32 m0, s31, 115712
    s_mov_b32 s30, 3678208
    buffer_load_dwordx4 v12, s[88:91], s30 offen lds
    s_add_u32 m0, s31, 116736
    s_mov_b32 s30, 3686400
    buffer_load_dwordx4 v12, s[88:91], s30 offen lds
    s_add_u32 m0, s31, 117760
    s_mov_b32 s30, 3694592
    buffer_load_dwordx4 v12, s[88:91], s30 offen lds
    s_waitcnt lgkmcnt(6)
    v_perm_b32 v144, v17, v16, s28
    v_perm_b32 v148, v17, v16, s29
    v_perm_b32 v145, v19, v18, s28
    v_perm_b32 v149, v19, v18, s29
    s_waitcnt lgkmcnt(4)
    v_perm_b32 v146, v21, v20, s28
    v_perm_b32 v150, v21, v20, s29
    v_perm_b32 v147, v23, v22, s28
    v_perm_b32 v151, v23, v22, s29
    s_waitcnt lgkmcnt(2)
    v_perm_b32 v152, v25, v24, s28
    v_perm_b32 v156, v25, v24, s29
    v_perm_b32 v153, v27, v26, s28
    v_perm_b32 v157, v27, v26, s29
    s_waitcnt lgkmcnt(0)
    v_perm_b32 v154, v29, v28, s28
    v_perm_b32 v158, v29, v28, s29
    v_perm_b32 v155, v31, v30, s28
    v_perm_b32 v159, v31, v30, s29
    s_waitcnt vmcnt(20)
    s_barrier
    ds_read2st64_b32 v[16:17], v13 offset0:128 offset1:132
    ds_read2st64_b32 v[18:19], v13 offset0:136 offset1:140
    ds_read2st64_b32 v[20:21], v13 offset0:144 offset1:148
    ds_read2st64_b32 v[22:23], v13 offset0:152 offset1:156
    ds_read2st64_b32 v[24:25], v13 offset0:160 offset1:164
    ds_read2st64_b32 v[26:27], v13 offset0:168 offset1:172
    ds_read2st64_b32 v[28:29], v13 offset0:176 offset1:180
    ds_read2st64_b32 v[30:31], v13 offset0:184 offset1:188
    s_waitcnt lgkmcnt(6)
    v_perm_b32 v160, v17, v16, s28
    v_perm_b32 v164, v17, v16, s29
    v_perm_b32 v161, v19, v18, s28
    v_perm_b32 v165, v19, v18, s29
    s_waitcnt lgkmcnt(4)
    v_perm_b32 v162, v21, v20, s28
    v_perm_b32 v166, v21, v20, s29
    v_perm_b32 v163, v23, v22, s28
    v_perm_b32 v167, v23, v22, s29
    s_waitcnt lgkmcnt(2)
    v_perm_b32 v168, v25, v24, s28
    v_perm_b32 v172, v25, v24, s29
    v_perm_b32 v169, v27, v26, s28
    v_perm_b32 v173, v27, v26, s29
    s_waitcnt lgkmcnt(0)
    v_perm_b32 v170, v29, v28, s28
    v_perm_b32 v174, v29, v28, s29
    v_perm_b32 v171, v31, v30, s28
    v_perm_b32 v175, v31, v30, s29
    s_waitcnt vmcnt(16)
    s_barrier
    ds_read2st64_b32 v[16:17], v13 offset0:192 offset1:196
    ds_read2st64_b32 v[18:19], v13 offset0:200 offset1:204
    ds_read2st64_b32 v[20:21], v13 offset0:208 offset1:212
    ds_read2st64_b32 v[22:23], v13 offset0:216 offset1:220
    ds_read2st64_b32 v[24:25], v13 offset0:224 offset1:228
    ds_read2st64_b32 v[26:27], v13 offset0:232 offset1:236
    ds_read2st64_b32 v[28:29], v13 offset0:240 offset1:244
    ds_read2st64_b32 v[30:31], v13 offset0:248 offset1:252
    s_waitcnt lgkmcnt(6)
    v_perm_b32 v176, v17, v16, s28
    v_perm_b32 v180, v17, v16, s29
    v_perm_b32 v177, v19, v18, s28
    v_perm_b32 v181, v19, v18, s29
    s_waitcnt lgkmcnt(4)
    v_perm_b32 v178, v21, v20, s28
    v_perm_b32 v182, v21, v20, s29
    v_perm_b32 v179, v23, v22, s28
    v_perm_b32 v183, v23, v22, s29
    s_waitcnt lgkmcnt(2)
    v_perm_b32 v184, v25, v24, s28
    v_perm_b32 v188, v25, v24, s29
    v_perm_b32 v185, v27, v26, s28
    v_perm_b32 v189, v27, v26, s29
    s_waitcnt lgkmcnt(0)
    v_perm_b32 v186, v29, v28, s28
    v_perm_b32 v190, v29, v28, s29
    v_perm_b32 v187, v31, v30, s28
    v_perm_b32 v191, v31, v30, s29
    s_waitcnt vmcnt(12)
    s_barrier
    ds_read2st64_b32 v[16:17], v14 offset0:0 offset1:4
    ds_read2st64_b32 v[18:19], v14 offset0:8 offset1:12
    ds_read2st64_b32 v[20:21], v14 offset0:16 offset1:20
    ds_read2st64_b32 v[22:23], v14 offset0:24 offset1:28
    ds_read2st64_b32 v[24:25], v14 offset0:32 offset1:36
    ds_read2st64_b32 v[26:27], v14 offset0:40 offset1:44
    ds_read2st64_b32 v[28:29], v14 offset0:48 offset1:52
    ds_read2st64_b32 v[30:31], v14 offset0:56 offset1:60
    s_waitcnt lgkmcnt(6)
    v_perm_b32 v192, v17, v16, s28
    v_perm_b32 v196, v17, v16, s29
    v_perm_b32 v193, v19, v18, s28
    v_perm_b32 v197, v19, v18, s29
    s_waitcnt lgkmcnt(4)
    v_perm_b32 v194, v21, v20, s28
    v_perm_b32 v198, v21, v20, s29
    v_perm_b32 v195, v23, v22, s28
    v_perm_b32 v199, v23, v22, s29
    s_waitcnt lgkmcnt(2)
    v_perm_b32 v200, v25, v24, s28
    v_perm_b32 v204, v25, v24, s29
    v_perm_b32 v201, v27, v26, s28
    v_perm_b32 v205, v27, v26, s29
    s_waitcnt lgkmcnt(0)
    v_perm_b32 v202, v29, v28, s28
    v_perm_b32 v206, v29, v28, s29
    v_perm_b32 v203, v31, v30, s28
    v_perm_b32 v207, v31, v30, s29
    s_waitcnt vmcnt(8)
    s_barrier
    ds_read2st64_b32 v[16:17], v14 offset0:64 offset1:68
    ds_read2st64_b32 v[18:19], v14 offset0:72 offset1:76
    ds_read2st64_b32 v[20:21], v14 offset0:80 offset1:84
    ds_read2st64_b32 v[22:23], v14 offset0:88 offset1:92
    ds_read2st64_b32 v[24:25], v14 offset0:96 offset1:100
    ds_read2st64_b32 v[26:27], v14 offset0:104 offset1:108
    ds_read2st64_b32 v[28:29], v14 offset0:112 offset1:116
    ds_read2st64_b32 v[30:31], v14 offset0:120 offset1:124
    s_waitcnt lgkmcnt(6)
    v_perm_b32 v208, v17, v16, s28
    v_perm_b32 v212, v17, v16, s29
    v_perm_b32 v209, v19, v18, s28
    v_perm_b32 v213, v19, v18, s29
    s_waitcnt lgkmcnt(4)
    v_perm_b32 v210, v21, v20, s28
    v_perm_b32 v214, v21, v20, s29
    v_perm_b32 v211, v23, v22, s28
    v_perm_b32 v215, v23, v22, s29
    s_waitcnt lgkmcnt(2)
    v_perm_b32 v216, v25, v24, s28
    v_perm_b32 v220, v25, v24, s29
    v_perm_b32 v217, v27, v26, s28
    v_perm_b32 v221, v27, v26, s29
    s_waitcnt lgkmcnt(0)
    v_perm_b32 v218, v29, v28, s28
    v_perm_b32 v222, v29, v28, s29
    v_perm_b32 v219, v31, v30, s28
    v_perm_b32 v223, v31, v30, s29
    s_waitcnt vmcnt(4)
    s_barrier
    ds_read2st64_b32 v[16:17], v14 offset0:128 offset1:132
    ds_read2st64_b32 v[18:19], v14 offset0:136 offset1:140
    ds_read2st64_b32 v[20:21], v14 offset0:144 offset1:148
    ds_read2st64_b32 v[22:23], v14 offset0:152 offset1:156
    ds_read2st64_b32 v[24:25], v14 offset0:160 offset1:164
    ds_read2st64_b32 v[26:27], v14 offset0:168 offset1:172
    ds_read2st64_b32 v[28:29], v14 offset0:176 offset1:180
    ds_read2st64_b32 v[30:31], v14 offset0:184 offset1:188
    s_waitcnt lgkmcnt(6)
    v_perm_b32 v224, v17, v16, s28
    v_perm_b32 v228, v17, v16, s29
    v_perm_b32 v225, v19, v18, s28
    v_perm_b32 v229, v19, v18, s29
    s_waitcnt lgkmcnt(4)
    v_perm_b32 v226, v21, v20, s28
    v_perm_b32 v230, v21, v20, s29
    v_perm_b32 v227, v23, v22, s28
    v_perm_b32 v231, v23, v22, s29
    s_waitcnt lgkmcnt(2)
    v_perm_b32 v232, v25, v24, s28
    v_perm_b32 v236, v25, v24, s29
    v_perm_b32 v233, v27, v26, s28
    v_perm_b32 v237, v27, v26, s29
    s_waitcnt lgkmcnt(0)
    v_perm_b32 v234, v29, v28, s28
    v_perm_b32 v238, v29, v28, s29
    v_perm_b32 v235, v31, v30, s28
    v_perm_b32 v239, v31, v30, s29
    s_waitcnt vmcnt(0)
    s_barrier
    ds_read2st64_b32 v[16:17], v14 offset0:192 offset1:196
    ds_read2st64_b32 v[18:19], v14 offset0:200 offset1:204
    ds_read2st64_b32 v[20:21], v14 offset0:208 offset1:212
    ds_read2st64_b32 v[22:23], v14 offset0:216 offset1:220
    ds_read2st64_b32 v[24:25], v14 offset0:224 offset1:228
    ds_read2st64_b32 v[26:27], v14 offset0:232 offset1:236
    ds_read2st64_b32 v[28:29], v14 offset0:240 offset1:244
    ds_read2st64_b32 v[30:31], v14 offset0:248 offset1:252
    s_waitcnt lgkmcnt(6)
    v_perm_b32 v240, v17, v16, s28
    v_perm_b32 v244, v17, v16, s29
    v_perm_b32 v241, v19, v18, s28
    v_perm_b32 v245, v19, v18, s29
    s_waitcnt lgkmcnt(4)
    v_perm_b32 v242, v21, v20, s28
    v_perm_b32 v246, v21, v20, s29
    v_perm_b32 v243, v23, v22, s28
    v_perm_b32 v247, v23, v22, s29
    s_waitcnt lgkmcnt(2)
    v_perm_b32 v248, v25, v24, s28
    v_perm_b32 v252, v25, v24, s29
    v_perm_b32 v249, v27, v26, s28
    v_perm_b32 v253, v27, v26, s29
    s_waitcnt lgkmcnt(0)
    v_perm_b32 v250, v29, v28, s28
    v_perm_b32 v254, v29, v28, s29
    v_perm_b32 v251, v31, v30, s28
    v_perm_b32 v255, v31, v30, s29
    s_barrier
    s_load_dwordx2 s[4:5], s[0:1], 0
    s_waitcnt lgkmcnt(0)
    s_mov_b32 s12, s4
    s_mov_b32 s13, s5
    s_mov_b32 s14, 2097152
    s_mov_b32 s15, 0x20000
    v_and_b32 v12, 15, v0
    v_lshrrev_b32 v13, 4, v0
    v_lshlrev_b32 v9, 5, v12
    v_add_u32 v9, 49152, v9
    s_lshl_b32 s30, s24, 3
    v_add_u32 v8, s30, v9
    v_mul_u32_u24 v10, 80, v13
    v_lshrrev_b32 v14, 2, v12
    v_cmp_eq_u32 s[50:51], v14, v13
    v_and_b32 v14, 3, v12
    v_cmp_eq_u32 s[52:53], 1, v14
    v_cmp_eq_u32 s[54:55], 2, v14
    v_cmp_eq_u32 s[56:57], 3, v14
    v_mov_b32 v56, 0x3f803f80
    v_mov_b32 v57, 0x3f803f80
    v_mov_b32 v58, 0x3f803f80
    v_mov_b32 v59, 0x3f803f80
    s_nop 1
    v_mfma_f32_16x16x32_bf16 v[84:87], a[0:3], v[56:59], 0
    v_mfma_f32_16x16x32_bf16 v[92:95], v[56:59], a[128:131], 0
    v_mfma_f32_16x16x32_bf16 v[100:103], v[128:131], v[56:59], 0
    v_mfma_f32_16x16x32_bf16 v[88:91], a[4:7], v[56:59], 0
    v_mfma_f32_16x16x32_bf16 v[96:99], v[56:59], a[132:135], 0
    v_mfma_f32_16x16x32_bf16 v[104:107], v[132:135], v[56:59], 0
    v_mfma_f32_16x16x32_bf16 v[84:87], a[8:11], v[56:59], v[84:87]
    v_mfma_f32_16x16x32_bf16 v[92:95], v[56:59], a[136:139], v[92:95]
    v_mfma_f32_16x16x32_bf16 v[100:103], v[136:139], v[56:59], v[100:103]
    v_mfma_f32_16x16x32_bf16 v[88:91], a[12:15], v[56:59], v[88:91]
    v_mfma_f32_16x16x32_bf16 v[96:99], v[56:59], a[140:143], v[96:99]
    v_mfma_f32_16x16x32_bf16 v[104:107], v[140:143], v[56:59], v[104:107]
    v_mfma_f32_16x16x32_bf16 v[84:87], a[16:19], v[56:59], v[84:87]
    v_mfma_f32_16x16x32_bf16 v[92:95], v[56:59], a[144:147], v[92:95]
    v_mfma_f32_16x16x32_bf16 v[100:103], v[144:147], v[56:59], v[100:103]
    v_mfma_f32_16x16x32_bf16 v[88:91], a[20:23], v[56:59], v[88:91]
    v_mfma_f32_16x16x32_bf16 v[96:99], v[56:59], a[148:151], v[96:99]
    v_mfma_f32_16x16x32_bf16 v[104:107], v[148:151], v[56:59], v[104:107]
    v_mfma_f32_16x16x32_bf16 v[84:87], a[24:27], v[56:59], v[84:87]
    v_mfma_f32_16x16x32_bf16 v[92:95], v[56:59], a[152:155], v[92:95]
    v_mfma_f32_16x16x32_bf16 v[100:103], v[152:155], v[56:59], v[100:103]
    v_mfma_f32_16x16x32_bf16 v[88:91], a[28:31], v[56:59], v[88:91]
    v_mfma_f32_16x16x32_bf16 v[96:99], v[56:59], a[156:159], v[96:99]
    v_mfma_f32_16x16x32_bf16 v[104:107], v[156:159], v[56:59], v[104:107]
    v_mfma_f32_16x16x32_bf16 v[84:87], a[32:35], v[56:59], v[84:87]
    v_mfma_f32_16x16x32_bf16 v[92:95], v[56:59], a[160:163], v[92:95]
    v_mfma_f32_16x16x32_bf16 v[100:103], v[160:163], v[56:59], v[100:103]
    v_mfma_f32_16x16x32_bf16 v[88:91], a[36:39], v[56:59], v[88:91]
    v_mfma_f32_16x16x32_bf16 v[96:99], v[56:59], a[164:167], v[96:99]
    v_mfma_f32_16x16x32_bf16 v[104:107], v[164:167], v[56:59], v[104:107]
    v_mfma_f32_16x16x32_bf16 v[84:87], a[40:43], v[56:59], v[84:87]
    v_mfma_f32_16x16x32_bf16 v[92:95], v[56:59], a[168:171], v[92:95]
    v_mfma_f32_16x16x32_bf16 v[100:103], v[168:171], v[56:59], v[100:103]
    v_mfma_f32_16x16x32_bf16 v[88:91], a[44:47], v[56:59], v[88:91]
    v_mfma_f32_16x16x32_bf16 v[96:99], v[56:59], a[172:175], v[96:99]
    v_mfma_f32_16x16x32_bf16 v[104:107], v[172:175], v[56:59], v[104:107]
    v_mfma_f32_16x16x32_bf16 v[84:87], a[48:51], v[56:59], v[84:87]
    v_mfma_f32_16x16x32_bf16 v[92:95], v[56:59], a[176:179], v[92:95]
    v_mfma_f32_16x16x32_bf16 v[100:103], v[176:179], v[56:59], v[100:103]
    v_mfma_f32_16x16x32_bf16 v[88:91], a[52:55], v[56:59], v[88:91]
    v_mfma_f32_16x16x32_bf16 v[96:99], v[56:59], a[180:183], v[96:99]
    v_mfma_f32_16x16x32_bf16 v[104:107], v[180:183], v[56:59], v[104:107]
    v_mfma_f32_16x16x32_bf16 v[84:87], a[56:59], v[56:59], v[84:87]
    v_mfma_f32_16x16x32_bf16 v[92:95], v[56:59], a[184:187], v[92:95]
    v_mfma_f32_16x16x32_bf16 v[100:103], v[184:187], v[56:59], v[100:103]
    v_mfma_f32_16x16x32_bf16 v[88:91], a[60:63], v[56:59], v[88:91]
    v_mfma_f32_16x16x32_bf16 v[96:99], v[56:59], a[188:191], v[96:99]
    v_mfma_f32_16x16x32_bf16 v[104:107], v[188:191], v[56:59], v[104:107]
    v_mfma_f32_16x16x32_bf16 v[84:87], a[64:67], v[56:59], v[84:87]
    v_mfma_f32_16x16x32_bf16 v[92:95], v[56:59], a[192:195], v[92:95]
    v_mfma_f32_16x16x32_bf16 v[100:103], v[192:195], v[56:59], v[100:103]
    v_mfma_f32_16x16x32_bf16 v[88:91], a[68:71], v[56:59], v[88:91]
    v_mfma_f32_16x16x32_bf16 v[96:99], v[56:59], a[196:199], v[96:99]
    v_mfma_f32_16x16x32_bf16 v[104:107], v[196:199], v[56:59], v[104:107]
    v_mfma_f32_16x16x32_bf16 v[84:87], a[72:75], v[56:59], v[84:87]
    v_mfma_f32_16x16x32_bf16 v[92:95], v[56:59], a[200:203], v[92:95]
    v_mfma_f32_16x16x32_bf16 v[100:103], v[200:203], v[56:59], v[100:103]
    v_mfma_f32_16x16x32_bf16 v[88:91], a[76:79], v[56:59], v[88:91]
    v_mfma_f32_16x16x32_bf16 v[96:99], v[56:59], a[204:207], v[96:99]
    v_mfma_f32_16x16x32_bf16 v[104:107], v[204:207], v[56:59], v[104:107]
    v_mfma_f32_16x16x32_bf16 v[84:87], a[80:83], v[56:59], v[84:87]
    v_mfma_f32_16x16x32_bf16 v[92:95], v[56:59], a[208:211], v[92:95]
    v_mfma_f32_16x16x32_bf16 v[100:103], v[208:211], v[56:59], v[100:103]
    v_mfma_f32_16x16x32_bf16 v[88:91], a[84:87], v[56:59], v[88:91]
    v_mfma_f32_16x16x32_bf16 v[96:99], v[56:59], a[212:215], v[96:99]
    v_mfma_f32_16x16x32_bf16 v[104:107], v[212:215], v[56:59], v[104:107]
    v_mfma_f32_16x16x32_bf16 v[84:87], a[88:91], v[56:59], v[84:87]
    v_mfma_f32_16x16x32_bf16 v[92:95], v[56:59], a[216:219], v[92:95]
    v_mfma_f32_16x16x32_bf16 v[100:103], v[216:219], v[56:59], v[100:103]
    v_mfma_f32_16x16x32_bf16 v[88:91], a[92:95], v[56:59], v[88:91]
    v_mfma_f32_16x16x32_bf16 v[96:99], v[56:59], a[220:223], v[96:99]
    v_mfma_f32_16x16x32_bf16 v[104:107], v[220:223], v[56:59], v[104:107]
    v_mfma_f32_16x16x32_bf16 v[84:87], a[96:99], v[56:59], v[84:87]
    v_mfma_f32_16x16x32_bf16 v[92:95], v[56:59], a[224:227], v[92:95]
    v_mfma_f32_16x16x32_bf16 v[100:103], v[224:227], v[56:59], v[100:103]
    v_mfma_f32_16x16x32_bf16 v[88:91], a[100:103], v[56:59], v[88:91]
    v_mfma_f32_16x16x32_bf16 v[96:99], v[56:59], a[228:231], v[96:99]
    v_mfma_f32_16x16x32_bf16 v[104:107], v[228:231], v[56:59], v[104:107]
    v_mfma_f32_16x16x32_bf16 v[84:87], a[104:107], v[56:59], v[84:87]
    v_mfma_f32_16x16x32_bf16 v[92:95], v[56:59], a[232:235], v[92:95]
    v_mfma_f32_16x16x32_bf16 v[100:103], v[232:235], v[56:59], v[100:103]
    v_mfma_f32_16x16x32_bf16 v[88:91], a[108:111], v[56:59], v[88:91]
    v_mfma_f32_16x16x32_bf16 v[96:99], v[56:59], a[236:239], v[96:99]
    v_mfma_f32_16x16x32_bf16 v[104:107], v[236:239], v[56:59], v[104:107]
    v_mfma_f32_16x16x32_bf16 v[84:87], a[112:115], v[56:59], v[84:87]
    v_mfma_f32_16x16x32_bf16 v[92:95], v[56:59], a[240:243], v[92:95]
    v_mfma_f32_16x16x32_bf16 v[100:103], v[240:243], v[56:59], v[100:103]
    v_mfma_f32_16x16x32_bf16 v[88:91], a[116:119], v[56:59], v[88:91]
    v_mfma_f32_16x16x32_bf16 v[96:99], v[56:59], a[244:247], v[96:99]
    v_mfma_f32_16x16x32_bf16 v[104:107], v[244:247], v[56:59], v[104:107]
    v_mfma_f32_16x16x32_bf16 v[84:87], a[120:123], v[56:59], v[84:87]
    v_mfma_f32_16x16x32_bf16 v[92:95], v[56:59], a[248:251], v[92:95]
    v_mfma_f32_16x16x32_bf16 v[100:103], v[248:251], v[56:59], v[100:103]
    v_mfma_f32_16x16x32_bf16 v[88:91], a[124:127], v[56:59], v[88:91]
    v_mfma_f32_16x16x32_bf16 v[96:99], v[56:59], a[252:255], v[96:99]
    v_mfma_f32_16x16x32_bf16 v[104:107], v[252:255], v[56:59], v[104:107]
    v_lshrrev_b32 v12, 5, v0
    v_bfe_u32 v13, v0, 2, 2
    v_lshlrev_b32 v120, 9, v12
    v_lshl_add_u32 v120, v13, 7, v120
    v_bfe_u32 v12, v0, 4, 1
    v_and_b32 v13, 3, v0
    v_lshl_add_u32 v120, v12, 6, v120
    v_lshl_add_u32 v120, v13, 4, v120
    v_mov_b32 v12, 0
    s_mov_b32 s27, 0
L_wi_30:
    global_load_dword v13, v12, s[6:7] offset:64 sc1
    s_waitcnt vmcnt(0)
    v_cmp_gt_u32 vcc, 0x100, v13
    s_cbranch_vccz L_wiok_31
    s_sleep 2
    s_add_u32 s27, s27, 1
    s_cmp_lt_u32 s27, 200000
    s_cbranch_scc1 L_wi_30
    s_branch L_p_fail
L_wiok_31:
    v_and_b32 v4, 1, v0
    v_lshlrev_b32 v4, 2, v4
    v_lshlrev_b32 v121, 3, v0
    v_bfe_u32 v12, v0, 4, 1
    v_add_u32 v12, 1, v12
    v_lshlrev_b32 v12, 13, v12
    v_and_b32 v13, 15, v0
    v_lshl_add_u32 v126, v13, 6, v12
    v_mov_b64 v[122:123], -1
    s_lshl_b32 s30, s32, 7
    s_lshl_b32 s31, s33, 4
    s_add_u32 s30, s30, s31
    s_lshl_b32 s31, s24, 2
    s_add_u32 s30, s30, s31
    s_add_u32 s30, s30, 0
    v_mov_b32 v5, s30
    s_mov_b32 s39, 0x3e0293ee
    s_mov_b32 s34, 0
    s_lshl_b32 s37, s33, 14
    s_mov_b32 s38, 64
    s_lshl_b32 s44, s24, 12
L_p_layer:
    s_mul_i32 s36, s32, 24
    s_lshl_b32 s30, s33, 2
    s_add_u32 s36, s36, s30
    s_add_u32 s36, s36, s24
    s_lshl_b32 s36, s36, 10
    s_mov_b32 s30, 0
    s_add_u32 s36, s36, s30
    s_add_u32 s36, s36, 1048576
    s_mul_i32 s45, s32, 8
    s_lshl_b32 s31, s33, 2
    s_add_u32 s45, s45, s31
    s_add_u32 s45, s45, s24
    s_lshl_b32 s45, s45, 9
    s_add_u32 s45, s45, s30
    s_add_u32 s45, s45, 52428800
    s_lshl_b32 s41, s34, 7
    s_mov_b32 s35, 0
    s_add_u32 s58, s44, 61472768
    s_mov_b32 s42, 0
    s_mov_b32 s43, 0
    s_add_u32 s30, s35, 0
    s_min_u32 s30, s30, 63
    s_lshl_b32 s30, s30, 1
    s_add_u32 s30, s30, s33
    s_lshl_b32 s40, s30, 7
    s_add_u32 s40, s40, 16384
    s_cmp_lg_u32 s24, 0
    s_cbranch_scc1 L_p1_32
    s_mov_b32 s27, 0
L_poll_33:
    buffer_load_dword v6, v4, s[8:11], s40 offen sc1
    s_waitcnt vmcnt(0)
    v_cmp_gt_u32 vcc, s34, v6
    s_cbranch_vccz L_pollok_34
    s_sleep 1
    s_add_u32 s27, s27, 1
    s_cmp_lt_u32 s27, 200000
    s_cbranch_scc1 L_poll_33
    s_branch L_p_fail
L_pollok_34:
L_p1_32:
    s_barrier
    s_add_u32 s30, s35, 0
    s_min_u32 s30, s30, 63
    s_lshl_b32 s30, s30, 15
    s_add_u32 s30, s30, s37
    s_add_u32 m0, s43, s44
    s_nop 0
    buffer_load_dwordx4 v2, s[12:15], s30 offen sc1 lds
    s_add_u32 m0, m0, 1024
    s_add_u32 s30, s30, s38
    buffer_load_dwordx4 v2, s[12:15], s30 offen sc1 lds
    s_add_u32 m0, m0, 1024
    s_add_u32 s30, s30, s38
    buffer_load_dwordx4 v2, s[12:15], s30 offen sc1 lds
    s_add_u32 m0, m0, 1024
    s_add_u32 s30, s30, s38
    buffer_load_dwordx4 v2, s[12:15], s30 offen sc1 lds
    s_add_u32 s43, s43, 0x4000
    s_cmp_eq_u32 s43, 0xc000
    s_cselect_b32 s43, 0, s43
    s_add_u32 s30, s35, 1
    s_min_u32 s30, s30, 63
    s_lshl_b32 s30, s30, 1
    s_add_u32 s30, s30, s33
    s_lshl_b32 s40, s30, 7
    s_add_u32 s40, s40, 16384
    buffer_load_dword v6, v4, s[8:11], s40 offen sc1
    s_waitcnt vmcnt(0)
    v_cmp_gt_u32 vcc, s34, v6
    s_cbranch_vccnz L_p_slow0
L_p_back0:
    s_add_u32 s30, s35, 1
    s_min_u32 s30, s30, 63
    s_lshl_b32 s30, s30, 15
    s_add_u32 s30, s30, s37
    s_add_u32 m0, s43, s44
    s_nop 0
    buffer_load_dwordx4 v2, s[12:15], s30 offen sc1 lds
    s_add_u32 m0, m0, 1024
    s_add_u32 s30, s30, s38
    buffer_load_dwordx4 v2, s[12:15], s30 offen sc1 lds
    s_add_u32 m0, m0, 1024
    s_add_u32 s30, s30, s38
    buffer_load_dwordx4 v2, s[12:15], s30 offen sc1 lds
    s_add_u32 m0, m0, 1024
    s_add_u32 s30, s30, s38
    buffer_load_dwordx4 v2, s[12:15], s30 offen sc1 lds
    s_add_u32 s43, s43, 0x4000
    s_cmp_eq_u32 s43, 0xc000
    s_cselect_b32 s43, 0, s43
    s_add_u32 s30, s35, 2
    s_min_u32 s30, s30, 63
    s_lshl_b32 s30, s30, 1
    s_add_u32 s30, s30, s33
    s_lshl_b32 s40, s30, 7
    s_add_u32 s40, s40, 16384
    buffer_load_dword v6, v4, s[8:11], s40 offen sc1
    buffer_load_dword v12, v4, s[8:11], s40 offen sc1
    v_add_u32 v7, s44, v124
L_p_loop:
    s_barrier
    ds_read_b128 v[32:35], v7 offset:0
    ds_read_b128 v[36:39], v7 offset:1024
    ds_read_b128 v[40:43], v7 offset:2048
    ds_read_b128 v[44:47], v7 offset:3072
    v_add_u32 v3, s42, v124
    s_add_u32 s42, s42, 0x4000
    s_cmp_eq_u32 s42, 0xc000
    s_cselect_b32 s42, 0, s42
    v_mul_f32 v76, v118, v76
    v_mul_f32 v77, v118, v77
    v_mul_f32 v78, v118, v78
    v_mul_f32 v79, v118, v79
    v_mul_f32 v80, v118, v80
    v_mul_f32 v81, v118, v81
    v_mul_f32 v82, v118, v82
    s_waitcnt lgkmcnt(3)
    v_mfma_f32_16x16x32_bf16 v[52:55], v[32:35], v[32:35], 0
    ds_read_b128 v[16:19], v3 offset:0
    v_mul_f32 v83, v118, v83
    v_mfma_f32_16x16x32_bf16 v[48:51], v[56:59], v[32:35], 0
    s_waitcnt lgkmcnt(3)
    v_fmac_f32 v76, v119, v100
    v_fmac_f32 v77, v119, v101
    v_mfma_f32_16x16x32_bf16 v[52:55], v[36:39], v[36:39], v[52:55]
    ds_read_b128 v[20:23], v3 offset:1024
    v_fmac_f32 v78, v119, v102
    v_mfma_f32_16x16x32_bf16 v[48:51], v[56:59], v[36:39], v[48:51]
    s_waitcnt lgkmcnt(3)
    v_fmac_f32 v79, v119, v103
    v_fmac_f32 v80, v119, v104
    v_mfma_f32_16x16x32_bf16 v[52:55], v[40:43], v[40:43], v[52:55]
    ds_read_b128 v[24:27], v3 offset:2048
    v_fmac_f32 v81, v119, v105
    v_mfma_f32_16x16x32_bf16 v[48:51], v[56:59], v[40:43], v[48:51]
    s_waitcnt lgkmcnt(3)
    v_fmac_f32 v82, v119, v106
    v_fmac_f32 v83, v119, v107
    v_mfma_f32_16x16x32_bf16 v[52:55], v[44:47], v[44:47], v[52:55]
    v_cvt_pk_bf16_f32 v76, v76, v80
    v_cvt_pk_bf16_f32 v77, v77, v81
    v_mfma_f32_16x16x32_bf16 v[48:51], v[56:59], v[44:47], v[48:51]
    s_waitcnt lgkmcnt(2)
    v_cvt_pk_bf16_f32 v78, v78, v82
    v_cvt_pk_bf16_f32 v79, v79, v83
    v_mfma_f32_16x16x32_bf16 v[60:63], a[0:3], v[16:19], 0
    ds_read_b128 v[28:31], v3 offset:3072
    v_mfma_f32_16x16x32_bf16 v[64:67], a[4:7], v[16:19], 0
    buffer_store_dwordx4 v[76:79], v1, s[8:11], s58 offen sc1
    v_mfma_f32_16x16x32_bf16 v[68:71], v[16:19], a[128:131], 0
    v_mfma_f32_16x16x32_bf16 v[72:75], v[16:19], a[132:135], 0
    v_cndmask_b32 v52, v52, v53, s[52:53]
    v_cndmask_b32 v52, v52, v54, s[54:55]
    v_cndmask_b32 v49, v52, v55, s[56:57]
    s_mov_b64 exec, s[50:51]
    ds_write_b64 v8, v[48:49]
    s_mov_b64 exec, -1
    s_waitcnt lgkmcnt(3)
    v_mfma_f32_16x16x32_bf16 v[60:63], a[8:11], v[20:23], v[60:63]
    ds_read_b128 v[16:19], v3 offset:4096
    v_mfma_f32_16x16x32_bf16 v[64:67], a[12:15], v[20:23], v[64:67]
    v_mfma_f32_16x16x32_bf16 v[68:71], v[20:23], a[136:139], v[68:71]
    v_mfma_f32_16x16x32_bf16 v[72:75], v[20:23], a[140:143], v[72:75]
    s_waitcnt lgkmcnt(3)
    v_mfma_f32_16x16x32_bf16 v[60:63], a[16:19], v[24:27], v[60:63]
    ds_read_b128 v[20:23], v3 offset:5120
    v_mfma_f32_16x16x32_bf16 v[64:67], a[20:23], v[24:27], v[64:67]
    v_mfma_f32_16x16x32_bf16 v[68:71], v[24:27], a[144:147], v[68:71]
    v_mfma_f32_16x16x32_bf16 v[72:75], v[24:27], a[148:151], v[72:75]
    s_waitcnt lgkmcnt(2)
    s_barrier
    ds_read_b128 v[32:35], v9
    ds_read_b128 v[36:39], v9 offset:16
    s_cmp_eq_u32 s35, 0
    s_cbranch_scc1 L_p_nofl
    s_waitcnt vmcnt(1)
    s_mov_b64 exec, 1
    buffer_store_dword v11, v5, s[8:11], 0 offen sc1
    s_mov_b64 exec, -1
L_p_nofl:
    v_mfma_f32_16x16x32_bf16 v[60:63], a[24:27], v[28:31], v[60:63]
    ds_read_b128 v[24:27], v3 offset:6144
    s_waitcnt vmcnt(2)
    v_mfma_f32_16x16x32_bf16 v[64:67], a[28:31], v[28:31], v[64:67]
    v_cmp_gt_u32 vcc, s34, v6
    s_add_u32 s41, s41, 1
    v_mfma_f32_16x16x32_bf16 v[68:71], v[28:31], a[152:155], v[68:71]
    v_mov_b32 v11, s41
    v_mfma_f32_16x16x32_bf16 v[72:75], v[28:31], a[156:159], v[72:75]
    s_waitcnt lgkmcnt(4)
    s_cbranch_vccnz L_p_slow
L_p_back:
    v_mfma_f32_16x16x32_bf16 v[60:63], a[32:35], v[16:19], v[60:63]
    ds_read_b128 v[28:31], v3 offset:7168
    s_add_u32 s30, s35, 2
    v_mfma_f32_16x16x32_bf16 v[64:67], a[36:39], v[16:19], v[64:67]
    s_min_u32 s30, s30, 63
    s_lshl_b32 s30, s30, 15
    s_add_u32 s30, s30, s37
    v_mfma_f32_16x16x32_bf16 v[68:71], v[16:19], a[160:163], v[68:71]
    s_add_u32 m0, s43, s44
    s_nop 0
    buffer_load_dwordx4 v2, s[12:15], s30 offen sc1 lds
    v_mfma_f32_16x16x32_bf16 v[72:75], v[16:19], a[164:167], v[72:75]
    s_waitcnt lgkmcnt(4)
    s_add_u32 m0, m0, 1024
    s_add_u32 s30, s30, s38
    buffer_load_dwordx4 v2, s[12:15], s30 offen sc1 lds
    v_mfma_f32_16x16x32_bf16 v[60:63], a[40:43], v[20:23], v[60:63]
    ds_read_b128 v[16:19], v3 offset:8192
    s_add_u32 m0, m0, 1024
    v_mfma_f32_16x16x32_bf16 v[64:67], a[44:47], v[20:23], v[64:67]
    s_add_u32 s30, s30, s38
    buffer_load_dwordx4 v2, s[12:15], s30 offen sc1 lds
    v_mfma_f32_16x16x32_bf16 v[68:71], v[20:23], a[168:171], v[68:71]
    s_add_u32 m0, m0, 1024
    s_add_u32 s30, s30, s38
    buffer_load_dwordx4 v2, s[12:15], s30 offen sc1 lds
    v_mfma_f32_16x16x32_bf16 v[72:75], v[20:23], a[172:175], v[72:75]
    s_waitcnt lgkmcnt(2)
    s_add_u32 s43, s43, 0x4000
    s_cmp_eq_u32 s43, 0xc000
    v_mfma_f32_16x16x32_bf16 v[60:63], a[48:51], v[24:27], v[60:63]
    ds_read_b128 v[20:23], v3 offset:9216
    s_cselect_b32 s43, 0, s43
    v_mfma_f32_16x16x32_bf16 v[64:67], a[52:55], v[24:27], v[64:67]
    s_add_u32 s30, s35, 3
    s_min_u32 s30, s30, 63
    s_lshl_b32 s30, s30, 1
    v_mfma_f32_16x16x32_bf16 v[68:71], v[24:27], a[176:179], v[68:71]
    s_add_u32 s30, s30, s33
    s_lshl_b32 s40, s30, 7
    s_add_u32 s40, s40, 16384
    buffer_load_dword v6, v4, s[8:11], s40 offen sc1
    v_mfma_f32_16x16x32_bf16 v[72:75], v[24:27], a[180:183], v[72:75]
    s_waitcnt lgkmcnt(2)
    v_add_f32 v32, v32, v36
    v_mfma_f32_16x16x32_bf16 v[60:63], a[56:59], v[28:31], v[60:63]
    ds_read_b128 v[24:27], v3 offset:10240
    v_add_f32 v33, v33, v37
    v_mfma_f32_16x16x32_bf16 v[64:67], a[60:63], v[28:31], v[64:67]
    v_add_f32 v34, v34, v38
    v_add_f32 v35, v35, v39
    v_mfma_f32_16x16x32_bf16 v[68:71], v[28:31], a[184:187], v[68:71]
    v_add_f32 v32, v32, v34
    v_add_f32 v33, v33, v35
    v_mfma_f32_16x16x32_bf16 v[72:75], v[28:31], a[188:191], v[72:75]
    s_waitcnt lgkmcnt(2)
    v_mul_f32 v32, 0xbb000000, v32
    v_mul_f32 v33, 0x3b000000, v33
    v_mfma_f32_16x16x32_bf16 v[60:63], a[64:67], v[16:19], v[60:63]
    ds_read_b128 v[28:31], v3 offset:11264
    v_fma_f32 v33, -v32, v32, v33
    v_mfma_f32_16x16x32_bf16 v[64:67], a[68:71], v[16:19], v[64:67]
    v_max_f32 v33, 0, v33
    v_add_f32 v33, 0x3727c5ac, v33
    v_mfma_f32_16x16x32_bf16 v[68:71], v[16:19], a[192:195], v[68:71]
    v_rsq_f32 v108, v33
    v_mfma_f32_16x16x32_bf16 v[72:75], v[16:19], a[196:199], v[72:75]
    s_waitcnt lgkmcnt(2)
    s_nop 0
    v_mul_f32 v109, v32, v108
    v_mfma_f32_16x16x32_bf16 v[60:63], a[72:75], v[20:23], v[60:63]
    ds_read_b128 v[16:19], v3 offset:12288
    v_mfma_f32_16x16x32_bf16 v[64:67], a[76:79], v[20:23], v[64:67]
    ds_bpermute_b32 v110, v10, v108 offset:0
    v_mfma_f32_16x16x32_bf16 v[68:71], v[20:23], a[200:203], v[68:71]
    ds_bpermute_b32 v114, v10, v109 offset:0
    v_mfma_f32_16x16x32_bf16 v[72:75], v[20:23], a[204:207], v[72:75]
    s_waitcnt lgkmcnt(4)
    ds_bpermute_b32 v111, v10, v108 offset:4
    v_mfma_f32_16x16x32_bf16 v[60:63], a[80:83], v[24:27], v[60:63]
    ds_read_b128 v[20:23], v3 offset:13312
    v_mfma_f32_16x16x32_bf16 v[64:67], a[84:87], v[24:27], v[64:67]
    ds_bpermute_b32 v115, v10, v109 offset:4
    v_mfma_f32_16x16x32_bf16 v[68:71], v[24:27], a[208:211], v[68:71]
    ds_bpermute_b32 v112, v10, v108 offset:8
    v_mfma_f32_16x16x32_bf16 v[72:75], v[24:27], a[212:215], v[72:75]
    s_waitcnt lgkmcnt(7)
    ds_bpermute_b32 v116, v10, v109 offset:8
    v_mfma_f32_16x16x32_bf16 v[60:63], a[88:91], v[28:31], v[60:63]
    ds_read_b128 v[24:27], v3 offset:14336
    v_mfma_f32_16x16x32_bf16 v[64:67], a[92:95], v[28:31], v[64:67]
    ds_bpermute_b32 v113, v10, v108 offset:12
    v_mfma_f32_16x16x32_bf16 v[68:71], v[28:31], a[216:219], v[68:71]
    ds_bpermute_b32 v117, v10, v109 offset:12
    v_mul_f32 v32, v109, v84
    v_mfma_f32_16x16x32_bf16 v[72:75], v[28:31], a[220:223], v[72:75]
    s_waitcnt lgkmcnt(10)
    v_mul_f32 v33, v109, v85
    v_mul_f32 v34, v109, v86
    v_mfma_f32_16x16x32_bf16 v[60:63], a[96:99], v[16:19], v[60:63]
    ds_read_b128 v[28:31], v3 offset:15360
    v_mul_f32 v35, v109, v87
    v_mfma_f32_16x16x32_bf16 v[64:67], a[100:103], v[16:19], v[64:67]
    v_mul_f32 v36, v109, v88
    v_mul_f32 v37, v109, v89
    v_mfma_f32_16x16x32_bf16 v[68:71], v[16:19], a[224:227], v[68:71]
    v_mul_f32 v38, v109, v90
    v_mul_f32 v39, v109, v91
    v_mfma_f32_16x16x32_bf16 v[72:75], v[16:19], a[228:231], v[72:75]
    s_waitcnt lgkmcnt(7)
    v_mul_f32 v118, s39, v108
    v_mul_f32 v119, s39, v109
    v_mfma_f32_16x16x32_bf16 v[60:63], a[104:107], v[20:23], v[60:63]
    ds_read_b128 v[16:19], v3 offset:0
    s_waitcnt lgkmcnt(2)
    v_mfma_f32_16x16x32_bf16 v[64:67], a[108:111], v[20:23], v[64:67]
    v_mul_f32 v40, v114, v92
    v_mul_f32 v41, v115, v93
    v_mfma_f32_16x16x32_bf16 v[68:71], v[20:23], a[232:235], v[68:71]
    v_mul_f32 v42, v116, v94
    v_mul_f32 v43, v117, v95
    v_mfma_f32_16x16x32_bf16 v[72:75], v[20:23], a[236:239], v[72:75]
    v_mul_f32 v44, v114, v96
    v_mul_f32 v45, v115, v97
    v_mfma_f32_16x16x32_bf16 v[60:63], a[112:115], v[24:27], v[60:63]
    ds_read_b128 v[20:23], v3 offset:1024
    v_mul_f32 v46, v116, v98
    v_mfma_f32_16x16x32_bf16 v[64:67], a[116:119], v[24:27], v[64:67]
    v_mul_f32 v47, v117, v99
    v_mfma_f32_16x16x32_bf16 v[68:71], v[24:27], a[240:243], v[68:71]
    buffer_store_dwordx2 v[122:123], v121, s[8:11], s45 offen sc1
    v_mfma_f32_16x16x32_bf16 v[72:75], v[24:27], a[244:247], v[72:75]
    s_waitcnt lgkmcnt(2)
    s_add_u32 s45, s45, 131072
    s_add_u32 s59, s36, 8192
    v_mfma_f32_16x16x32_bf16 v[60:63], a[120:123], v[28:31], v[60:63]
    ds_read_b128 v[24:27], v3 offset:2048
    s_add_u32 s60, s36, 16384
    v_mfma_f32_16x16x32_bf16 v[64:67], a[124:127], v[28:31], v[64:67]
    v_mfma_f32_16x16x32_bf16 v[68:71], v[28:31], a[248:251], v[68:71]
    v_mfma_f32_16x16x32_bf16 v[72:75], v[28:31], a[252:255], v[72:75]
    s_waitcnt lgkmcnt(2)
    v_mfma_f32_16x16x32_bf16 v[76:79], v[128:131], v[16:19], 0
    ds_read_b128 v[28:31], v3 offset:3072
    v_fmac_f32 v32, v108, v60
    v_fmac_f32 v33, v108, v61
    v_mfma_f32_16x16x32_bf16 v[80:83], v[132:135], v[16:19], 0
    s_waitcnt lgkmcnt(2)
    v_fmac_f32 v34, v108, v62
    v_fmac_f32 v35, v108, v63
    v_fmac_f32 v36, v108, v64
    v_mfma_f32_16x16x32_bf16 v[76:79], v[136:139], v[20:23], v[76:79]
    ds_read_b128 v[16:19], v3 offset:4096
    v_fmac_f32 v37, v108, v65
    v_fmac_f32 v38, v108, v66
    v_mfma_f32_16x16x32_bf16 v[80:83], v[140:143], v[20:23], v[80:83]
    s_waitcnt lgkmcnt(2)
    v_fmac_f32 v39, v108, v67
    v_cvt_pk_bf16_f32 v60, v32, v36
    v_cvt_pk_bf16_f32 v61, v33, v37
    v_mfma_f32_16x16x32_bf16 v[76:79], v[144:147], v[24:27], v[76:79]
    ds_read_b128 v[20:23], v3 offset:5120
    v_cvt_pk_bf16_f32 v62, v34, v38
    v_cvt_pk_bf16_f32 v63, v35, v39
    v_mfma_f32_16x16x32_bf16 v[80:83], v[148:151], v[24:27], v[80:83]
    s_waitcnt lgkmcnt(2)
    buffer_store_dwordx4 v[60:63], v120, s[8:11], s59 offen sc1
    v_mfma_f32_16x16x32_bf16 v[76:79], v[152:155], v[28:31], v[76:79]
    ds_read_b128 v[24:27], v3 offset:6144
    v_fmac_f32 v40, v110, v68
    v_fmac_f32 v41, v111, v69
    v_mfma_f32_16x16x32_bf16 v[80:83], v[156:159], v[28:31], v[80:83]
    s_waitcnt lgkmcnt(2)
    v_fmac_f32 v42, v112, v70
    v_fmac_f32 v43, v113, v71
    v_fmac_f32 v44, v110, v72
    v_mfma_f32_16x16x32_bf16 v[76:79], v[160:163], v[16:19], v[76:79]
    ds_read_b128 v[28:31], v3 offset:7168
    v_fmac_f32 v45, v111, v73
    v_fmac_f32 v46, v112, v74
    v_mfma_f32_16x16x32_bf16 v[80:83], v[164:167], v[16:19], v[80:83]
    s_waitcnt lgkmcnt(2)
    v_fmac_f32 v47, v113, v75
    v_cvt_pk_bf16_f32 v68, v40, v41
    v_cvt_pk_bf16_f32 v69, v42, v43
    v_mfma_f32_16x16x32_bf16 v[76:79], v[168:171], v[20:23], v[76:79]
    ds_read_b128 v[16:19], v3 offset:8192
    v_cvt_pk_bf16_f32 v70, v44, v45
    v_cvt_pk_bf16_f32 v71, v46, v47
    v_mfma_f32_16x16x32_bf16 v[80:83], v[172:175], v[20:23], v[80:83]
    s_waitcnt lgkmcnt(2)
    buffer_store_dwordx4 v[68:71], v1, s[8:11], s60 offen sc1
    v_mfma_f32_16x16x32_bf16 v[76:79], v[176:179], v[24:27], v[76:79]
    ds_read_b128 v[20:23], v3 offset:9216
    s_mov_b32 s58, s36
    s_add_u32 s36, s36, 786432
    v_mfma_f32_16x16x32_bf16 v[80:83], v[180:183], v[24:27], v[80:83]
    s_waitcnt lgkmcnt(2)
    s_add_u32 s35, s35, 1
    s_add_u32 s30, s42, s44
    v_add_u32 v7, s30, v124
    v_mfma_f32_16x16x32_bf16 v[76:79], v[184:187], v[28:31], v[76:79]
    ds_read_b128 v[24:27], v3 offset:10240
    v_mfma_f32_16x16x32_bf16 v[80:83], v[188:191], v[28:31], v[80:83]
    s_waitcnt lgkmcnt(2)
    v_mfma_f32_16x16x32_bf16 v[76:79], v[192:195], v[16:19], v[76:79]
    ds_read_b128 v[28:31], v3 offset:11264
    v_mfma_f32_16x16x32_bf16 v[80:83], v[196:199], v[16:19], v[80:83]
    s_waitcnt lgkmcnt(2)
    v_mfma_f32_16x16x32_bf16 v[76:79], v[200:203], v[20:23], v[76:79]
    ds_read_b128 v[16:19], v3 offset:12288
    v_mfma_f32_16x16x32_bf16 v[80:83], v[204:207], v[20:23], v[80:83]
    s_waitcnt lgkmcnt(2)
    v_mfma_f32_16x16x32_bf16 v[76:79], v[208:211], v[24:27], v[76:79]
    ds_read_b128 v[20:23], v3 offset:13312
    v_mfma_f32_16x16x32_bf16 v[80:83], v[212:215], v[24:27], v[80:83]
    s_waitcnt lgkmcnt(2)
    v_mfma_f32_16x16x32_bf16 v[76:79], v[216:219], v[28:31], v[76:79]
    ds_read_b128 v[24:27], v3 offset:14336
    v_mfma_f32_16x16x32_bf16 v[80:83], v[220:223], v[28:31], v[80:83]
    s_waitcnt lgkmcnt(2)
    v_mfma_f32_16x16x32_bf16 v[76:79], v[224:227], v[16:19], v[76:79]
    ds_read_b128 v[28:31], v3 offset:15360
    v_mfma_f32_16x16x32_bf16 v[80:83], v[228:231], v[16:19], v[80:83]
    s_waitcnt lgkmcnt(2)
    v_mfma_f32_16x16x32_bf16 v[76:79], v[232:235], v[20:23], v[76:79]
    v_mfma_f32_16x16x32_bf16 v[80:83], v[236:239], v[20:23], v[80:83]
    s_waitcnt lgkmcnt(1)
    v_mfma_f32_16x16x32_bf16 v[76:79], v[240:243], v[24:27], v[76:79]
    v_mfma_f32_16x16x32_bf16 v[80:83], v[244:247], v[24:27], v[80:83]
    s_waitcnt lgkmcnt(0)
    v_mfma_f32_16x16x32_bf16 v[76:79], v[248:251], v[28:31], v[76:79]
    v_mfma_f32_16x16x32_bf16 v[80:83], v[252:255], v[28:31], v[80:83]
    s_cmp_lt_u32 s35, 64
    s_cbranch_scc1 L_p_loop
    s_nop 7
    v_mul_f32 v76, v118, v76
    v_mul_f32 v77, v118, v77
    v_mul_f32 v78, v118, v78
    v_mul_f32 v79, v118, v79
    v_mul_f32 v80, v118, v80
    v_mul_f32 v81, v118, v81
    v_mul_f32 v82, v118, v82
    v_mul_f32 v83, v118, v83
    v_fmac_f32 v76, v119, v100
    v_fmac_f32 v77, v119, v101
    v_fmac_f32 v78, v119, v102
    v_fmac_f32 v79, v119, v103
    v_fmac_f32 v80, v119, v104
    v_fmac_f32 v81, v119, v105
    v_fmac_f32 v82, v119, v106
    v_fmac_f32 v83, v119, v107
    v_cvt_pk_bf16_f32 v76, v76, v80
    v_cvt_pk_bf16_f32 v77, v77, v81
    v_cvt_pk_bf16_f32 v78, v78, v82
    v_cvt_pk_bf16_f32 v79, v79, v83
    buffer_store_dwordx4 v[76:79], v1, s[8:11], s58 offen sc1
    s_add_u32 s41, s41, 1
    v_mov_b32 v11, s41
    s_waitcnt vmcnt(0) lgkmcnt(0)
    s_mov_b64 exec, 1
    buffer_store_dword v11, v5, s[8:11], 0 offen sc1
    s_mov_b64 exec, -1
    s_barrier
    s_cmp_eq_u32 s34, 1
    s_cbranch_scc0 L_p_second
    s_branch L_b_helper
L_p_second:
    s_mov_b32 s34, 1
    s_mov_b32 s12, s8
    s_mov_b32 s13, s9
    s_mov_b32 s14, s10
    v_add_u32 v2, s44, v1
    v_mov_b32 v124, v1
    s_add_u32 s37, s37, 72351744
    s_mov_b32 s38, 1024
    s_branch L_p_layer
L_p_slow:
    s_mov_b32 s27, 0
L_poll_35:
    buffer_load_dword v6, v4, s[8:11], s40 offen sc1
    s_waitcnt vmcnt(0)
    v_cmp_gt_u32 vcc, s34, v6
    s_cbranch_vccz L_pollok_36
    s_sleep 1
    s_add_u32 s27, s27, 1
    s_cmp_lt_u32 s27, 200000
    s_cbranch_scc1 L_poll_35
    s_branch L_p_fail
L_pollok_36:
    s_branch L_p_back
L_p_slow0:
    s_mov_b32 s27, 0
L_poll_37:
    buffer_load_dword v6, v4, s[8:11], s40 offen sc1
    s_waitcnt vmcnt(0)
    v_cmp_gt_u32 vcc, s34, v6
    s_cbranch_vccz L_pollok_38
    s_sleep 1
    s_add_u32 s27, s27, 1
    s_cmp_lt_u32 s27, 200000
    s_cbranch_scc1 L_poll_37
    s_branch L_p_fail
L_pollok_38:
    s_branch L_p_back0
L_p_fail:
    s_endpgm
L_role_x1:
    s_lshr_b32 s32, s25, 5
    s_sub_u32 s32, s32, 5
    s_and_b32 s33, s25, 31
    s_sub_u32 s33, s33, 24
    s_lshl_b32 s37, s33, 2
    s_add_u32 s37, s37, s24
    s_lshl_b32 s30, s32, 3
    s_add_u32 s30, s30, s33
    s_and_b32 s62, s30, 1
    s_lshr_b32 s60, s30, 1
    s_mov_b32 s63, 0
    s_mov_b32 s61, 12
    s_mov_b32 s64, 36
    s_mov_b32 s101, 1
    s_load_dwordx2 s[4:5], s[0:1], 72
    s_waitcnt lgkmcnt(0)
    s_mov_b32 s16, s4
    s_mov_b32 s17, s5
    s_mov_b32 s18, 524288
    s_mov_b32 s19, 0x20000
    s_lshl_b32 s92, s62, 9
    s_lshl_b32 s31, s24, 7
    s_add_u32 s92, s92, s31
    s_lshl_b32 s93, s24, 15
    v_bfe_u32 v16, v0, 3, 1
    v_mul_u32_u24 v14, 16, v16
    v_bfe_u32 v16, v0, 2, 1
    v_mul_u32_u24 v16, 4, v16
    v_add_u32 v14, v14, v16
    v_bfe_u32 v16, v0, 4, 1
    v_add_u32 v14, v14, v16
    v_lshrrev_b32 v16, 5, v0
    v_mul_u32_u24 v16, 2, v16
    v_add_u32 v14, v14, v16
    v_mul_u32_u24 v14, 1024, v14
    v_and_b32 v16, 3, v0
    v_lshl_add_u32 v14, v16, 4, v14
    v_add_u32 v14, s92, v14
    v_lshlrev_b32 v15, 2, v0
    v_add_u32 v15, s93, v15
    s_add_u32 m0, s93, 0
    s_mov_b32 s30, 0
    buffer_load_dwordx4 v14, s[16:19], s30 offen  lds
    s_add_u32 m0, s93, 1024
    s_mov_b32 s30, 8192
    buffer_load_dwordx4 v14, s[16:19], s30 offen  lds
    s_add_u32 m0, s93, 2048
    s_mov_b32 s30, 64
    buffer_load_dwordx4 v14, s[16:19], s30 offen  lds
    s_add_u32 m0, s93, 3072
    s_mov_b32 s30, 8256
    buffer_load_dwordx4 v14, s[16:19], s30 offen  lds
    s_add_u32 m0, s93, 4096
    s_mov_b32 s30, 32768
    buffer_load_dwordx4 v14, s[16:19], s30 offen  lds
    s_add_u32 m0, s93, 5120
    s_mov_b32 s30, 40960
    buffer_load_dwordx4 v14, s[16:19], s30 offen  lds
    s_add_u32 m0, s93, 6144
    s_mov_b32 s30, 32832
    buffer_load_dwordx4 v14, s[16:19], s30 offen  lds
    s_add_u32 m0, s93, 7168
    s_mov_b32 s30, 41024
    buffer_load_dwordx4 v14, s[16:19], s30 offen  lds
    s_add_u32 m0, s93, 8192
    s_mov_b32 s30, 65536
    buffer_load_dwordx4 v14, s[16:19], s30 offen  lds
    s_add_u32 m0, s93, 9216
    s_mov_b32 s30, 73728
    buffer_load_dwordx4 v14, s[16:19], s30 offen  lds
    s_add_u32 m0, s93, 10240
    s_mov_b32 s30, 65600
    buffer_load_dwordx4 v14, s[16:19], s30 offen  lds
    s_add_u32 m0, s93, 11264
    s_mov_b32 s30, 73792
    buffer_load_dwordx4 v14, s[16:19], s30 offen  lds
    s_add_u32 m0, s93, 12288
    s_mov_b32 s30, 98304
    buffer_load_dwordx4 v14, s[16:19], s30 offen  lds
    s_add_u32 m0, s93, 13312
    s_mov_b32 s30, 106496
    buffer_load_dwordx4 v14, s[16:19], s30 offen  lds
    s_add_u32 m0, s93, 14336
    s_mov_b32 s30, 98368
    buffer_load_dwordx4 v14, s[16:19], s30 offen  lds
    s_add_u32 m0, s93, 15360
    s_mov_b32 s30, 106560
    buffer_load_dwordx4 v14, s[16:19], s30 offen  lds
    s_add_u32 m0, s93, 16384
    s_mov_b32 s30, 131072
    buffer_load_dwordx4 v14, s[16:19], s30 offen  lds
    s_add_u32 m0, s93, 17408
    s_mov_b32 s30, 139264
    buffer_load_dwordx4 v14, s[16:19], s30 offen  lds
    s_add_u32 m0, s93, 18432
    s_mov_b32 s30, 131136
    buffer_load_dwordx4 v14, s[16:19], s30 offen  lds
    s_add_u32 m0, s93, 19456
    s_mov_b32 s30, 139328
    buffer_load_dwordx4 v14, s[16:19], s30 offen  lds
    s_add_u32 m0, s93, 20480
    s_mov_b32 s30, 163840
    buffer_load_dwordx4 v14, s[16:19], s30 offen  lds
    s_add_u32 m0, s93, 21504
    s_mov_b32 s30, 172032
    buffer_load_dwordx4 v14, s[16:19], s30 offen  lds
    s_add_u32 m0, s93, 22528
    s_mov_b32 s30, 163904
    buffer_load_dwordx4 v14, s[16:19], s30 offen  lds
    s_add_u32 m0, s93, 23552
    s_mov_b32 s30, 172096
    buffer_load_dwordx4 v14, s[16:19], s30 offen  lds
    s_add_u32 m0, s93, 24576
    s_mov_b32 s30, 196608
    buffer_load_dwordx4 v14, s[16:19], s30 offen  lds
    s_add_u32 m0, s93, 25600
    s_mov_b32 s30, 204800
    buffer_load_dwordx4 v14, s[16:19], s30 offen  lds
    s_add_u32 m0, s93, 26624
    s_mov_b32 s30, 196672
    buffer_load_dwordx4 v14, s[16:19], s30 offen  lds
    s_add_u32 m0, s93, 27648
    s_mov_b32 s30, 204864
    buffer_load_dwordx4 v14, s[16:19], s30 offen  lds
    s_add_u32 m0, s93, 28672
    s_mov_b32 s30, 229376
    buffer_load_dwordx4 v14, s[16:19], s30 offen  lds
    s_add_u32 m0, s93, 29696
    s_mov_b32 s30, 237568
    buffer_load_dwordx4 v14, s[16:19], s30 offen  lds
    s_waitcnt vmcnt(29)
    ds_read2st64_b32 v[16:17], v15 offset0:0 offset1:1
    ds_read2st64_b32 v[18:19], v15 offset0:2 offset1:3
    s_add_u32 m0, s93, 30720
    s_mov_b32 s30, 229440
    buffer_load_dwordx4 v14, s[16:19], s30 offen  lds
    s_waitcnt vmcnt(29)
    ds_read2st64_b32 v[20:21], v15 offset0:4 offset1:5
    ds_read2st64_b32 v[22:23], v15 offset0:6 offset1:7
    s_waitcnt lgkmcnt(2)
    v_perm_b32 v32, v17, v16, s28
    v_accvgpr_write_b32 a0, v32
    v_perm_b32 v33, v17, v16, s29
    v_accvgpr_write_b32 a4, v33
    v_perm_b32 v32, v19, v18, s28
    v_accvgpr_write_b32 a1, v32
    v_perm_b32 v33, v19, v18, s29
    v_accvgpr_write_b32 a5, v33
    s_add_u32 m0, s93, 31744
    s_mov_b32 s30, 237632
    buffer_load_dwordx4 v14, s[16:19], s30 offen  lds
    s_waitcnt vmcnt(29)
    ds_read2st64_b32 v[24:25], v15 offset0:8 offset1:9
    ds_read2st64_b32 v[26:27], v15 offset0:10 offset1:11
    s_waitcnt lgkmcnt(2)
    v_perm_b32 v32, v21, v20, s28
    v_accvgpr_write_b32 a2, v32
    v_perm_b32 v33, v21, v20, s29
    v_accvgpr_write_b32 a6, v33
    v_perm_b32 v32, v23, v22, s28
    v_accvgpr_write_b32 a3, v32
    v_perm_b32 v33, v23, v22, s29
    v_accvgpr_write_b32 a7, v33
    s_add_u32 m0, s93, 0
    s_mov_b32 s30, 262144
    buffer_load_dwordx4 v14, s[16:19], s30 offen  lds
    s_waitcnt vmcnt(29)
    ds_read2st64_b32 v[28:29], v15 offset0:12 offset1:13
    ds_read2st64_b32 v[30:31], v15 offset0:14 offset1:15
    s_waitcnt lgkmcnt(2)
    v_perm_b32 v32, v25, v24, s28
    v_accvgpr_write_b32 a8, v32
    v_perm_b32 v33, v25, v24, s29
    v_accvgpr_write_b32 a12, v33
    v_perm_b32 v32, v27, v26, s28
    v_accvgpr_write_b32 a9, v32
    v_perm_b32 v33, v27, v26, s29
    v_accvgpr_write_b32 a13, v33
    s_add_u32 m0, s93, 1024
    s_mov_b32 s30, 270336
    buffer_load_dwordx4 v14, s[16:19], s30 offen  lds
    s_waitcnt vmcnt(29)
    ds_read2st64_b32 v[16:17], v15 offset0:16 offset1:17
    ds_read2st64_b32 v[18:19], v15 offset0:18 offset1:19
    s_waitcnt lgkmcnt(2)
    v_perm_b32 v32, v29, v28, s28
    v_accvgpr_write_b32 a10, v32
    v_perm_b32 v33, v29, v28, s29
    v_accvgpr_write_b32 a14, v33
    v_perm_b32 v32, v31, v30, s28
    v_accvgpr_write_b32 a11, v32
    v_perm_b32 v33, v31, v30, s29
    v_accvgpr_write_b32 a15, v33
    s_add_u32 m0, s93, 2048
    s_mov_b32 s30, 262208
    buffer_load_dwordx4 v14, s[16:19], s30 offen  lds
    s_waitcnt vmcnt(29)
    ds_read2st64_b32 v[20:21], v15 offset0:20 offset1:21
    ds_read2st64_b32 v[22:23], v15 offset0:22 offset1:23
    s_waitcnt lgkmcnt(2)
    v_perm_b32 v32, v17, v16, s28
    v_accvgpr_write_b32 a16, v32
    v_perm_b32 v33, v17, v16, s29
    v_accvgpr_write_b32 a20, v33
    v_perm_b32 v32, v19, v18, s28
    v_accvgpr_write_b32 a17, v32
    v_perm_b32 v33, v19, v18, s29
    v_accvgpr_write_b32 a21, v33
    s_add_u32 m0, s93, 3072
    s_mov_b32 s30, 270400
    buffer_load_dwordx4 v14, s[16:19], s30 offen  lds
    s_waitcnt vmcnt(29)
    ds_read2st64_b32 v[24:25], v15 offset0:24 offset1:25
    ds_read2st64_b32 v[26:27], v15 offset0:26 offset1:27
    s_waitcnt lgkmcnt(2)
    v_perm_b32 v32, v21, v20, s28
    v_accvgpr_write_b32 a18, v32
    v_perm_b32 v33, v21, v20, s29
    v_accvgpr_write_b32 a22, v33
    v_perm_b32 v32, v23, v22, s28
    v_accvgpr_write_b32 a19, v32
    v_perm_b32 v33, v23, v22, s29
    v_accvgpr_write_b32 a23, v33
    s_add_u32 m0, s93, 4096
    s_mov_b32 s30, 294912
    buffer_load_dwordx4 v14, s[16:19], s30 offen  lds
    s_waitcnt vmcnt(29)
    ds_read2st64_b32 v[28:29], v15 offset0:28 offset1:29
    ds_read2st64_b32 v[30:31], v15 offset0:30 offset1:31
    s_waitcnt lgkmcnt(2)
    v_perm_b32 v32, v25, v24, s28
    v_accvgpr_write_b32 a24, v32
    v_perm_b32 v33, v25, v24, s29
    v_accvgpr_write_b32 a28, v33
    v_perm_b32 v32, v27, v26, s28
    v_accvgpr_write_b32 a25, v32
    v_perm_b32 v33, v27, v26, s29
    v_accvgpr_write_b32 a29, v33
    s_add_u32 m0, s93, 5120
    s_mov_b32 s30, 303104
    buffer_load_dwordx4 v14, s[16:19], s30 offen  lds
    s_waitcnt vmcnt(29)
    ds_read2st64_b32 v[16:17], v15 offset0:32 offset1:33
    ds_read2st64_b32 v[18:19], v15 offset0:34 offset1:35
    s_waitcnt lgkmcnt(2)
    v_perm_b32 v32, v29, v28, s28
    v_accvgpr_write_b32 a26, v32
    v_perm_b32 v33, v29, v28, s29
    v_accvgpr_write_b32 a30, v33
    v_perm_b32 v32, v31, v30, s28
    v_accvgpr_write_b32 a27, v32
    v_perm_b32 v33, v31, v30, s29
    v_accvgpr_write_b32 a31, v33
    s_add_u32 m0, s93, 6144
    s_mov_b32 s30, 294976
    buffer_load_dwordx4 v14, s[16:19], s30 offen  lds
    s_waitcnt vmcnt(29)
    ds_read2st64_b32 v[20:21], v15 offset0:36 offset1:37
    ds_read2st64_b32 v[22:23], v15 offset0:38 offset1:39
    s_waitcnt lgkmcnt(2)
    v_perm_b32 v32, v17, v16, s28
    v_accvgpr_write_b32 a32, v32
    v_perm_b32 v33, v17, v16, s29
    v_accvgpr_write_b32 a36, v33
    v_perm_b32 v32, v19, v18, s28
    v_accvgpr_write_b32 a33, v32
    v_perm_b32 v33, v19, v18, s29
    v_accvgpr_write_b32 a37, v33
    s_add_u32 m0, s93, 7168
    s_mov_b32 s30, 303168
    buffer_load_dwordx4 v14, s[16:19], s30 offen  lds
    s_waitcnt vmcnt(29)
    ds_read2st64_b32 v[24:25], v15 offset0:40 offset1:41
    ds_read2st64_b32 v[26:27], v15 offset0:42 offset1:43
    s_waitcnt lgkmcnt(2)
    v_perm_b32 v32, v21, v20, s28
    v_accvgpr_write_b32 a34, v32
    v_perm_b32 v33, v21, v20, s29
    v_accvgpr_write_b32 a38, v33
    v_perm_b32 v32, v23, v22, s28
    v_accvgpr_write_b32 a35, v32
    v_perm_b32 v33, v23, v22, s29
    v_accvgpr_write_b32 a39, v33
    s_add_u32 m0, s93, 8192
    s_mov_b32 s30, 327680
    buffer_load_dwordx4 v14, s[16:19], s30 offen  lds
    s_waitcnt vmcnt(29)
    ds_read2st64_b32 v[28:29], v15 offset0:44 offset1:45
    ds_read2st64_b32 v[30:31], v15 offset0:46 offset1:47
    s_waitcnt lgkmcnt(2)
    v_perm_b32 v32, v25, v24, s28
    v_accvgpr_write_b32 a40, v32
    v_perm_b32 v33, v25, v24, s29
    v_accvgpr_write_b32 a44, v33
    v_perm_b32 v32, v27, v26, s28
    v_accvgpr_write_b32 a41, v32
    v_perm_b32 v33, v27, v26, s29
    v_accvgpr_write_b32 a45, v33
    s_add_u32 m0, s93, 9216
    s_mov_b32 s30, 335872
    buffer_load_dwordx4 v14, s[16:19], s30 offen  lds
    s_waitcnt vmcnt(29)
    ds_read2st64_b32 v[16:17], v15 offset0:48 offset1:49
    ds_read2st64_b32 v[18:19], v15 offset0:50 offset1:51
    s_waitcnt lgkmcnt(2)
    v_perm_b32 v32, v29, v28, s28
    v_accvgpr_write_b32 a42, v32
    v_perm_b32 v33, v29, v28, s29
    v_accvgpr_write_b32 a46, v33
    v_perm_b32 v32, v31, v30, s28
    v_accvgpr_write_b32 a43, v32
    v_perm_b32 v33, v31, v30, s29
    v_accvgpr_write_b32 a47, v33
    s_add_u32 m0, s93, 10240
    s_mov_b32 s30, 327744
    buffer_load_dwordx4 v14, s[16:19], s30 offen  lds
    s_waitcnt vmcnt(29)
    ds_read2st64_b32 v[20:21], v15 offset0:52 offset1:53
    ds_read2st64_b32 v[22:23], v15 offset0:54 offset1:55
    s_waitcnt lgkmcnt(2)
    v_perm_b32 v32, v17, v16, s28
    v_accvgpr_write_b32 a48, v32
    v_perm_b32 v33, v17, v16, s29
    v_accvgpr_write_b32 a52, v33
    v_perm_b32 v32, v19, v18, s28
    v_accvgpr_write_b32 a49, v32
    v_perm_b32 v33, v19, v18, s29
    v_accvgpr_write_b32 a53, v33
    s_add_u32 m0, s93, 11264
    s_mov_b32 s30, 335936
    buffer_load_dwordx4 v14, s[16:19], s30 offen  lds
    s_waitcnt vmcnt(29)
    ds_read2st64_b32 v[24:25], v15 offset0:56 offset1:57
    ds_read2st64_b32 v[26:27], v15 offset0:58 offset1:59
    s_waitcnt lgkmcnt(2)
    v_perm_b32 v32, v21, v20, s28
    v_accvgpr_write_b32 a50, v32
    v_perm_b32 v33, v21, v20, s29
    v_accvgpr_write_b32 a54, v33
    v_perm_b32 v32, v23, v22, s28
    v_accvgpr_write_b32 a51, v32
    v_perm_b32 v33, v23, v22, s29
    v_accvgpr_write_b32 a55, v33
    s_add_u32 m0, s93, 12288
    s_mov_b32 s30, 360448
    buffer_load_dwordx4 v14, s[16:19], s30 offen  lds
    s_waitcnt vmcnt(29)
    ds_read2st64_b32 v[28:29], v15 offset0:60 offset1:61
    ds_read2st64_b32 v[30:31], v15 offset0:62 offset1:63
    s_waitcnt lgkmcnt(2)
    v_perm_b32 v32, v25, v24, s28
    v_accvgpr_write_b32 a56, v32
    v_perm_b32 v33, v25, v24, s29
    v_accvgpr_write_b32 a60, v33
    v_perm_b32 v32, v27, v26, s28
    v_accvgpr_write_b32 a57, v32
    v_perm_b32 v33, v27, v26, s29
    v_accvgpr_write_b32 a61, v33
    s_add_u32 m0, s93, 13312
    s_mov_b32 s30, 368640
    buffer_load_dwordx4 v14, s[16:19], s30 offen  lds
    s_waitcnt vmcnt(29)
    ds_read2st64_b32 v[16:17], v15 offset0:64 offset1:65
    ds_read2st64_b32 v[18:19], v15 offset0:66 offset1:67
    s_waitcnt lgkmcnt(2)
    v_perm_b32 v32, v29, v28, s28
    v_accvgpr_write_b32 a58, v32
    v_perm_b32 v33, v29, v28, s29
    v_accvgpr_write_b32 a62, v33
    v_perm_b32 v32, v31, v30, s28
    v_accvgpr_write_b32 a59, v32
    v_perm_b32 v33, v31, v30, s29
    v_accvgpr_write_b32 a63, v33
    s_add_u32 m0, s93, 14336
    s_mov_b32 s30, 360512
    buffer_load_dwordx4 v14, s[16:19], s30 offen  lds
    s_waitcnt vmcnt(29)
    ds_read2st64_b32 v[20:21], v15 offset0:68 offset1:69
    ds_read2st64_b32 v[22:23], v15 offset0:70 offset1:71
    s_waitcnt lgkmcnt(2)
    v_perm_b32 v32, v17, v16, s28
    v_accvgpr_write_b32 a64, v32
    v_perm_b32 v33, v17, v16, s29
    v_accvgpr_write_b32 a68, v33
    v_perm_b32 v32, v19, v18, s28
    v_accvgpr_write_b32 a65, v32
    v_perm_b32 v33, v19, v18, s29
    v_accvgpr_write_b32 a69, v33
    s_add_u32 m0, s93, 15360
    s_mov_b32 s30, 368704
    buffer_load_dwordx4 v14, s[16:19], s30 offen  lds
    s_waitcnt vmcnt(29)
    ds_read2st64_b32 v[24:25], v15 offset0:72 offset1:73
    ds_read2st64_b32 v[26:27], v15 offset0:74 offset1:75
    s_waitcnt lgkmcnt(2)
    v_perm_b32 v32, v21, v20, s28
    v_accvgpr_write_b32 a66, v32
    v_perm_b32 v33, v21, v20, s29
    v_accvgpr_write_b32 a70, v33
    v_perm_b32 v32, v23, v22, s28
    v_accvgpr_write_b32 a67, v32
    v_perm_b32 v33, v23, v22, s29
    v_accvgpr_write_b32 a71, v33
    s_add_u32 m0, s93, 16384
    s_mov_b32 s30, 393216
    buffer_load_dwordx4 v14, s[16:19], s30 offen  lds
    s_waitcnt vmcnt(29)
    ds_read2st64_b32 v[28:29], v15 offset0:76 offset1:77
    ds_read2st64_b32 v[30:31], v15 offset0:78 offset1:79
    s_waitcnt lgkmcnt(2)
    v_perm_b32 v32, v25, v24, s28
    v_accvgpr_write_b32 a72, v32
    v_perm_b32 v33, v25, v24, s29
    v_accvgpr_write_b32 a76, v33
    v_perm_b32 v32, v27, v26, s28
    v_accvgpr_write_b32 a73, v32
    v_perm_b32 v33, v27, v26, s29
    v_accvgpr_write_b32 a77, v33
    s_add_u32 m0, s93, 17408
    s_mov_b32 s30, 401408
    buffer_load_dwordx4 v14, s[16:19], s30 offen  lds
    s_waitcnt vmcnt(29)
    ds_read2st64_b32 v[16:17], v15 offset0:80 offset1:81
    ds_read2st64_b32 v[18:19], v15 offset0:82 offset1:83
    s_waitcnt lgkmcnt(2)
    v_perm_b32 v32, v29, v28, s28
    v_accvgpr_write_b32 a74, v32
    v_perm_b32 v33, v29, v28, s29
    v_accvgpr_write_b32 a78, v33
    v_perm_b32 v32, v31, v30, s28
    v_accvgpr_write_b32 a75, v32
    v_perm_b32 v33, v31, v30, s29
    v_accvgpr_write_b32 a79, v33
    s_add_u32 m0, s93, 18432
    s_mov_b32 s30, 393280
    buffer_load_dwordx4 v14, s[16:19], s30 offen  lds
    s_waitcnt vmcnt(29)
    ds_read2st64_b32 v[20:21], v15 offset0:84 offset1:85
    ds_read2st64_b32 v[22:23], v15 offset0:86 offset1:87
    s_waitcnt lgkmcnt(2)
    v_perm_b32 v32, v17, v16, s28
    v_accvgpr_write_b32 a80, v32
    v_perm_b32 v33, v17, v16, s29
    v_accvgpr_write_b32 a84, v33
    v_perm_b32 v32, v19, v18, s28
    v_accvgpr_write_b32 a81, v32
    v_perm_b32 v33, v19, v18, s29
    v_accvgpr_write_b32 a85, v33
    s_add_u32 m0, s93, 19456
    s_mov_b32 s30, 401472
    buffer_load_dwordx4 v14, s[16:19], s30 offen  lds
    s_waitcnt vmcnt(29)
    ds_read2st64_b32 v[24:25], v15 offset0:88 offset1:89
    ds_read2st64_b32 v[26:27], v15 offset0:90 offset1:91
    s_waitcnt lgkmcnt(2)
    v_perm_b32 v32, v21, v20, s28
    v_accvgpr_write_b32 a82, v32
    v_perm_b32 v33, v21, v20, s29
    v_accvgpr_write_b32 a86, v33
    v_perm_b32 v32, v23, v22, s28
    v_accvgpr_write_b32 a83, v32
    v_perm_b32 v33, v23, v22, s29
    v_accvgpr_write_b32 a87, v33
    s_add_u32 m0, s93, 20480
    s_mov_b32 s30, 425984
    buffer_load_dwordx4 v14, s[16:19], s30 offen  lds
    s_waitcnt vmcnt(29)
    ds_read2st64_b32 v[28:29], v15 offset0:92 offset1:93
    ds_read2st64_b32 v[30:31], v15 offset0:94 offset1:95
    s_waitcnt lgkmcnt(2)
    v_perm_b32 v32, v25, v24, s28
    v_accvgpr_write_b32 a88, v32
    v_perm_b32 v33, v25, v24, s29
    v_accvgpr_write_b32 a92, v33
    v_perm_b32 v32, v27, v26, s28
    v_accvgpr_write_b32 a89, v32
    v_perm_b32 v33, v27, v26, s29
    v_accvgpr_write_b32 a93, v33
    s_add_u32 m0, s93, 21504
    s_mov_b32 s30, 434176
    buffer_load_dwordx4 v14, s[16:19], s30 offen  lds
    s_waitcnt vmcnt(29)
    ds_read2st64_b32 v[16:17], v15 offset0:96 offset1:97
    ds_read2st64_b32 v[18:19], v15 offset0:98 offset1:99
    s_waitcnt lgkmcnt(2)
    v_perm_b32 v32, v29, v28, s28
    v_accvgpr_write_b32 a90, v32
    v_perm_b32 v33, v29, v28, s29
    v_accvgpr_write_b32 a94, v33
    v_perm_b32 v32, v31, v30, s28
    v_accvgpr_write_b32 a91, v32
    v_perm_b32 v33, v31, v30, s29
    v_accvgpr_write_b32 a95, v33
    s_add_u32 m0, s93, 22528
    s_mov_b32 s30, 426048
    buffer_load_dwordx4 v14, s[16:19], s30 offen  lds
    s_waitcnt vmcnt(29)
    ds_read2st64_b32 v[20:21], v15 offset0:100 offset1:101
    ds_read2st64_b32 v[22:23], v15 offset0:102 offset1:103
    s_waitcnt lgkmcnt(2)
    v_perm_b32 v32, v17, v16, s28
    v_accvgpr_write_b32 a96, v32
    v_perm_b32 v33, v17, v16, s29
    v_accvgpr_write_b32 a100, v33
    v_perm_b32 v32, v19, v18, s28
    v_accvgpr_write_b32 a97, v32
    v_perm_b32 v33, v19, v18, s29
    v_accvgpr_write_b32 a101, v33
    s_add_u32 m0, s93, 23552
    s_mov_b32 s30, 434240
    buffer_load_dwordx4 v14, s[16:19], s30 offen  lds
    s_waitcnt vmcnt(29)
    ds_read2st64_b32 v[24:25], v15 offset0:104 offset1:105
    ds_read2st64_b32 v[26:27], v15 offset0:106 offset1:107
    s_waitcnt lgkmcnt(2)
    v_perm_b32 v32, v21, v20, s28
    v_accvgpr_write_b32 a98, v32
    v_perm_b32 v33, v21, v20, s29
    v_accvgpr_write_b32 a102, v33
    v_perm_b32 v32, v23, v22, s28
    v_accvgpr_write_b32 a99, v32
    v_perm_b32 v33, v23, v22, s29
    v_accvgpr_write_b32 a103, v33
    s_add_u32 m0, s93, 24576
    s_mov_b32 s30, 458752
    buffer_load_dwordx4 v14, s[16:19], s30 offen  lds
    s_waitcnt vmcnt(29)
    ds_read2st64_b32 v[28:29], v15 offset0:108 offset1:109
    ds_read2st64_b32 v[30:31], v15 offset0:110 offset1:111
    s_waitcnt lgkmcnt(2)
    v_perm_b32 v32, v25, v24, s28
    v_accvgpr_write_b32 a104, v32
    v_perm_b32 v33, v25, v24, s29
    v_accvgpr_write_b32 a108, v33
    v_perm_b32 v32, v27, v26, s28
    v_accvgpr_write_b32 a105, v32
    v_perm_b32 v33, v27, v26, s29
    v_accvgpr_write_b32 a109, v33
    s_add_u32 m0, s93, 25600
    s_mov_b32 s30, 466944
    buffer_load_dwordx4 v14, s[16:19], s30 offen  lds
    s_waitcnt vmcnt(29)
    ds_read2st64_b32 v[16:17], v15 offset0:112 offset1:113
    ds_read2st64_b32 v[18:19], v15 offset0:114 offset1:115
    s_waitcnt lgkmcnt(2)
    v_perm_b32 v32, v29, v28, s28
    v_accvgpr_write_b32 a106, v32
    v_perm_b32 v33, v29, v28, s29
    v_accvgpr_write_b32 a110, v33
    v_perm_b32 v32, v31, v30, s28
    v_accvgpr_write_b32 a107, v32
    v_perm_b32 v33, v31, v30, s29
    v_accvgpr_write_b32 a111, v33
    s_add_u32 m0, s93, 26624
    s_mov_b32 s30, 458816
    buffer_load_dwordx4 v14, s[16:19], s30 offen  lds
    s_waitcnt vmcnt(29)
    ds_read2st64_b32 v[20:21], v15 offset0:116 offset1:117
    ds_read2st64_b32 v[22:23], v15 offset0:118 offset1:119
    s_waitcnt lgkmcnt(2)
    v_perm_b32 v32, v17, v16, s28
    v_accvgpr_write_b32 a112, v32
    v_perm_b32 v33, v17, v16, s29
    v_accvgpr_write_b32 a116, v33
    v_perm_b32 v32, v19, v18, s28
    v_accvgpr_write_b32 a113, v32
    v_perm_b32 v33, v19, v18, s29
    v_accvgpr_write_b32 a117, v33
    s_add_u32 m0, s93, 27648
    s_mov_b32 s30, 467008
    buffer_load_dwordx4 v14, s[16:19], s30 offen  lds
    s_waitcnt vmcnt(29)
    ds_read2st64_b32 v[24:25], v15 offset0:120 offset1:121
    ds_read2st64_b32 v[26:27], v15 offset0:122 offset1:123
    s_waitcnt lgkmcnt(2)
    v_perm_b32 v32, v21, v20, s28
    v_accvgpr_write_b32 a114, v32
    v_perm_b32 v33, v21, v20, s29
    v_accvgpr_write_b32 a118, v33
    v_perm_b32 v32, v23, v22, s28
    v_accvgpr_write_b32 a115, v32
    v_perm_b32 v33, v23, v22, s29
    v_accvgpr_write_b32 a119, v33
    s_add_u32 m0, s93, 28672
    s_mov_b32 s30, 491520
    buffer_load_dwordx4 v14, s[16:19], s30 offen  lds
    s_waitcnt vmcnt(29)
    ds_read2st64_b32 v[28:29], v15 offset0:124 offset1:125
    ds_read2st64_b32 v[30:31], v15 offset0:126 offset1:127
    s_waitcnt lgkmcnt(2)
    v_perm_b32 v32, v25, v24, s28
    v_accvgpr_write_b32 a120, v32
    v_perm_b32 v33, v25, v24, s29
    v_accvgpr_write_b32 a124, v33
    v_perm_b32 v32, v27, v26, s28
    v_accvgpr_write_b32 a121, v32
    v_perm_b32 v33, v27, v26, s29
    v_accvgpr_write_b32 a125, v33
    s_add_u32 m0, s93, 29696
    s_mov_b32 s30, 499712
    buffer_load_dwordx4 v14, s[16:19], s30 offen  lds
    s_waitcnt vmcnt(29)
    ds_read2st64_b32 v[16:17], v15 offset0:0 offset1:1
    ds_read2st64_b32 v[18:19], v15 offset0:2 offset1:3
    s_waitcnt lgkmcnt(2)
    v_perm_b32 v32, v29, v28, s28
    v_accvgpr_write_b32 a122, v32
    v_perm_b32 v33, v29, v28, s29
    v_accvgpr_write_b32 a126, v33
    v_perm_b32 v32, v31, v30, s28
    v_accvgpr_write_b32 a123, v32
    v_perm_b32 v33, v31, v30, s29
    v_accvgpr_write_b32 a127, v33
    s_add_u32 m0, s93, 30720
    s_mov_b32 s30, 491584
    buffer_load_dwordx4 v14, s[16:19], s30 offen  lds
    s_waitcnt vmcnt(29)
    ds_read2st64_b32 v[20:21], v15 offset0:4 offset1:5
    ds_read2st64_b32 v[22:23], v15 offset0:6 offset1:7
    s_waitcnt lgkmcnt(2)
    v_perm_b32 v32, v17, v16, s28
    v_accvgpr_write_b32 a128, v32
    v_perm_b32 v33, v17, v16, s29
    v_accvgpr_write_b32 a132, v33
    v_perm_b32 v32, v19, v18, s28
    v_accvgpr_write_b32 a129, v32
    v_perm_b32 v33, v19, v18, s29
    v_accvgpr_write_b32 a133, v33
    s_add_u32 m0, s93, 31744
    s_mov_b32 s30, 499776
    buffer_load_dwordx4 v14, s[16:19], s30 offen  lds
    s_waitcnt vmcnt(29)
    ds_read2st64_b32 v[24:25], v15 offset0:8 offset1:9
    ds_read2st64_b32 v[26:27], v15 offset0:10 offset1:11
    s_waitcnt lgkmcnt(2)
    v_perm_b32 v32, v21, v20, s28
    v_accvgpr_write_b32 a130, v32
    v_perm_b32 v33, v21, v20, s29
    v_accvgpr_write_b32 a134, v33
    v_perm_b32 v32, v23, v22, s28
    v_accvgpr_write_b32 a131, v32
    v_perm_b32 v33, v23, v22, s29
    v_accvgpr_write_b32 a135, v33
    s_waitcnt vmcnt(28)
    ds_read2st64_b32 v[28:29], v15 offset0:12 offset1:13
    ds_read2st64_b32 v[30:31], v15 offset0:14 offset1:15
    s_waitcnt lgkmcnt(2)
    v_perm_b32 v32, v25, v24, s28
    v_accvgpr_write_b32 a136, v32
    v_perm_b32 v33, v25, v24, s29
    v_accvgpr_write_b32 a140, v33
    v_perm_b32 v32, v27, v26, s28
    v_accvgpr_write_b32 a137, v32
    v_perm_b32 v33, v27, v26, s29
    v_accvgpr_write_b32 a141, v33
    s_waitcnt vmcnt(27)
    ds_read2st64_b32 v[16:17], v15 offset0:16 offset1:17
    ds_read2st64_b32 v[18:19], v15 offset0:18 offset1:19
    s_waitcnt lgkmcnt(2)
    v_perm_b32 v32, v29, v28, s28
    v_accvgpr_write_b32 a138, v32
    v_perm_b32 v33, v29, v28, s29
    v_accvgpr_write_b32 a142, v33
    v_perm_b32 v32, v31, v30, s28
    v_accvgpr_write_b32 a139, v32
    v_perm_b32 v33, v31, v30, s29
    v_accvgpr_write_b32 a143, v33
    s_waitcnt vmcnt(26)
    ds_read2st64_b32 v[20:21], v15 offset0:20 offset1:21
    ds_read2st64_b32 v[22:23], v15 offset0:22 offset1:23
    s_waitcnt lgkmcnt(2)
    v_perm_b32 v32, v17, v16, s28
    v_accvgpr_write_b32 a144, v32
    v_perm_b32 v33, v17, v16, s29
    v_accvgpr_write_b32 a148, v33
    v_perm_b32 v32, v19, v18, s28
    v_accvgpr_write_b32 a145, v32
    v_perm_b32 v33, v19, v18, s29
    v_accvgpr_write_b32 a149, v33
    s_waitcnt vmcnt(25)
    ds_read2st64_b32 v[24:25], v15 offset0:24 offset1:25
    ds_read2st64_b32 v[26:27], v15 offset0:26 offset1:27
    s_waitcnt lgkmcnt(2)
    v_perm_b32 v32, v21, v20, s28
    v_accvgpr_write_b32 a146, v32
    v_perm_b32 v33, v21, v20, s29
    v_accvgpr_write_b32 a150, v33
    v_perm_b32 v32, v23, v22, s28
    v_accvgpr_write_b32 a147, v32
    v_perm_b32 v33, v23, v22, s29
    v_accvgpr_write_b32 a151, v33
    s_waitcnt vmcnt(24)
    ds_read2st64_b32 v[28:29], v15 offset0:28 offset1:29
    ds_read2st64_b32 v[30:31], v15 offset0:30 offset1:31
    s_waitcnt lgkmcnt(2)
    v_perm_b32 v32, v25, v24, s28
    v_accvgpr_write_b32 a152, v32
    v_perm_b32 v33, v25, v24, s29
    v_accvgpr_write_b32 a156, v33
    v_perm_b32 v32, v27, v26, s28
    v_accvgpr_write_b32 a153, v32
    v_perm_b32 v33, v27, v26, s29
    v_accvgpr_write_b32 a157, v33
    s_waitcnt vmcnt(23)
    ds_read2st64_b32 v[16:17], v15 offset0:32 offset1:33
    ds_read2st64_b32 v[18:19], v15 offset0:34 offset1:35
    s_waitcnt lgkmcnt(2)
    v_perm_b32 v32, v29, v28, s28
    v_accvgpr_write_b32 a154, v32
    v_perm_b32 v33, v29, v28, s29
    v_accvgpr_write_b32 a158, v33
    v_perm_b32 v32, v31, v30, s28
    v_accvgpr_write_b32 a155, v32
    v_perm_b32 v33, v31, v30, s29
    v_accvgpr_write_b32 a159, v33
    s_waitcnt vmcnt(22)
    ds_read2st64_b32 v[20:21], v15 offset0:36 offset1:37
    ds_read2st64_b32 v[22:23], v15 offset0:38 offset1:39
    s_waitcnt lgkmcnt(2)
    v_perm_b32 v32, v17, v16, s28
    v_accvgpr_write_b32 a160, v32
    v_perm_b32 v33, v17, v16, s29
    v_accvgpr_write_b32 a164, v33
    v_perm_b32 v32, v19, v18, s28
    v_accvgpr_write_b32 a161, v32
    v_perm_b32 v33, v19, v18, s29
    v_accvgpr_write_b32 a165, v33
    s_waitcnt vmcnt(21)
    ds_read2st64_b32 v[24:25], v15 offset0:40 offset1:41
    ds_read2st64_b32 v[26:27], v15 offset0:42 offset1:43
    s_waitcnt lgkmcnt(2)
    v_perm_b32 v32, v21, v20, s28
    v_accvgpr_write_b32 a162, v32
    v_perm_b32 v33, v21, v20, s29
    v_accvgpr_write_b32 a166, v33
    v_perm_b32 v32, v23, v22, s28
    v_accvgpr_write_b32 a163, v32
    v_perm_b32 v33, v23, v22, s29
    v_accvgpr_write_b32 a167, v33
    s_waitcnt vmcnt(20)
    ds_read2st64_b32 v[28:29], v15 offset0:44 offset1:45
    ds_read2st64_b32 v[30:31], v15 offset0:46 offset1:47
    s_waitcnt lgkmcnt(2)
    v_perm_b32 v32, v25, v24, s28
    v_accvgpr_write_b32 a168, v32
    v_perm_b32 v33, v25, v24, s29
    v_accvgpr_write_b32 a172, v33
    v_perm_b32 v32, v27, v26, s28
    v_accvgpr_write_b32 a169, v32
    v_perm_b32 v33, v27, v26, s29
    v_accvgpr_write_b32 a173, v33
    s_waitcnt vmcnt(19)
    ds_read2st64_b32 v[16:17], v15 offset0:48 offset1:49
    ds_read2st64_b32 v[18:19], v15 offset0:50 offset1:51
    s_waitcnt lgkmcnt(2)
    v_perm_b32 v32, v29, v28, s28
    v_accvgpr_write_b32 a170, v32
    v_perm_b32 v33, v29, v28, s29
    v_accvgpr_write_b32 a174, v33
    v_perm_b32 v32, v31, v30, s28
    v_accvgpr_write_b32 a171, v32
    v_perm_b32 v33, v31, v30, s29
    v_accvgpr_write_b32 a175, v33
    s_waitcnt vmcnt(18)
    ds_read2st64_b32 v[20:21], v15 offset0:52 offset1:53
    ds_read2st64_b32 v[22:23], v15 offset0:54 offset1:55
    s_waitcnt lgkmcnt(2)
    v_perm_b32 v32, v17, v16, s28
    v_accvgpr_write_b32 a176, v32
    v_perm_b32 v33, v17, v16, s29
    v_accvgpr_write_b32 a180, v33
    v_perm_b32 v32, v19, v18, s28
    v_accvgpr_write_b32 a177, v32
    v_perm_b32 v33, v19, v18, s29
    v_accvgpr_write_b32 a181, v33
    s_waitcnt vmcnt(17)
    ds_read2st64_b32 v[24:25], v15 offset0:56 offset1:57
    ds_read2st64_b32 v[26:27], v15 offset0:58 offset1:59
    s_waitcnt lgkmcnt(2)
    v_perm_b32 v32, v21, v20, s28
    v_accvgpr_write_b32 a178, v32
    v_perm_b32 v33, v21, v20, s29
    v_accvgpr_write_b32 a182, v33
    v_perm_b32 v32, v23, v22, s28
    v_accvgpr_write_b32 a179, v32
    v_perm_b32 v33, v23, v22, s29
    v_accvgpr_write_b32 a183, v33
    s_waitcnt vmcnt(16)
    ds_read2st64_b32 v[28:29], v15 offset0:60 offset1:61
    ds_read2st64_b32 v[30:31], v15 offset0:62 offset1:63
    s_waitcnt lgkmcnt(2)
    v_perm_b32 v32, v25, v24, s28
    v_accvgpr_write_b32 a184, v32
    v_perm_b32 v33, v25, v24, s29
    v_accvgpr_write_b32 a188, v33
    v_perm_b32 v32, v27, v26, s28
    v_accvgpr_write_b32 a185, v32
    v_perm_b32 v33, v27, v26, s29
    v_accvgpr_write_b32 a189, v33
    s_waitcnt vmcnt(15)
    ds_read2st64_b32 v[16:17], v15 offset0:64 offset1:65
    ds_read2st64_b32 v[18:19], v15 offset0:66 offset1:67
    s_waitcnt lgkmcnt(2)
    v_perm_b32 v32, v29, v28, s28
    v_accvgpr_write_b32 a186, v32
    v_perm_b32 v33, v29, v28, s29
    v_accvgpr_write_b32 a190, v33
    v_perm_b32 v32, v31, v30, s28
    v_accvgpr_write_b32 a187, v32
    v_perm_b32 v33, v31, v30, s29
    v_accvgpr_write_b32 a191, v33
    s_waitcnt vmcnt(14)
    ds_read2st64_b32 v[20:21], v15 offset0:68 offset1:69
    ds_read2st64_b32 v[22:23], v15 offset0:70 offset1:71
    s_waitcnt lgkmcnt(2)
    v_perm_b32 v32, v17, v16, s28
    v_accvgpr_write_b32 a192, v32
    v_perm_b32 v33, v17, v16, s29
    v_accvgpr_write_b32 a196, v33
    v_perm_b32 v32, v19, v18, s28
    v_accvgpr_write_b32 a193, v32
    v_perm_b32 v33, v19, v18, s29
    v_accvgpr_write_b32 a197, v33
    s_waitcnt vmcnt(13)
    ds_read2st64_b32 v[24:25], v15 offset0:72 offset1:73
    ds_read2st64_b32 v[26:27], v15 offset0:74 offset1:75
    s_waitcnt lgkmcnt(2)
    v_perm_b32 v32, v21, v20, s28
    v_accvgpr_write_b32 a194, v32
    v_perm_b32 v33, v21, v20, s29
    v_accvgpr_write_b32 a198, v33
    v_perm_b32 v32, v23, v22, s28
    v_accvgpr_write_b32 a195, v32
    v_perm_b32 v33, v23, v22, s29
    v_accvgpr_write_b32 a199, v33
    s_waitcnt vmcnt(12)
    ds_read2st64_b32 v[28:29], v15 offset0:76 offset1:77
    ds_read2st64_b32 v[30:31], v15 offset0:78 offset1:79
    s_waitcnt lgkmcnt(2)
    v_perm_b32 v32, v25, v24, s28
    v_accvgpr_write_b32 a200, v32
    v_perm_b32 v33, v25, v24, s29
    v_accvgpr_write_b32 a204, v33
    v_perm_b32 v32, v27, v26, s28
    v_accvgpr_write_b32 a201, v32
    v_perm_b32 v33, v27, v26, s29
    v_accvgpr_write_b32 a205, v33
    s_waitcnt vmcnt(11)
    ds_read2st64_b32 v[16:17], v15 offset0:80 offset1:81
    ds_read2st64_b32 v[18:19], v15 offset0:82 offset1:83
    s_waitcnt lgkmcnt(2)
    v_perm_b32 v32, v29, v28, s28
    v_accvgpr_write_b32 a202, v32
    v_perm_b32 v33, v29, v28, s29
    v_accvgpr_write_b32 a206, v33
    v_perm_b32 v32, v31, v30, s28
    v_accvgpr_write_b32 a203, v32
    v_perm_b32 v33, v31, v30, s29
    v_accvgpr_write_b32 a207, v33
    s_waitcnt vmcnt(10)
    ds_read2st64_b32 v[20:21], v15 offset0:84 offset1:85
    ds_read2st64_b32 v[22:23], v15 offset0:86 offset1:87
    s_waitcnt lgkmcnt(2)
    v_perm_b32 v32, v17, v16, s28
    v_accvgpr_write_b32 a208, v32
    v_perm_b32 v33, v17, v16, s29
    v_accvgpr_write_b32 a212, v33
    v_perm_b32 v32, v19, v18, s28
    v_accvgpr_write_b32 a209, v32
    v_perm_b32 v33, v19, v18, s29
    v_accvgpr_write_b32 a213, v33
    s_waitcnt vmcnt(9)
    ds_read2st64_b32 v[24:25], v15 offset0:88 offset1:89
    ds_read2st64_b32 v[26:27], v15 offset0:90 offset1:91
    s_waitcnt lgkmcnt(2)
    v_perm_b32 v32, v21, v20, s28
    v_accvgpr_write_b32 a210, v32
    v_perm_b32 v33, v21, v20, s29
    v_accvgpr_write_b32 a214, v33
    v_perm_b32 v32, v23, v22, s28
    v_accvgpr_write_b32 a211, v32
    v_perm_b32 v33, v23, v22, s29
    v_accvgpr_write_b32 a215, v33
    s_waitcnt vmcnt(8)
    ds_read2st64_b32 v[28:29], v15 offset0:92 offset1:93
    ds_read2st64_b32 v[30:31], v15 offset0:94 offset1:95
    s_waitcnt lgkmcnt(2)
    v_perm_b32 v32, v25, v24, s28
    v_accvgpr_write_b32 a216, v32
    v_perm_b32 v33, v25, v24, s29
    v_accvgpr_write_b32 a220, v33
    v_perm_b32 v32, v27, v26, s28
    v_accvgpr_write_b32 a217, v32
    v_perm_b32 v33, v27, v26, s29
    v_accvgpr_write_b32 a221, v33
    s_waitcnt vmcnt(7)
    ds_read2st64_b32 v[16:17], v15 offset0:96 offset1:97
    ds_read2st64_b32 v[18:19], v15 offset0:98 offset1:99
    s_waitcnt lgkmcnt(2)
    v_perm_b32 v32, v29, v28, s28
    v_accvgpr_write_b32 a218, v32
    v_perm_b32 v33, v29, v28, s29
    v_accvgpr_write_b32 a222, v33
    v_perm_b32 v32, v31, v30, s28
    v_accvgpr_write_b32 a219, v32
    v_perm_b32 v33, v31, v30, s29
    v_accvgpr_write_b32 a223, v33
    s_waitcnt vmcnt(6)
    ds_read2st64_b32 v[20:21], v15 offset0:100 offset1:101
    ds_read2st64_b32 v[22:23], v15 offset0:102 offset1:103
    s_waitcnt lgkmcnt(2)
    v_perm_b32 v32, v17, v16, s28
    v_accvgpr_write_b32 a224, v32
    v_perm_b32 v33, v17, v16, s29
    v_accvgpr_write_b32 a228, v33
    v_perm_b32 v32, v19, v18, s28
    v_accvgpr_write_b32 a225, v32
    v_perm_b32 v33, v19, v18, s29
    v_accvgpr_write_b32 a229, v33
    s_waitcnt vmcnt(5)
    ds_read2st64_b32 v[24:25], v15 offset0:104 offset1:105
    ds_read2st64_b32 v[26:27], v15 offset0:106 offset1:107
    s_waitcnt lgkmcnt(2)
    v_perm_b32 v32, v21, v20, s28
    v_accvgpr_write_b32 a226, v32
    v_perm_b32 v33, v21, v20, s29
    v_accvgpr_write_b32 a230, v33
    v_perm_b32 v32, v23, v22, s28
    v_accvgpr_write_b32 a227, v32
    v_perm_b32 v33, v23, v22, s29
    v_accvgpr_write_b32 a231, v33
    s_waitcnt vmcnt(4)
    ds_read2st64_b32 v[28:29], v15 offset0:108 offset1:109
    ds_read2st64_b32 v[30:31], v15 offset0:110 offset1:111
    s_waitcnt lgkmcnt(2)
    v_perm_b32 v32, v25, v24, s28
    v_accvgpr_write_b32 a232, v32
    v_perm_b32 v33, v25, v24, s29
    v_accvgpr_write_b32 a236, v33
    v_perm_b32 v32, v27, v26, s28
    v_accvgpr_write_b32 a233, v32
    v_perm_b32 v33, v27, v26, s29
    v_accvgpr_write_b32 a237, v33
    s_waitcnt vmcnt(3)
    ds_read2st64_b32 v[16:17], v15 offset0:112 offset1:113
    ds_read2st64_b32 v[18:19], v15 offset0:114 offset1:115
    s_waitcnt lgkmcnt(2)
    v_perm_b32 v32, v29, v28, s28
    v_accvgpr_write_b32 a234, v32
    v_perm_b32 v33, v29, v28, s29
    v_accvgpr_write_b32 a238, v33
    v_perm_b32 v32, v31, v30, s28
    v_accvgpr_write_b32 a235, v32
    v_perm_b32 v33, v31, v30, s29
    v_accvgpr_write_b32 a239, v33
    s_waitcnt vmcnt(2)
    ds_read2st64_b32 v[20:21], v15 offset0:116 offset1:117
    ds_read2st64_b32 v[22:23], v15 offset0:118 offset1:119
    s_waitcnt lgkmcnt(2)
    v_perm_b32 v32, v17, v16, s28
    v_accvgpr_write_b32 a240, v32
    v_perm_b32 v33, v17, v16, s29
    v_accvgpr_write_b32 a244, v33
    v_perm_b32 v32, v19, v18, s28
    v_accvgpr_write_b32 a241, v32
    v_perm_b32 v33, v19, v18, s29
    v_accvgpr_write_b32 a245, v33
    s_waitcnt vmcnt(1)
    ds_read2st64_b32 v[24:25], v15 offset0:120 offset1:121
    ds_read2st64_b32 v[26:27], v15 offset0:122 offset1:123
    s_waitcnt lgkmcnt(2)
    v_perm_b32 v32, v21, v20, s28
    v_accvgpr_write_b32 a242, v32
    v_perm_b32 v33, v21, v20, s29
    v_accvgpr_write_b32 a246, v33
    v_perm_b32 v32, v23, v22, s28
    v_accvgpr_write_b32 a243, v32
    v_perm_b32 v33, v23, v22, s29
    v_accvgpr_write_b32 a247, v33
    s_waitcnt vmcnt(0)
    ds_read2st64_b32 v[28:29], v15 offset0:124 offset1:125
    ds_read2st64_b32 v[30:31], v15 offset0:126 offset1:127
    s_waitcnt lgkmcnt(2)
    v_perm_b32 v32, v25, v24, s28
    v_accvgpr_write_b32 a248, v32
    v_perm_b32 v33, v25, v24, s29
    v_accvgpr_write_b32 a252, v33
    v_perm_b32 v32, v27, v26, s28
    v_accvgpr_write_b32 a249, v32
    v_perm_b32 v33, v27, v26, s29
    v_accvgpr_write_b32 a253, v33
    s_waitcnt lgkmcnt(0)
    v_perm_b32 v32, v29, v28, s28
    v_accvgpr_write_b32 a250, v32
    v_perm_b32 v33, v29, v28, s29
    v_accvgpr_write_b32 a254, v33
    v_perm_b32 v32, v31, v30, s28
    v_accvgpr_write_b32 a251, v32
    v_perm_b32 v33, v31, v30, s29
    v_accvgpr_write_b32 a255, v33
    s_barrier
    s_sub_u32 s92, s25, 160
    s_lshl_b32 s92, s92, 2
    s_add_u32 s92, s92, s24
    v_mov_b32 v10, 0
    s_mov_b32 s27, 0
L_wi_39:
    global_load_dword v11, v10, s[6:7] offset:64 sc1
    s_waitcnt vmcnt(0)
    v_cmp_gt_u32 vcc, 0x100, v11
    s_cbranch_vccz L_wiok_40
    s_sleep 2
    s_add_u32 s27, s27, 1
    s_cmp_lt_u32 s27, 200000
    s_cbranch_scc1 L_wi_39
    s_branch L_x1_fail
L_wiok_40:
    s_lshr_b32 s30, s25, 5
    s_lshl_b32 s30, s30, 2
    s_add_u32 s30, s30, 128
    v_mov_b32 v10, s30
    global_load_dword v11, v10, s[6:7] sc1
    s_waitcnt vmcnt(0)
    v_readfirstlane_b32 s30, v11
    s_cmp_ge_u32 s30, 32
    s_cselect_b32 s49, 1, 0
    v_lshlrev_b32 v1, 4, v0
    v_lshlrev_b32 v2, 3, v0
    v_and_b32 v3, 7, v0
    v_lshlrev_b32 v3, 2, v3
    v_mov_b32 v4, 0
    v_mov_b32 v8, 0xf149f2ca
    v_lshrrev_b32 v10, 4, v0
    v_and_b32 v11, 15, v0
    v_lshrrev_b32 v12, 1, v10
    v_and_b32 v13, 1, v10
    v_lshrrev_b32 v14, 2, v11
    v_and_b32 v15, 1, v11
    v_lshlrev_b32 v7, 8, v12
    v_lshl_add_u32 v7, v13, 5, v7
    v_lshl_add_u32 v7, v14, 6, v7
    v_lshl_add_u32 v7, v15, 4, v7
    v_lshlrev_b32 v9, 9, v12
    v_lshl_add_u32 v9, v14, 7, v9
    v_lshl_add_u32 v9, v13, 6, v9
    v_and_b32 v15, 3, v11
    v_lshl_add_u32 v9, v15, 4, v9
    v_lshlrev_b32 v188, 7, v15
    s_lshl_b32 s30, s37, 9
    v_add_u32 v188, s30, v188
    v_lshlrev_b32 v10, 2, v10
    s_load_dwordx2 s[4:5], s[0:1], 0
    s_waitcnt lgkmcnt(0)
    s_mov_b32 s12, s4
    s_mov_b32 s13, s5
    s_mov_b32 s14, 2097152
    s_mov_b32 s15, 0x20000
    v_add_u32 v12, 0, v10
    v_cmp_le_u32 s[50:51], v12, v11
    v_add_u32 v12, 1, v10
    v_cmp_le_u32 s[52:53], v12, v11
    v_add_u32 v12, 2, v10
    v_cmp_le_u32 s[54:55], v12, v11
    v_add_u32 v12, 3, v10
    v_cmp_le_u32 s[56:57], v12, v11
    s_lshl_b32 s30, s37, 7
    s_add_u32 s42, s30, 0
    s_lshl_b32 s30, s32, 7
    s_add_u32 s43, s30, 8704
    v_lshlrev_b32 v189, 2, v11
    s_lshl_b32 s31, s37, 2
    s_add_u32 s44, s30, s31
    s_add_u32 s44, s44, 8192
    s_mov_b32 s34, s32
    s_branch L_x1_layer
L_x1_second:
    s_mov_b32 s63, 1
    s_mov_b32 s61, 44
    s_mov_b32 s64, 128
    s_mov_b32 s101, 0
L_x1_layer:
    v_mov_b32 v185, 0
    v_mov_b32 v186, 0
    s_and_b32 s47, s34, 128
    s_add_u32 s47, s47, 128
L_x1_pro:
    s_lshr_b32 s30, s34, 7
    s_mov_b32 s38, 0
    s_lshl_b32 s45, s30, 7
    s_bfe_u32 s30, s34, 0x60001
    s_add_u32 s45, s45, s30
    s_add_u32 s45, s45, 2
    s_mul_i32 s31, s37, 1
    s_mul_i32 s30, s30, 32
    s_add_u32 s30, s30, s31
    s_mul_i32 s30, s30, 24576
    s_add_u32 s38, s38, s30
    s_add_u32 s38, s38, 1048576
    s_mov_b32 s27, 0
L_poll_41:
    buffer_load_dword v6, v3, s[8:11], s42 offen sc1
    s_waitcnt vmcnt(0)
    v_cmp_gt_u32 vcc, s45, v6
    s_cbranch_vccz L_pollok_42
    s_sleep 1
    s_add_u32 s27, s27, 1
    s_cmp_lt_u32 s27, 200000
    s_cbranch_scc1 L_poll_41
    s_branch L_x1_fail
L_pollok_42:
    s_bitcmp1_b32 s34, 0
    s_cbranch_scc1 L_x1_pro1
L_x1_pro0:
    s_lshl_b32 s30, s34, 14
    s_and_b32 s30, s30, 0x1fffff
    s_cmp_ge_u32 s34, 128
    s_cbranch_scc1 L_rt_43
    buffer_load_dword v5, v188, s[12:15], s30 offen
    s_branch L_rt_44
L_rt_43:
    s_add_u32 s30, s30, 72351744
    buffer_load_dword v5, v188, s[8:11], s30 offen sc1
L_rt_44:
    s_add_u32 s30, s38, 0
    buffer_load_dwordx4 v[16:19], v1, s[8:11], s30 offen offset:0 sc1
    buffer_load_dwordx4 v[20:23], v1, s[8:11], s30 offen offset:1024 sc1
    buffer_load_dwordx4 v[24:27], v1, s[8:11], s30 offen offset:2048 sc1
    buffer_load_dwordx4 v[28:31], v1, s[8:11], s30 offen offset:3072 sc1
    s_add_u32 s30, s38, 8192
    buffer_load_dwordx4 v[112:115], v9, s[8:11], s30 offen offset:0 sc1
    buffer_load_dwordx4 v[116:119], v9, s[8:11], s30 offen offset:1024 sc1
    buffer_load_dwordx4 v[120:123], v9, s[8:11], s30 offen offset:2048 sc1
    buffer_load_dwordx4 v[124:127], v9, s[8:11], s30 offen offset:3072 sc1
    s_add_u32 s30, s38, 16384
    buffer_load_dwordx4 v[48:51], v1, s[8:11], s30 offen offset:0 sc1
    buffer_load_dwordx4 v[52:55], v1, s[8:11], s30 offen offset:1024 sc1
    buffer_load_dwordx4 v[56:59], v1, s[8:11], s30 offen offset:2048 sc1
    buffer_load_dwordx4 v[60:63], v1, s[8:11], s30 offen offset:3072 sc1
    s_waitcnt vmcnt(0)
    s_branch L_x1_task0
L_x1_pro1:
    s_lshl_b32 s30, s34, 14
    s_and_b32 s30, s30, 0x1fffff
    s_cmp_ge_u32 s34, 128
    s_cbranch_scc1 L_rt_45
    buffer_load_dword v5, v188, s[12:15], s30 offen
    s_branch L_rt_46
L_rt_45:
    s_add_u32 s30, s30, 72351744
    buffer_load_dword v5, v188, s[8:11], s30 offen sc1
L_rt_46:
    s_add_u32 s30, s38, 4096
    buffer_load_dwordx4 v[32:35], v1, s[8:11], s30 offen offset:0 sc1
    buffer_load_dwordx4 v[36:39], v1, s[8:11], s30 offen offset:1024 sc1
    buffer_load_dwordx4 v[40:43], v1, s[8:11], s30 offen offset:2048 sc1
    buffer_load_dwordx4 v[44:47], v1, s[8:11], s30 offen offset:3072 sc1
    s_add_u32 s30, s38, 12288
    buffer_load_dwordx4 v[112:115], v9, s[8:11], s30 offen offset:0 sc1
    buffer_load_dwordx4 v[116:119], v9, s[8:11], s30 offen offset:1024 sc1
    buffer_load_dwordx4 v[120:123], v9, s[8:11], s30 offen offset:2048 sc1
    buffer_load_dwordx4 v[124:127], v9, s[8:11], s30 offen offset:3072 sc1
    s_add_u32 s30, s38, 8192
    buffer_load_dwordx4 v[128:131], v9, s[8:11], s30 offen offset:0 sc1
    buffer_load_dwordx4 v[132:135], v9, s[8:11], s30 offen offset:1024 sc1
    buffer_load_dwordx4 v[136:139], v9, s[8:11], s30 offen offset:2048 sc1
    buffer_load_dwordx4 v[140:143], v9, s[8:11], s30 offen offset:3072 sc1
    s_add_u32 s30, s38, 16384
    buffer_load_dwordx4 v[80:83], v1, s[8:11], s30 offen offset:0 sc1
    buffer_load_dwordx4 v[88:91], v1, s[8:11], s30 offen offset:1024 sc1
    buffer_load_dwordx4 v[96:99], v1, s[8:11], s30 offen offset:2048 sc1
    buffer_load_dwordx4 v[104:107], v1, s[8:11], s30 offen offset:3072 sc1
    s_add_u32 s30, s38, 20480
    buffer_load_dwordx4 v[84:87], v1, s[8:11], s30 offen offset:0 sc1
    buffer_load_dwordx4 v[92:95], v1, s[8:11], s30 offen offset:1024 sc1
    buffer_load_dwordx4 v[100:103], v1, s[8:11], s30 offen offset:2048 sc1
    buffer_load_dwordx4 v[108:111], v1, s[8:11], s30 offen offset:3072 sc1
    s_waitcnt vmcnt(0)
    s_branch L_x1_task1
L_x1_task0:
    v_mfma_f32_16x16x32_bf16 v[168:171], v[112:115], v[16:19], 0
    v_mfma_f32_16x16x32_bf16 v[168:171], v[116:119], v[20:23], v[168:171]
    v_mfma_f32_16x16x32_bf16 v[168:171], v[120:123], v[24:27], v[168:171]
    v_mfma_f32_16x16x32_bf16 v[168:171], v[124:127], v[28:31], v[168:171]
    s_mul_i32 s30, s34, 21846
    s_bfe_u32 s30, s30, 0x20010
    s_lshl_b32 s35, s32, 2
    s_add_u32 s35, s35, s30
    s_and_b32 s36, s34, 127
    s_lshr_b32 s30, s36, 1
    s_mul_i32 s31, s37, 1
    s_mul_i32 s30, s30, 32
    s_add_u32 s30, s30, s31
    s_lshl_b32 s39, s30, 12
    s_add_u32 s39, s39, 1048576
    s_add_u32 s39, s39, 51380224
    s_lshl_b32 s40, s35, 17
    s_lshl_b32 s30, s37, 12
    s_add_u32 s40, s40, s30
    s_add_u32 s40, s40, 74448896
    s_sub_u32 s46, s34, 11
    s_max_i32 s46, s46, 0
    s_add_u32 s41, s34, 1
    s_add_u32 s34, s34, 3
    s_lshr_b32 s30, s34, 7
    s_mov_b32 s38, 0
    s_lshl_b32 s45, s30, 7
    s_bfe_u32 s30, s34, 0x60001
    s_add_u32 s45, s45, s30
    s_add_u32 s45, s45, 2
    s_mul_i32 s31, s37, 1
    s_mul_i32 s30, s30, 32
    s_add_u32 s30, s30, s31
    s_mul_i32 s30, s30, 24576
    s_add_u32 s38, s38, s30
    s_add_u32 s38, s38, 1048576
    v_cndmask_b32 v168, v8, v168, s[50:51]
    v_cndmask_b32 v169, v8, v169, s[52:53]
    v_cndmask_b32 v170, v8, v170, s[54:55]
    v_cndmask_b32 v171, v8, v171, s[56:57]
    v_max3_f32 v10, v168, v169, v170
    v_max_f32 v10, v10, v171
    v_cmp_gt_u32 vcc, s45, v6
    s_mov_b32 s48, 0
    s_cmp_lt_u32 s34, s47
    s_cbranch_scc0 L_x1_nopf0
    s_cbranch_vccnz L_x1_nopf0
    s_mov_b32 s48, 1
    s_lshl_b32 s30, s34, 14
    s_and_b32 s30, s30, 0x1fffff
    s_cmp_ge_u32 s34, 128
    s_cbranch_scc1 L_rt_47
    buffer_load_dword v5, v188, s[12:15], s30 offen
    s_branch L_rt_48
L_rt_47:
    s_add_u32 s30, s30, 72351744
    buffer_load_dword v5, v188, s[8:11], s30 offen sc1
L_rt_48:
    s_add_u32 s30, s38, 4096
    buffer_load_dwordx4 v[32:35], v1, s[8:11], s30 offen offset:0 sc1
    buffer_load_dwordx4 v[36:39], v1, s[8:11], s30 offen offset:1024 sc1
    buffer_load_dwordx4 v[40:43], v1, s[8:11], s30 offen offset:2048 sc1
    buffer_load_dwordx4 v[44:47], v1, s[8:11], s30 offen offset:3072 sc1
    s_add_u32 s30, s38, 12288
    buffer_load_dwordx4 v[112:115], v9, s[8:11], s30 offen offset:0 sc1
    buffer_load_dwordx4 v[116:119], v9, s[8:11], s30 offen offset:1024 sc1
    buffer_load_dwordx4 v[120:123], v9, s[8:11], s30 offen offset:2048 sc1
    buffer_load_dwordx4 v[124:127], v9, s[8:11], s30 offen offset:3072 sc1
    s_add_u32 s30, s38, 8192
    buffer_load_dwordx4 v[128:131], v9, s[8:11], s30 offen offset:0 sc1
    buffer_load_dwordx4 v[132:135], v9, s[8:11], s30 offen offset:1024 sc1
    buffer_load_dwordx4 v[136:139], v9, s[8:11], s30 offen offset:2048 sc1
    buffer_load_dwordx4 v[140:143], v9, s[8:11], s30 offen offset:3072 sc1
    s_add_u32 s30, s38, 16384
    buffer_load_dwordx4 v[80:83], v1, s[8:11], s30 offen offset:0 sc1
    buffer_load_dwordx4 v[88:91], v1, s[8:11], s30 offen offset:1024 sc1
    buffer_load_dwordx4 v[96:99], v1, s[8:11], s30 offen offset:2048 sc1
    buffer_load_dwordx4 v[104:107], v1, s[8:11], s30 offen offset:3072 sc1
    s_add_u32 s30, s38, 20480
    buffer_load_dwordx4 v[84:87], v1, s[8:11], s30 offen offset:0 sc1
    buffer_load_dwordx4 v[92:95], v1, s[8:11], s30 offen offset:1024 sc1
    buffer_load_dwordx4 v[100:103], v1, s[8:11], s30 offen offset:2048 sc1
    buffer_load_dwordx4 v[108:111], v1, s[8:11], s30 offen offset:3072 sc1
L_x1_nopf0:
    s_mov_b32 s27, 0
L_x1_kv0:
    buffer_load_dwordx4 v[144:147], v7, s[8:11], s39 offen offset:0 sc1
    buffer_load_dwordx4 v[148:151], v7, s[8:11], s39 offen offset:512 sc1
    buffer_load_dwordx4 v[152:155], v7, s[8:11], s39 offen offset:1024 sc1
    buffer_load_dwordx4 v[156:159], v7, s[8:11], s39 offen offset:1536 sc1
    buffer_load_dwordx2 v[160:161], v2, s[8:11], s39 offen offset:2048 sc1
    buffer_load_dwordx2 v[162:163], v2, s[8:11], s39 offen offset:2560 sc1
    buffer_load_dwordx2 v[164:165], v2, s[8:11], s39 offen offset:3072 sc1
    buffer_load_dwordx2 v[166:167], v2, s[8:11], s39 offen offset:3584 sc1
    s_add_u32 s27, s27, 1
    s_cmp_lt_u32 s27, 200000
    s_cbranch_scc0 L_x1_fail
    s_waitcnt vmcnt(7)
    v_mfma_f32_16x16x32_bf16 v[176:179], v[144:147], v[16:19], 0
    v_max3_u32 v5, v144, v145, 0
    v_max3_u32 v5, v146, v147, v5
    s_waitcnt vmcnt(6)
    v_mfma_f32_16x16x32_bf16 v[176:179], v[148:151], v[20:23], v[176:179]
    v_max3_u32 v5, v148, v149, v5
    v_max3_u32 v5, v150, v151, v5
    s_waitcnt vmcnt(5)
    v_mfma_f32_16x16x32_bf16 v[176:179], v[152:155], v[24:27], v[176:179]
    v_max3_u32 v5, v152, v153, v5
    v_max3_u32 v5, v154, v155, v5
    s_waitcnt vmcnt(4)
    v_mfma_f32_16x16x32_bf16 v[176:179], v[156:159], v[28:31], v[176:179]
    v_max3_u32 v5, v156, v157, v5
    v_max3_u32 v5, v158, v159, v5
    s_waitcnt vmcnt(0)
    v_max3_u32 v5, v160, v161, v5
    v_max3_u32 v5, v162, v163, v5
    v_max3_u32 v5, v164, v165, v5
    v_max3_u32 v5, v166, v167, v5
    v_cmp_eq_u32 vcc, -1, v5
    s_cbranch_vccnz L_x1_kw0
    buffer_load_dword v5, v189, s[8:11], s43 offen sc1
    buffer_load_dword v6, v3, s[8:11], s42 offen sc1
    v_max3_f32 v10, v10, v176, v177
    v_mov_b32 v11, v10
    s_nop 1
    v_permlane16_swap_b32 v10, v11
    s_nop 1
    v_max_f32 v10, v10, v11
    v_mov_b32 v11, v10
    s_nop 1
    v_permlane32_swap_b32 v10, v11
    s_nop 1
    v_max_f32 v10, v10, v11
    v_sub_f32 v176, v176, v10
    v_sub_f32 v177, v177, v10
    v_sub_f32 v168, v168, v10
    v_sub_f32 v169, v169, v10
    v_sub_f32 v170, v170, v10
    v_sub_f32 v171, v171, v10
    v_exp_f32 v176, v176
    v_exp_f32 v177, v177
    v_exp_f32 v168, v168
    v_exp_f32 v169, v169
    v_exp_f32 v170, v170
    v_exp_f32 v171, v171
    v_cvt_pk_bf16_f32 v184, v176, v177
    v_cvt_pk_bf16_f32 v187, v176, v177
    v_cvt_pk_bf16_f32 v182, v168, v169
    v_cvt_pk_bf16_f32 v183, v170, v171
    s_nop 1
    v_mfma_f32_16x16x16_bf16 v[192:195], v[48:49], v[182:183], 0
    v_add_f32 v10, v176, v177
    v_add_f32 v10, v10, v168
    v_mfma_f32_16x16x16_bf16 v[196:199], v[50:51], v[182:183], 0
    v_add_f32 v10, v10, v169
    v_add_f32 v10, v10, v170
    v_mfma_f32_16x16x16_bf16 v[200:203], v[52:53], v[182:183], 0
    v_add_f32 v10, v10, v171
    v_mov_b32 v11, v10
    v_mfma_f32_16x16x16_bf16 v[204:207], v[54:55], v[182:183], 0
    s_nop 1
    v_permlane16_swap_b32 v10, v11
    s_nop 1
    v_add_f32 v10, v10, v11
    v_mfma_f32_16x16x16_bf16 v[208:211], v[56:57], v[182:183], 0
    v_mov_b32 v11, v10
    s_nop 1
    v_permlane32_swap_b32 v10, v11
    v_mfma_f32_16x16x16_bf16 v[212:215], v[58:59], v[182:183], 0
    s_nop 1
    v_add_f32 v10, v10, v11
    v_rcp_f32 v10, v10
    v_mfma_f32_16x16x16_bf16 v[216:219], v[60:61], v[182:183], 0
    v_mfma_f32_16x16x16_bf16 v[220:223], v[62:63], v[182:183], 0
    v_mfma_f32_16x16x16_bf16 v[192:195], v[160:161], v[184:185], v[192:195]
    v_mfma_f32_16x16x16_bf16 v[196:199], v[160:161], v[186:187], v[196:199]
    v_mfma_f32_16x16x16_bf16 v[200:203], v[162:163], v[184:185], v[200:203]
    v_mfma_f32_16x16x16_bf16 v[204:207], v[162:163], v[186:187], v[204:207]
    v_mfma_f32_16x16x16_bf16 v[208:211], v[164:165], v[184:185], v[208:211]
    v_mfma_f32_16x16x16_bf16 v[212:215], v[164:165], v[186:187], v[212:215]
    v_mfma_f32_16x16x16_bf16 v[216:219], v[166:167], v[184:185], v[216:219]
    v_mfma_f32_16x16x16_bf16 v[220:223], v[166:167], v[186:187], v[220:223]
    s_waitcnt vmcnt(1)
    v_cmp_gt_u32 vcc, s46, v5
    v_mul_f32 v192, v10, v192
    v_mul_f32 v193, v10, v193
    v_mul_f32 v194, v10, v194
    v_mul_f32 v195, v10, v195
    v_mul_f32 v196, v10, v196
    v_mul_f32 v197, v10, v197
    v_mul_f32 v198, v10, v198
    v_mul_f32 v199, v10, v199
    v_cvt_pk_bf16_f32 v192, v192, v196
    v_cvt_pk_bf16_f32 v193, v193, v197
    v_cvt_pk_bf16_f32 v194, v194, v198
    v_cvt_pk_bf16_f32 v195, v195, v199
    s_cbranch_vccnz L_x1_bp0
L_x1_free0:
    s_cmp_eq_u32 s49, 0
    s_cbranch_scc1 L_far_51
    buffer_store_dwordx4 v[192:195], v1, s[8:11], s40 offen offset:0
L_join_52:
    v_mul_f32 v200, v10, v200
    v_mul_f32 v201, v10, v201
    v_mul_f32 v202, v10, v202
    v_mul_f32 v203, v10, v203
    v_mul_f32 v204, v10, v204
    v_mul_f32 v205, v10, v205
    v_mul_f32 v206, v10, v206
    v_mul_f32 v207, v10, v207
    v_cvt_pk_bf16_f32 v200, v200, v204
    v_cvt_pk_bf16_f32 v201, v201, v205
    v_cvt_pk_bf16_f32 v202, v202, v206
    v_cvt_pk_bf16_f32 v203, v203, v207
    s_cmp_eq_u32 s49, 0
    s_cbranch_scc1 L_far_53
    buffer_store_dwordx4 v[200:203], v1, s[8:11], s40 offen offset:1024
L_join_54:
    v_mul_f32 v208, v10, v208
    v_mul_f32 v209, v10, v209
    v_mul_f32 v210, v10, v210
    v_mul_f32 v211, v10, v211
    v_mul_f32 v212, v10, v212
    v_mul_f32 v213, v10, v213
    v_mul_f32 v214, v10, v214
    v_mul_f32 v215, v10, v215
    v_cvt_pk_bf16_f32 v208, v208, v212
    v_cvt_pk_bf16_f32 v209, v209, v213
    v_cvt_pk_bf16_f32 v210, v210, v214
    v_cvt_pk_bf16_f32 v211, v211, v215
    s_cmp_eq_u32 s49, 0
    s_cbranch_scc1 L_far_55
    buffer_store_dwordx4 v[208:211], v1, s[8:11], s40 offen offset:2048
L_join_56:
    v_mul_f32 v216, v10, v216
    v_mul_f32 v217, v10, v217
    v_mul_f32 v218, v10, v218
    v_mul_f32 v219, v10, v219
    v_mul_f32 v220, v10, v220
    v_mul_f32 v221, v10, v221
    v_mul_f32 v222, v10, v222
    v_mul_f32 v223, v10, v223
    v_cvt_pk_bf16_f32 v216, v216, v220
    v_cvt_pk_bf16_f32 v217, v217, v221
    v_cvt_pk_bf16_f32 v218, v218, v222
    v_cvt_pk_bf16_f32 v219, v219, v223
    s_cmp_eq_u32 s49, 0
    s_cbranch_scc1 L_far_57
    buffer_store_dwordx4 v[216:219], v1, s[8:11], s40 offen offset:3072
L_join_58:
    s_waitcnt vmcnt(0)
    v_mov_b32 v10, s41
    s_mov_b64 exec, 1
    s_cmp_eq_u32 s49, 0
    s_cbranch_scc1 L_far_59
    buffer_store_dword v10, v4, s[8:11], s44 offen
L_join_60:
    s_mov_b64 exec, -1
    s_cmp_eq_u32 s48, 1
    s_cbranch_scc1 L_x1_task1
    s_cmp_lt_u32 s34, s47
    s_cbranch_scc1 L_x1_pro
    s_branch L_bo
L_x1_task1:
    v_mfma_f32_16x16x32_bf16 v[168:171], v[112:115], v[32:35], 0
    v_mfma_f32_16x16x32_bf16 v[172:175], v[128:131], v[32:35], 0
    v_swap_b32 v82, v84
    v_swap_b32 v83, v85
    v_mfma_f32_16x16x32_bf16 v[168:171], v[116:119], v[36:39], v[168:171]
    v_mfma_f32_16x16x32_bf16 v[172:175], v[132:135], v[36:39], v[172:175]
    v_swap_b32 v90, v92
    v_swap_b32 v91, v93
    v_mfma_f32_16x16x32_bf16 v[168:171], v[120:123], v[40:43], v[168:171]
    v_mfma_f32_16x16x32_bf16 v[172:175], v[136:139], v[40:43], v[172:175]
    v_swap_b32 v98, v100
    v_swap_b32 v99, v101
    v_mfma_f32_16x16x32_bf16 v[168:171], v[124:127], v[44:47], v[168:171]
    v_mfma_f32_16x16x32_bf16 v[172:175], v[140:143], v[44:47], v[172:175]
    v_swap_b32 v106, v108
    v_swap_b32 v107, v109
    s_mul_i32 s30, s34, 21846
    s_bfe_u32 s30, s30, 0x20010
    s_lshl_b32 s35, s32, 2
    s_add_u32 s35, s35, s30
    s_and_b32 s36, s34, 127
    s_lshr_b32 s30, s36, 1
    s_mul_i32 s31, s37, 1
    s_mul_i32 s30, s30, 32
    s_add_u32 s30, s30, s31
    s_lshl_b32 s39, s30, 12
    s_add_u32 s39, s39, 1048576
    s_add_u32 s39, s39, 51380224
    s_lshl_b32 s40, s35, 17
    s_lshl_b32 s30, s37, 12
    s_add_u32 s40, s40, s30
    s_add_u32 s40, s40, 74448896
    s_sub_u32 s46, s34, 11
    s_max_i32 s46, s46, 0
    s_add_u32 s41, s34, 1
    s_add_u32 s34, s34, 3
    s_lshr_b32 s30, s34, 7
    s_mov_b32 s38, 0
    s_lshl_b32 s45, s30, 7
    s_bfe_u32 s30, s34, 0x60001
    s_add_u32 s45, s45, s30
    s_add_u32 s45, s45, 2
    s_mul_i32 s31, s37, 1
    s_mul_i32 s30, s30, 32
    s_add_u32 s30, s30, s31
    s_mul_i32 s30, s30, 24576
    s_add_u32 s38, s38, s30
    s_add_u32 s38, s38, 1048576
    v_cndmask_b32 v168, v8, v168, s[50:51]
    v_cndmask_b32 v169, v8, v169, s[52:53]
    v_cndmask_b32 v170, v8, v170, s[54:55]
    v_cndmask_b32 v171, v8, v171, s[56:57]
    v_max3_f32 v10, v168, v169, v170
    v_max_f32 v10, v10, v171
    v_max3_f32 v10, v10, v172, v173
    v_max3_f32 v10, v10, v174, v175
    v_cmp_gt_u32 vcc, s45, v6
    s_mov_b32 s48, 0
    s_cmp_lt_u32 s34, s47
    s_cbranch_scc0 L_x1_nopf1
    s_cbranch_vccnz L_x1_nopf1
    s_mov_b32 s48, 1
    s_lshl_b32 s30, s34, 14
    s_and_b32 s30, s30, 0x1fffff
    s_cmp_ge_u32 s34, 128
    s_cbranch_scc1 L_rt_61
    buffer_load_dword v5, v188, s[12:15], s30 offen
    s_branch L_rt_62
L_rt_61:
    s_add_u32 s30, s30, 72351744
    buffer_load_dword v5, v188, s[8:11], s30 offen sc1
L_rt_62:
    s_add_u32 s30, s38, 0
    buffer_load_dwordx4 v[16:19], v1, s[8:11], s30 offen offset:0 sc1
    buffer_load_dwordx4 v[20:23], v1, s[8:11], s30 offen offset:1024 sc1
    buffer_load_dwordx4 v[24:27], v1, s[8:11], s30 offen offset:2048 sc1
    buffer_load_dwordx4 v[28:31], v1, s[8:11], s30 offen offset:3072 sc1
    s_add_u32 s30, s38, 8192
    buffer_load_dwordx4 v[112:115], v9, s[8:11], s30 offen offset:0 sc1
    buffer_load_dwordx4 v[116:119], v9, s[8:11], s30 offen offset:1024 sc1
    buffer_load_dwordx4 v[120:123], v9, s[8:11], s30 offen offset:2048 sc1
    buffer_load_dwordx4 v[124:127], v9, s[8:11], s30 offen offset:3072 sc1
    s_add_u32 s30, s38, 16384
    buffer_load_dwordx4 v[48:51], v1, s[8:11], s30 offen offset:0 sc1
    buffer_load_dwordx4 v[52:55], v1, s[8:11], s30 offen offset:1024 sc1
    buffer_load_dwordx4 v[56:59], v1, s[8:11], s30 offen offset:2048 sc1
    buffer_load_dwordx4 v[60:63], v1, s[8:11], s30 offen offset:3072 sc1
L_x1_nopf1:
    s_mov_b32 s27, 0
L_x1_kv1:
    buffer_load_dwordx4 v[144:147], v7, s[8:11], s39 offen offset:0 sc1
    buffer_load_dwordx4 v[148:151], v7, s[8:11], s39 offen offset:512 sc1
    buffer_load_dwordx4 v[152:155], v7, s[8:11], s39 offen offset:1024 sc1
    buffer_load_dwordx4 v[156:159], v7, s[8:11], s39 offen offset:1536 sc1
    buffer_load_dwordx2 v[160:161], v2, s[8:11], s39 offen offset:2048 sc1
    buffer_load_dwordx2 v[162:163], v2, s[8:11], s39 offen offset:2560 sc1
    buffer_load_dwordx2 v[164:165], v2, s[8:11], s39 offen offset:3072 sc1
    buffer_load_dwordx2 v[166:167], v2, s[8:11], s39 offen offset:3584 sc1
    s_add_u32 s27, s27, 1
    s_cmp_lt_u32 s27, 200000
    s_cbranch_scc0 L_x1_fail
    s_waitcnt vmcnt(7)
    v_mfma_f32_16x16x32_bf16 v[176:179], v[144:147], v[32:35], 0
    v_max3_u32 v5, v144, v145, 0
    v_max3_u32 v5, v146, v147, v5
    s_waitcnt vmcnt(6)
    v_mfma_f32_16x16x32_bf16 v[176:179], v[148:151], v[36:39], v[176:179]
    v_max3_u32 v5, v148, v149, v5
    v_max3_u32 v5, v150, v151, v5
    s_waitcnt vmcnt(5)
    v_mfma_f32_16x16x32_bf16 v[176:179], v[152:155], v[40:43], v[176:179]
    v_max3_u32 v5, v152, v153, v5
    v_max3_u32 v5, v154, v155, v5
    s_waitcnt vmcnt(4)
    v_mfma_f32_16x16x32_bf16 v[176:179], v[156:159], v[44:47], v[176:179]
    v_max3_u32 v5, v156, v157, v5
    v_max3_u32 v5, v158, v159, v5
    s_waitcnt vmcnt(0)
    v_max3_u32 v5, v160, v161, v5
    v_max3_u32 v5, v162, v163, v5
    v_max3_u32 v5, v164, v165, v5
    v_max3_u32 v5, v166, v167, v5
    v_cmp_eq_u32 vcc, -1, v5
    s_cbranch_vccnz L_x1_kw1
    buffer_load_dword v5, v189, s[8:11], s43 offen sc1
    buffer_load_dword v6, v3, s[8:11], s42 offen sc1
    v_max3_f32 v10, v10, v176, v177
    v_mov_b32 v11, v10
    s_nop 1
    v_permlane16_swap_b32 v10, v11
    s_nop 1
    v_max_f32 v10, v10, v11
    v_mov_b32 v11, v10
    s_nop 1
    v_permlane32_swap_b32 v10, v11
    s_nop 1
    v_max_f32 v10, v10, v11
    v_sub_f32 v176, v176, v10
    v_sub_f32 v177, v177, v10
    v_sub_f32 v168, v168, v10
    v_sub_f32 v169, v169, v10
    v_sub_f32 v170, v170, v10
    v_sub_f32 v171, v171, v10
    v_sub_f32 v172, v172, v10
    v_sub_f32 v173, v173, v10
    v_sub_f32 v174, v174, v10
    v_sub_f32 v175, v175, v10
    v_exp_f32 v176, v176
    v_exp_f32 v177, v177
    v_exp_f32 v168, v168
    v_exp_f32 v169, v169
    v_exp_f32 v170, v170
    v_exp_f32 v171, v171
    v_exp_f32 v172, v172
    v_exp_f32 v173, v173
    v_exp_f32 v174, v174
    v_exp_f32 v175, v175
    v_cvt_pk_bf16_f32 v184, v176, v177
    v_cvt_pk_bf16_f32 v187, v176, v177
    v_cvt_pk_bf16_f32 v182, v168, v169
    v_cvt_pk_bf16_f32 v183, v170, v171
    v_cvt_pk_bf16_f32 v180, v172, v173
    v_cvt_pk_bf16_f32 v181, v174, v175
    s_nop 1
    v_mfma_f32_16x16x32_bf16 v[192:195], v[80:83], v[180:183], 0
    v_add_f32 v10, v176, v177
    v_add_f32 v10, v10, v168
    v_mfma_f32_16x16x32_bf16 v[196:199], v[84:87], v[180:183], 0
    v_add_f32 v10, v10, v169
    v_add_f32 v10, v10, v170
    v_mfma_f32_16x16x32_bf16 v[200:203], v[88:91], v[180:183], 0
    v_add_f32 v10, v10, v171
    v_add_f32 v10, v10, v172
    v_mfma_f32_16x16x32_bf16 v[204:207], v[92:95], v[180:183], 0
    v_add_f32 v10, v10, v173
    v_add_f32 v10, v10, v174
    v_mfma_f32_16x16x32_bf16 v[208:211], v[96:99], v[180:183], 0
    v_add_f32 v10, v10, v175
    v_mov_b32 v11, v10
    v_mfma_f32_16x16x32_bf16 v[212:215], v[100:103], v[180:183], 0
    s_nop 1
    v_permlane16_swap_b32 v10, v11
    s_nop 1
    v_add_f32 v10, v10, v11
    v_mfma_f32_16x16x32_bf16 v[216:219], v[104:107], v[180:183], 0
    v_mov_b32 v11, v10
    s_nop 1
    v_permlane32_swap_b32 v10, v11
    v_mfma_f32_16x16x32_bf16 v[220:223], v[108:111], v[180:183], 0
    s_nop 1
    v_add_f32 v10, v10, v11
    v_rcp_f32 v10, v10
    v_mfma_f32_16x16x16_bf16 v[192:195], v[160:161], v[184:185], v[192:195]
    v_mfma_f32_16x16x16_bf16 v[196:199], v[160:161], v[186:187], v[196:199]
    v_mfma_f32_16x16x16_bf16 v[200:203], v[162:163], v[184:185], v[200:203]
    v_mfma_f32_16x16x16_bf16 v[204:207], v[162:163], v[186:187], v[204:207]
    v_mfma_f32_16x16x16_bf16 v[208:211], v[164:165], v[184:185], v[208:211]
    v_mfma_f32_16x16x16_bf16 v[212:215], v[164:165], v[186:187], v[212:215]
    v_mfma_f32_16x16x16_bf16 v[216:219], v[166:167], v[184:185], v[216:219]
    v_mfma_f32_16x16x16_bf16 v[220:223], v[166:167], v[186:187], v[220:223]
    s_waitcnt vmcnt(1)
    v_cmp_gt_u32 vcc, s46, v5
    v_mul_f32 v192, v10, v192
    v_mul_f32 v193, v10, v193
    v_mul_f32 v194, v10, v194
    v_mul_f32 v195, v10, v195
    v_mul_f32 v196, v10, v196
    v_mul_f32 v197, v10, v197
    v_mul_f32 v198, v10, v198
    v_mul_f32 v199, v10, v199
    v_cvt_pk_bf16_f32 v192, v192, v196
    v_cvt_pk_bf16_f32 v193, v193, v197
    v_cvt_pk_bf16_f32 v194, v194, v198
    v_cvt_pk_bf16_f32 v195, v195, v199
    s_cbranch_vccnz L_x1_bp1
L_x1_free1:
    s_cmp_eq_u32 s49, 0
    s_cbranch_scc1 L_far_65
    buffer_store_dwordx4 v[192:195], v1, s[8:11], s40 offen offset:0
L_join_66:
    v_mul_f32 v200, v10, v200
    v_mul_f32 v201, v10, v201
    v_mul_f32 v202, v10, v202
    v_mul_f32 v203, v10, v203
    v_mul_f32 v204, v10, v204
    v_mul_f32 v205, v10, v205
    v_mul_f32 v206, v10, v206
    v_mul_f32 v207, v10, v207
    v_cvt_pk_bf16_f32 v200, v200, v204
    v_cvt_pk_bf16_f32 v201, v201, v205
    v_cvt_pk_bf16_f32 v202, v202, v206
    v_cvt_pk_bf16_f32 v203, v203, v207
    s_cmp_eq_u32 s49, 0
    s_cbranch_scc1 L_far_67
    buffer_store_dwordx4 v[200:203], v1, s[8:11], s40 offen offset:1024
L_join_68:
    v_mul_f32 v208, v10, v208
    v_mul_f32 v209, v10, v209
    v_mul_f32 v210, v10, v210
    v_mul_f32 v211, v10, v211
    v_mul_f32 v212, v10, v212
    v_mul_f32 v213, v10, v213
    v_mul_f32 v214, v10, v214
    v_mul_f32 v215, v10, v215
    v_cvt_pk_bf16_f32 v208, v208, v212
    v_cvt_pk_bf16_f32 v209, v209, v213
    v_cvt_pk_bf16_f32 v210, v210, v214
    v_cvt_pk_bf16_f32 v211, v211, v215
    s_cmp_eq_u32 s49, 0
    s_cbranch_scc1 L_far_69
    buffer_store_dwordx4 v[208:211], v1, s[8:11], s40 offen offset:2048
L_join_70:
    v_mul_f32 v216, v10, v216
    v_mul_f32 v217, v10, v217
    v_mul_f32 v218, v10, v218
    v_mul_f32 v219, v10, v219
    v_mul_f32 v220, v10, v220
    v_mul_f32 v221, v10, v221
    v_mul_f32 v222, v10, v222
    v_mul_f32 v223, v10, v223
    v_cvt_pk_bf16_f32 v216, v216, v220
    v_cvt_pk_bf16_f32 v217, v217, v221
    v_cvt_pk_bf16_f32 v218, v218, v222
    v_cvt_pk_bf16_f32 v219, v219, v223
    s_cmp_eq_u32 s49, 0
    s_cbranch_scc1 L_far_71
    buffer_store_dwordx4 v[216:219], v1, s[8:11], s40 offen offset:3072
L_join_72:
    s_waitcnt vmcnt(0)
    v_mov_b32 v10, s41
    s_mov_b64 exec, 1
    s_cmp_eq_u32 s49, 0
    s_cbranch_scc1 L_far_73
    buffer_store_dword v10, v4, s[8:11], s44 offen
L_join_74:
    s_mov_b64 exec, -1
    s_cmp_eq_u32 s48, 1
    s_cbranch_scc1 L_x1_task0
    s_cmp_lt_u32 s34, s47
    s_cbranch_scc1 L_x1_pro
    s_branch L_bo
L_x1_fail:
    s_endpgm
L_x1_kw0:
    s_sleep 0
    s_branch L_x1_kv0
L_x1_bp0:
    s_mov_b32 s27, 0
L_poll_49:
    buffer_load_dword v5, v189, s[8:11], s43 offen sc1
    s_waitcnt vmcnt(0)
    v_cmp_gt_u32 vcc, s46, v5
    s_cbranch_vccz L_pollok_50
    s_sleep 1
    s_add_u32 s27, s27, 1
    s_cmp_lt_u32 s27, 200000
    s_cbranch_scc1 L_poll_49
    s_branch L_x1_fail
L_pollok_50:
    s_branch L_x1_free0
L_far_51:
    buffer_store_dwordx4 v[192:195], v1, s[8:11], s40 offen offset:0 sc1
    s_branch L_join_52
L_far_53:
    buffer_store_dwordx4 v[200:203], v1, s[8:11], s40 offen offset:1024 sc1
    s_branch L_join_54
L_far_55:
    buffer_store_dwordx4 v[208:211], v1, s[8:11], s40 offen offset:2048 sc1
    s_branch L_join_56
L_far_57:
    buffer_store_dwordx4 v[216:219], v1, s[8:11], s40 offen offset:3072 sc1
    s_branch L_join_58
L_far_59:
    buffer_store_dword v10, v4, s[8:11], s44 offen sc1
    s_branch L_join_60
L_x1_kw1:
    s_sleep 0
    s_branch L_x1_kv1
L_x1_bp1:
    s_mov_b32 s27, 0
L_poll_63:
    buffer_load_dword v5, v189, s[8:11], s43 offen sc1
    s_waitcnt vmcnt(0)
    v_cmp_gt_u32 vcc, s46, v5
    s_cbranch_vccz L_pollok_64
    s_sleep 1
    s_add_u32 s27, s27, 1
    s_cmp_lt_u32 s27, 200000
    s_cbranch_scc1 L_poll_63
    s_branch L_x1_fail
L_pollok_64:
    s_branch L_x1_free1
L_far_65:
    buffer_store_dwordx4 v[192:195], v1, s[8:11], s40 offen offset:0 sc1
    s_branch L_join_66
L_far_67:
    buffer_store_dwordx4 v[200:203], v1, s[8:11], s40 offen offset:1024 sc1
    s_branch L_join_68
L_far_69:
    buffer_store_dwordx4 v[208:211], v1, s[8:11], s40 offen offset:2048 sc1
    s_branch L_join_70
L_far_71:
    buffer_store_dwordx4 v[216:219], v1, s[8:11], s40 offen offset:3072 sc1
    s_branch L_join_72
L_far_73:
    buffer_store_dword v10, v4, s[8:11], s44 offen sc1
    s_branch L_join_74
L_bo:
    v_lshlrev_b32 v248, 4, v0
    v_mov_b32 v251, v248
    v_and_b32 v249, 31, v0
    v_lshlrev_b32 v249, 5, v249
    v_lshrrev_b32 v250, 4, v0
    v_and_b32 v252, 15, v0
    v_lshlrev_b32 v252, 10, v252
    v_lshl_add_u32 v252, v250, 4, v252
    s_mov_b32 s67, 1048576
    s_add_u32 s71, s63, 1
    s_lshl_b32 s95, s24, 12
    s_mov_b32 s66, s60
    s_load_dwordx2 s[4:5], s[0:1], 80
    s_waitcnt lgkmcnt(0)
    s_mov_b32 s20, s4
    s_mov_b32 s21, s5
    s_mov_b32 s22, 2097152
    s_mov_b32 s23, 0x20000
    s_min_u32 s94, s66, 127
    s_lshr_b32 s94, s94, 1
    s_lshl_b32 s94, s94, 10
    s_add_u32 s94, s94, 65536
    s_cmp_lg_u32 s24, 0
    s_cbranch_scc1 L_p1_75
    s_mov_b32 s27, 0
L_poll_76:
    buffer_load_dword v250, v249, s[8:11], s94 offen sc1
    s_waitcnt vmcnt(0)
    v_cmp_gt_u32 vcc, s71, v250
    s_cbranch_vccz L_pollok_77
    s_sleep 1
    s_add_u32 s27, s27, 1
    s_cmp_lt_u32 s27, 200000
    s_cbranch_scc1 L_poll_76
    s_branch L_bo_fail
L_pollok_77:
L_p1_75:
    s_barrier
    s_branch L_bo_fetch
L_bo_loop:
    s_cmp_eq_u32 s96, 1
    s_cbranch_scc1 L_bo_have
    s_min_u32 s94, s66, 127
    s_lshr_b32 s94, s94, 1
    s_lshl_b32 s94, s94, 10
    s_add_u32 s94, s94, 65536
    s_mov_b32 s27, 0
L_poll_78:
    buffer_load_dword v250, v249, s[8:11], s94 offen sc1
    s_waitcnt vmcnt(0)
    v_cmp_gt_u32 vcc, s71, v250
    s_cbranch_vccz L_pollok_79
    s_sleep 1
    s_add_u32 s27, s27, 1
    s_cmp_lt_u32 s27, 200000
    s_cbranch_scc1 L_poll_78
    s_branch L_bo_fail
L_pollok_79:
L_bo_fetch:
    s_lshl_b32 s30, s66, 14
    s_add_u32 s30, s30, s67
    s_lshl_b32 s31, s24, 12
    s_add_u32 s68, s30, s31
    s_add_u32 s68, s68, 69206016
    s_mov_b32 m0, s95
    s_lshl_b32 s31, s62, 13
    s_add_u32 s30, s30, s31
    buffer_load_dwordx4 v248, s[8:11], s68 offen offset:0 sc1 lds
    buffer_load_dwordx4 v248, s[8:11], s68 offen offset:1024 sc1 lds
    buffer_load_dwordx4 v248, s[8:11], s68 offen offset:2048 sc1 lds
    buffer_load_dwordx4 v248, s[8:11], s68 offen offset:3072 sc1 lds
    s_lshl_b32 s31, s24, 11
    s_add_u32 s30, s30, s31
    s_add_u32 s30, s30, 60817408
    s_xor_b32 s95, s95, 0x4000
    buffer_load_dwordx4 v[240:243], v248, s[8:11], s30 offen offset:0 sc1
    buffer_load_dwordx4 v[244:247], v248, s[8:11], s30 offen offset:1024 sc1
    s_add_u32 s30, s66, s61
    s_min_u32 s94, s30, 127
    s_lshr_b32 s94, s94, 1
    s_lshl_b32 s94, s94, 10
    s_add_u32 s94, s94, 65536
    buffer_load_dword v250, v249, s[8:11], s94 offen sc1
    s_waitcnt vmcnt(0)
    s_branch L_bo_go
L_bo_have:
    s_waitcnt vmcnt(2)
L_bo_go:
    v_cmp_gt_u32 vcc, s71, v250
    s_barrier
    ds_read_b128 v[200:203], v251 offset:0
    ds_read_b128 v[204:207], v251 offset:1024
    ds_read_b128 v[208:211], v251 offset:2048
    v_mov_b64 v[232:233], v[240:241]
    v_mov_b64 v[234:235], v[242:243]
    v_mov_b64 v[236:237], v[244:245]
    v_mov_b64 v[238:239], v[246:247]
    s_waitcnt lgkmcnt(2)
    v_mfma_f32_16x16x32_bf16 v[216:219], a[0:3], v[200:203], 0
    ds_read_b128 v[212:215], v251 offset:3072
    v_mfma_f32_16x16x32_bf16 v[220:223], a[4:7], v[200:203], 0
    v_mfma_f32_16x16x32_bf16 v[224:227], a[8:11], v[200:203], 0
    v_mfma_f32_16x16x32_bf16 v[228:231], a[12:15], v[200:203], 0
    s_add_u32 s97, s66, s61
    s_mov_b32 s96, 0
    s_cmp_lt_u32 s97, s64
    s_cbranch_scc0 L_bo_nopf
    s_cbranch_vccnz L_bo_nopf
    s_mov_b32 s96, 1
    s_lshl_b32 s30, s97, 14
    s_add_u32 s30, s30, s67
    s_lshl_b32 s31, s24, 12
    s_add_u32 s68, s30, s31
    s_add_u32 s68, s68, 69206016
    s_mov_b32 m0, s95
    s_lshl_b32 s31, s62, 13
    s_add_u32 s30, s30, s31
    buffer_load_dwordx4 v248, s[8:11], s68 offen offset:0 sc1 lds
    buffer_load_dwordx4 v248, s[8:11], s68 offen offset:1024 sc1 lds
    buffer_load_dwordx4 v248, s[8:11], s68 offen offset:2048 sc1 lds
    buffer_load_dwordx4 v248, s[8:11], s68 offen offset:3072 sc1 lds
    s_lshl_b32 s31, s24, 11
    s_add_u32 s30, s30, s31
    s_add_u32 s30, s30, 60817408
    s_xor_b32 s95, s95, 0x4000
    buffer_load_dwordx4 v[240:243], v248, s[8:11], s30 offen offset:0 sc1
    buffer_load_dwordx4 v[244:247], v248, s[8:11], s30 offen offset:1024 sc1
    s_add_u32 s30, s97, s61
    s_min_u32 s94, s30, 127
    s_lshr_b32 s94, s94, 1
    s_lshl_b32 s94, s94, 10
    s_add_u32 s94, s94, 65536
    buffer_load_dword v250, v249, s[8:11], s94 offen sc1
L_bo_nopf:
    s_waitcnt lgkmcnt(2)
    v_mfma_f32_16x16x32_bf16 v[216:219], a[16:19], v[204:207], v[216:219]
    ds_read_b128 v[200:203], v251 offset:4096
    v_mfma_f32_16x16x32_bf16 v[220:223], a[20:23], v[204:207], v[220:223]
    v_mfma_f32_16x16x32_bf16 v[224:227], a[24:27], v[204:207], v[224:227]
    v_mfma_f32_16x16x32_bf16 v[228:231], a[28:31], v[204:207], v[228:231]
    s_waitcnt lgkmcnt(2)
    v_mfma_f32_16x16x32_bf16 v[216:219], a[32:35], v[208:211], v[216:219]
    ds_read_b128 v[204:207], v251 offset:5120
    v_mfma_f32_16x16x32_bf16 v[220:223], a[36:39], v[208:211], v[220:223]
    v_mfma_f32_16x16x32_bf16 v[224:227], a[40:43], v[208:211], v[224:227]
    v_mfma_f32_16x16x32_bf16 v[228:231], a[44:47], v[208:211], v[228:231]
    s_waitcnt lgkmcnt(2)
    v_mfma_f32_16x16x32_bf16 v[216:219], a[48:51], v[212:215], v[216:219]
    ds_read_b128 v[208:211], v251 offset:6144
    v_mfma_f32_16x16x32_bf16 v[220:223], a[52:55], v[212:215], v[220:223]
    v_mfma_f32_16x16x32_bf16 v[224:227], a[56:59], v[212:215], v[224:227]
    v_mfma_f32_16x16x32_bf16 v[228:231], a[60:63], v[212:215], v[228:231]
    s_waitcnt lgkmcnt(2)
    v_mfma_f32_16x16x32_bf16 v[216:219], a[64:67], v[200:203], v[216:219]
    ds_read_b128 v[212:215], v251 offset:7168
    v_mfma_f32_16x16x32_bf16 v[220:223], a[68:71], v[200:203], v[220:223]
    v_mfma_f32_16x16x32_bf16 v[224:227], a[72:75], v[200:203], v[224:227]
    v_mfma_f32_16x16x32_bf16 v[228:231], a[76:79], v[200:203], v[228:231]
    s_waitcnt lgkmcnt(2)
    v_mfma_f32_16x16x32_bf16 v[216:219], a[80:83], v[204:207], v[216:219]
    ds_read_b128 v[200:203], v251 offset:8192
    v_mfma_f32_16x16x32_bf16 v[220:223], a[84:87], v[204:207], v[220:223]
    v_mfma_f32_16x16x32_bf16 v[224:227], a[88:91], v[204:207], v[224:227]
    v_mfma_f32_16x16x32_bf16 v[228:231], a[92:95], v[204:207], v[228:231]
    s_waitcnt lgkmcnt(2)
    v_mfma_f32_16x16x32_bf16 v[216:219], a[96:99], v[208:211], v[216:219]
    ds_read_b128 v[204:207], v251 offset:9216
    v_mfma_f32_16x16x32_bf16 v[220:223], a[100:103], v[208:211], v[220:223]
    v_mfma_f32_16x16x32_bf16 v[224:227], a[104:107], v[208:211], v[224:227]
    v_mfma_f32_16x16x32_bf16 v[228:231], a[108:111], v[208:211], v[228:231]
    s_waitcnt lgkmcnt(2)
    v_mfma_f32_16x16x32_bf16 v[216:219], a[112:115], v[212:215], v[216:219]
    ds_read_b128 v[208:211], v251 offset:10240
    v_mfma_f32_16x16x32_bf16 v[220:223], a[116:119], v[212:215], v[220:223]
    v_mfma_f32_16x16x32_bf16 v[224:227], a[120:123], v[212:215], v[224:227]
    v_mfma_f32_16x16x32_bf16 v[228:231], a[124:127], v[212:215], v[228:231]
    s_waitcnt lgkmcnt(2)
    v_mfma_f32_16x16x32_bf16 v[216:219], a[128:131], v[200:203], v[216:219]
    ds_read_b128 v[212:215], v251 offset:11264
    v_mfma_f32_16x16x32_bf16 v[220:223], a[132:135], v[200:203], v[220:223]
    v_mfma_f32_16x16x32_bf16 v[224:227], a[136:139], v[200:203], v[224:227]
    v_mfma_f32_16x16x32_bf16 v[228:231], a[140:143], v[200:203], v[228:231]
    s_waitcnt lgkmcnt(2)
    v_mfma_f32_16x16x32_bf16 v[216:219], a[144:147], v[204:207], v[216:219]
    ds_read_b128 v[200:203], v251 offset:12288
    v_mfma_f32_16x16x32_bf16 v[220:223], a[148:151], v[204:207], v[220:223]
    v_mfma_f32_16x16x32_bf16 v[224:227], a[152:155], v[204:207], v[224:227]
    v_mfma_f32_16x16x32_bf16 v[228:231], a[156:159], v[204:207], v[228:231]
    s_waitcnt lgkmcnt(2)
    v_mfma_f32_16x16x32_bf16 v[216:219], a[160:163], v[208:211], v[216:219]
    ds_read_b128 v[204:207], v251 offset:13312
    v_mfma_f32_16x16x32_bf16 v[220:223], a[164:167], v[208:211], v[220:223]
    v_mfma_f32_16x16x32_bf16 v[224:227], a[168:171], v[208:211], v[224:227]
    v_mfma_f32_16x16x32_bf16 v[228:231], a[172:175], v[208:211], v[228:231]
    s_waitcnt lgkmcnt(2)
    v_mfma_f32_16x16x32_bf16 v[216:219], a[176:179], v[212:215], v[216:219]
    ds_read_b128 v[208:211], v251 offset:14336
    v_mfma_f32_16x16x32_bf16 v[220:223], a[180:183], v[212:215], v[220:223]
    v_mfma_f32_16x16x32_bf16 v[224:227], a[184:187], v[212:215], v[224:227]
    v_mfma_f32_16x16x32_bf16 v[228:231], a[188:191], v[212:215], v[228:231]
    s_waitcnt lgkmcnt(2)
    v_mfma_f32_16x16x32_bf16 v[216:219], a[192:195], v[200:203], v[216:219]
    ds_read_b128 v[212:215], v251 offset:15360
    v_mfma_f32_16x16x32_bf16 v[220:223], a[196:199], v[200:203], v[220:223]
    v_mfma_f32_16x16x32_bf16 v[224:227], a[200:203], v[200:203], v[224:227]
    v_mfma_f32_16x16x32_bf16 v[228:231], a[204:207], v[200:203], v[228:231]
    s_waitcnt lgkmcnt(2)
    v_mfma_f32_16x16x32_bf16 v[216:219], a[208:211], v[204:207], v[216:219]
    v_mfma_f32_16x16x32_bf16 v[220:223], a[212:215], v[204:207], v[220:223]
    v_mfma_f32_16x16x32_bf16 v[224:227], a[216:219], v[204:207], v[224:227]
    v_mfma_f32_16x16x32_bf16 v[228:231], a[220:223], v[204:207], v[228:231]
    s_waitcnt lgkmcnt(1)
    v_mfma_f32_16x16x32_bf16 v[216:219], a[224:227], v[208:211], v[216:219]
    v_mfma_f32_16x16x32_bf16 v[220:223], a[228:231], v[208:211], v[220:223]
    v_mfma_f32_16x16x32_bf16 v[224:227], a[232:235], v[208:211], v[224:227]
    v_mfma_f32_16x16x32_bf16 v[228:231], a[236:239], v[208:211], v[228:231]
    s_waitcnt lgkmcnt(0)
    v_mfma_f32_16x16x32_bf16 v[216:219], a[240:243], v[212:215], v[216:219]
    v_mfma_f32_16x16x32_bf16 v[220:223], a[244:247], v[212:215], v[220:223]
    v_mfma_f32_16x16x32_bf16 v[224:227], a[248:251], v[212:215], v[224:227]
    v_mfma_f32_16x16x32_bf16 v[228:231], a[252:255], v[212:215], v[228:231]
    v_xor_b32 v251, 0x4000, v251
    s_lshl_b32 s30, s66, 14
    s_nop 2
    v_lshlrev_b32 v200, 16, v232
    v_and_b32 v201, 0xffff0000, v232
    v_add_f32 v216, v216, v200
    v_add_f32 v220, v220, v201
    v_cvt_pk_bf16_f32 v232, v216, v220
    v_lshlrev_b32 v200, 16, v233
    v_and_b32 v201, 0xffff0000, v233
    v_add_f32 v217, v217, v200
    v_add_f32 v221, v221, v201
    v_cvt_pk_bf16_f32 v233, v217, v221
    v_lshlrev_b32 v200, 16, v234
    v_and_b32 v201, 0xffff0000, v234
    v_add_f32 v218, v218, v200
    v_add_f32 v222, v222, v201
    v_cvt_pk_bf16_f32 v234, v218, v222
    v_lshlrev_b32 v200, 16, v235
    v_and_b32 v201, 0xffff0000, v235
    v_add_f32 v219, v219, v200
    v_add_f32 v223, v223, v201
    v_cvt_pk_bf16_f32 v235, v219, v223
    v_lshlrev_b32 v200, 16, v236
    v_and_b32 v201, 0xffff0000, v236
    v_add_f32 v224, v224, v200
    v_add_f32 v228, v228, v201
    v_cvt_pk_bf16_f32 v236, v224, v228
    v_lshlrev_b32 v200, 16, v237
    v_and_b32 v201, 0xffff0000, v237
    v_add_f32 v225, v225, v200
    v_add_f32 v229, v229, v201
    v_cvt_pk_bf16_f32 v237, v225, v229
    v_lshlrev_b32 v200, 16, v238
    v_and_b32 v201, 0xffff0000, v238
    v_add_f32 v226, v226, v200
    v_add_f32 v230, v230, v201
    v_cvt_pk_bf16_f32 v238, v226, v230
    v_lshlrev_b32 v200, 16, v239
    v_and_b32 v201, 0xffff0000, v239
    v_add_f32 v227, v227, v200
    v_add_f32 v231, v231, v201
    v_cvt_pk_bf16_f32 v239, v227, v231
    s_cmp_eq_u32 s63, 0
    s_cbranch_scc1 L_bo_mid
    s_lshl_b32 s31, s62, 9
    s_add_u32 s30, s30, s31
    s_lshl_b32 s31, s24, 7
    s_add_u32 s30, s30, s31
    buffer_store_dwordx4 v[232:235], v252, s[20:23], s30 offen
    buffer_store_dwordx4 v[236:239], v252, s[20:23], s30 offen offset:64
    s_branch L_bo_next
L_bo_mid:
    s_lshl_b32 s31, s62, 13
    s_add_u32 s30, s30, s31
    s_lshl_b32 s31, s24, 11
    s_add_u32 s30, s30, s31
    s_add_u32 s30, s30, 72351744
    buffer_store_dwordx4 v[232:235], v248, s[8:11], s30 offen sc1
    buffer_store_dwordx4 v[236:239], v248, s[8:11], s30 offen offset:1024 sc1
    s_lshl_b32 s30, s66, 7
    s_lshl_b32 s31, s62, 2
    s_add_u32 s30, s30, s31
    s_add_u32 s30, s30, 16384
    s_cmp_lg_u32 s24, 1
    s_waitcnt vmcnt(0)
    s_barrier
    s_cbranch_scc1 L_bo_next
    v_mov_b32 v200, 1
    s_mov_b64 exec, 1
    buffer_store_dword v200, v249, s[8:11], s30 offen sc1
    s_mov_b64 exec, -1
L_bo_next:
    s_mov_b32 s66, s97
    s_cmp_lt_u32 s66, s64
    s_cbranch_scc1 L_bo_loop
    s_cmp_eq_u32 s101, 1
    s_cbranch_scc1 L_x1_second
    s_cmp_eq_u32 s101, 2
    s_cbranch_scc0 L_bo_fail
    s_branch L_b_second
L_bo_fail:
    s_endpgm
L_role_x2:
    s_lshr_b32 s32, s25, 5
    s_sub_u32 s32, s32, 5
    s_and_b32 s33, s25, 31
    s_sub_u32 s33, s33, 0
    v_lshlrev_b32 v1, 4, v0
    v_lshrrev_b32 v10, 4, v0
    v_and_b32 v11, 15, v0
    v_lshlrev_b32 v4, 13, v10
    v_lshl_add_u32 v4, v11, 2, v4
    s_lshl_b32 s30, s24, 20
    s_lshl_b32 s31, s33, 6
    s_add_u32 s30, s30, s31
    v_add_u32 v4, s30, v4
    v_add_u32 v5, 0x400, v4
    v_lshlrev_b32 v6, 10, v11
    v_lshl_add_u32 v6, v10, 4, v6
    v_add_u32 v6, s31, v6
    s_lshl_b32 s30, s24, 11
    v_add_u32 v7, s30, v1
    v_mov_b32 v8, v1
    v_and_b32 v2, 7, v0
    v_lshlrev_b32 v2, 2, v2
    s_lshl_b32 s30, s32, 7
    s_lshl_b32 s31, s24, 5
    s_add_u32 s39, s30, s31
    s_add_u32 s39, s39, 8192
    s_add_u32 s44, s30, 4096
    s_lshl_b32 s31, s33, 2
    s_add_u32 s40, s30, s31
    s_add_u32 s40, s40, 8704
    s_mov_b32 s34, s32
    s_load_dwordx2 s[4:5], s[0:1], 40
    s_waitcnt lgkmcnt(0)
    s_mov_b32 s16, s4
    s_mov_b32 s17, s5
    s_mov_b32 s18, 4194304
    s_mov_b32 s19, 0x20000
    s_lshl_b32 s92, s24, 20
    s_lshl_b32 s31, s33, 6
    s_add_u32 s92, s92, s31
    s_lshl_b32 s93, s24, 15
    v_bfe_u32 v16, v0, 3, 1
    v_mul_u32_u24 v4, 16, v16
    v_bfe_u32 v16, v0, 2, 1
    v_mul_u32_u24 v16, 8, v16
    v_add_u32 v4, v4, v16
    v_bfe_u32 v16, v0, 4, 1
    v_add_u32 v4, v4, v16
    v_lshrrev_b32 v16, 5, v0
    v_mul_u32_u24 v16, 2, v16
    v_add_u32 v4, v4, v16
    v_mul_u32_u24 v4, 1024, v4
    v_and_b32 v16, 3, v0
    v_lshl_add_u32 v4, v16, 4, v4
    v_add_u32 v4, s92, v4
    v_lshlrev_b32 v5, 2, v0
    v_add_u32 v5, s93, v5
    s_add_u32 m0, s93, 0
    s_mov_b32 s30, 0
    buffer_load_dwordx4 v4, s[16:19], s30 offen  lds
    s_add_u32 m0, s93, 1024
    s_mov_b32 s30, 4096
    buffer_load_dwordx4 v4, s[16:19], s30 offen  lds
    s_add_u32 m0, s93, 2048
    s_mov_b32 s30, 32768
    buffer_load_dwordx4 v4, s[16:19], s30 offen  lds
    s_add_u32 m0, s93, 3072
    s_mov_b32 s30, 36864
    buffer_load_dwordx4 v4, s[16:19], s30 offen  lds
    s_add_u32 m0, s93, 4096
    s_mov_b32 s30, 65536
    buffer_load_dwordx4 v4, s[16:19], s30 offen  lds
    s_add_u32 m0, s93, 5120
    s_mov_b32 s30, 69632
    buffer_load_dwordx4 v4, s[16:19], s30 offen  lds
    s_add_u32 m0, s93, 6144
    s_mov_b32 s30, 98304
    buffer_load_dwordx4 v4, s[16:19], s30 offen  lds
    s_add_u32 m0, s93, 7168
    s_mov_b32 s30, 102400
    buffer_load_dwordx4 v4, s[16:19], s30 offen  lds
    s_add_u32 m0, s93, 8192
    s_mov_b32 s30, 131072
    buffer_load_dwordx4 v4, s[16:19], s30 offen  lds
    s_add_u32 m0, s93, 9216
    s_mov_b32 s30, 135168
    buffer_load_dwordx4 v4, s[16:19], s30 offen  lds
    s_add_u32 m0, s93, 10240
    s_mov_b32 s30, 163840
    buffer_load_dwordx4 v4, s[16:19], s30 offen  lds
    s_add_u32 m0, s93, 11264
    s_mov_b32 s30, 167936
    buffer_load_dwordx4 v4, s[16:19], s30 offen  lds
    s_add_u32 m0, s93, 12288
    s_mov_b32 s30, 196608
    buffer_load_dwordx4 v4, s[16:19], s30 offen  lds
    s_add_u32 m0, s93, 13312
    s_mov_b32 s30, 200704
    buffer_load_dwordx4 v4, s[16:19], s30 offen  lds
    s_add_u32 m0, s93, 14336
    s_mov_b32 s30, 229376
    buffer_load_dwordx4 v4, s[16:19], s30 offen  lds
    s_add_u32 m0, s93, 15360
    s_mov_b32 s30, 233472
    buffer_load_dwordx4 v4, s[16:19], s30 offen  lds
    s_add_u32 m0, s93, 16384
    s_mov_b32 s30, 262144
    buffer_load_dwordx4 v4, s[16:19], s30 offen  lds
    s_add_u32 m0, s93, 17408
    s_mov_b32 s30, 266240
    buffer_load_dwordx4 v4, s[16:19], s30 offen  lds
    s_add_u32 m0, s93, 18432
    s_mov_b32 s30, 294912
    buffer_load_dwordx4 v4, s[16:19], s30 offen  lds
    s_add_u32 m0, s93, 19456
    s_mov_b32 s30, 299008
    buffer_load_dwordx4 v4, s[16:19], s30 offen  lds
    s_add_u32 m0, s93, 20480
    s_mov_b32 s30, 327680
    buffer_load_dwordx4 v4, s[16:19], s30 offen  lds
    s_add_u32 m0, s93, 21504
    s_mov_b32 s30, 331776
    buffer_load_dwordx4 v4, s[16:19], s30 offen  lds
    s_add_u32 m0, s93, 22528
    s_mov_b32 s30, 360448
    buffer_load_dwordx4 v4, s[16:19], s30 offen  lds
    s_add_u32 m0, s93, 23552
    s_mov_b32 s30, 364544
    buffer_load_dwordx4 v4, s[16:19], s30 offen  lds
    s_add_u32 m0, s93, 24576
    s_mov_b32 s30, 393216
    buffer_load_dwordx4 v4, s[16:19], s30 offen  lds
    s_add_u32 m0, s93, 25600
    s_mov_b32 s30, 397312
    buffer_load_dwordx4 v4, s[16:19], s30 offen  lds
    s_add_u32 m0, s93, 26624
    s_mov_b32 s30, 425984
    buffer_load_dwordx4 v4, s[16:19], s30 offen  lds
    s_add_u32 m0, s93, 27648
    s_mov_b32 s30, 430080
    buffer_load_dwordx4 v4, s[16:19], s30 offen  lds
    s_add_u32 m0, s93, 28672
    s_mov_b32 s30, 458752
    buffer_load_dwordx4 v4, s[16:19], s30 offen  lds
    s_add_u32 m0, s93, 29696
    s_mov_b32 s30, 462848
    buffer_load_dwordx4 v4, s[16:19], s30 offen  lds
    s_waitcnt vmcnt(29)
    ds_read2st64_b32 v[16:17], v5 offset0:0 offset1:1
    ds_read2st64_b32 v[18:19], v5 offset0:2 offset1:3
    s_add_u32 m0, s93, 30720
    s_mov_b32 s30, 491520
    buffer_load_dwordx4 v4, s[16:19], s30 offen  lds
    s_waitcnt vmcnt(29)
    ds_read2st64_b32 v[20:21], v5 offset0:4 offset1:5
    ds_read2st64_b32 v[22:23], v5 offset0:6 offset1:7
    s_waitcnt lgkmcnt(2)
    v_perm_b32 v32, v17, v16, s28
    v_accvgpr_write_b32 a0, v32
    v_perm_b32 v33, v17, v16, s29
    v_accvgpr_write_b32 a4, v33
    v_perm_b32 v32, v19, v18, s28
    v_accvgpr_write_b32 a1, v32
    v_perm_b32 v33, v19, v18, s29
    v_accvgpr_write_b32 a5, v33
    s_add_u32 m0, s93, 31744
    s_mov_b32 s30, 495616
    buffer_load_dwordx4 v4, s[16:19], s30 offen  lds
    s_waitcnt vmcnt(29)
    ds_read2st64_b32 v[24:25], v5 offset0:8 offset1:9
    ds_read2st64_b32 v[26:27], v5 offset0:10 offset1:11
    s_waitcnt lgkmcnt(2)
    v_perm_b32 v32, v21, v20, s28
    v_accvgpr_write_b32 a2, v32
    v_perm_b32 v33, v21, v20, s29
    v_accvgpr_write_b32 a6, v33
    v_perm_b32 v32, v23, v22, s28
    v_accvgpr_write_b32 a3, v32
    v_perm_b32 v33, v23, v22, s29
    v_accvgpr_write_b32 a7, v33
    s_add_u32 m0, s93, 0
    s_mov_b32 s30, 524288
    buffer_load_dwordx4 v4, s[16:19], s30 offen  lds
    s_waitcnt vmcnt(29)
    ds_read2st64_b32 v[28:29], v5 offset0:12 offset1:13
    ds_read2st64_b32 v[30:31], v5 offset0:14 offset1:15
    s_waitcnt lgkmcnt(2)
    v_perm_b32 v32, v25, v24, s28
    v_accvgpr_write_b32 a8, v32
    v_perm_b32 v33, v25, v24, s29
    v_accvgpr_write_b32 a12, v33
    v_perm_b32 v32, v27, v26, s28
    v_accvgpr_write_b32 a9, v32
    v_perm_b32 v33, v27, v26, s29
    v_accvgpr_write_b32 a13, v33
    s_add_u32 m0, s93, 1024
    s_mov_b32 s30, 528384
    buffer_load_dwordx4 v4, s[16:19], s30 offen  lds
    s_waitcnt vmcnt(29)
    ds_read2st64_b32 v[16:17], v5 offset0:16 offset1:17
    ds_read2st64_b32 v[18:19], v5 offset0:18 offset1:19
    s_waitcnt lgkmcnt(2)
    v_perm_b32 v32, v29, v28, s28
    v_accvgpr_write_b32 a10, v32
    v_perm_b32 v33, v29, v28, s29
    v_accvgpr_write_b32 a14, v33
    v_perm_b32 v32, v31, v30, s28
    v_accvgpr_write_b32 a11, v32
    v_perm_b32 v33, v31, v30, s29
    v_accvgpr_write_b32 a15, v33
    s_add_u32 m0, s93, 2048
    s_mov_b32 s30, 557056
    buffer_load_dwordx4 v4, s[16:19], s30 offen  lds
    s_waitcnt vmcnt(29)
    ds_read2st64_b32 v[20:21], v5 offset0:20 offset1:21
    ds_read2st64_b32 v[22:23], v5 offset0:22 offset1:23
    s_waitcnt lgkmcnt(2)
    v_perm_b32 v32, v17, v16, s28
    v_accvgpr_write_b32 a16, v32
    v_perm_b32 v33, v17, v16, s29
    v_accvgpr_write_b32 a20, v33
    v_perm_b32 v32, v19, v18, s28
    v_accvgpr_write_b32 a17, v32
    v_perm_b32 v33, v19, v18, s29
    v_accvgpr_write_b32 a21, v33
    s_add_u32 m0, s93, 3072
    s_mov_b32 s30, 561152
    buffer_load_dwordx4 v4, s[16:19], s30 offen  lds
    s_waitcnt vmcnt(29)
    ds_read2st64_b32 v[24:25], v5 offset0:24 offset1:25
    ds_read2st64_b32 v[26:27], v5 offset0:26 offset1:27
    s_waitcnt lgkmcnt(2)
    v_perm_b32 v32, v21, v20, s28
    v_accvgpr_write_b32 a18, v32
    v_perm_b32 v33, v21, v20, s29
    v_accvgpr_write_b32 a22, v33
    v_perm_b32 v32, v23, v22, s28
    v_accvgpr_write_b32 a19, v32
    v_perm_b32 v33, v23, v22, s29
    v_accvgpr_write_b32 a23, v33
    s_add_u32 m0, s93, 4096
    s_mov_b32 s30, 589824
    buffer_load_dwordx4 v4, s[16:19], s30 offen  lds
    s_waitcnt vmcnt(29)
    ds_read2st64_b32 v[28:29], v5 offset0:28 offset1:29
    ds_read2st64_b32 v[30:31], v5 offset0:30 offset1:31
    s_waitcnt lgkmcnt(2)
    v_perm_b32 v32, v25, v24, s28
    v_accvgpr_write_b32 a24, v32
    v_perm_b32 v33, v25, v24, s29
    v_accvgpr_write_b32 a28, v33
    v_perm_b32 v32, v27, v26, s28
    v_accvgpr_write_b32 a25, v32
    v_perm_b32 v33, v27, v26, s29
    v_accvgpr_write_b32 a29, v33
    s_add_u32 m0, s93, 5120
    s_mov_b32 s30, 593920
    buffer_load_dwordx4 v4, s[16:19], s30 offen  lds
    s_waitcnt vmcnt(29)
    ds_read2st64_b32 v[16:17], v5 offset0:32 offset1:33
    ds_read2st64_b32 v[18:19], v5 offset0:34 offset1:35
    s_waitcnt lgkmcnt(2)
    v_perm_b32 v32, v29, v28, s28
    v_accvgpr_write_b32 a26, v32
    v_perm_b32 v33, v29, v28, s29
    v_accvgpr_write_b32 a30, v33
    v_perm_b32 v32, v31, v30, s28
    v_accvgpr_write_b32 a27, v32
    v_perm_b32 v33, v31, v30, s29
    v_accvgpr_write_b32 a31, v33
    s_add_u32 m0, s93, 6144
    s_mov_b32 s30, 622592
    buffer_load_dwordx4 v4, s[16:19], s30 offen  lds
    s_waitcnt vmcnt(29)
    ds_read2st64_b32 v[20:21], v5 offset0:36 offset1:37
    ds_read2st64_b32 v[22:23], v5 offset0:38 offset1:39
    s_waitcnt lgkmcnt(2)
    v_perm_b32 v32, v17, v16, s28
    v_accvgpr_write_b32 a32, v32
    v_perm_b32 v33, v17, v16, s29
    v_accvgpr_write_b32 a36, v33
    v_perm_b32 v32, v19, v18, s28
    v_accvgpr_write_b32 a33, v32
    v_perm_b32 v33, v19, v18, s29
    v_accvgpr_write_b32 a37, v33
    s_add_u32 m0, s93, 7168
    s_mov_b32 s30, 626688
    buffer_load_dwordx4 v4, s[16:19], s30 offen  lds
    s_waitcnt vmcnt(29)
    ds_read2st64_b32 v[24:25], v5 offset0:40 offset1:41
    ds_read2st64_b32 v[26:27], v5 offset0:42 offset1:43
    s_waitcnt lgkmcnt(2)
    v_perm_b32 v32, v21, v20, s28
    v_accvgpr_write_b32 a34, v32
    v_perm_b32 v33, v21, v20, s29
    v_accvgpr_write_b32 a38, v33
    v_perm_b32 v32, v23, v22, s28
    v_accvgpr_write_b32 a35, v32
    v_perm_b32 v33, v23, v22, s29
    v_accvgpr_write_b32 a39, v33
    s_add_u32 m0, s93, 8192
    s_mov_b32 s30, 655360
    buffer_load_dwordx4 v4, s[16:19], s30 offen  lds
    s_waitcnt vmcnt(29)
    ds_read2st64_b32 v[28:29], v5 offset0:44 offset1:45
    ds_read2st64_b32 v[30:31], v5 offset0:46 offset1:47
    s_waitcnt lgkmcnt(2)
    v_perm_b32 v32, v25, v24, s28
    v_accvgpr_write_b32 a40, v32
    v_perm_b32 v33, v25, v24, s29
    v_accvgpr_write_b32 a44, v33
    v_perm_b32 v32, v27, v26, s28
    v_accvgpr_write_b32 a41, v32
    v_perm_b32 v33, v27, v26, s29
    v_accvgpr_write_b32 a45, v33
    s_add_u32 m0, s93, 9216
    s_mov_b32 s30, 659456
    buffer_load_dwordx4 v4, s[16:19], s30 offen  lds
    s_waitcnt vmcnt(29)
    ds_read2st64_b32 v[16:17], v5 offset0:48 offset1:49
    ds_read2st64_b32 v[18:19], v5 offset0:50 offset1:51
    s_waitcnt lgkmcnt(2)
    v_perm_b32 v32, v29, v28, s28
    v_accvgpr_write_b32 a42, v32
    v_perm_b32 v33, v29, v28, s29
    v_accvgpr_write_b32 a46, v33
    v_perm_b32 v32, v31, v30, s28
    v_accvgpr_write_b32 a43, v32
    v_perm_b32 v33, v31, v30, s29
    v_accvgpr_write_b32 a47, v33
    s_add_u32 m0, s93, 10240
    s_mov_b32 s30, 688128
    buffer_load_dwordx4 v4, s[16:19], s30 offen  lds
    s_waitcnt vmcnt(29)
    ds_read2st64_b32 v[20:21], v5 offset0:52 offset1:53
    ds_read2st64_b32 v[22:23], v5 offset0:54 offset1:55
    s_waitcnt lgkmcnt(2)
    v_perm_b32 v32, v17, v16, s28
    v_accvgpr_write_b32 a48, v32
    v_perm_b32 v33, v17, v16, s29
    v_accvgpr_write_b32 a52, v33
    v_perm_b32 v32, v19, v18, s28
    v_accvgpr_write_b32 a49, v32
    v_perm_b32 v33, v19, v18, s29
    v_accvgpr_write_b32 a53, v33
    s_add_u32 m0, s93, 11264
    s_mov_b32 s30, 692224
    buffer_load_dwordx4 v4, s[16:19], s30 offen  lds
    s_waitcnt vmcnt(29)
    ds_read2st64_b32 v[24:25], v5 offset0:56 offset1:57
    ds_read2st64_b32 v[26:27], v5 offset0:58 offset1:59
    s_waitcnt lgkmcnt(2)
    v_perm_b32 v32, v21, v20, s28
    v_accvgpr_write_b32 a50, v32
    v_perm_b32 v33, v21, v20, s29
    v_accvgpr_write_b32 a54, v33
    v_perm_b32 v32, v23, v22, s28
    v_accvgpr_write_b32 a51, v32
    v_perm_b32 v33, v23, v22, s29
    v_accvgpr_write_b32 a55, v33
    s_add_u32 m0, s93, 12288
    s_mov_b32 s30, 720896
    buffer_load_dwordx4 v4, s[16:19], s30 offen  lds
    s_waitcnt vmcnt(29)
    ds_read2st64_b32 v[28:29], v5 offset0:60 offset1:61
    ds_read2st64_b32 v[30:31], v5 offset0:62 offset1:63
    s_waitcnt lgkmcnt(2)
    v_perm_b32 v32, v25, v24, s28
    v_accvgpr_write_b32 a56, v32
    v_perm_b32 v33, v25, v24, s29
    v_accvgpr_write_b32 a60, v33
    v_perm_b32 v32, v27, v26, s28
    v_accvgpr_write_b32 a57, v32
    v_perm_b32 v33, v27, v26, s29
    v_accvgpr_write_b32 a61, v33
    s_add_u32 m0, s93, 13312
    s_mov_b32 s30, 724992
    buffer_load_dwordx4 v4, s[16:19], s30 offen  lds
    s_waitcnt vmcnt(29)
    ds_read2st64_b32 v[16:17], v5 offset0:64 offset1:65
    ds_read2st64_b32 v[18:19], v5 offset0:66 offset1:67
    s_waitcnt lgkmcnt(2)
    v_perm_b32 v32, v29, v28, s28
    v_accvgpr_write_b32 a58, v32
    v_perm_b32 v33, v29, v28, s29
    v_accvgpr_write_b32 a62, v33
    v_perm_b32 v32, v31, v30, s28
    v_accvgpr_write_b32 a59, v32
    v_perm_b32 v33, v31, v30, s29
    v_accvgpr_write_b32 a63, v33
    s_add_u32 m0, s93, 14336
    s_mov_b32 s30, 753664
    buffer_load_dwordx4 v4, s[16:19], s30 offen  lds
    s_waitcnt vmcnt(29)
    ds_read2st64_b32 v[20:21], v5 offset0:68 offset1:69
    ds_read2st64_b32 v[22:23], v5 offset0:70 offset1:71
    s_waitcnt lgkmcnt(2)
    v_perm_b32 v32, v17, v16, s28
    v_accvgpr_write_b32 a64, v32
    v_perm_b32 v33, v17, v16, s29
    v_accvgpr_write_b32 a68, v33
    v_perm_b32 v32, v19, v18, s28
    v_accvgpr_write_b32 a65, v32
    v_perm_b32 v33, v19, v18, s29
    v_accvgpr_write_b32 a69, v33
    s_add_u32 m0, s93, 15360
    s_mov_b32 s30, 757760
    buffer_load_dwordx4 v4, s[16:19], s30 offen  lds
    s_waitcnt vmcnt(29)
    ds_read2st64_b32 v[24:25], v5 offset0:72 offset1:73
    ds_read2st64_b32 v[26:27], v5 offset0:74 offset1:75
    s_waitcnt lgkmcnt(2)
    v_perm_b32 v32, v21, v20, s28
    v_accvgpr_write_b32 a66, v32
    v_perm_b32 v33, v21, v20, s29
    v_accvgpr_write_b32 a70, v33
    v_perm_b32 v32, v23, v22, s28
    v_accvgpr_write_b32 a67, v32
    v_perm_b32 v33, v23, v22, s29
    v_accvgpr_write_b32 a71, v33
    s_add_u32 m0, s93, 16384
    s_mov_b32 s30, 786432
    buffer_load_dwordx4 v4, s[16:19], s30 offen  lds
    s_waitcnt vmcnt(29)
    ds_read2st64_b32 v[28:29], v5 offset0:76 offset1:77
    ds_read2st64_b32 v[30:31], v5 offset0:78 offset1:79
    s_waitcnt lgkmcnt(2)
    v_perm_b32 v32, v25, v24, s28
    v_accvgpr_write_b32 a72, v32
    v_perm_b32 v33, v25, v24, s29
    v_accvgpr_write_b32 a76, v33
    v_perm_b32 v32, v27, v26, s28
    v_accvgpr_write_b32 a73, v32
    v_perm_b32 v33, v27, v26, s29
    v_accvgpr_write_b32 a77, v33
    s_add_u32 m0, s93, 17408
    s_mov_b32 s30, 790528
    buffer_load_dwordx4 v4, s[16:19], s30 offen  lds
    s_waitcnt vmcnt(29)
    ds_read2st64_b32 v[16:17], v5 offset0:80 offset1:81
    ds_read2st64_b32 v[18:19], v5 offset0:82 offset1:83
    s_waitcnt lgkmcnt(2)
    v_perm_b32 v32, v29, v28, s28
    v_accvgpr_write_b32 a74, v32
    v_perm_b32 v33, v29, v28, s29
    v_accvgpr_write_b32 a78, v33
    v_perm_b32 v32, v31, v30, s28
    v_accvgpr_write_b32 a75, v32
    v_perm_b32 v33, v31, v30, s29
    v_accvgpr_write_b32 a79, v33
    s_add_u32 m0, s93, 18432
    s_mov_b32 s30, 819200
    buffer_load_dwordx4 v4, s[16:19], s30 offen  lds
    s_waitcnt vmcnt(29)
    ds_read2st64_b32 v[20:21], v5 offset0:84 offset1:85
    ds_read2st64_b32 v[22:23], v5 offset0:86 offset1:87
    s_waitcnt lgkmcnt(2)
    v_perm_b32 v32, v17, v16, s28
    v_accvgpr_write_b32 a80, v32
    v_perm_b32 v33, v17, v16, s29
    v_accvgpr_write_b32 a84, v33
    v_perm_b32 v32, v19, v18, s28
    v_accvgpr_write_b32 a81, v32
    v_perm_b32 v33, v19, v18, s29
    v_accvgpr_write_b32 a85, v33
    s_add_u32 m0, s93, 19456
    s_mov_b32 s30, 823296
    buffer_load_dwordx4 v4, s[16:19], s30 offen  lds
    s_waitcnt vmcnt(29)
    ds_read2st64_b32 v[24:25], v5 offset0:88 offset1:89
    ds_read2st64_b32 v[26:27], v5 offset0:90 offset1:91
    s_waitcnt lgkmcnt(2)
    v_perm_b32 v32, v21, v20, s28
    v_accvgpr_write_b32 a82, v32
    v_perm_b32 v33, v21, v20, s29
    v_accvgpr_write_b32 a86, v33
    v_perm_b32 v32, v23, v22, s28
    v_accvgpr_write_b32 a83, v32
    v_perm_b32 v33, v23, v22, s29
    v_accvgpr_write_b32 a87, v33
    s_add_u32 m0, s93, 20480
    s_mov_b32 s30, 851968
    buffer_load_dwordx4 v4, s[16:19], s30 offen  lds
    s_waitcnt vmcnt(29)
    ds_read2st64_b32 v[28:29], v5 offset0:92 offset1:93
    ds_read2st64_b32 v[30:31], v5 offset0:94 offset1:95
    s_waitcnt lgkmcnt(2)
    v_perm_b32 v32, v25, v24, s28
    v_accvgpr_write_b32 a88, v32
    v_perm_b32 v33, v25, v24, s29
    v_accvgpr_write_b32 a92, v33
    v_perm_b32 v32, v27, v26, s28
    v_accvgpr_write_b32 a89, v32
    v_perm_b32 v33, v27, v26, s29
    v_accvgpr_write_b32 a93, v33
    s_add_u32 m0, s93, 21504
    s_mov_b32 s30, 856064
    buffer_load_dwordx4 v4, s[16:19], s30 offen  lds
    s_waitcnt vmcnt(29)
    ds_read2st64_b32 v[16:17], v5 offset0:96 offset1:97
    ds_read2st64_b32 v[18:19], v5 offset0:98 offset1:99
    s_waitcnt lgkmcnt(2)
    v_perm_b32 v32, v29, v28, s28
    v_accvgpr_write_b32 a90, v32
    v_perm_b32 v33, v29, v28, s29
    v_accvgpr_write_b32 a94, v33
    v_perm_b32 v32, v31, v30, s28
    v_accvgpr_write_b32 a91, v32
    v_perm_b32 v33, v31, v30, s29
    v_accvgpr_write_b32 a95, v33
    s_add_u32 m0, s93, 22528
    s_mov_b32 s30, 884736
    buffer_load_dwordx4 v4, s[16:19], s30 offen  lds
    s_waitcnt vmcnt(29)
    ds_read2st64_b32 v[20:21], v5 offset0:100 offset1:101
    ds_read2st64_b32 v[22:23], v5 offset0:102 offset1:103
    s_waitcnt lgkmcnt(2)
    v_perm_b32 v32, v17, v16, s28
    v_accvgpr_write_b32 a96, v32
    v_perm_b32 v33, v17, v16, s29
    v_accvgpr_write_b32 a100, v33
    v_perm_b32 v32, v19, v18, s28
    v_accvgpr_write_b32 a97, v32
    v_perm_b32 v33, v19, v18, s29
    v_accvgpr_write_b32 a101, v33
    s_add_u32 m0, s93, 23552
    s_mov_b32 s30, 888832
    buffer_load_dwordx4 v4, s[16:19], s30 offen  lds
    s_waitcnt vmcnt(29)
    ds_read2st64_b32 v[24:25], v5 offset0:104 offset1:105
    ds_read2st64_b32 v[26:27], v5 offset0:106 offset1:107
    s_waitcnt lgkmcnt(2)
    v_perm_b32 v32, v21, v20, s28
    v_accvgpr_write_b32 a98, v32
    v_perm_b32 v33, v21, v20, s29
    v_accvgpr_write_b32 a102, v33
    v_perm_b32 v32, v23, v22, s28
    v_accvgpr_write_b32 a99, v32
    v_perm_b32 v33, v23, v22, s29
    v_accvgpr_write_b32 a103, v33
    s_add_u32 m0, s93, 24576
    s_mov_b32 s30, 917504
    buffer_load_dwordx4 v4, s[16:19], s30 offen  lds
    s_waitcnt vmcnt(29)
    ds_read2st64_b32 v[28:29], v5 offset0:108 offset1:109
    ds_read2st64_b32 v[30:31], v5 offset0:110 offset1:111
    s_waitcnt lgkmcnt(2)
    v_perm_b32 v32, v25, v24, s28
    v_accvgpr_write_b32 a104, v32
    v_perm_b32 v33, v25, v24, s29
    v_accvgpr_write_b32 a108, v33
    v_perm_b32 v32, v27, v26, s28
    v_accvgpr_write_b32 a105, v32
    v_perm_b32 v33, v27, v26, s29
    v_accvgpr_write_b32 a109, v33
    s_add_u32 m0, s93, 25600
    s_mov_b32 s30, 921600
    buffer_load_dwordx4 v4, s[16:19], s30 offen  lds
    s_waitcnt vmcnt(29)
    ds_read2st64_b32 v[16:17], v5 offset0:112 offset1:113
    ds_read2st64_b32 v[18:19], v5 offset0:114 offset1:115
    s_waitcnt lgkmcnt(2)
    v_perm_b32 v32, v29, v28, s28
    v_accvgpr_write_b32 a106, v32
    v_perm_b32 v33, v29, v28, s29
    v_accvgpr_write_b32 a110, v33
    v_perm_b32 v32, v31, v30, s28
    v_accvgpr_write_b32 a107, v32
    v_perm_b32 v33, v31, v30, s29
    v_accvgpr_write_b32 a111, v33
    s_add_u32 m0, s93, 26624
    s_mov_b32 s30, 950272
    buffer_load_dwordx4 v4, s[16:19], s30 offen  lds
    s_waitcnt vmcnt(29)
    ds_read2st64_b32 v[20:21], v5 offset0:116 offset1:117
    ds_read2st64_b32 v[22:23], v5 offset0:118 offset1:119
    s_waitcnt lgkmcnt(2)
    v_perm_b32 v32, v17, v16, s28
    v_accvgpr_write_b32 a112, v32
    v_perm_b32 v33, v17, v16, s29
    v_accvgpr_write_b32 a116, v33
    v_perm_b32 v32, v19, v18, s28
    v_accvgpr_write_b32 a113, v32
    v_perm_b32 v33, v19, v18, s29
    v_accvgpr_write_b32 a117, v33
    s_add_u32 m0, s93, 27648
    s_mov_b32 s30, 954368
    buffer_load_dwordx4 v4, s[16:19], s30 offen  lds
    s_waitcnt vmcnt(29)
    ds_read2st64_b32 v[24:25], v5 offset0:120 offset1:121
    ds_read2st64_b32 v[26:27], v5 offset0:122 offset1:123
    s_waitcnt lgkmcnt(2)
    v_perm_b32 v32, v21, v20, s28
    v_accvgpr_write_b32 a114, v32
    v_perm_b32 v33, v21, v20, s29
    v_accvgpr_write_b32 a118, v33
    v_perm_b32 v32, v23, v22, s28
    v_accvgpr_write_b32 a115, v32
    v_perm_b32 v33, v23, v22, s29
    v_accvgpr_write_b32 a119, v33
    s_add_u32 m0, s93, 28672
    s_mov_b32 s30, 983040
    buffer_load_dwordx4 v4, s[16:19], s30 offen  lds
    s_waitcnt vmcnt(29)
    ds_read2st64_b32 v[28:29], v5 offset0:124 offset1:125
    ds_read2st64_b32 v[30:31], v5 offset0:126 offset1:127
    s_waitcnt lgkmcnt(2)
    v_perm_b32 v32, v25, v24, s28
    v_accvgpr_write_b32 a120, v32
    v_perm_b32 v33, v25, v24, s29
    v_accvgpr_write_b32 a124, v33
    v_perm_b32 v32, v27, v26, s28
    v_accvgpr_write_b32 a121, v32
    v_perm_b32 v33, v27, v26, s29
    v_accvgpr_write_b32 a125, v33
    s_add_u32 m0, s93, 29696
    s_mov_b32 s30, 987136
    buffer_load_dwordx4 v4, s[16:19], s30 offen  lds
    s_waitcnt vmcnt(29)
    ds_read2st64_b32 v[16:17], v5 offset0:0 offset1:1
    ds_read2st64_b32 v[18:19], v5 offset0:2 offset1:3
    s_waitcnt lgkmcnt(2)
    v_perm_b32 v32, v29, v28, s28
    v_accvgpr_write_b32 a122, v32
    v_perm_b32 v33, v29, v28, s29
    v_accvgpr_write_b32 a126, v33
    v_perm_b32 v32, v31, v30, s28
    v_accvgpr_write_b32 a123, v32
    v_perm_b32 v33, v31, v30, s29
    v_accvgpr_write_b32 a127, v33
    s_add_u32 m0, s93, 30720
    s_mov_b32 s30, 1015808
    buffer_load_dwordx4 v4, s[16:19], s30 offen  lds
    s_waitcnt vmcnt(29)
    ds_read2st64_b32 v[20:21], v5 offset0:4 offset1:5
    ds_read2st64_b32 v[22:23], v5 offset0:6 offset1:7
    s_waitcnt lgkmcnt(2)
    v_perm_b32 v32, v17, v16, s28
    v_accvgpr_write_b32 a128, v32
    v_perm_b32 v33, v17, v16, s29
    v_accvgpr_write_b32 a132, v33
    v_perm_b32 v32, v19, v18, s28
    v_accvgpr_write_b32 a129, v32
    v_perm_b32 v33, v19, v18, s29
    v_accvgpr_write_b32 a133, v33
    s_add_u32 m0, s93, 31744
    s_mov_b32 s30, 1019904
    buffer_load_dwordx4 v4, s[16:19], s30 offen  lds
    s_waitcnt vmcnt(29)
    ds_read2st64_b32 v[24:25], v5 offset0:8 offset1:9
    ds_read2st64_b32 v[26:27], v5 offset0:10 offset1:11
    s_waitcnt lgkmcnt(2)
    v_perm_b32 v32, v21, v20, s28
    v_accvgpr_write_b32 a130, v32
    v_perm_b32 v33, v21, v20, s29
    v_accvgpr_write_b32 a134, v33
    v_perm_b32 v32, v23, v22, s28
    v_accvgpr_write_b32 a131, v32
    v_perm_b32 v33, v23, v22, s29
    v_accvgpr_write_b32 a135, v33
    s_waitcnt vmcnt(28)
    ds_read2st64_b32 v[28:29], v5 offset0:12 offset1:13
    ds_read2st64_b32 v[30:31], v5 offset0:14 offset1:15
    s_waitcnt lgkmcnt(2)
    v_perm_b32 v32, v25, v24, s28
    v_accvgpr_write_b32 a136, v32
    v_perm_b32 v33, v25, v24, s29
    v_accvgpr_write_b32 a140, v33
    v_perm_b32 v32, v27, v26, s28
    v_accvgpr_write_b32 a137, v32
    v_perm_b32 v33, v27, v26, s29
    v_accvgpr_write_b32 a141, v33
    s_waitcnt vmcnt(27)
    ds_read2st64_b32 v[16:17], v5 offset0:16 offset1:17
    ds_read2st64_b32 v[18:19], v5 offset0:18 offset1:19
    s_waitcnt lgkmcnt(2)
    v_perm_b32 v32, v29, v28, s28
    v_accvgpr_write_b32 a138, v32
    v_perm_b32 v33, v29, v28, s29
    v_accvgpr_write_b32 a142, v33
    v_perm_b32 v32, v31, v30, s28
    v_accvgpr_write_b32 a139, v32
    v_perm_b32 v33, v31, v30, s29
    v_accvgpr_write_b32 a143, v33
    s_waitcnt vmcnt(26)
    ds_read2st64_b32 v[20:21], v5 offset0:20 offset1:21
    ds_read2st64_b32 v[22:23], v5 offset0:22 offset1:23
    s_waitcnt lgkmcnt(2)
    v_perm_b32 v32, v17, v16, s28
    v_accvgpr_write_b32 a144, v32
    v_perm_b32 v33, v17, v16, s29
    v_accvgpr_write_b32 a148, v33
    v_perm_b32 v32, v19, v18, s28
    v_accvgpr_write_b32 a145, v32
    v_perm_b32 v33, v19, v18, s29
    v_accvgpr_write_b32 a149, v33
    s_waitcnt vmcnt(25)
    ds_read2st64_b32 v[24:25], v5 offset0:24 offset1:25
    ds_read2st64_b32 v[26:27], v5 offset0:26 offset1:27
    s_waitcnt lgkmcnt(2)
    v_perm_b32 v32, v21, v20, s28
    v_accvgpr_write_b32 a146, v32
    v_perm_b32 v33, v21, v20, s29
    v_accvgpr_write_b32 a150, v33
    v_perm_b32 v32, v23, v22, s28
    v_accvgpr_write_b32 a147, v32
    v_perm_b32 v33, v23, v22, s29
    v_accvgpr_write_b32 a151, v33
    s_waitcnt vmcnt(24)
    ds_read2st64_b32 v[28:29], v5 offset0:28 offset1:29
    ds_read2st64_b32 v[30:31], v5 offset0:30 offset1:31
    s_waitcnt lgkmcnt(2)
    v_perm_b32 v32, v25, v24, s28
    v_accvgpr_write_b32 a152, v32
    v_perm_b32 v33, v25, v24, s29
    v_accvgpr_write_b32 a156, v33
    v_perm_b32 v32, v27, v26, s28
    v_accvgpr_write_b32 a153, v32
    v_perm_b32 v33, v27, v26, s29
    v_accvgpr_write_b32 a157, v33
    s_waitcnt vmcnt(23)
    ds_read2st64_b32 v[16:17], v5 offset0:32 offset1:33
    ds_read2st64_b32 v[18:19], v5 offset0:34 offset1:35
    s_waitcnt lgkmcnt(2)
    v_perm_b32 v32, v29, v28, s28
    v_accvgpr_write_b32 a154, v32
    v_perm_b32 v33, v29, v28, s29
    v_accvgpr_write_b32 a158, v33
    v_perm_b32 v32, v31, v30, s28
    v_accvgpr_write_b32 a155, v32
    v_perm_b32 v33, v31, v30, s29
    v_accvgpr_write_b32 a159, v33
    s_waitcnt vmcnt(22)
    ds_read2st64_b32 v[20:21], v5 offset0:36 offset1:37
    ds_read2st64_b32 v[22:23], v5 offset0:38 offset1:39
    s_waitcnt lgkmcnt(2)
    v_perm_b32 v32, v17, v16, s28
    v_accvgpr_write_b32 a160, v32
    v_perm_b32 v33, v17, v16, s29
    v_accvgpr_write_b32 a164, v33
    v_perm_b32 v32, v19, v18, s28
    v_accvgpr_write_b32 a161, v32
    v_perm_b32 v33, v19, v18, s29
    v_accvgpr_write_b32 a165, v33
    s_waitcnt vmcnt(21)
    ds_read2st64_b32 v[24:25], v5 offset0:40 offset1:41
    ds_read2st64_b32 v[26:27], v5 offset0:42 offset1:43
    s_waitcnt lgkmcnt(2)
    v_perm_b32 v32, v21, v20, s28
    v_accvgpr_write_b32 a162, v32
    v_perm_b32 v33, v21, v20, s29
    v_accvgpr_write_b32 a166, v33
    v_perm_b32 v32, v23, v22, s28
    v_accvgpr_write_b32 a163, v32
    v_perm_b32 v33, v23, v22, s29
    v_accvgpr_write_b32 a167, v33
    s_waitcnt vmcnt(20)
    ds_read2st64_b32 v[28:29], v5 offset0:44 offset1:45
    ds_read2st64_b32 v[30:31], v5 offset0:46 offset1:47
    s_waitcnt lgkmcnt(2)
    v_perm_b32 v32, v25, v24, s28
    v_accvgpr_write_b32 a168, v32
    v_perm_b32 v33, v25, v24, s29
    v_accvgpr_write_b32 a172, v33
    v_perm_b32 v32, v27, v26, s28
    v_accvgpr_write_b32 a169, v32
    v_perm_b32 v33, v27, v26, s29
    v_accvgpr_write_b32 a173, v33
    s_waitcnt vmcnt(19)
    ds_read2st64_b32 v[16:17], v5 offset0:48 offset1:49
    ds_read2st64_b32 v[18:19], v5 offset0:50 offset1:51
    s_waitcnt lgkmcnt(2)
    v_perm_b32 v32, v29, v28, s28
    v_accvgpr_write_b32 a170, v32
    v_perm_b32 v33, v29, v28, s29
    v_accvgpr_write_b32 a174, v33
    v_perm_b32 v32, v31, v30, s28
    v_accvgpr_write_b32 a171, v32
    v_perm_b32 v33, v31, v30, s29
    v_accvgpr_write_b32 a175, v33
    s_waitcnt vmcnt(18)
    ds_read2st64_b32 v[20:21], v5 offset0:52 offset1:53
    ds_read2st64_b32 v[22:23], v5 offset0:54 offset1:55
    s_waitcnt lgkmcnt(2)
    v_perm_b32 v32, v17, v16, s28
    v_accvgpr_write_b32 a176, v32
    v_perm_b32 v33, v17, v16, s29
    v_accvgpr_write_b32 a180, v33
    v_perm_b32 v32, v19, v18, s28
    v_accvgpr_write_b32 a177, v32
    v_perm_b32 v33, v19, v18, s29
    v_accvgpr_write_b32 a181, v33
    s_waitcnt vmcnt(17)
    ds_read2st64_b32 v[24:25], v5 offset0:56 offset1:57
    ds_read2st64_b32 v[26:27], v5 offset0:58 offset1:59
    s_waitcnt lgkmcnt(2)
    v_perm_b32 v32, v21, v20, s28
    v_accvgpr_write_b32 a178, v32
    v_perm_b32 v33, v21, v20, s29
    v_accvgpr_write_b32 a182, v33
    v_perm_b32 v32, v23, v22, s28
    v_accvgpr_write_b32 a179, v32
    v_perm_b32 v33, v23, v22, s29
    v_accvgpr_write_b32 a183, v33
    s_waitcnt vmcnt(16)
    ds_read2st64_b32 v[28:29], v5 offset0:60 offset1:61
    ds_read2st64_b32 v[30:31], v5 offset0:62 offset1:63
    s_waitcnt lgkmcnt(2)
    v_perm_b32 v32, v25, v24, s28
    v_accvgpr_write_b32 a184, v32
    v_perm_b32 v33, v25, v24, s29
    v_accvgpr_write_b32 a188, v33
    v_perm_b32 v32, v27, v26, s28
    v_accvgpr_write_b32 a185, v32
    v_perm_b32 v33, v27, v26, s29
    v_accvgpr_write_b32 a189, v33
    s_waitcnt vmcnt(15)
    ds_read2st64_b32 v[16:17], v5 offset0:64 offset1:65
    ds_read2st64_b32 v[18:19], v5 offset0:66 offset1:67
    s_waitcnt lgkmcnt(2)
    v_perm_b32 v32, v29, v28, s28
    v_accvgpr_write_b32 a186, v32
    v_perm_b32 v33, v29, v28, s29
    v_accvgpr_write_b32 a190, v33
    v_perm_b32 v32, v31, v30, s28
    v_accvgpr_write_b32 a187, v32
    v_perm_b32 v33, v31, v30, s29
    v_accvgpr_write_b32 a191, v33
    s_waitcnt vmcnt(14)
    ds_read2st64_b32 v[20:21], v5 offset0:68 offset1:69
    ds_read2st64_b32 v[22:23], v5 offset0:70 offset1:71
    s_waitcnt lgkmcnt(2)
    v_perm_b32 v32, v17, v16, s28
    v_accvgpr_write_b32 a192, v32
    v_perm_b32 v33, v17, v16, s29
    v_accvgpr_write_b32 a196, v33
    v_perm_b32 v32, v19, v18, s28
    v_accvgpr_write_b32 a193, v32
    v_perm_b32 v33, v19, v18, s29
    v_accvgpr_write_b32 a197, v33
    s_waitcnt vmcnt(13)
    ds_read2st64_b32 v[24:25], v5 offset0:72 offset1:73
    ds_read2st64_b32 v[26:27], v5 offset0:74 offset1:75
    s_waitcnt lgkmcnt(2)
    v_perm_b32 v32, v21, v20, s28
    v_accvgpr_write_b32 a194, v32
    v_perm_b32 v33, v21, v20, s29
    v_accvgpr_write_b32 a198, v33
    v_perm_b32 v32, v23, v22, s28
    v_accvgpr_write_b32 a195, v32
    v_perm_b32 v33, v23, v22, s29
    v_accvgpr_write_b32 a199, v33
    s_waitcnt vmcnt(12)
    ds_read2st64_b32 v[28:29], v5 offset0:76 offset1:77
    ds_read2st64_b32 v[30:31], v5 offset0:78 offset1:79
    s_waitcnt lgkmcnt(2)
    v_perm_b32 v32, v25, v24, s28
    v_accvgpr_write_b32 a200, v32
    v_perm_b32 v33, v25, v24, s29
    v_accvgpr_write_b32 a204, v33
    v_perm_b32 v32, v27, v26, s28
    v_accvgpr_write_b32 a201, v32
    v_perm_b32 v33, v27, v26, s29
    v_accvgpr_write_b32 a205, v33
    s_waitcnt vmcnt(11)
    ds_read2st64_b32 v[16:17], v5 offset0:80 offset1:81
    ds_read2st64_b32 v[18:19], v5 offset0:82 offset1:83
    s_waitcnt lgkmcnt(2)
    v_perm_b32 v32, v29, v28, s28
    v_accvgpr_write_b32 a202, v32
    v_perm_b32 v33, v29, v28, s29
    v_accvgpr_write_b32 a206, v33
    v_perm_b32 v32, v31, v30, s28
    v_accvgpr_write_b32 a203, v32
    v_perm_b32 v33, v31, v30, s29
    v_accvgpr_write_b32 a207, v33
    s_waitcnt vmcnt(10)
    ds_read2st64_b32 v[20:21], v5 offset0:84 offset1:85
    ds_read2st64_b32 v[22:23], v5 offset0:86 offset1:87
    s_waitcnt lgkmcnt(2)
    v_perm_b32 v32, v17, v16, s28
    v_accvgpr_write_b32 a208, v32
    v_perm_b32 v33, v17, v16, s29
    v_accvgpr_write_b32 a212, v33
    v_perm_b32 v32, v19, v18, s28
    v_accvgpr_write_b32 a209, v32
    v_perm_b32 v33, v19, v18, s29
    v_accvgpr_write_b32 a213, v33
    s_waitcnt vmcnt(9)
    ds_read2st64_b32 v[24:25], v5 offset0:88 offset1:89
    ds_read2st64_b32 v[26:27], v5 offset0:90 offset1:91
    s_waitcnt lgkmcnt(2)
    v_perm_b32 v32, v21, v20, s28
    v_accvgpr_write_b32 a210, v32
    v_perm_b32 v33, v21, v20, s29
    v_accvgpr_write_b32 a214, v33
    v_perm_b32 v32, v23, v22, s28
    v_accvgpr_write_b32 a211, v32
    v_perm_b32 v33, v23, v22, s29
    v_accvgpr_write_b32 a215, v33
    s_waitcnt vmcnt(8)
    ds_read2st64_b32 v[28:29], v5 offset0:92 offset1:93
    ds_read2st64_b32 v[30:31], v5 offset0:94 offset1:95
    s_waitcnt lgkmcnt(2)
    v_perm_b32 v32, v25, v24, s28
    v_accvgpr_write_b32 a216, v32
    v_perm_b32 v33, v25, v24, s29
    v_accvgpr_write_b32 a220, v33
    v_perm_b32 v32, v27, v26, s28
    v_accvgpr_write_b32 a217, v32
    v_perm_b32 v33, v27, v26, s29
    v_accvgpr_write_b32 a221, v33
    s_waitcnt vmcnt(7)
    ds_read2st64_b32 v[16:17], v5 offset0:96 offset1:97
    ds_read2st64_b32 v[18:19], v5 offset0:98 offset1:99
    s_waitcnt lgkmcnt(2)
    v_perm_b32 v32, v29, v28, s28
    v_accvgpr_write_b32 a218, v32
    v_perm_b32 v33, v29, v28, s29
    v_accvgpr_write_b32 a222, v33
    v_perm_b32 v32, v31, v30, s28
    v_accvgpr_write_b32 a219, v32
    v_perm_b32 v33, v31, v30, s29
    v_accvgpr_write_b32 a223, v33
    s_waitcnt vmcnt(6)
    ds_read2st64_b32 v[20:21], v5 offset0:100 offset1:101
    ds_read2st64_b32 v[22:23], v5 offset0:102 offset1:103
    s_waitcnt lgkmcnt(2)
    v_perm_b32 v32, v17, v16, s28
    v_accvgpr_write_b32 a224, v32
    v_perm_b32 v33, v17, v16, s29
    v_accvgpr_write_b32 a228, v33
    v_perm_b32 v32, v19, v18, s28
    v_accvgpr_write_b32 a225, v32
    v_perm_b32 v33, v19, v18, s29
    v_accvgpr_write_b32 a229, v33
    s_waitcnt vmcnt(5)
    ds_read2st64_b32 v[24:25], v5 offset0:104 offset1:105
    ds_read2st64_b32 v[26:27], v5 offset0:106 offset1:107
    s_waitcnt lgkmcnt(2)
    v_perm_b32 v32, v21, v20, s28
    v_accvgpr_write_b32 a226, v32
    v_perm_b32 v33, v21, v20, s29
    v_accvgpr_write_b32 a230, v33
    v_perm_b32 v32, v23, v22, s28
    v_accvgpr_write_b32 a227, v32
    v_perm_b32 v33, v23, v22, s29
    v_accvgpr_write_b32 a231, v33
    s_waitcnt vmcnt(4)
    ds_read2st64_b32 v[28:29], v5 offset0:108 offset1:109
    ds_read2st64_b32 v[30:31], v5 offset0:110 offset1:111
    s_waitcnt lgkmcnt(2)
    v_perm_b32 v32, v25, v24, s28
    v_accvgpr_write_b32 a232, v32
    v_perm_b32 v33, v25, v24, s29
    v_accvgpr_write_b32 a236, v33
    v_perm_b32 v32, v27, v26, s28
    v_accvgpr_write_b32 a233, v32
    v_perm_b32 v33, v27, v26, s29
    v_accvgpr_write_b32 a237, v33
    s_waitcnt vmcnt(3)
    ds_read2st64_b32 v[16:17], v5 offset0:112 offset1:113
    ds_read2st64_b32 v[18:19], v5 offset0:114 offset1:115
    s_waitcnt lgkmcnt(2)
    v_perm_b32 v32, v29, v28, s28
    v_accvgpr_write_b32 a234, v32
    v_perm_b32 v33, v29, v28, s29
    v_accvgpr_write_b32 a238, v33
    v_perm_b32 v32, v31, v30, s28
    v_accvgpr_write_b32 a235, v32
    v_perm_b32 v33, v31, v30, s29
    v_accvgpr_write_b32 a239, v33
    s_waitcnt vmcnt(2)
    ds_read2st64_b32 v[20:21], v5 offset0:116 offset1:117
    ds_read2st64_b32 v[22:23], v5 offset0:118 offset1:119
    s_waitcnt lgkmcnt(2)
    v_perm_b32 v32, v17, v16, s28
    v_accvgpr_write_b32 a240, v32
    v_perm_b32 v33, v17, v16, s29
    v_accvgpr_write_b32 a244, v33
    v_perm_b32 v32, v19, v18, s28
    v_accvgpr_write_b32 a241, v32
    v_perm_b32 v33, v19, v18, s29
    v_accvgpr_write_b32 a245, v33
    s_waitcnt vmcnt(1)
    ds_read2st64_b32 v[24:25], v5 offset0:120 offset1:121
    ds_read2st64_b32 v[26:27], v5 offset0:122 offset1:123
    s_waitcnt lgkmcnt(2)
    v_perm_b32 v32, v21, v20, s28
    v_accvgpr_write_b32 a242, v32
    v_perm_b32 v33, v21, v20, s29
    v_accvgpr_write_b32 a246, v33
    v_perm_b32 v32, v23, v22, s28
    v_accvgpr_write_b32 a243, v32
    v_perm_b32 v33, v23, v22, s29
    v_accvgpr_write_b32 a247, v33
    s_waitcnt vmcnt(0)
    ds_read2st64_b32 v[28:29], v5 offset0:124 offset1:125
    ds_read2st64_b32 v[30:31], v5 offset0:126 offset1:127
    s_waitcnt lgkmcnt(2)
    v_perm_b32 v32, v25, v24, s28
    v_accvgpr_write_b32 a248, v32
    v_perm_b32 v33, v25, v24, s29
    v_accvgpr_write_b32 a252, v33
    v_perm_b32 v32, v27, v26, s28
    v_accvgpr_write_b32 a249, v32
    v_perm_b32 v33, v27, v26, s29
    v_accvgpr_write_b32 a253, v33
    s_waitcnt lgkmcnt(0)
    v_perm_b32 v32, v29, v28, s28
    v_accvgpr_write_b32 a250, v32
    v_perm_b32 v33, v29, v28, s29
    v_accvgpr_write_b32 a254, v33
    v_perm_b32 v32, v31, v30, s28
    v_accvgpr_write_b32 a251, v32
    v_perm_b32 v33, v31, v30, s29
    v_accvgpr_write_b32 a255, v33
    s_barrier
    s_load_dwordx2 s[4:5], s[0:1], 0
    s_waitcnt lgkmcnt(0)
    s_mov_b32 s12, s4
    s_mov_b32 s13, s5
    s_mov_b32 s14, 2097152
    s_mov_b32 s15, 0x20000
    s_sub_u32 s92, s25, 160
    s_lshl_b32 s92, s92, 2
    s_add_u32 s92, s92, s24
    v_mov_b32 v10, 0
    s_mov_b32 s27, 0
L_wi_80:
    global_load_dword v11, v10, s[6:7] offset:64 sc1
    s_waitcnt vmcnt(0)
    v_cmp_gt_u32 vcc, 0x100, v11
    s_cbranch_vccz L_wiok_81
    s_sleep 2
    s_add_u32 s27, s27, 1
    s_cmp_lt_u32 s27, 200000
    s_cbranch_scc1 L_wi_80
    s_branch L_x2_fail
L_wiok_81:
    s_lshr_b32 s30, s25, 5
    s_lshl_b32 s30, s30, 2
    s_add_u32 s30, s30, 128
    v_mov_b32 v10, s30
    global_load_dword v11, v10, s[6:7] sc1
    s_waitcnt vmcnt(0)
    v_readfirstlane_b32 s30, v11
    s_cmp_ge_u32 s30, 32
    s_cselect_b32 s42, 1, 0
L_x2_loop:
    s_mul_i32 s30, s34, 21846
    s_bfe_u32 s30, s30, 0x20010
    s_lshl_b32 s35, s32, 2
    s_add_u32 s35, s35, s30
    s_and_b32 s36, s34, 127
    s_lshl_b32 s37, s35, 17
    s_lshl_b32 s30, s24, 15
    s_add_u32 s37, s37, s30
    s_add_u32 s37, s37, 74448896
    s_sub_u32 s43, s34, 11
    s_max_i32 s43, s43, 0
    s_add_u32 s38, s34, 1
    s_lshl_b32 s41, s36, 14
    s_mov_b32 s27, 0
L_poll_82:
    buffer_load_dword v3, v2, s[8:11], s39 offen sc1
    s_waitcnt vmcnt(0)
    v_cmp_gt_u32 vcc, s38, v3
    s_cbranch_vccz L_pollok_83
    s_sleep 0
    s_add_u32 s27, s27, 1
    s_cmp_lt_u32 s27, 200000
    s_cbranch_scc1 L_poll_82
    s_branch L_x2_fail
L_pollok_83:
    s_cmp_lg_u32 s24, 0
    s_cbranch_scc1 L_x2_r2
    buffer_load_dword v3, v2, s[8:11], s44 offen sc1
    s_cmp_ge_u32 s34, 128
    s_cbranch_scc1 L_x2_r1
    buffer_load_dwordx4 v[20:23], v6, s[12:15], s41 offen
L_x2_r2:
    buffer_load_dwordx4 v[128:131], v1, s[8:11], s37 offen offset:0 sc1
    buffer_load_dwordx4 v[132:135], v1, s[8:11], s37 offen offset:1024 sc1
    buffer_load_dwordx4 v[136:139], v1, s[8:11], s37 offen offset:2048 sc1
    buffer_load_dwordx4 v[140:143], v1, s[8:11], s37 offen offset:3072 sc1
    s_add_u32 s37, s37, 4096
    buffer_load_dwordx4 v[144:147], v1, s[8:11], s37 offen offset:0 sc1
    buffer_load_dwordx4 v[148:151], v1, s[8:11], s37 offen offset:1024 sc1
    s_waitcnt vmcnt(5)
    v_mfma_f32_16x16x32_bf16 v[12:15], a[0:3], v[128:131], 0
    buffer_load_dwordx4 v[152:155], v1, s[8:11], s37 offen offset:2048 sc1
    v_mfma_f32_16x16x32_bf16 v[16:19], a[4:7], v[128:131], 0
    s_waitcnt vmcnt(5)
    v_mfma_f32_16x16x32_bf16 v[12:15], a[8:11], v[132:135], v[12:15]
    buffer_load_dwordx4 v[156:159], v1, s[8:11], s37 offen offset:3072 sc1
    v_mfma_f32_16x16x32_bf16 v[16:19], a[12:15], v[132:135], v[16:19]
    s_waitcnt vmcnt(5)
    v_mfma_f32_16x16x32_bf16 v[12:15], a[16:19], v[136:139], v[12:15]
    s_add_u32 s37, s37, 4096
    buffer_load_dwordx4 v[160:163], v1, s[8:11], s37 offen offset:0 sc1
    v_mfma_f32_16x16x32_bf16 v[16:19], a[20:23], v[136:139], v[16:19]
    s_waitcnt vmcnt(5)
    v_mfma_f32_16x16x32_bf16 v[12:15], a[24:27], v[140:143], v[12:15]
    buffer_load_dwordx4 v[164:167], v1, s[8:11], s37 offen offset:1024 sc1
    v_mfma_f32_16x16x32_bf16 v[16:19], a[28:31], v[140:143], v[16:19]
    s_waitcnt vmcnt(5)
    v_mfma_f32_16x16x32_bf16 v[12:15], a[32:35], v[144:147], v[12:15]
    buffer_load_dwordx4 v[168:171], v1, s[8:11], s37 offen offset:2048 sc1
    v_mfma_f32_16x16x32_bf16 v[16:19], a[36:39], v[144:147], v[16:19]
    s_waitcnt vmcnt(5)
    v_mfma_f32_16x16x32_bf16 v[12:15], a[40:43], v[148:151], v[12:15]
    buffer_load_dwordx4 v[172:175], v1, s[8:11], s37 offen offset:3072 sc1
    v_mfma_f32_16x16x32_bf16 v[16:19], a[44:47], v[148:151], v[16:19]
    s_waitcnt vmcnt(5)
    v_mfma_f32_16x16x32_bf16 v[12:15], a[48:51], v[152:155], v[12:15]
    s_add_u32 s37, s37, 4096
    buffer_load_dwordx4 v[176:179], v1, s[8:11], s37 offen offset:0 sc1
    v_mfma_f32_16x16x32_bf16 v[16:19], a[52:55], v[152:155], v[16:19]
    s_waitcnt vmcnt(5)
    v_mfma_f32_16x16x32_bf16 v[12:15], a[56:59], v[156:159], v[12:15]
    buffer_load_dwordx4 v[180:183], v1, s[8:11], s37 offen offset:1024 sc1
    v_mfma_f32_16x16x32_bf16 v[16:19], a[60:63], v[156:159], v[16:19]
    s_waitcnt vmcnt(5)
    v_mfma_f32_16x16x32_bf16 v[12:15], a[64:67], v[160:163], v[12:15]
    buffer_load_dwordx4 v[184:187], v1, s[8:11], s37 offen offset:2048 sc1
    v_mfma_f32_16x16x32_bf16 v[16:19], a[68:71], v[160:163], v[16:19]
    s_waitcnt vmcnt(5)
    v_mfma_f32_16x16x32_bf16 v[12:15], a[72:75], v[164:167], v[12:15]
    buffer_load_dwordx4 v[188:191], v1, s[8:11], s37 offen offset:3072 sc1
    v_mfma_f32_16x16x32_bf16 v[16:19], a[76:79], v[164:167], v[16:19]
    s_waitcnt vmcnt(5)
    v_mfma_f32_16x16x32_bf16 v[12:15], a[80:83], v[168:171], v[12:15]
    s_add_u32 s37, s37, 4096
    buffer_load_dwordx4 v[192:195], v1, s[8:11], s37 offen offset:0 sc1
    v_mfma_f32_16x16x32_bf16 v[16:19], a[84:87], v[168:171], v[16:19]
    s_waitcnt vmcnt(5)
    v_mfma_f32_16x16x32_bf16 v[12:15], a[88:91], v[172:175], v[12:15]
    buffer_load_dwordx4 v[196:199], v1, s[8:11], s37 offen offset:1024 sc1
    v_mfma_f32_16x16x32_bf16 v[16:19], a[92:95], v[172:175], v[16:19]
    s_waitcnt vmcnt(5)
    v_mfma_f32_16x16x32_bf16 v[12:15], a[96:99], v[176:179], v[12:15]
    buffer_load_dwordx4 v[200:203], v1, s[8:11], s37 offen offset:2048 sc1
    v_mfma_f32_16x16x32_bf16 v[16:19], a[100:103], v[176:179], v[16:19]
    s_waitcnt vmcnt(5)
    v_mfma_f32_16x16x32_bf16 v[12:15], a[104:107], v[180:183], v[12:15]
    buffer_load_dwordx4 v[204:207], v1, s[8:11], s37 offen offset:3072 sc1
    v_mfma_f32_16x16x32_bf16 v[16:19], a[108:111], v[180:183], v[16:19]
    s_waitcnt vmcnt(5)
    v_mfma_f32_16x16x32_bf16 v[12:15], a[112:115], v[184:187], v[12:15]
    s_add_u32 s37, s37, 4096
    buffer_load_dwordx4 v[208:211], v1, s[8:11], s37 offen offset:0 sc1
    v_mfma_f32_16x16x32_bf16 v[16:19], a[116:119], v[184:187], v[16:19]
    s_waitcnt vmcnt(5)
    v_mfma_f32_16x16x32_bf16 v[12:15], a[120:123], v[188:191], v[12:15]
    buffer_load_dwordx4 v[212:215], v1, s[8:11], s37 offen offset:1024 sc1
    v_mfma_f32_16x16x32_bf16 v[16:19], a[124:127], v[188:191], v[16:19]
    s_waitcnt vmcnt(5)
    v_mfma_f32_16x16x32_bf16 v[12:15], a[128:131], v[192:195], v[12:15]
    buffer_load_dwordx4 v[216:219], v1, s[8:11], s37 offen offset:2048 sc1
    v_mfma_f32_16x16x32_bf16 v[16:19], a[132:135], v[192:195], v[16:19]
    s_waitcnt vmcnt(5)
    v_mfma_f32_16x16x32_bf16 v[12:15], a[136:139], v[196:199], v[12:15]
    buffer_load_dwordx4 v[220:223], v1, s[8:11], s37 offen offset:3072 sc1
    v_mfma_f32_16x16x32_bf16 v[16:19], a[140:143], v[196:199], v[16:19]
    s_waitcnt vmcnt(5)
    v_mfma_f32_16x16x32_bf16 v[12:15], a[144:147], v[200:203], v[12:15]
    s_add_u32 s37, s37, 4096
    buffer_load_dwordx4 v[224:227], v1, s[8:11], s37 offen offset:0 sc1
    v_mfma_f32_16x16x32_bf16 v[16:19], a[148:151], v[200:203], v[16:19]
    s_waitcnt vmcnt(5)
    v_mfma_f32_16x16x32_bf16 v[12:15], a[152:155], v[204:207], v[12:15]
    buffer_load_dwordx4 v[228:231], v1, s[8:11], s37 offen offset:1024 sc1
    v_mfma_f32_16x16x32_bf16 v[16:19], a[156:159], v[204:207], v[16:19]
    s_waitcnt vmcnt(5)
    v_mfma_f32_16x16x32_bf16 v[12:15], a[160:163], v[208:211], v[12:15]
    buffer_load_dwordx4 v[232:235], v1, s[8:11], s37 offen offset:2048 sc1
    v_mfma_f32_16x16x32_bf16 v[16:19], a[164:167], v[208:211], v[16:19]
    s_waitcnt vmcnt(5)
    v_mfma_f32_16x16x32_bf16 v[12:15], a[168:171], v[212:215], v[12:15]
    buffer_load_dwordx4 v[236:239], v1, s[8:11], s37 offen offset:3072 sc1
    v_mfma_f32_16x16x32_bf16 v[16:19], a[172:175], v[212:215], v[16:19]
    s_waitcnt vmcnt(5)
    v_mfma_f32_16x16x32_bf16 v[12:15], a[176:179], v[216:219], v[12:15]
    s_add_u32 s37, s37, 4096
    buffer_load_dwordx4 v[240:243], v1, s[8:11], s37 offen offset:0 sc1
    v_mfma_f32_16x16x32_bf16 v[16:19], a[180:183], v[216:219], v[16:19]
    s_waitcnt vmcnt(5)
    v_mfma_f32_16x16x32_bf16 v[12:15], a[184:187], v[220:223], v[12:15]
    buffer_load_dwordx4 v[244:247], v1, s[8:11], s37 offen offset:1024 sc1
    v_mfma_f32_16x16x32_bf16 v[16:19], a[188:191], v[220:223], v[16:19]
    s_waitcnt vmcnt(5)
    v_mfma_f32_16x16x32_bf16 v[12:15], a[192:195], v[224:227], v[12:15]
    buffer_load_dwordx4 v[248:251], v1, s[8:11], s37 offen offset:2048 sc1
    v_mfma_f32_16x16x32_bf16 v[16:19], a[196:199], v[224:227], v[16:19]
    s_waitcnt vmcnt(5)
    v_mfma_f32_16x16x32_bf16 v[12:15], a[200:203], v[228:231], v[12:15]
    buffer_load_dwordx4 v[252:255], v1, s[8:11], s37 offen offset:3072 sc1
    v_mfma_f32_16x16x32_bf16 v[16:19], a[204:207], v[228:231], v[16:19]
    s_waitcnt vmcnt(5)
    v_mfma_f32_16x16x32_bf16 v[12:15], a[208:211], v[232:235], v[12:15]
    v_mfma_f32_16x16x32_bf16 v[16:19], a[212:215], v[232:235], v[16:19]
    s_waitcnt vmcnt(4)
    v_mfma_f32_16x16x32_bf16 v[12:15], a[216:219], v[236:239], v[12:15]
    v_mfma_f32_16x16x32_bf16 v[16:19], a[220:223], v[236:239], v[16:19]
    s_waitcnt vmcnt(3)
    v_mfma_f32_16x16x32_bf16 v[12:15], a[224:227], v[240:243], v[12:15]
    v_mfma_f32_16x16x32_bf16 v[16:19], a[228:231], v[240:243], v[16:19]
    s_waitcnt vmcnt(2)
    v_mfma_f32_16x16x32_bf16 v[12:15], a[232:235], v[244:247], v[12:15]
    v_mfma_f32_16x16x32_bf16 v[16:19], a[236:239], v[244:247], v[16:19]
    s_waitcnt vmcnt(1)
    v_mfma_f32_16x16x32_bf16 v[12:15], a[240:243], v[248:251], v[12:15]
    v_mfma_f32_16x16x32_bf16 v[16:19], a[244:247], v[248:251], v[16:19]
    s_waitcnt vmcnt(0)
    v_mfma_f32_16x16x32_bf16 v[12:15], a[248:251], v[252:255], v[12:15]
    v_mfma_f32_16x16x32_bf16 v[16:19], a[252:255], v[252:255], v[16:19]
    s_nop 7
    ds_write_b128 v7, v[12:15]
    ds_write_b128 v7, v[16:19] offset:1024
    s_waitcnt lgkmcnt(0)
    s_barrier
    s_cmp_lg_u32 s24, 0
    s_cbranch_scc1 L_x2_next
    ds_read_b128 v[24:27], v8 offset:2048
    ds_read_b128 v[28:31], v8 offset:3072
    ds_read_b128 v[32:35], v8 offset:4096
    ds_read_b128 v[36:39], v8 offset:5120
    ds_read_b128 v[40:43], v8 offset:6144
    ds_read_b128 v[44:47], v8 offset:7168
    s_waitcnt vmcnt(0)
    v_cmp_gt_u32 vcc, s43, v3
    v_lshlrev_b32 v10, 16, v20
    v_and_b32 v11, 0xffff0000, v20
    v_add_f32 v12, v12, v10
    v_add_f32 v16, v16, v11
    v_lshlrev_b32 v10, 16, v21
    v_and_b32 v11, 0xffff0000, v21
    v_add_f32 v13, v13, v10
    v_add_f32 v17, v17, v11
    v_lshlrev_b32 v10, 16, v22
    v_and_b32 v11, 0xffff0000, v22
    v_add_f32 v14, v14, v10
    v_add_f32 v18, v18, v11
    v_lshlrev_b32 v10, 16, v23
    v_and_b32 v11, 0xffff0000, v23
    v_add_f32 v15, v15, v10
    v_add_f32 v19, v19, v11
    s_waitcnt lgkmcnt(5)
    v_pk_add_f32 v[12:13], v[12:13], v[24:25]
    v_pk_add_f32 v[14:15], v[14:15], v[26:27]
    s_waitcnt lgkmcnt(4)
    v_pk_add_f32 v[16:17], v[16:17], v[28:29]
    v_pk_add_f32 v[18:19], v[18:19], v[30:31]
    s_waitcnt lgkmcnt(3)
    v_pk_add_f32 v[12:13], v[12:13], v[32:33]
    v_pk_add_f32 v[14:15], v[14:15], v[34:35]
    s_waitcnt lgkmcnt(2)
    v_pk_add_f32 v[16:17], v[16:17], v[36:37]
    v_pk_add_f32 v[18:19], v[18:19], v[38:39]
    s_waitcnt lgkmcnt(1)
    v_pk_add_f32 v[12:13], v[12:13], v[40:41]
    v_pk_add_f32 v[14:15], v[14:15], v[42:43]
    s_waitcnt lgkmcnt(0)
    v_pk_add_f32 v[16:17], v[16:17], v[44:45]
    v_pk_add_f32 v[18:19], v[18:19], v[46:47]
    v_cvt_pk_bf16_f32 v20, v12, v16
    v_cvt_pk_bf16_f32 v21, v13, v17
    v_cvt_pk_bf16_f32 v22, v14, v18
    v_cvt_pk_bf16_f32 v23, v15, v19
    s_cbranch_vccnz L_x2_bp
L_x2_free:
    s_lshl_b32 s30, s33, 10
    s_lshl_b32 s31, s35, 14
    s_add_u32 s30, s30, s31
    s_add_u32 s30, s30, 91226112
    s_cmp_eq_u32 s42, 0
    s_cbranch_scc1 L_far_86
    buffer_store_dwordx4 v[20:23], v1, s[8:11], s30 offen
L_join_87:
    s_waitcnt vmcnt(0)
    v_mov_b32 v10, s38
    s_mov_b64 exec, 1
    s_cmp_eq_u32 s42, 0
    s_cbranch_scc1 L_far_88
    buffer_store_dword v10, v2, s[8:11], s40 offen
L_join_89:
    s_mov_b64 exec, -1
L_x2_next:
    v_xor_b32 v7, 0x2000, v7
    v_xor_b32 v8, 0x2000, v8
    s_add_u32 s34, s34, 3
    s_cmp_lt_u32 s34, 256
    s_cbranch_scc1 L_x2_loop
L_x2_fail:
    s_endpgm
L_x2_r1:
    s_lshl_b32 s30, s33, 10
    s_add_u32 s30, s30, s41
    s_add_u32 s30, s30, 72351744
    buffer_load_dwordx4 v[20:23], v1, s[8:11], s30 offen sc1
    s_branch L_x2_r2
L_x2_bp:
    s_mov_b32 s27, 0
L_poll_84:
    buffer_load_dword v3, v2, s[8:11], s44 offen sc1
    s_waitcnt vmcnt(0)
    v_cmp_gt_u32 vcc, s43, v3
    s_cbranch_vccz L_pollok_85
    s_sleep 1
    s_add_u32 s27, s27, 1
    s_cmp_lt_u32 s27, 200000
    s_cbranch_scc1 L_poll_84
    s_branch L_x2_fail
L_pollok_85:
    s_branch L_x2_free
L_far_86:
    buffer_store_dwordx4 v[20:23], v1, s[8:11], s30 offen sc1
    s_branch L_join_87
L_far_88:
    buffer_store_dword v10, v2, s[8:11], s40 offen sc1
    s_branch L_join_89
L_role_x3:
    s_lshr_b32 s32, s25, 5
    s_sub_u32 s32, s32, 5
    s_and_b32 s33, s25, 31
    s_sub_u32 s33, s33, 16
    s_lshl_b32 s41, s33, 2
    s_add_u32 s41, s41, s24
    v_lshrrev_b32 v13, 4, v0
    v_and_b32 v14, 15, v0
    v_mul_u32_u24 v3, 24576, v13
    v_lshl_add_u32 v3, v14, 1, v3
    s_lshl_b32 s30, s41, 5
    v_add_u32 v3, s30, v3
    v_lshlrev_b32 v1, 2, v14
    v_lshlrev_b32 v14, 4, v14
    v_and_b32 v15, 1, v13
    v_lshl_add_u32 v14, v15, 3, v14
    v_lshrrev_b32 v13, 1, v13
    v_lshl_add_u32 v10, v13, 9, v14
    v_lshl_add_u32 v11, v13, 8, v14
    v_lshlrev_b32 v4, 4, v0
    s_lshl_b32 s39, s32, 7
    s_add_u32 s39, s39, 8704
    s_lshl_b32 s40, s41, 7
    s_lshl_b32 s30, s32, 2
    s_add_u32 s40, s40, s30
    s_add_u32 s40, s40, 12288
    s_mov_b32 s42, 0x3eb8aa3b
    s_lshl_b32 s44, s24, 12
    s_mov_b32 s43, 0
    s_mov_b32 s34, s32
    s_load_dwordx2 s[4:5], s[0:1], 64
    s_waitcnt lgkmcnt(0)
    s_mov_b32 s16, s4
    s_mov_b32 s17, s5
    s_mov_b32 s18, 1572864
    s_mov_b32 s19, 0x20000
    s_mov_b32 s30, 0
    buffer_load_ushort v16, v3, s[16:19], s30 offen
    buffer_load_ushort v17, v3, s[16:19], s30 offen offset:3072
    s_mov_b32 s30, 6144
    buffer_load_ushort v18, v3, s[16:19], s30 offen
    buffer_load_ushort v19, v3, s[16:19], s30 offen offset:3072
    s_mov_b32 s30, 12288
    buffer_load_ushort v20, v3, s[16:19], s30 offen
    buffer_load_ushort v21, v3, s[16:19], s30 offen offset:3072
    s_mov_b32 s30, 18432
    buffer_load_ushort v22, v3, s[16:19], s30 offen
    buffer_load_ushort v23, v3, s[16:19], s30 offen offset:3072
    s_mov_b32 s30, 98304
    buffer_load_ushort v24, v3, s[16:19], s30 offen
    buffer_load_ushort v25, v3, s[16:19], s30 offen offset:3072
    s_mov_b32 s30, 104448
    buffer_load_ushort v26, v3, s[16:19], s30 offen
    buffer_load_ushort v27, v3, s[16:19], s30 offen offset:3072
    s_mov_b32 s30, 110592
    buffer_load_ushort v28, v3, s[16:19], s30 offen
    buffer_load_ushort v29, v3, s[16:19], s30 offen offset:3072
    s_mov_b32 s30, 116736
    buffer_load_ushort v30, v3, s[16:19], s30 offen
    buffer_load_ushort v31, v3, s[16:19], s30 offen offset:3072
    s_mov_b32 s30, 196608
    buffer_load_ushort v32, v3, s[16:19], s30 offen
    buffer_load_ushort v33, v3, s[16:19], s30 offen offset:3072
    s_mov_b32 s30, 202752
    buffer_load_ushort v34, v3, s[16:19], s30 offen
    buffer_load_ushort v35, v3, s[16:19], s30 offen offset:3072
    s_mov_b32 s30, 208896
    buffer_load_ushort v36, v3, s[16:19], s30 offen
    buffer_load_ushort v37, v3, s[16:19], s30 offen offset:3072
    s_mov_b32 s30, 215040
    buffer_load_ushort v38, v3, s[16:19], s30 offen
    buffer_load_ushort v39, v3, s[16:19], s30 offen offset:3072
    s_mov_b32 s30, 294912
    buffer_load_ushort v40, v3, s[16:19], s30 offen
    buffer_load_ushort v41, v3, s[16:19], s30 offen offset:3072
    s_mov_b32 s30, 301056
    buffer_load_ushort v42, v3, s[16:19], s30 offen
    buffer_load_ushort v43, v3, s[16:19], s30 offen offset:3072
    s_mov_b32 s30, 307200
    buffer_load_ushort v44, v3, s[16:19], s30 offen
    buffer_load_ushort v45, v3, s[16:19], s30 offen offset:3072
    s_mov_b32 s30, 313344
    buffer_load_ushort v46, v3, s[16:19], s30 offen
    buffer_load_ushort v47, v3, s[16:19], s30 offen offset:3072
    s_mov_b32 s30, 393216
    buffer_load_ushort v48, v3, s[16:19], s30 offen
    buffer_load_ushort v49, v3, s[16:19], s30 offen offset:3072
    s_mov_b32 s30, 399360
    buffer_load_ushort v50, v3, s[16:19], s30 offen
    buffer_load_ushort v51, v3, s[16:19], s30 offen offset:3072
    s_mov_b32 s30, 405504
    buffer_load_ushort v52, v3, s[16:19], s30 offen
    buffer_load_ushort v53, v3, s[16:19], s30 offen offset:3072
    s_mov_b32 s30, 411648
    buffer_load_ushort v54, v3, s[16:19], s30 offen
    buffer_load_ushort v55, v3, s[16:19], s30 offen offset:3072
    s_mov_b32 s30, 491520
    buffer_load_ushort v56, v3, s[16:19], s30 offen
    buffer_load_ushort v57, v3, s[16:19], s30 offen offset:3072
    s_mov_b32 s30, 497664
    buffer_load_ushort v58, v3, s[16:19], s30 offen
    buffer_load_ushort v59, v3, s[16:19], s30 offen offset:3072
    s_mov_b32 s30, 503808
    buffer_load_ushort v60, v3, s[16:19], s30 offen
    buffer_load_ushort v61, v3, s[16:19], s30 offen offset:3072
    s_mov_b32 s30, 509952
    buffer_load_ushort v62, v3, s[16:19], s30 offen
    buffer_load_ushort v63, v3, s[16:19], s30 offen offset:3072
    s_mov_b32 s30, 589824
    buffer_load_ushort v64, v3, s[16:19], s30 offen
    buffer_load_ushort v65, v3, s[16:19], s30 offen offset:3072
    s_mov_b32 s30, 595968
    buffer_load_ushort v66, v3, s[16:19], s30 offen
    buffer_load_ushort v67, v3, s[16:19], s30 offen offset:3072
    s_mov_b32 s30, 602112
    buffer_load_ushort v68, v3, s[16:19], s30 offen
    buffer_load_ushort v69, v3, s[16:19], s30 offen offset:3072
    s_mov_b32 s30, 608256
    buffer_load_ushort v70, v3, s[16:19], s30 offen
    buffer_load_ushort v71, v3, s[16:19], s30 offen offset:3072
    s_mov_b32 s30, 688128
    buffer_load_ushort v72, v3, s[16:19], s30 offen
    buffer_load_ushort v73, v3, s[16:19], s30 offen offset:3072
    s_mov_b32 s30, 694272
    buffer_load_ushort v74, v3, s[16:19], s30 offen
    buffer_load_ushort v75, v3, s[16:19], s30 offen offset:3072
    s_waitcnt vmcnt(58)
    v_perm_b32 v13, v17, v16, s28
    v_accvgpr_write_b32 a0, v13
    s_mov_b32 s30, 700416
    buffer_load_ushort v16, v3, s[16:19], s30 offen
    buffer_load_ushort v17, v3, s[16:19], s30 offen offset:3072
    s_waitcnt vmcnt(58)
    v_perm_b32 v13, v19, v18, s28
    v_accvgpr_write_b32 a1, v13
    s_mov_b32 s30, 706560
    buffer_load_ushort v18, v3, s[16:19], s30 offen
    buffer_load_ushort v19, v3, s[16:19], s30 offen offset:3072
    s_waitcnt vmcnt(58)
    v_perm_b32 v13, v21, v20, s28
    v_accvgpr_write_b32 a2, v13
    s_mov_b32 s30, 786432
    buffer_load_ushort v20, v3, s[16:19], s30 offen
    buffer_load_ushort v21, v3, s[16:19], s30 offen offset:3072
    s_waitcnt vmcnt(58)
    v_perm_b32 v13, v23, v22, s28
    v_accvgpr_write_b32 a3, v13
    s_mov_b32 s30, 792576
    buffer_load_ushort v22, v3, s[16:19], s30 offen
    buffer_load_ushort v23, v3, s[16:19], s30 offen offset:3072
    s_waitcnt vmcnt(58)
    v_perm_b32 v13, v25, v24, s28
    v_accvgpr_write_b32 a4, v13
    s_mov_b32 s30, 798720
    buffer_load_ushort v24, v3, s[16:19], s30 offen
    buffer_load_ushort v25, v3, s[16:19], s30 offen offset:3072
    s_waitcnt vmcnt(58)
    v_perm_b32 v13, v27, v26, s28
    v_accvgpr_write_b32 a5, v13
    s_mov_b32 s30, 804864
    buffer_load_ushort v26, v3, s[16:19], s30 offen
    buffer_load_ushort v27, v3, s[16:19], s30 offen offset:3072
    s_waitcnt vmcnt(58)
    v_perm_b32 v13, v29, v28, s28
    v_accvgpr_write_b32 a6, v13
    s_mov_b32 s30, 884736
    buffer_load_ushort v28, v3, s[16:19], s30 offen
    buffer_load_ushort v29, v3, s[16:19], s30 offen offset:3072
    s_waitcnt vmcnt(58)
    v_perm_b32 v13, v31, v30, s28
    v_accvgpr_write_b32 a7, v13
    s_mov_b32 s30, 890880
    buffer_load_ushort v30, v3, s[16:19], s30 offen
    buffer_load_ushort v31, v3, s[16:19], s30 offen offset:3072
    s_waitcnt vmcnt(58)
    v_perm_b32 v13, v33, v32, s28
    v_accvgpr_write_b32 a8, v13
    s_mov_b32 s30, 897024
    buffer_load_ushort v32, v3, s[16:19], s30 offen
    buffer_load_ushort v33, v3, s[16:19], s30 offen offset:3072
    s_waitcnt vmcnt(58)
    v_perm_b32 v13, v35, v34, s28
    v_accvgpr_write_b32 a9, v13
    s_mov_b32 s30, 903168
    buffer_load_ushort v34, v3, s[16:19], s30 offen
    buffer_load_ushort v35, v3, s[16:19], s30 offen offset:3072
    s_waitcnt vmcnt(58)
    v_perm_b32 v13, v37, v36, s28
    v_accvgpr_write_b32 a10, v13
    s_mov_b32 s30, 983040
    buffer_load_ushort v36, v3, s[16:19], s30 offen
    buffer_load_ushort v37, v3, s[16:19], s30 offen offset:3072
    s_waitcnt vmcnt(58)
    v_perm_b32 v13, v39, v38, s28
    v_accvgpr_write_b32 a11, v13
    s_mov_b32 s30, 989184
    buffer_load_ushort v38, v3, s[16:19], s30 offen
    buffer_load_ushort v39, v3, s[16:19], s30 offen offset:3072
    s_waitcnt vmcnt(58)
    v_perm_b32 v13, v41, v40, s28
    v_accvgpr_write_b32 a12, v13
    s_mov_b32 s30, 995328
    buffer_load_ushort v40, v3, s[16:19], s30 offen
    buffer_load_ushort v41, v3, s[16:19], s30 offen offset:3072
    s_waitcnt vmcnt(58)
    v_perm_b32 v13, v43, v42, s28
    v_accvgpr_write_b32 a13, v13
    s_mov_b32 s30, 1001472
    buffer_load_ushort v42, v3, s[16:19], s30 offen
    buffer_load_ushort v43, v3, s[16:19], s30 offen offset:3072
    s_waitcnt vmcnt(58)
    v_perm_b32 v13, v45, v44, s28
    v_accvgpr_write_b32 a14, v13
    s_mov_b32 s30, 1081344
    buffer_load_ushort v44, v3, s[16:19], s30 offen
    buffer_load_ushort v45, v3, s[16:19], s30 offen offset:3072
    s_waitcnt vmcnt(58)
    v_perm_b32 v13, v47, v46, s28
    v_accvgpr_write_b32 a15, v13
    s_mov_b32 s30, 1087488
    buffer_load_ushort v46, v3, s[16:19], s30 offen
    buffer_load_ushort v47, v3, s[16:19], s30 offen offset:3072
    s_waitcnt vmcnt(58)
    v_perm_b32 v13, v49, v48, s28
    v_accvgpr_write_b32 a16, v13
    s_mov_b32 s30, 1093632
    buffer_load_ushort v48, v3, s[16:19], s30 offen
    buffer_load_ushort v49, v3, s[16:19], s30 offen offset:3072
    s_waitcnt vmcnt(58)
    v_perm_b32 v13, v51, v50, s28
    v_accvgpr_write_b32 a17, v13
    s_mov_b32 s30, 1099776
    buffer_load_ushort v50, v3, s[16:19], s30 offen
    buffer_load_ushort v51, v3, s[16:19], s30 offen offset:3072
    s_waitcnt vmcnt(58)
    v_perm_b32 v13, v53, v52, s28
    v_accvgpr_write_b32 a18, v13
    s_mov_b32 s30, 1179648
    buffer_load_ushort v52, v3, s[16:19], s30 offen
    buffer_load_ushort v53, v3, s[16:19], s30 offen offset:3072
    s_waitcnt vmcnt(58)
    v_perm_b32 v13, v55, v54, s28
    v_accvgpr_write_b32 a19, v13
    s_mov_b32 s30, 1185792
    buffer_load_ushort v54, v3, s[16:19], s30 offen
    buffer_load_ushort v55, v3, s[16:19], s30 offen offset:3072
    s_waitcnt vmcnt(58)
    v_perm_b32 v13, v57, v56, s28
    v_accvgpr_write_b32 a20, v13
    s_mov_b32 s30, 1191936
    buffer_load_ushort v56, v3, s[16:19], s30 offen
    buffer_load_ushort v57, v3, s[16:19], s30 offen offset:3072
    s_waitcnt vmcnt(58)
    v_perm_b32 v13, v59, v58, s28
    v_accvgpr_write_b32 a21, v13
    s_mov_b32 s30, 1198080
    buffer_load_ushort v58, v3, s[16:19], s30 offen
    buffer_load_ushort v59, v3, s[16:19], s30 offen offset:3072
    s_waitcnt vmcnt(58)
    v_perm_b32 v13, v61, v60, s28
    v_accvgpr_write_b32 a22, v13
    s_mov_b32 s30, 1277952
    buffer_load_ushort v60, v3, s[16:19], s30 offen
    buffer_load_ushort v61, v3, s[16:19], s30 offen offset:3072
    s_waitcnt vmcnt(58)
    v_perm_b32 v13, v63, v62, s28
    v_accvgpr_write_b32 a23, v13
    s_mov_b32 s30, 1284096
    buffer_load_ushort v62, v3, s[16:19], s30 offen
    buffer_load_ushort v63, v3, s[16:19], s30 offen offset:3072
    s_waitcnt vmcnt(58)
    v_perm_b32 v13, v65, v64, s28
    v_accvgpr_write_b32 a24, v13
    s_mov_b32 s30, 1290240
    buffer_load_ushort v64, v3, s[16:19], s30 offen
    buffer_load_ushort v65, v3, s[16:19], s30 offen offset:3072
    s_waitcnt vmcnt(58)
    v_perm_b32 v13, v67, v66, s28
    v_accvgpr_write_b32 a25, v13
    s_mov_b32 s30, 1296384
    buffer_load_ushort v66, v3, s[16:19], s30 offen
    buffer_load_ushort v67, v3, s[16:19], s30 offen offset:3072
    s_waitcnt vmcnt(58)
    v_perm_b32 v13, v69, v68, s28
    v_accvgpr_write_b32 a26, v13
    s_mov_b32 s30, 1376256
    buffer_load_ushort v68, v3, s[16:19], s30 offen
    buffer_load_ushort v69, v3, s[16:19], s30 offen offset:3072
    s_waitcnt vmcnt(58)
    v_perm_b32 v13, v71, v70, s28
    v_accvgpr_write_b32 a27, v13
    s_mov_b32 s30, 1382400
    buffer_load_ushort v70, v3, s[16:19], s30 offen
    buffer_load_ushort v71, v3, s[16:19], s30 offen offset:3072
    s_waitcnt vmcnt(58)
    v_perm_b32 v13, v73, v72, s28
    v_accvgpr_write_b32 a28, v13
    s_mov_b32 s30, 1388544
    buffer_load_ushort v72, v3, s[16:19], s30 offen
    buffer_load_ushort v73, v3, s[16:19], s30 offen offset:3072
    s_waitcnt vmcnt(58)
    v_perm_b32 v13, v75, v74, s28
    v_accvgpr_write_b32 a29, v13
    s_mov_b32 s30, 1394688
    buffer_load_ushort v74, v3, s[16:19], s30 offen
    buffer_load_ushort v75, v3, s[16:19], s30 offen offset:3072
    s_waitcnt vmcnt(58)
    v_perm_b32 v13, v17, v16, s28
    v_accvgpr_write_b32 a30, v13
    s_mov_b32 s30, 1474560
    buffer_load_ushort v16, v3, s[16:19], s30 offen
    buffer_load_ushort v17, v3, s[16:19], s30 offen offset:3072
    s_waitcnt vmcnt(58)
    v_perm_b32 v13, v19, v18, s28
    v_accvgpr_write_b32 a31, v13
    s_mov_b32 s30, 1480704
    buffer_load_ushort v18, v3, s[16:19], s30 offen
    buffer_load_ushort v19, v3, s[16:19], s30 offen offset:3072
    s_waitcnt vmcnt(58)
    v_perm_b32 v13, v21, v20, s28
    v_accvgpr_write_b32 a32, v13
    s_mov_b32 s30, 1486848
    buffer_load_ushort v20, v3, s[16:19], s30 offen
    buffer_load_ushort v21, v3, s[16:19], s30 offen offset:3072
    s_waitcnt vmcnt(58)
    v_perm_b32 v13, v23, v22, s28
    v_accvgpr_write_b32 a33, v13
    s_mov_b32 s30, 1492992
    buffer_load_ushort v22, v3, s[16:19], s30 offen
    buffer_load_ushort v23, v3, s[16:19], s30 offen offset:3072
    s_waitcnt vmcnt(58)
    v_perm_b32 v13, v25, v24, s28
    v_accvgpr_write_b32 a34, v13
    s_mov_b32 s30, 1024
    buffer_load_ushort v24, v3, s[16:19], s30 offen
    buffer_load_ushort v25, v3, s[16:19], s30 offen offset:3072
    s_waitcnt vmcnt(58)
    v_perm_b32 v13, v27, v26, s28
    v_accvgpr_write_b32 a35, v13
    s_mov_b32 s30, 7168
    buffer_load_ushort v26, v3, s[16:19], s30 offen
    buffer_load_ushort v27, v3, s[16:19], s30 offen offset:3072
    s_waitcnt vmcnt(58)
    v_perm_b32 v13, v29, v28, s28
    v_accvgpr_write_b32 a36, v13
    s_mov_b32 s30, 13312
    buffer_load_ushort v28, v3, s[16:19], s30 offen
    buffer_load_ushort v29, v3, s[16:19], s30 offen offset:3072
    s_waitcnt vmcnt(58)
    v_perm_b32 v13, v31, v30, s28
    v_accvgpr_write_b32 a37, v13
    s_mov_b32 s30, 19456
    buffer_load_ushort v30, v3, s[16:19], s30 offen
    buffer_load_ushort v31, v3, s[16:19], s30 offen offset:3072
    s_waitcnt vmcnt(58)
    v_perm_b32 v13, v33, v32, s28
    v_accvgpr_write_b32 a38, v13
    s_mov_b32 s30, 99328
    buffer_load_ushort v32, v3, s[16:19], s30 offen
    buffer_load_ushort v33, v3, s[16:19], s30 offen offset:3072
    s_waitcnt vmcnt(58)
    v_perm_b32 v13, v35, v34, s28
    v_accvgpr_write_b32 a39, v13
    s_mov_b32 s30, 105472
    buffer_load_ushort v34, v3, s[16:19], s30 offen
    buffer_load_ushort v35, v3, s[16:19], s30 offen offset:3072
    s_waitcnt vmcnt(58)
    v_perm_b32 v13, v37, v36, s28
    v_accvgpr_write_b32 a40, v13
    s_mov_b32 s30, 111616
    buffer_load_ushort v36, v3, s[16:19], s30 offen
    buffer_load_ushort v37, v3, s[16:19], s30 offen offset:3072
    s_waitcnt vmcnt(58)
    v_perm_b32 v13, v39, v38, s28
    v_accvgpr_write_b32 a41, v13
    s_mov_b32 s30, 117760
    buffer_load_ushort v38, v3, s[16:19], s30 offen
    buffer_load_ushort v39, v3, s[16:19], s30 offen offset:3072
    s_waitcnt vmcnt(58)
    v_perm_b32 v13, v41, v40, s28
    v_accvgpr_write_b32 a42, v13
    s_mov_b32 s30, 197632
    buffer_load_ushort v40, v3, s[16:19], s30 offen
    buffer_load_ushort v41, v3, s[16:19], s30 offen offset:3072
    s_waitcnt vmcnt(58)
    v_perm_b32 v13, v43, v42, s28
    v_accvgpr_write_b32 a43, v13
    s_mov_b32 s30, 203776
    buffer_load_ushort v42, v3, s[16:19], s30 offen
    buffer_load_ushort v43, v3, s[16:19], s30 offen offset:3072
    s_waitcnt vmcnt(58)
    v_perm_b32 v13, v45, v44, s28
    v_accvgpr_write_b32 a44, v13
    s_mov_b32 s30, 209920
    buffer_load_ushort v44, v3, s[16:19], s30 offen
    buffer_load_ushort v45, v3, s[16:19], s30 offen offset:3072
    s_waitcnt vmcnt(58)
    v_perm_b32 v13, v47, v46, s28
    v_accvgpr_write_b32 a45, v13
    s_mov_b32 s30, 216064
    buffer_load_ushort v46, v3, s[16:19], s30 offen
    buffer_load_ushort v47, v3, s[16:19], s30 offen offset:3072
    s_waitcnt vmcnt(58)
    v_perm_b32 v13, v49, v48, s28
    v_accvgpr_write_b32 a46, v13
    s_mov_b32 s30, 295936
    buffer_load_ushort v48, v3, s[16:19], s30 offen
    buffer_load_ushort v49, v3, s[16:19], s30 offen offset:3072
    s_waitcnt vmcnt(58)
    v_perm_b32 v13, v51, v50, s28
    v_accvgpr_write_b32 a47, v13
    s_mov_b32 s30, 302080
    buffer_load_ushort v50, v3, s[16:19], s30 offen
    buffer_load_ushort v51, v3, s[16:19], s30 offen offset:3072
    s_waitcnt vmcnt(58)
    v_perm_b32 v13, v53, v52, s28
    v_accvgpr_write_b32 a48, v13
    s_mov_b32 s30, 308224
    buffer_load_ushort v52, v3, s[16:19], s30 offen
    buffer_load_ushort v53, v3, s[16:19], s30 offen offset:3072
    s_waitcnt vmcnt(58)
    v_perm_b32 v13, v55, v54, s28
    v_accvgpr_write_b32 a49, v13
    s_mov_b32 s30, 314368
    buffer_load_ushort v54, v3, s[16:19], s30 offen
    buffer_load_ushort v55, v3, s[16:19], s30 offen offset:3072
    s_waitcnt vmcnt(58)
    v_perm_b32 v13, v57, v56, s28
    v_accvgpr_write_b32 a50, v13
    s_mov_b32 s30, 394240
    buffer_load_ushort v56, v3, s[16:19], s30 offen
    buffer_load_ushort v57, v3, s[16:19], s30 offen offset:3072
    s_waitcnt vmcnt(58)
    v_perm_b32 v13, v59, v58, s28
    v_accvgpr_write_b32 a51, v13
    s_mov_b32 s30, 400384
    buffer_load_ushort v58, v3, s[16:19], s30 offen
    buffer_load_ushort v59, v3, s[16:19], s30 offen offset:3072
    s_waitcnt vmcnt(58)
    v_perm_b32 v13, v61, v60, s28
    v_accvgpr_write_b32 a52, v13
    s_mov_b32 s30, 406528
    buffer_load_ushort v60, v3, s[16:19], s30 offen
    buffer_load_ushort v61, v3, s[16:19], s30 offen offset:3072
    s_waitcnt vmcnt(58)
    v_perm_b32 v13, v63, v62, s28
    v_accvgpr_write_b32 a53, v13
    s_mov_b32 s30, 412672
    buffer_load_ushort v62, v3, s[16:19], s30 offen
    buffer_load_ushort v63, v3, s[16:19], s30 offen offset:3072
    s_waitcnt vmcnt(58)
    v_perm_b32 v13, v65, v64, s28
    v_accvgpr_write_b32 a54, v13
    s_mov_b32 s30, 492544
    buffer_load_ushort v64, v3, s[16:19], s30 offen
    buffer_load_ushort v65, v3, s[16:19], s30 offen offset:3072
    s_waitcnt vmcnt(58)
    v_perm_b32 v13, v67, v66, s28
    v_accvgpr_write_b32 a55, v13
    s_mov_b32 s30, 498688
    buffer_load_ushort v66, v3, s[16:19], s30 offen
    buffer_load_ushort v67, v3, s[16:19], s30 offen offset:3072
    s_waitcnt vmcnt(58)
    v_perm_b32 v13, v69, v68, s28
    v_accvgpr_write_b32 a56, v13
    s_mov_b32 s30, 504832
    buffer_load_ushort v68, v3, s[16:19], s30 offen
    buffer_load_ushort v69, v3, s[16:19], s30 offen offset:3072
    s_waitcnt vmcnt(58)
    v_perm_b32 v13, v71, v70, s28
    v_accvgpr_write_b32 a57, v13
    s_mov_b32 s30, 510976
    buffer_load_ushort v70, v3, s[16:19], s30 offen
    buffer_load_ushort v71, v3, s[16:19], s30 offen offset:3072
    s_waitcnt vmcnt(58)
    v_perm_b32 v13, v73, v72, s28
    v_accvgpr_write_b32 a58, v13
    s_mov_b32 s30, 590848
    buffer_load_ushort v72, v3, s[16:19], s30 offen
    buffer_load_ushort v73, v3, s[16:19], s30 offen offset:3072
    s_waitcnt vmcnt(58)
    v_perm_b32 v13, v75, v74, s28
    v_accvgpr_write_b32 a59, v13
    s_mov_b32 s30, 596992
    buffer_load_ushort v74, v3, s[16:19], s30 offen
    buffer_load_ushort v75, v3, s[16:19], s30 offen offset:3072
    s_waitcnt vmcnt(58)
    v_perm_b32 v13, v17, v16, s28
    v_accvgpr_write_b32 a60, v13
    s_mov_b32 s30, 603136
    buffer_load_ushort v16, v3, s[16:19], s30 offen
    buffer_load_ushort v17, v3, s[16:19], s30 offen offset:3072
    s_waitcnt vmcnt(58)
    v_perm_b32 v13, v19, v18, s28
    v_accvgpr_write_b32 a61, v13
    s_mov_b32 s30, 609280
    buffer_load_ushort v18, v3, s[16:19], s30 offen
    buffer_load_ushort v19, v3, s[16:19], s30 offen offset:3072
    s_waitcnt vmcnt(58)
    v_perm_b32 v13, v21, v20, s28
    v_accvgpr_write_b32 a62, v13
    s_mov_b32 s30, 689152
    buffer_load_ushort v20, v3, s[16:19], s30 offen
    buffer_load_ushort v21, v3, s[16:19], s30 offen offset:3072
    s_waitcnt vmcnt(58)
    v_perm_b32 v13, v23, v22, s28
    v_accvgpr_write_b32 a63, v13
    s_mov_b32 s30, 695296
    buffer_load_ushort v22, v3, s[16:19], s30 offen
    buffer_load_ushort v23, v3, s[16:19], s30 offen offset:3072
    s_waitcnt vmcnt(58)
    v_perm_b32 v13, v25, v24, s28
    v_accvgpr_write_b32 a64, v13
    s_mov_b32 s30, 701440
    buffer_load_ushort v24, v3, s[16:19], s30 offen
    buffer_load_ushort v25, v3, s[16:19], s30 offen offset:3072
    s_waitcnt vmcnt(58)
    v_perm_b32 v13, v27, v26, s28
    v_accvgpr_write_b32 a65, v13
    s_mov_b32 s30, 707584
    buffer_load_ushort v26, v3, s[16:19], s30 offen
    buffer_load_ushort v27, v3, s[16:19], s30 offen offset:3072
    s_waitcnt vmcnt(58)
    v_perm_b32 v13, v29, v28, s28
    v_accvgpr_write_b32 a66, v13
    s_mov_b32 s30, 787456
    buffer_load_ushort v28, v3, s[16:19], s30 offen
    buffer_load_ushort v29, v3, s[16:19], s30 offen offset:3072
    s_waitcnt vmcnt(58)
    v_perm_b32 v13, v31, v30, s28
    v_accvgpr_write_b32 a67, v13
    s_mov_b32 s30, 793600
    buffer_load_ushort v30, v3, s[16:19], s30 offen
    buffer_load_ushort v31, v3, s[16:19], s30 offen offset:3072
    s_waitcnt vmcnt(58)
    v_perm_b32 v13, v33, v32, s28
    v_accvgpr_write_b32 a68, v13
    s_mov_b32 s30, 799744
    buffer_load_ushort v32, v3, s[16:19], s30 offen
    buffer_load_ushort v33, v3, s[16:19], s30 offen offset:3072
    s_waitcnt vmcnt(58)
    v_perm_b32 v13, v35, v34, s28
    v_accvgpr_write_b32 a69, v13
    s_mov_b32 s30, 805888
    buffer_load_ushort v34, v3, s[16:19], s30 offen
    buffer_load_ushort v35, v3, s[16:19], s30 offen offset:3072
    s_waitcnt vmcnt(58)
    v_perm_b32 v13, v37, v36, s28
    v_accvgpr_write_b32 a70, v13
    s_mov_b32 s30, 885760
    buffer_load_ushort v36, v3, s[16:19], s30 offen
    buffer_load_ushort v37, v3, s[16:19], s30 offen offset:3072
    s_waitcnt vmcnt(58)
    v_perm_b32 v13, v39, v38, s28
    v_accvgpr_write_b32 a71, v13
    s_mov_b32 s30, 891904
    buffer_load_ushort v38, v3, s[16:19], s30 offen
    buffer_load_ushort v39, v3, s[16:19], s30 offen offset:3072
    s_waitcnt vmcnt(58)
    v_perm_b32 v13, v41, v40, s28
    v_accvgpr_write_b32 a72, v13
    s_mov_b32 s30, 898048
    buffer_load_ushort v40, v3, s[16:19], s30 offen
    buffer_load_ushort v41, v3, s[16:19], s30 offen offset:3072
    s_waitcnt vmcnt(58)
    v_perm_b32 v13, v43, v42, s28
    v_accvgpr_write_b32 a73, v13
    s_mov_b32 s30, 904192
    buffer_load_ushort v42, v3, s[16:19], s30 offen
    buffer_load_ushort v43, v3, s[16:19], s30 offen offset:3072
    s_waitcnt vmcnt(58)
    v_perm_b32 v13, v45, v44, s28
    v_accvgpr_write_b32 a74, v13
    s_mov_b32 s30, 984064
    buffer_load_ushort v44, v3, s[16:19], s30 offen
    buffer_load_ushort v45, v3, s[16:19], s30 offen offset:3072
    s_waitcnt vmcnt(58)
    v_perm_b32 v13, v47, v46, s28
    v_accvgpr_write_b32 a75, v13
    s_mov_b32 s30, 990208
    buffer_load_ushort v46, v3, s[16:19], s30 offen
    buffer_load_ushort v47, v3, s[16:19], s30 offen offset:3072
    s_waitcnt vmcnt(58)
    v_perm_b32 v13, v49, v48, s28
    v_accvgpr_write_b32 a76, v13
    s_mov_b32 s30, 996352
    buffer_load_ushort v48, v3, s[16:19], s30 offen
    buffer_load_ushort v49, v3, s[16:19], s30 offen offset:3072
    s_waitcnt vmcnt(58)
    v_perm_b32 v13, v51, v50, s28
    v_accvgpr_write_b32 a77, v13
    s_mov_b32 s30, 1002496
    buffer_load_ushort v50, v3, s[16:19], s30 offen
    buffer_load_ushort v51, v3, s[16:19], s30 offen offset:3072
    s_waitcnt vmcnt(58)
    v_perm_b32 v13, v53, v52, s28
    v_accvgpr_write_b32 a78, v13
    s_mov_b32 s30, 1082368
    buffer_load_ushort v52, v3, s[16:19], s30 offen
    buffer_load_ushort v53, v3, s[16:19], s30 offen offset:3072
    s_waitcnt vmcnt(58)
    v_perm_b32 v13, v55, v54, s28
    v_accvgpr_write_b32 a79, v13
    s_mov_b32 s30, 1088512
    buffer_load_ushort v54, v3, s[16:19], s30 offen
    buffer_load_ushort v55, v3, s[16:19], s30 offen offset:3072
    s_waitcnt vmcnt(58)
    v_perm_b32 v13, v57, v56, s28
    v_accvgpr_write_b32 a80, v13
    s_mov_b32 s30, 1094656
    buffer_load_ushort v56, v3, s[16:19], s30 offen
    buffer_load_ushort v57, v3, s[16:19], s30 offen offset:3072
    s_waitcnt vmcnt(58)
    v_perm_b32 v13, v59, v58, s28
    v_accvgpr_write_b32 a81, v13
    s_mov_b32 s30, 1100800
    buffer_load_ushort v58, v3, s[16:19], s30 offen
    buffer_load_ushort v59, v3, s[16:19], s30 offen offset:3072
    s_waitcnt vmcnt(58)
    v_perm_b32 v13, v61, v60, s28
    v_accvgpr_write_b32 a82, v13
    s_mov_b32 s30, 1180672
    buffer_load_ushort v60, v3, s[16:19], s30 offen
    buffer_load_ushort v61, v3, s[16:19], s30 offen offset:3072
    s_waitcnt vmcnt(58)
    v_perm_b32 v13, v63, v62, s28
    v_accvgpr_write_b32 a83, v13
    s_mov_b32 s30, 1186816
    buffer_load_ushort v62, v3, s[16:19], s30 offen
    buffer_load_ushort v63, v3, s[16:19], s30 offen offset:3072
    s_waitcnt vmcnt(58)
    v_perm_b32 v13, v65, v64, s28
    v_accvgpr_write_b32 a84, v13
    s_mov_b32 s30, 1192960
    buffer_load_ushort v64, v3, s[16:19], s30 offen
    buffer_load_ushort v65, v3, s[16:19], s30 offen offset:3072
    s_waitcnt vmcnt(58)
    v_perm_b32 v13, v67, v66, s28
    v_accvgpr_write_b32 a85, v13
    s_mov_b32 s30, 1199104
    buffer_load_ushort v66, v3, s[16:19], s30 offen
    buffer_load_ushort v67, v3, s[16:19], s30 offen offset:3072
    s_waitcnt vmcnt(58)
    v_perm_b32 v13, v69, v68, s28
    v_accvgpr_write_b32 a86, v13
    s_mov_b32 s30, 1278976
    buffer_load_ushort v68, v3, s[16:19], s30 offen
    buffer_load_ushort v69, v3, s[16:19], s30 offen offset:3072
    s_waitcnt vmcnt(58)
    v_perm_b32 v13, v71, v70, s28
    v_accvgpr_write_b32 a87, v13
    s_mov_b32 s30, 1285120
    buffer_load_ushort v70, v3, s[16:19], s30 offen
    buffer_load_ushort v71, v3, s[16:19], s30 offen offset:3072
    s_waitcnt vmcnt(58)
    v_perm_b32 v13, v73, v72, s28
    v_accvgpr_write_b32 a88, v13
    s_mov_b32 s30, 1291264
    buffer_load_ushort v72, v3, s[16:19], s30 offen
    buffer_load_ushort v73, v3, s[16:19], s30 offen offset:3072
    s_waitcnt vmcnt(58)
    v_perm_b32 v13, v75, v74, s28
    v_accvgpr_write_b32 a89, v13
    s_mov_b32 s30, 1297408
    buffer_load_ushort v74, v3, s[16:19], s30 offen
    buffer_load_ushort v75, v3, s[16:19], s30 offen offset:3072
    s_waitcnt vmcnt(58)
    v_perm_b32 v13, v17, v16, s28
    v_accvgpr_write_b32 a90, v13
    s_mov_b32 s30, 1377280
    buffer_load_ushort v16, v3, s[16:19], s30 offen
    buffer_load_ushort v17, v3, s[16:19], s30 offen offset:3072
    s_waitcnt vmcnt(58)
    v_perm_b32 v13, v19, v18, s28
    v_accvgpr_write_b32 a91, v13
    s_mov_b32 s30, 1383424
    buffer_load_ushort v18, v3, s[16:19], s30 offen
    buffer_load_ushort v19, v3, s[16:19], s30 offen offset:3072
    s_waitcnt vmcnt(58)
    v_perm_b32 v13, v21, v20, s28
    v_accvgpr_write_b32 a92, v13
    s_mov_b32 s30, 1389568
    buffer_load_ushort v20, v3, s[16:19], s30 offen
    buffer_load_ushort v21, v3, s[16:19], s30 offen offset:3072
    s_waitcnt vmcnt(58)
    v_perm_b32 v13, v23, v22, s28
    v_accvgpr_write_b32 a93, v13
    s_mov_b32 s30, 1395712
    buffer_load_ushort v22, v3, s[16:19], s30 offen
    buffer_load_ushort v23, v3, s[16:19], s30 offen offset:3072
    s_waitcnt vmcnt(58)
    v_perm_b32 v13, v25, v24, s28
    v_accvgpr_write_b32 a94, v13
    s_mov_b32 s30, 1475584
    buffer_load_ushort v24, v3, s[16:19], s30 offen
    buffer_load_ushort v25, v3, s[16:19], s30 offen offset:3072
    s_waitcnt vmcnt(58)
    v_perm_b32 v13, v27, v26, s28
    v_accvgpr_write_b32 a95, v13
    s_mov_b32 s30, 1481728
    buffer_load_ushort v26, v3, s[16:19], s30 offen
    buffer_load_ushort v27, v3, s[16:19], s30 offen offset:3072
    s_waitcnt vmcnt(58)
    v_perm_b32 v13, v29, v28, s28
    v_accvgpr_write_b32 a96, v13
    s_mov_b32 s30, 1487872
    buffer_load_ushort v28, v3, s[16:19], s30 offen
    buffer_load_ushort v29, v3, s[16:19], s30 offen offset:3072
    s_waitcnt vmcnt(58)
    v_perm_b32 v13, v31, v30, s28
    v_accvgpr_write_b32 a97, v13
    s_mov_b32 s30, 1494016
    buffer_load_ushort v30, v3, s[16:19], s30 offen
    buffer_load_ushort v31, v3, s[16:19], s30 offen offset:3072
    s_waitcnt vmcnt(58)
    v_perm_b32 v13, v33, v32, s28
    v_accvgpr_write_b32 a98, v13
    s_mov_b32 s30, 2048
    buffer_load_ushort v32, v3, s[16:19], s30 offen
    buffer_load_ushort v33, v3, s[16:19], s30 offen offset:3072
    s_waitcnt vmcnt(58)
    v_perm_b32 v13, v35, v34, s28
    v_accvgpr_write_b32 a99, v13
    s_mov_b32 s30, 8192
    buffer_load_ushort v34, v3, s[16:19], s30 offen
    buffer_load_ushort v35, v3, s[16:19], s30 offen offset:3072
    s_waitcnt vmcnt(58)
    v_perm_b32 v13, v37, v36, s28
    v_accvgpr_write_b32 a100, v13
    s_mov_b32 s30, 14336
    buffer_load_ushort v36, v3, s[16:19], s30 offen
    buffer_load_ushort v37, v3, s[16:19], s30 offen offset:3072
    s_waitcnt vmcnt(58)
    v_perm_b32 v13, v39, v38, s28
    v_accvgpr_write_b32 a101, v13
    s_mov_b32 s30, 20480
    buffer_load_ushort v38, v3, s[16:19], s30 offen
    buffer_load_ushort v39, v3, s[16:19], s30 offen offset:3072
    s_waitcnt vmcnt(58)
    v_perm_b32 v13, v41, v40, s28
    v_accvgpr_write_b32 a102, v13
    s_mov_b32 s30, 100352
    buffer_load_ushort v40, v3, s[16:19], s30 offen
    buffer_load_ushort v41, v3, s[16:19], s30 offen offset:3072
    s_waitcnt vmcnt(58)
    v_perm_b32 v13, v43, v42, s28
    v_accvgpr_write_b32 a103, v13
    s_mov_b32 s30, 106496
    buffer_load_ushort v42, v3, s[16:19], s30 offen
    buffer_load_ushort v43, v3, s[16:19], s30 offen offset:3072
    s_waitcnt vmcnt(58)
    v_perm_b32 v13, v45, v44, s28
    v_accvgpr_write_b32 a104, v13
    s_mov_b32 s30, 112640
    buffer_load_ushort v44, v3, s[16:19], s30 offen
    buffer_load_ushort v45, v3, s[16:19], s30 offen offset:3072
    s_waitcnt vmcnt(58)
    v_perm_b32 v13, v47, v46, s28
    v_accvgpr_write_b32 a105, v13
    s_mov_b32 s30, 118784
    buffer_load_ushort v46, v3, s[16:19], s30 offen
    buffer_load_ushort v47, v3, s[16:19], s30 offen offset:3072
    s_waitcnt vmcnt(58)
    v_perm_b32 v13, v49, v48, s28
    v_accvgpr_write_b32 a106, v13
    s_mov_b32 s30, 198656
    buffer_load_ushort v48, v3, s[16:19], s30 offen
    buffer_load_ushort v49, v3, s[16:19], s30 offen offset:3072
    s_waitcnt vmcnt(58)
    v_perm_b32 v13, v51, v50, s28
    v_accvgpr_write_b32 a107, v13
    s_mov_b32 s30, 204800
    buffer_load_ushort v50, v3, s[16:19], s30 offen
    buffer_load_ushort v51, v3, s[16:19], s30 offen offset:3072
    s_waitcnt vmcnt(58)
    v_perm_b32 v13, v53, v52, s28
    v_accvgpr_write_b32 a108, v13
    s_mov_b32 s30, 210944
    buffer_load_ushort v52, v3, s[16:19], s30 offen
    buffer_load_ushort v53, v3, s[16:19], s30 offen offset:3072
    s_waitcnt vmcnt(58)
    v_perm_b32 v13, v55, v54, s28
    v_accvgpr_write_b32 a109, v13
    s_mov_b32 s30, 217088
    buffer_load_ushort v54, v3, s[16:19], s30 offen
    buffer_load_ushort v55, v3, s[16:19], s30 offen offset:3072
    s_waitcnt vmcnt(58)
    v_perm_b32 v13, v57, v56, s28
    v_accvgpr_write_b32 a110, v13
    s_mov_b32 s30, 296960
    buffer_load_ushort v56, v3, s[16:19], s30 offen
    buffer_load_ushort v57, v3, s[16:19], s30 offen offset:3072
    s_waitcnt vmcnt(58)
    v_perm_b32 v13, v59, v58, s28
    v_accvgpr_write_b32 a111, v13
    s_mov_b32 s30, 303104
    buffer_load_ushort v58, v3, s[16:19], s30 offen
    buffer_load_ushort v59, v3, s[16:19], s30 offen offset:3072
    s_waitcnt vmcnt(58)
    v_perm_b32 v13, v61, v60, s28
    v_accvgpr_write_b32 a112, v13
    s_mov_b32 s30, 309248
    buffer_load_ushort v60, v3, s[16:19], s30 offen
    buffer_load_ushort v61, v3, s[16:19], s30 offen offset:3072
    s_waitcnt vmcnt(58)
    v_perm_b32 v13, v63, v62, s28
    v_accvgpr_write_b32 a113, v13
    s_mov_b32 s30, 315392
    buffer_load_ushort v62, v3, s[16:19], s30 offen
    buffer_load_ushort v63, v3, s[16:19], s30 offen offset:3072
    s_waitcnt vmcnt(58)
    v_perm_b32 v13, v65, v64, s28
    v_accvgpr_write_b32 a114, v13
    s_mov_b32 s30, 395264
    buffer_load_ushort v64, v3, s[16:19], s30 offen
    buffer_load_ushort v65, v3, s[16:19], s30 offen offset:3072
    s_waitcnt vmcnt(58)
    v_perm_b32 v13, v67, v66, s28
    v_accvgpr_write_b32 a115, v13
    s_mov_b32 s30, 401408
    buffer_load_ushort v66, v3, s[16:19], s30 offen
    buffer_load_ushort v67, v3, s[16:19], s30 offen offset:3072
    s_waitcnt vmcnt(58)
    v_perm_b32 v13, v69, v68, s28
    v_accvgpr_write_b32 a116, v13
    s_mov_b32 s30, 407552
    buffer_load_ushort v68, v3, s[16:19], s30 offen
    buffer_load_ushort v69, v3, s[16:19], s30 offen offset:3072
    s_waitcnt vmcnt(58)
    v_perm_b32 v13, v71, v70, s28
    v_accvgpr_write_b32 a117, v13
    s_mov_b32 s30, 413696
    buffer_load_ushort v70, v3, s[16:19], s30 offen
    buffer_load_ushort v71, v3, s[16:19], s30 offen offset:3072
    s_waitcnt vmcnt(58)
    v_perm_b32 v13, v73, v72, s28
    v_accvgpr_write_b32 a118, v13
    s_mov_b32 s30, 493568
    buffer_load_ushort v72, v3, s[16:19], s30 offen
    buffer_load_ushort v73, v3, s[16:19], s30 offen offset:3072
    s_waitcnt vmcnt(58)
    v_perm_b32 v13, v75, v74, s28
    v_accvgpr_write_b32 a119, v13
    s_mov_b32 s30, 499712
    buffer_load_ushort v74, v3, s[16:19], s30 offen
    buffer_load_ushort v75, v3, s[16:19], s30 offen offset:3072
    s_waitcnt vmcnt(58)
    v_perm_b32 v13, v17, v16, s28
    v_accvgpr_write_b32 a120, v13
    s_mov_b32 s30, 505856
    buffer_load_ushort v16, v3, s[16:19], s30 offen
    buffer_load_ushort v17, v3, s[16:19], s30 offen offset:3072
    s_waitcnt vmcnt(58)
    v_perm_b32 v13, v19, v18, s28
    v_accvgpr_write_b32 a121, v13
    s_mov_b32 s30, 512000
    buffer_load_ushort v18, v3, s[16:19], s30 offen
    buffer_load_ushort v19, v3, s[16:19], s30 offen offset:3072
    s_waitcnt vmcnt(58)
    v_perm_b32 v13, v21, v20, s28
    v_accvgpr_write_b32 a122, v13
    s_mov_b32 s30, 591872
    buffer_load_ushort v20, v3, s[16:19], s30 offen
    buffer_load_ushort v21, v3, s[16:19], s30 offen offset:3072
    s_waitcnt vmcnt(58)
    v_perm_b32 v13, v23, v22, s28
    v_accvgpr_write_b32 a123, v13
    s_mov_b32 s30, 598016
    buffer_load_ushort v22, v3, s[16:19], s30 offen
    buffer_load_ushort v23, v3, s[16:19], s30 offen offset:3072
    s_waitcnt vmcnt(58)
    v_perm_b32 v13, v25, v24, s28
    v_accvgpr_write_b32 a124, v13
    s_mov_b32 s30, 604160
    buffer_load_ushort v24, v3, s[16:19], s30 offen
    buffer_load_ushort v25, v3, s[16:19], s30 offen offset:3072
    s_waitcnt vmcnt(58)
    v_perm_b32 v13, v27, v26, s28
    v_accvgpr_write_b32 a125, v13
    s_mov_b32 s30, 610304
    buffer_load_ushort v26, v3, s[16:19], s30 offen
    buffer_load_ushort v27, v3, s[16:19], s30 offen offset:3072
    s_waitcnt vmcnt(58)
    v_perm_b32 v13, v29, v28, s28
    v_accvgpr_write_b32 a126, v13
    s_mov_b32 s30, 690176
    buffer_load_ushort v28, v3, s[16:19], s30 offen
    buffer_load_ushort v29, v3, s[16:19], s30 offen offset:3072
    s_waitcnt vmcnt(58)
    v_perm_b32 v13, v31, v30, s28
    v_accvgpr_write_b32 a127, v13
    s_mov_b32 s30, 696320
    buffer_load_ushort v30, v3, s[16:19], s30 offen
    buffer_load_ushort v31, v3, s[16:19], s30 offen offset:3072
    s_waitcnt vmcnt(58)
    v_perm_b32 v13, v33, v32, s28
    v_accvgpr_write_b32 a128, v13
    s_mov_b32 s30, 702464
    buffer_load_ushort v32, v3, s[16:19], s30 offen
    buffer_load_ushort v33, v3, s[16:19], s30 offen offset:3072
    s_waitcnt vmcnt(58)
    v_perm_b32 v13, v35, v34, s28
    v_accvgpr_write_b32 a129, v13
    s_mov_b32 s30, 708608
    buffer_load_ushort v34, v3, s[16:19], s30 offen
    buffer_load_ushort v35, v3, s[16:19], s30 offen offset:3072
    s_waitcnt vmcnt(58)
    v_perm_b32 v13, v37, v36, s28
    v_accvgpr_write_b32 a130, v13
    s_mov_b32 s30, 788480
    buffer_load_ushort v36, v3, s[16:19], s30 offen
    buffer_load_ushort v37, v3, s[16:19], s30 offen offset:3072
    s_waitcnt vmcnt(58)
    v_perm_b32 v13, v39, v38, s28
    v_accvgpr_write_b32 a131, v13
    s_mov_b32 s30, 794624
    buffer_load_ushort v38, v3, s[16:19], s30 offen
    buffer_load_ushort v39, v3, s[16:19], s30 offen offset:3072
    s_waitcnt vmcnt(58)
    v_perm_b32 v13, v41, v40, s28
    v_accvgpr_write_b32 a132, v13
    s_mov_b32 s30, 800768
    buffer_load_ushort v40, v3, s[16:19], s30 offen
    buffer_load_ushort v41, v3, s[16:19], s30 offen offset:3072
    s_waitcnt vmcnt(58)
    v_perm_b32 v13, v43, v42, s28
    v_accvgpr_write_b32 a133, v13
    s_mov_b32 s30, 806912
    buffer_load_ushort v42, v3, s[16:19], s30 offen
    buffer_load_ushort v43, v3, s[16:19], s30 offen offset:3072
    s_waitcnt vmcnt(58)
    v_perm_b32 v13, v45, v44, s28
    v_accvgpr_write_b32 a134, v13
    s_mov_b32 s30, 886784
    buffer_load_ushort v44, v3, s[16:19], s30 offen
    buffer_load_ushort v45, v3, s[16:19], s30 offen offset:3072
    s_waitcnt vmcnt(58)
    v_perm_b32 v13, v47, v46, s28
    v_accvgpr_write_b32 a135, v13
    s_mov_b32 s30, 892928
    buffer_load_ushort v46, v3, s[16:19], s30 offen
    buffer_load_ushort v47, v3, s[16:19], s30 offen offset:3072
    s_waitcnt vmcnt(58)
    v_perm_b32 v13, v49, v48, s28
    v_accvgpr_write_b32 a136, v13
    s_mov_b32 s30, 899072
    buffer_load_ushort v48, v3, s[16:19], s30 offen
    buffer_load_ushort v49, v3, s[16:19], s30 offen offset:3072
    s_waitcnt vmcnt(58)
    v_perm_b32 v13, v51, v50, s28
    v_accvgpr_write_b32 a137, v13
    s_mov_b32 s30, 905216
    buffer_load_ushort v50, v3, s[16:19], s30 offen
    buffer_load_ushort v51, v3, s[16:19], s30 offen offset:3072
    s_waitcnt vmcnt(58)
    v_perm_b32 v13, v53, v52, s28
    v_accvgpr_write_b32 a138, v13
    s_mov_b32 s30, 985088
    buffer_load_ushort v52, v3, s[16:19], s30 offen
    buffer_load_ushort v53, v3, s[16:19], s30 offen offset:3072
    s_waitcnt vmcnt(58)
    v_perm_b32 v13, v55, v54, s28
    v_accvgpr_write_b32 a139, v13
    s_mov_b32 s30, 991232
    buffer_load_ushort v54, v3, s[16:19], s30 offen
    buffer_load_ushort v55, v3, s[16:19], s30 offen offset:3072
    s_waitcnt vmcnt(58)
    v_perm_b32 v13, v57, v56, s28
    v_accvgpr_write_b32 a140, v13
    s_mov_b32 s30, 997376
    buffer_load_ushort v56, v3, s[16:19], s30 offen
    buffer_load_ushort v57, v3, s[16:19], s30 offen offset:3072
    s_waitcnt vmcnt(58)
    v_perm_b32 v13, v59, v58, s28
    v_accvgpr_write_b32 a141, v13
    s_mov_b32 s30, 1003520
    buffer_load_ushort v58, v3, s[16:19], s30 offen
    buffer_load_ushort v59, v3, s[16:19], s30 offen offset:3072
    s_waitcnt vmcnt(58)
    v_perm_b32 v13, v61, v60, s28
    v_accvgpr_write_b32 a142, v13
    s_mov_b32 s30, 1083392
    buffer_load_ushort v60, v3, s[16:19], s30 offen
    buffer_load_ushort v61, v3, s[16:19], s30 offen offset:3072
    s_waitcnt vmcnt(58)
    v_perm_b32 v13, v63, v62, s28
    v_accvgpr_write_b32 a143, v13
    s_mov_b32 s30, 1089536
    buffer_load_ushort v62, v3, s[16:19], s30 offen
    buffer_load_ushort v63, v3, s[16:19], s30 offen offset:3072
    s_waitcnt vmcnt(58)
    v_perm_b32 v13, v65, v64, s28
    v_accvgpr_write_b32 a144, v13
    s_mov_b32 s30, 1095680
    buffer_load_ushort v64, v3, s[16:19], s30 offen
    buffer_load_ushort v65, v3, s[16:19], s30 offen offset:3072
    s_waitcnt vmcnt(58)
    v_perm_b32 v13, v67, v66, s28
    v_accvgpr_write_b32 a145, v13
    s_mov_b32 s30, 1101824
    buffer_load_ushort v66, v3, s[16:19], s30 offen
    buffer_load_ushort v67, v3, s[16:19], s30 offen offset:3072
    s_waitcnt vmcnt(58)
    v_perm_b32 v13, v69, v68, s28
    v_accvgpr_write_b32 a146, v13
    s_mov_b32 s30, 1181696
    buffer_load_ushort v68, v3, s[16:19], s30 offen
    buffer_load_ushort v69, v3, s[16:19], s30 offen offset:3072
    s_waitcnt vmcnt(58)
    v_perm_b32 v13, v71, v70, s28
    v_accvgpr_write_b32 a147, v13
    s_mov_b32 s30, 1187840
    buffer_load_ushort v70, v3, s[16:19], s30 offen
    buffer_load_ushort v71, v3, s[16:19], s30 offen offset:3072
    s_waitcnt vmcnt(58)
    v_perm_b32 v13, v73, v72, s28
    v_accvgpr_write_b32 a148, v13
    s_mov_b32 s30, 1193984
    buffer_load_ushort v72, v3, s[16:19], s30 offen
    buffer_load_ushort v73, v3, s[16:19], s30 offen offset:3072
    s_waitcnt vmcnt(58)
    v_perm_b32 v13, v75, v74, s28
    v_accvgpr_write_b32 a149, v13
    s_mov_b32 s30, 1200128
    buffer_load_ushort v74, v3, s[16:19], s30 offen
    buffer_load_ushort v75, v3, s[16:19], s30 offen offset:3072
    s_waitcnt vmcnt(58)
    v_perm_b32 v13, v17, v16, s28
    v_accvgpr_write_b32 a150, v13
    s_mov_b32 s30, 1280000
    buffer_load_ushort v16, v3, s[16:19], s30 offen
    buffer_load_ushort v17, v3, s[16:19], s30 offen offset:3072
    s_waitcnt vmcnt(58)
    v_perm_b32 v13, v19, v18, s28
    v_accvgpr_write_b32 a151, v13
    s_mov_b32 s30, 1286144
    buffer_load_ushort v18, v3, s[16:19], s30 offen
    buffer_load_ushort v19, v3, s[16:19], s30 offen offset:3072
    s_waitcnt vmcnt(58)
    v_perm_b32 v13, v21, v20, s28
    v_accvgpr_write_b32 a152, v13
    s_mov_b32 s30, 1292288
    buffer_load_ushort v20, v3, s[16:19], s30 offen
    buffer_load_ushort v21, v3, s[16:19], s30 offen offset:3072
    s_waitcnt vmcnt(58)
    v_perm_b32 v13, v23, v22, s28
    v_accvgpr_write_b32 a153, v13
    s_mov_b32 s30, 1298432
    buffer_load_ushort v22, v3, s[16:19], s30 offen
    buffer_load_ushort v23, v3, s[16:19], s30 offen offset:3072
    s_waitcnt vmcnt(58)
    v_perm_b32 v13, v25, v24, s28
    v_accvgpr_write_b32 a154, v13
    s_mov_b32 s30, 1378304
    buffer_load_ushort v24, v3, s[16:19], s30 offen
    buffer_load_ushort v25, v3, s[16:19], s30 offen offset:3072
    s_waitcnt vmcnt(58)
    v_perm_b32 v13, v27, v26, s28
    v_accvgpr_write_b32 a155, v13
    s_mov_b32 s30, 1384448
    buffer_load_ushort v26, v3, s[16:19], s30 offen
    buffer_load_ushort v27, v3, s[16:19], s30 offen offset:3072
    s_waitcnt vmcnt(58)
    v_perm_b32 v13, v29, v28, s28
    v_accvgpr_write_b32 a156, v13
    s_mov_b32 s30, 1390592
    buffer_load_ushort v28, v3, s[16:19], s30 offen
    buffer_load_ushort v29, v3, s[16:19], s30 offen offset:3072
    s_waitcnt vmcnt(58)
    v_perm_b32 v13, v31, v30, s28
    v_accvgpr_write_b32 a157, v13
    s_mov_b32 s30, 1396736
    buffer_load_ushort v30, v3, s[16:19], s30 offen
    buffer_load_ushort v31, v3, s[16:19], s30 offen offset:3072
    s_waitcnt vmcnt(58)
    v_perm_b32 v13, v33, v32, s28
    v_accvgpr_write_b32 a158, v13
    s_mov_b32 s30, 1476608
    buffer_load_ushort v32, v3, s[16:19], s30 offen
    buffer_load_ushort v33, v3, s[16:19], s30 offen offset:3072
    s_waitcnt vmcnt(58)
    v_perm_b32 v13, v35, v34, s28
    v_accvgpr_write_b32 a159, v13
    s_mov_b32 s30, 1482752
    buffer_load_ushort v34, v3, s[16:19], s30 offen
    buffer_load_ushort v35, v3, s[16:19], s30 offen offset:3072
    s_waitcnt vmcnt(58)
    v_perm_b32 v13, v37, v36, s28
    v_accvgpr_write_b32 a160, v13
    s_mov_b32 s30, 1488896
    buffer_load_ushort v36, v3, s[16:19], s30 offen
    buffer_load_ushort v37, v3, s[16:19], s30 offen offset:3072
    s_waitcnt vmcnt(58)
    v_perm_b32 v13, v39, v38, s28
    v_accvgpr_write_b32 a161, v13
    s_mov_b32 s30, 1495040
    buffer_load_ushort v38, v3, s[16:19], s30 offen
    buffer_load_ushort v39, v3, s[16:19], s30 offen offset:3072
    s_waitcnt vmcnt(58)
    v_perm_b32 v13, v41, v40, s28
    v_accvgpr_write_b32 a162, v13
    s_waitcnt vmcnt(56)
    v_perm_b32 v13, v43, v42, s28
    v_accvgpr_write_b32 a163, v13
    s_waitcnt vmcnt(54)
    v_perm_b32 v13, v45, v44, s28
    v_accvgpr_write_b32 a164, v13
    s_waitcnt vmcnt(52)
    v_perm_b32 v13, v47, v46, s28
    v_accvgpr_write_b32 a165, v13
    s_waitcnt vmcnt(50)
    v_perm_b32 v13, v49, v48, s28
    v_accvgpr_write_b32 a166, v13
    s_waitcnt vmcnt(48)
    v_perm_b32 v13, v51, v50, s28
    v_accvgpr_write_b32 a167, v13
    s_waitcnt vmcnt(46)
    v_perm_b32 v13, v53, v52, s28
    v_accvgpr_write_b32 a168, v13
    s_waitcnt vmcnt(44)
    v_perm_b32 v13, v55, v54, s28
    v_accvgpr_write_b32 a169, v13
    s_waitcnt vmcnt(42)
    v_perm_b32 v13, v57, v56, s28
    v_accvgpr_write_b32 a170, v13
    s_waitcnt vmcnt(40)
    v_perm_b32 v13, v59, v58, s28
    v_accvgpr_write_b32 a171, v13
    s_waitcnt vmcnt(38)
    v_perm_b32 v13, v61, v60, s28
    v_accvgpr_write_b32 a172, v13
    s_waitcnt vmcnt(36)
    v_perm_b32 v13, v63, v62, s28
    v_accvgpr_write_b32 a173, v13
    s_waitcnt vmcnt(34)
    v_perm_b32 v13, v65, v64, s28
    v_accvgpr_write_b32 a174, v13
    s_waitcnt vmcnt(32)
    v_perm_b32 v13, v67, v66, s28
    v_accvgpr_write_b32 a175, v13
    s_waitcnt vmcnt(30)
    v_perm_b32 v13, v69, v68, s28
    v_accvgpr_write_b32 a176, v13
    s_waitcnt vmcnt(28)
    v_perm_b32 v13, v71, v70, s28
    v_accvgpr_write_b32 a177, v13
    s_waitcnt vmcnt(26)
    v_perm_b32 v13, v73, v72, s28
    v_accvgpr_write_b32 a178, v13
    s_waitcnt vmcnt(24)
    v_perm_b32 v13, v75, v74, s28
    v_accvgpr_write_b32 a179, v13
    s_waitcnt vmcnt(22)
    v_perm_b32 v13, v17, v16, s28
    v_accvgpr_write_b32 a180, v13
    s_waitcnt vmcnt(20)
    v_perm_b32 v13, v19, v18, s28
    v_accvgpr_write_b32 a181, v13
    s_waitcnt vmcnt(18)
    v_perm_b32 v13, v21, v20, s28
    v_accvgpr_write_b32 a182, v13
    s_waitcnt vmcnt(16)
    v_perm_b32 v13, v23, v22, s28
    v_accvgpr_write_b32 a183, v13
    s_waitcnt vmcnt(14)
    v_perm_b32 v13, v25, v24, s28
    v_accvgpr_write_b32 a184, v13
    s_waitcnt vmcnt(12)
    v_perm_b32 v13, v27, v26, s28
    v_accvgpr_write_b32 a185, v13
    s_waitcnt vmcnt(10)
    v_perm_b32 v13, v29, v28, s28
    v_accvgpr_write_b32 a186, v13
    s_waitcnt vmcnt(8)
    v_perm_b32 v13, v31, v30, s28
    v_accvgpr_write_b32 a187, v13
    s_waitcnt vmcnt(6)
    v_perm_b32 v13, v33, v32, s28
    v_accvgpr_write_b32 a188, v13
    s_waitcnt vmcnt(4)
    v_perm_b32 v13, v35, v34, s28
    v_accvgpr_write_b32 a189, v13
    s_waitcnt vmcnt(2)
    v_perm_b32 v13, v37, v36, s28
    v_accvgpr_write_b32 a190, v13
    s_waitcnt vmcnt(0)
    v_perm_b32 v13, v39, v38, s28
    v_accvgpr_write_b32 a191, v13
    v_and_b32 v13, 15, v0
    v_lshrrev_b32 v14, 4, v0
    v_lshlrev_b32 v8, 5, v13
    v_add_u32 v8, 32768, v8
    s_lshl_b32 s30, s24, 3
    v_add_u32 v7, s30, v8
    v_mul_u32_u24 v9, 80, v14
    v_lshrrev_b32 v15, 2, v13
    v_cmp_eq_u32 s[50:51], v15, v14
    v_and_b32 v15, 3, v13
    v_cmp_eq_u32 s[52:53], 1, v15
    v_cmp_eq_u32 s[54:55], 2, v15
    v_cmp_eq_u32 s[56:57], 3, v15
    v_mov_b32 v56, 0x3f803f80
    v_mov_b32 v57, 0x3f803f80
    v_mov_b32 v58, 0x3f803f80
    v_mov_b32 v59, 0x3f803f80
    s_nop 1
    v_mfma_f32_16x16x32_bf16 v[84:87], a[0:3], v[56:59], 0
    v_mfma_f32_16x16x32_bf16 v[88:91], a[64:67], v[56:59], 0
    v_mfma_f32_16x16x32_bf16 v[92:95], v[56:59], a[128:131], 0
    v_mfma_f32_16x16x32_bf16 v[84:87], a[4:7], v[56:59], v[84:87]
    v_mfma_f32_16x16x32_bf16 v[88:91], a[68:71], v[56:59], v[88:91]
    v_mfma_f32_16x16x32_bf16 v[92:95], v[56:59], a[132:135], v[92:95]
    v_mfma_f32_16x16x32_bf16 v[84:87], a[8:11], v[56:59], v[84:87]
    v_mfma_f32_16x16x32_bf16 v[88:91], a[72:75], v[56:59], v[88:91]
    v_mfma_f32_16x16x32_bf16 v[92:95], v[56:59], a[136:139], v[92:95]
    v_mfma_f32_16x16x32_bf16 v[84:87], a[12:15], v[56:59], v[84:87]
    v_mfma_f32_16x16x32_bf16 v[88:91], a[76:79], v[56:59], v[88:91]
    v_mfma_f32_16x16x32_bf16 v[92:95], v[56:59], a[140:143], v[92:95]
    v_mfma_f32_16x16x32_bf16 v[84:87], a[16:19], v[56:59], v[84:87]
    v_mfma_f32_16x16x32_bf16 v[88:91], a[80:83], v[56:59], v[88:91]
    v_mfma_f32_16x16x32_bf16 v[92:95], v[56:59], a[144:147], v[92:95]
    v_mfma_f32_16x16x32_bf16 v[84:87], a[20:23], v[56:59], v[84:87]
    v_mfma_f32_16x16x32_bf16 v[88:91], a[84:87], v[56:59], v[88:91]
    v_mfma_f32_16x16x32_bf16 v[92:95], v[56:59], a[148:151], v[92:95]
    v_mfma_f32_16x16x32_bf16 v[84:87], a[24:27], v[56:59], v[84:87]
    v_mfma_f32_16x16x32_bf16 v[88:91], a[88:91], v[56:59], v[88:91]
    v_mfma_f32_16x16x32_bf16 v[92:95], v[56:59], a[152:155], v[92:95]
    v_mfma_f32_16x16x32_bf16 v[84:87], a[28:31], v[56:59], v[84:87]
    v_mfma_f32_16x16x32_bf16 v[88:91], a[92:95], v[56:59], v[88:91]
    v_mfma_f32_16x16x32_bf16 v[92:95], v[56:59], a[156:159], v[92:95]
    v_mfma_f32_16x16x32_bf16 v[84:87], a[32:35], v[56:59], v[84:87]
    v_mfma_f32_16x16x32_bf16 v[88:91], a[96:99], v[56:59], v[88:91]
    v_mfma_f32_16x16x32_bf16 v[92:95], v[56:59], a[160:163], v[92:95]
    v_mfma_f32_16x16x32_bf16 v[84:87], a[36:39], v[56:59], v[84:87]
    v_mfma_f32_16x16x32_bf16 v[88:91], a[100:103], v[56:59], v[88:91]
    v_mfma_f32_16x16x32_bf16 v[92:95], v[56:59], a[164:167], v[92:95]
    v_mfma_f32_16x16x32_bf16 v[84:87], a[40:43], v[56:59], v[84:87]
    v_mfma_f32_16x16x32_bf16 v[88:91], a[104:107], v[56:59], v[88:91]
    v_mfma_f32_16x16x32_bf16 v[92:95], v[56:59], a[168:171], v[92:95]
    v_mfma_f32_16x16x32_bf16 v[84:87], a[44:47], v[56:59], v[84:87]
    v_mfma_f32_16x16x32_bf16 v[88:91], a[108:111], v[56:59], v[88:91]
    v_mfma_f32_16x16x32_bf16 v[92:95], v[56:59], a[172:175], v[92:95]
    v_mfma_f32_16x16x32_bf16 v[84:87], a[48:51], v[56:59], v[84:87]
    v_mfma_f32_16x16x32_bf16 v[88:91], a[112:115], v[56:59], v[88:91]
    v_mfma_f32_16x16x32_bf16 v[92:95], v[56:59], a[176:179], v[92:95]
    v_mfma_f32_16x16x32_bf16 v[84:87], a[52:55], v[56:59], v[84:87]
    v_mfma_f32_16x16x32_bf16 v[88:91], a[116:119], v[56:59], v[88:91]
    v_mfma_f32_16x16x32_bf16 v[92:95], v[56:59], a[180:183], v[92:95]
    v_mfma_f32_16x16x32_bf16 v[84:87], a[56:59], v[56:59], v[84:87]
    v_mfma_f32_16x16x32_bf16 v[88:91], a[120:123], v[56:59], v[88:91]
    v_mfma_f32_16x16x32_bf16 v[92:95], v[56:59], a[184:187], v[92:95]
    v_mfma_f32_16x16x32_bf16 v[84:87], a[60:63], v[56:59], v[84:87]
    v_mfma_f32_16x16x32_bf16 v[88:91], a[124:127], v[56:59], v[88:91]
    v_mfma_f32_16x16x32_bf16 v[92:95], v[56:59], a[188:191], v[92:95]
    v_cmp_gt_u32 vcc, 32, v0
    v_lshlrev_b32 v13, 7, v0
    s_lshl_b32 s30, s41, 12
    s_add_u32 s30, s30, 74448896
    v_add_u32 v13, s30, v13
    v_and_b32 v14, 3, v0
    v_lshlrev_b32 v14, 7, v14
    s_lshl_b32 s30, s41, 9
    s_add_u32 s30, s30, 91226112
    v_add_u32 v14, s30, v14
    v_cndmask_b32 v122, v14, v13, vcc
    v_mov_b32 v13, 14
    v_cndmask_b32 v123, v13, 17, vcc
    s_lshl_b32 s31, s32, 2
    s_add_u32 s31, s31, 0
    v_lshlrev_b32 v124, v123, s31
    v_add_u32 v124, v122, v124
    buffer_load_dword v124, v124, s[8:11], 0 offen sc1
    s_waitcnt vmcnt(0)
    s_lshl_b32 s31, s32, 2
    s_add_u32 s31, s31, 1
    v_lshlrev_b32 v124, v123, s31
    v_add_u32 v124, v122, v124
    buffer_load_dword v124, v124, s[8:11], 0 offen sc1
    s_waitcnt vmcnt(0)
    s_lshl_b32 s31, s32, 2
    s_add_u32 s31, s31, 2
    v_lshlrev_b32 v124, v123, s31
    v_add_u32 v124, v122, v124
    buffer_load_dword v124, v124, s[8:11], 0 offen sc1
    s_waitcnt vmcnt(0)
    s_lshl_b32 s31, s32, 2
    s_add_u32 s31, s31, 3
    v_lshlrev_b32 v124, v123, s31
    v_add_u32 v124, v122, v124
    buffer_load_dword v124, v124, s[8:11], 0 offen sc1
    s_waitcnt vmcnt(0)
    v_mov_b32 v13, 0
    s_mov_b32 s27, 0
L_wi_90:
    global_load_dword v14, v13, s[6:7] offset:64 sc1
    s_waitcnt vmcnt(0)
    v_cmp_gt_u32 vcc, 0x100, v14
    s_cbranch_vccz L_wiok_91
    s_sleep 2
    s_add_u32 s27, s27, 1
    s_cmp_lt_u32 s27, 200000
    s_cbranch_scc1 L_wi_90
    s_branch L_x3_fail
L_wiok_91:
    s_lshr_b32 s30, s25, 5
    s_lshl_b32 s30, s30, 2
    s_add_u32 s30, s30, 128
    v_mov_b32 v13, s30
    global_load_dword v14, v13, s[6:7] sc1
    s_waitcnt vmcnt(0)
    v_readfirstlane_b32 s30, v14
    s_cmp_ge_u32 s30, 32
    s_cselect_b32 s49, 1, 0
    s_lshl_b32 s58, s32, 7
    s_lshl_b32 s30, s33, 2
    s_add_u32 s58, s58, s30
    s_add_u32 s58, s58, 4096
L_x3_loop:
    s_mul_i32 s30, s34, 21846
    s_bfe_u32 s30, s30, 0x20010
    s_lshl_b32 s35, s32, 2
    s_add_u32 s35, s35, s30
    s_and_b32 s36, s34, 127
    s_lshl_b32 s30, s36, 14
    s_lshl_b32 s31, s41, 9
    s_add_u32 s45, s30, s31
    s_add_u32 s45, s45, 61865984
    s_lshl_b32 s30, s35, 14
    s_add_u32 s31, s31, s43
    v_lshrrev_b32 v12, 1, v4
    v_add_u32 v12, s31, v12
    s_add_u32 s30, s30, s44
    s_mov_b32 s35, 63963136
    s_add_u32 s37, s30, 91226112
    s_add_u32 s38, s34, 1
    s_mul_i32 s30, s41, 196608
    s_add_u32 s30, s30, s35
    s_lshr_b32 s31, s36, 1
    s_lshl_b32 s31, s31, 10
    s_add_u32 s30, s30, s31
    s_and_b32 s31, s36, 1
    s_lshl_b32 s31, s31, 8
    s_add_u32 s46, s30, s31
    s_add_u32 s47, s46, 65536
    s_add_u32 s48, s47, 65536
    s_add_u32 s48, s48, s31
    s_add_u32 m0, s43, s44
    v_add_u32 v6, m0, v4
    v_add_u32 v5, s43, v4
    s_xor_b32 s43, s43, 0x4000
    s_mov_b32 s27, 0
L_poll_92:
    buffer_load_dword v2, v1, s[8:11], s39 offen sc1
    s_waitcnt vmcnt(0)
    v_cmp_gt_u32 vcc, s38, v2
    s_cbranch_vccz L_pollok_93
    s_sleep 0
    s_add_u32 s27, s27, 1
    s_cmp_lt_u32 s27, 200000
    s_cbranch_scc1 L_poll_92
    s_branch L_x3_fail
L_pollok_93:
    buffer_load_dwordx4 v4, s[8:11], s37 offen offset:0 sc1 lds
    buffer_load_dwordx4 v4, s[8:11], s37 offen offset:1024 sc1 lds
    buffer_load_dwordx4 v4, s[8:11], s37 offen offset:2048 sc1 lds
    buffer_load_dwordx4 v4, s[8:11], s37 offen offset:3072 sc1 lds
    s_waitcnt vmcnt(0)
    s_barrier
    ds_read_b128 v[32:35], v6 offset:0
    ds_read_b128 v[36:39], v6 offset:1024
    ds_read_b128 v[40:43], v6 offset:2048
    ds_read_b128 v[44:47], v6 offset:3072
    s_cmp_lg_u32 s24, 3
    s_cbranch_scc1 L_x3_nf
    v_mov_b32 v124, s38
    s_mov_b64 exec, 1
    s_cmp_eq_u32 s49, 0
    s_cbranch_scc1 L_far_94
    buffer_store_dword v124, v1, s[8:11], s58 offen
L_join_95:
    s_mov_b64 exec, -1
L_x3_nf:
    s_waitcnt lgkmcnt(3)
    v_mfma_f32_16x16x32_bf16 v[52:55], v[32:35], v[32:35], 0
    ds_read_b128 v[16:19], v5 offset:0
    v_mfma_f32_16x16x32_bf16 v[48:51], v[56:59], v[32:35], 0
    s_waitcnt lgkmcnt(3)
    v_mfma_f32_16x16x32_bf16 v[52:55], v[36:39], v[36:39], v[52:55]
    ds_read_b128 v[20:23], v5 offset:1024
    v_mfma_f32_16x16x32_bf16 v[48:51], v[56:59], v[36:39], v[48:51]
    s_waitcnt lgkmcnt(3)
    v_mfma_f32_16x16x32_bf16 v[52:55], v[40:43], v[40:43], v[52:55]
    ds_read_b128 v[24:27], v5 offset:2048
    v_mfma_f32_16x16x32_bf16 v[48:51], v[56:59], v[40:43], v[48:51]
    s_waitcnt lgkmcnt(3)
    v_mfma_f32_16x16x32_bf16 v[52:55], v[44:47], v[44:47], v[52:55]
    ds_read_b64 v[120:121], v12
    v_mfma_f32_16x16x32_bf16 v[48:51], v[56:59], v[44:47], v[48:51]
    s_waitcnt lgkmcnt(3)
    v_mfma_f32_16x16x32_bf16 v[60:63], a[0:3], v[16:19], 0
    ds_read_b128 v[28:31], v5 offset:3072
    v_mfma_f32_16x16x32_bf16 v[64:67], a[64:67], v[16:19], 0
    v_mfma_f32_16x16x32_bf16 v[68:71], v[16:19], a[128:131], 0
    v_cndmask_b32 v52, v52, v53, s[52:53]
    v_cndmask_b32 v52, v52, v54, s[54:55]
    v_cndmask_b32 v49, v52, v55, s[56:57]
    s_mov_b64 exec, s[50:51]
    ds_write_b64 v7, v[48:49]
    s_mov_b64 exec, -1
    s_waitcnt lgkmcnt(4)
    v_mfma_f32_16x16x32_bf16 v[60:63], a[4:7], v[20:23], v[60:63]
    ds_read_b128 v[16:19], v5 offset:4096
    v_mfma_f32_16x16x32_bf16 v[64:67], a[68:71], v[20:23], v[64:67]
    v_mfma_f32_16x16x32_bf16 v[68:71], v[20:23], a[132:135], v[68:71]
    s_waitcnt lgkmcnt(3)
    v_lshrrev_b32 v12, 1, v4
    buffer_store_dwordx2 v[120:121], v12, s[8:11], s45 offen sc1
    v_mfma_f32_16x16x32_bf16 v[60:63], a[8:11], v[24:27], v[60:63]
    ds_read_b128 v[20:23], v5 offset:5120
    v_mfma_f32_16x16x32_bf16 v[64:67], a[72:75], v[24:27], v[64:67]
    v_mfma_f32_16x16x32_bf16 v[68:71], v[24:27], a[136:139], v[68:71]
    s_waitcnt lgkmcnt(2)
    s_barrier
    ds_read_b128 v[32:35], v8
    ds_read_b128 v[36:39], v8 offset:16
    v_mfma_f32_16x16x32_bf16 v[60:63], a[12:15], v[28:31], v[60:63]
    ds_read_b128 v[24:27], v5 offset:6144
    v_mfma_f32_16x16x32_bf16 v[64:67], a[76:79], v[28:31], v[64:67]
    v_mfma_f32_16x16x32_bf16 v[68:71], v[28:31], a[140:143], v[68:71]
    s_waitcnt lgkmcnt(4)
    v_mfma_f32_16x16x32_bf16 v[60:63], a[16:19], v[16:19], v[60:63]
    ds_read_b128 v[28:31], v5 offset:7168
    v_mfma_f32_16x16x32_bf16 v[64:67], a[80:83], v[16:19], v[64:67]
    s_waitcnt lgkmcnt(2)
    v_add_f32 v32, v32, v36
    v_add_f32 v33, v33, v37
    v_mfma_f32_16x16x32_bf16 v[68:71], v[16:19], a[144:147], v[68:71]
    v_add_f32 v34, v34, v38
    v_add_f32 v35, v35, v39
    v_mfma_f32_16x16x32_bf16 v[60:63], a[20:23], v[20:23], v[60:63]
    ds_read_b128 v[16:19], v5 offset:8192
    v_add_f32 v32, v32, v34
    v_mfma_f32_16x16x32_bf16 v[64:67], a[84:87], v[20:23], v[64:67]
    v_add_f32 v33, v33, v35
    v_mul_f32 v32, 0xbb000000, v32
    v_mfma_f32_16x16x32_bf16 v[68:71], v[20:23], a[148:151], v[68:71]
    s_waitcnt lgkmcnt(2)
    v_mul_f32 v33, 0x3b000000, v33
    v_fma_f32 v33, -v32, v32, v33
    v_mfma_f32_16x16x32_bf16 v[60:63], a[24:27], v[24:27], v[60:63]
    ds_read_b128 v[20:23], v5 offset:9216
    v_max_f32 v33, 0, v33
    v_mfma_f32_16x16x32_bf16 v[64:67], a[88:91], v[24:27], v[64:67]
    v_add_f32 v33, 0x3727c5ac, v33
    v_mfma_f32_16x16x32_bf16 v[68:71], v[24:27], a[152:155], v[68:71]
    s_waitcnt lgkmcnt(2)
    v_rsq_f32 v108, v33
    v_mfma_f32_16x16x32_bf16 v[60:63], a[28:31], v[28:31], v[60:63]
    ds_read_b128 v[24:27], v5 offset:10240
    s_nop 0
    v_mfma_f32_16x16x32_bf16 v[64:67], a[92:95], v[28:31], v[64:67]
    v_mul_f32 v109, v32, v108
    v_mfma_f32_16x16x32_bf16 v[68:71], v[28:31], a[156:159], v[68:71]
    s_waitcnt lgkmcnt(2)
    ds_bpermute_b32 v110, v9, v108 offset:0
    v_mfma_f32_16x16x32_bf16 v[60:63], a[32:35], v[16:19], v[60:63]
    ds_read_b128 v[28:31], v5 offset:11264
    v_mfma_f32_16x16x32_bf16 v[64:67], a[96:99], v[16:19], v[64:67]
    ds_bpermute_b32 v114, v9, v109 offset:0
    v_mfma_f32_16x16x32_bf16 v[68:71], v[16:19], a[160:163], v[68:71]
    s_waitcnt lgkmcnt(4)
    ds_bpermute_b32 v111, v9, v108 offset:4
    v_mfma_f32_16x16x32_bf16 v[60:63], a[36:39], v[20:23], v[60:63]
    ds_read_b128 v[16:19], v5 offset:12288
    v_mfma_f32_16x16x32_bf16 v[64:67], a[100:103], v[20:23], v[64:67]
    ds_bpermute_b32 v115, v9, v109 offset:4
    v_mfma_f32_16x16x32_bf16 v[68:71], v[20:23], a[164:167], v[68:71]
    s_waitcnt lgkmcnt(6)
    ds_bpermute_b32 v112, v9, v108 offset:8
    v_mfma_f32_16x16x32_bf16 v[60:63], a[40:43], v[24:27], v[60:63]
    ds_read_b128 v[20:23], v5 offset:13312
    v_mfma_f32_16x16x32_bf16 v[64:67], a[104:107], v[24:27], v[64:67]
    ds_bpermute_b32 v116, v9, v109 offset:8
    v_mfma_f32_16x16x32_bf16 v[68:71], v[24:27], a[168:171], v[68:71]
    s_waitcnt lgkmcnt(7)
    ds_bpermute_b32 v113, v9, v108 offset:12
    v_mfma_f32_16x16x32_bf16 v[60:63], a[44:47], v[28:31], v[60:63]
    ds_read_b128 v[24:27], v5 offset:14336
    v_mfma_f32_16x16x32_bf16 v[64:67], a[108:111], v[28:31], v[64:67]
    ds_bpermute_b32 v117, v9, v109 offset:12
    v_mul_f32 v118, s42, v108
    v_mfma_f32_16x16x32_bf16 v[68:71], v[28:31], a[172:175], v[68:71]
    s_waitcnt lgkmcnt(7)
    v_mul_f32 v119, s42, v109
    v_mul_f32 v32, v119, v84
    v_mfma_f32_16x16x32_bf16 v[60:63], a[48:51], v[16:19], v[60:63]
    ds_read_b128 v[28:31], v5 offset:15360
    v_mul_f32 v36, v109, v88
    v_mfma_f32_16x16x32_bf16 v[64:67], a[112:115], v[16:19], v[64:67]
    v_mul_f32 v33, v119, v85
    v_mul_f32 v37, v109, v89
    v_mfma_f32_16x16x32_bf16 v[68:71], v[16:19], a[176:179], v[68:71]
    s_waitcnt lgkmcnt(5)
    v_mul_f32 v34, v119, v86
    v_mul_f32 v38, v109, v90
    v_mfma_f32_16x16x32_bf16 v[60:63], a[52:55], v[20:23], v[60:63]
    v_mul_f32 v35, v119, v87
    v_mul_f32 v39, v109, v91
    v_mfma_f32_16x16x32_bf16 v[64:67], a[116:119], v[20:23], v[64:67]
    s_waitcnt lgkmcnt(1)
    v_mul_f32 v40, v114, v92
    v_mul_f32 v41, v115, v93
    v_mfma_f32_16x16x32_bf16 v[68:71], v[20:23], a[180:183], v[68:71]
    v_mul_f32 v42, v116, v94
    v_mul_f32 v43, v117, v95
    v_mfma_f32_16x16x32_bf16 v[60:63], a[56:59], v[24:27], v[60:63]
    v_mfma_f32_16x16x32_bf16 v[64:67], a[120:123], v[24:27], v[64:67]
    v_mfma_f32_16x16x32_bf16 v[68:71], v[24:27], a[184:187], v[68:71]
    s_waitcnt lgkmcnt(0)
    v_mfma_f32_16x16x32_bf16 v[60:63], a[60:63], v[28:31], v[60:63]
    v_mfma_f32_16x16x32_bf16 v[64:67], a[124:127], v[28:31], v[64:67]
    v_mfma_f32_16x16x32_bf16 v[68:71], v[28:31], a[188:191], v[68:71]
    s_nop 5
    v_fmac_f32 v32, v118, v60
    v_fmac_f32 v33, v118, v61
    v_fmac_f32 v34, v118, v62
    v_fmac_f32 v35, v118, v63
    v_cvt_pk_bf16_f32 v60, v32, v33
    v_cvt_pk_bf16_f32 v61, v34, v35
    buffer_store_dwordx2 v[60:61], v10, s[8:11], s46 offen sc1
    v_fmac_f32 v36, v108, v64
    v_fmac_f32 v37, v108, v65
    v_fmac_f32 v38, v108, v66
    v_fmac_f32 v39, v108, v67
    v_cvt_pk_bf16_f32 v64, v36, v37
    v_cvt_pk_bf16_f32 v65, v38, v39
    buffer_store_dwordx2 v[64:65], v10, s[8:11], s47 offen sc1
    v_fmac_f32 v40, v110, v68
    v_fmac_f32 v41, v111, v69
    v_fmac_f32 v42, v112, v70
    v_fmac_f32 v43, v113, v71
    v_cvt_pk_bf16_f32 v68, v40, v41
    v_cvt_pk_bf16_f32 v69, v42, v43
    buffer_store_dwordx2 v[68:69], v11, s[8:11], s48 offen sc1
    s_waitcnt vmcnt(0)
    v_mov_b32 v13, s38
    s_mov_b64 exec, 1
    buffer_store_dword v13, v1, s[8:11], s40 offen sc1
    s_mov_b64 exec, -1
    s_add_u32 s34, s34, 3
    s_cmp_lt_u32 s34, 256
    s_cbranch_scc1 L_x3_loop
L_x3_fail:
    s_endpgm
L_far_94:
    buffer_store_dword v124, v1, s[8:11], s58 offen sc1
    s_branch L_join_95
L_role_batt:
    s_and_b32 s62, s25, 1
    s_load_dwordx2 s[4:5], s[0:1], 72
    s_waitcnt lgkmcnt(0)
    s_mov_b32 s16, s4
    s_mov_b32 s17, s5
    s_mov_b32 s18, 524288
    s_mov_b32 s19, 0x20000
    s_lshl_b32 s92, s62, 9
    s_lshl_b32 s31, s24, 7
    s_add_u32 s92, s92, s31
    s_lshl_b32 s93, s24, 15
    v_bfe_u32 v16, v0, 3, 1
    v_mul_u32_u24 v14, 16, v16
    v_bfe_u32 v16, v0, 2, 1
    v_mul_u32_u24 v16, 4, v16
    v_add_u32 v14, v14, v16
    v_bfe_u32 v16, v0, 4, 1
    v_add_u32 v14, v14, v16
    v_lshrrev_b32 v16, 5, v0
    v_mul_u32_u24 v16, 2, v16
    v_add_u32 v14, v14, v16
    v_mul_u32_u24 v14, 1024, v14
    v_and_b32 v16, 3, v0
    v_lshl_add_u32 v14, v16, 4, v14
    v_add_u32 v14, s92, v14
    v_lshlrev_b32 v15, 2, v0
    v_add_u32 v15, s93, v15
    s_add_u32 m0, s93, 0
    s_mov_b32 s30, 0
    buffer_load_dwordx4 v14, s[16:19], s30 offen  lds
    s_add_u32 m0, s93, 1024
    s_mov_b32 s30, 8192
    buffer_load_dwordx4 v14, s[16:19], s30 offen  lds
    s_add_u32 m0, s93, 2048
    s_mov_b32 s30, 64
    buffer_load_dwordx4 v14, s[16:19], s30 offen  lds
    s_add_u32 m0, s93, 3072
    s_mov_b32 s30, 8256
    buffer_load_dwordx4 v14, s[16:19], s30 offen  lds
    s_add_u32 m0, s93, 4096
    s_mov_b32 s30, 32768
    buffer_load_dwordx4 v14, s[16:19], s30 offen  lds
    s_add_u32 m0, s93, 5120
    s_mov_b32 s30, 40960
    buffer_load_dwordx4 v14, s[16:19], s30 offen  lds
    s_add_u32 m0, s93, 6144
    s_mov_b32 s30, 32832
    buffer_load_dwordx4 v14, s[16:19], s30 offen  lds
    s_add_u32 m0, s93, 7168
    s_mov_b32 s30, 41024
    buffer_load_dwordx4 v14, s[16:19], s30 offen  lds
    s_add_u32 m0, s93, 8192
    s_mov_b32 s30, 65536
    buffer_load_dwordx4 v14, s[16:19], s30 offen  lds
    s_add_u32 m0, s93, 9216
    s_mov_b32 s30, 73728
    buffer_load_dwordx4 v14, s[16:19], s30 offen  lds
    s_add_u32 m0, s93, 10240
    s_mov_b32 s30, 65600
    buffer_load_dwordx4 v14, s[16:19], s30 offen  lds
    s_add_u32 m0, s93, 11264
    s_mov_b32 s30, 73792
    buffer_load_dwordx4 v14, s[16:19], s30 offen  lds
    s_add_u32 m0, s93, 12288
    s_mov_b32 s30, 98304
    buffer_load_dwordx4 v14, s[16:19], s30 offen  lds
    s_add_u32 m0, s93, 13312
    s_mov_b32 s30, 106496
    buffer_load_dwordx4 v14, s[16:19], s30 offen  lds
    s_add_u32 m0, s93, 14336
    s_mov_b32 s30, 98368
    buffer_load_dwordx4 v14, s[16:19], s30 offen  lds
    s_add_u32 m0, s93, 15360
    s_mov_b32 s30, 106560
    buffer_load_dwordx4 v14, s[16:19], s30 offen  lds
    s_add_u32 m0, s93, 16384
    s_mov_b32 s30, 131072
    buffer_load_dwordx4 v14, s[16:19], s30 offen  lds
    s_add_u32 m0, s93, 17408
    s_mov_b32 s30, 139264
    buffer_load_dwordx4 v14, s[16:19], s30 offen  lds
    s_add_u32 m0, s93, 18432
    s_mov_b32 s30, 131136
    buffer_load_dwordx4 v14, s[16:19], s30 offen  lds
    s_add_u32 m0, s93, 19456
    s_mov_b32 s30, 139328
    buffer_load_dwordx4 v14, s[16:19], s30 offen  lds
    s_add_u32 m0, s93, 20480
    s_mov_b32 s30, 163840
    buffer_load_dwordx4 v14, s[16:19], s30 offen  lds
    s_add_u32 m0, s93, 21504
    s_mov_b32 s30, 172032
    buffer_load_dwordx4 v14, s[16:19], s30 offen  lds
    s_add_u32 m0, s93, 22528
    s_mov_b32 s30, 163904
    buffer_load_dwordx4 v14, s[16:19], s30 offen  lds
    s_add_u32 m0, s93, 23552
    s_mov_b32 s30, 172096
    buffer_load_dwordx4 v14, s[16:19], s30 offen  lds
    s_add_u32 m0, s93, 24576
    s_mov_b32 s30, 196608
    buffer_load_dwordx4 v14, s[16:19], s30 offen  lds
    s_add_u32 m0, s93, 25600
    s_mov_b32 s30, 204800
    buffer_load_dwordx4 v14, s[16:19], s30 offen  lds
    s_add_u32 m0, s93, 26624
    s_mov_b32 s30, 196672
    buffer_load_dwordx4 v14, s[16:19], s30 offen  lds
    s_add_u32 m0, s93, 27648
    s_mov_b32 s30, 204864
    buffer_load_dwordx4 v14, s[16:19], s30 offen  lds
    s_add_u32 m0, s93, 28672
    s_mov_b32 s30, 229376
    buffer_load_dwordx4 v14, s[16:19], s30 offen  lds
    s_add_u32 m0, s93, 29696
    s_mov_b32 s30, 237568
    buffer_load_dwordx4 v14, s[16:19], s30 offen  lds
    s_waitcnt vmcnt(29)
    ds_read2st64_b32 v[16:17], v15 offset0:0 offset1:1
    ds_read2st64_b32 v[18:19], v15 offset0:2 offset1:3
    s_add_u32 m0, s93, 30720
    s_mov_b32 s30, 229440
    buffer_load_dwordx4 v14, s[16:19], s30 offen  lds
    s_waitcnt vmcnt(29)
    ds_read2st64_b32 v[20:21], v15 offset0:4 offset1:5
    ds_read2st64_b32 v[22:23], v15 offset0:6 offset1:7
    s_waitcnt lgkmcnt(2)
    v_perm_b32 v32, v17, v16, s28
    v_accvgpr_write_b32 a0, v32
    v_perm_b32 v33, v17, v16, s29
    v_accvgpr_write_b32 a4, v33
    v_perm_b32 v32, v19, v18, s28
    v_accvgpr_write_b32 a1, v32
    v_perm_b32 v33, v19, v18, s29
    v_accvgpr_write_b32 a5, v33
    s_add_u32 m0, s93, 31744
    s_mov_b32 s30, 237632
    buffer_load_dwordx4 v14, s[16:19], s30 offen  lds
    s_waitcnt vmcnt(29)
    ds_read2st64_b32 v[24:25], v15 offset0:8 offset1:9
    ds_read2st64_b32 v[26:27], v15 offset0:10 offset1:11
    s_waitcnt lgkmcnt(2)
    v_perm_b32 v32, v21, v20, s28
    v_accvgpr_write_b32 a2, v32
    v_perm_b32 v33, v21, v20, s29
    v_accvgpr_write_b32 a6, v33
    v_perm_b32 v32, v23, v22, s28
    v_accvgpr_write_b32 a3, v32
    v_perm_b32 v33, v23, v22, s29
    v_accvgpr_write_b32 a7, v33
    s_add_u32 m0, s93, 0
    s_mov_b32 s30, 262144
    buffer_load_dwordx4 v14, s[16:19], s30 offen  lds
    s_waitcnt vmcnt(29)
    ds_read2st64_b32 v[28:29], v15 offset0:12 offset1:13
    ds_read2st64_b32 v[30:31], v15 offset0:14 offset1:15
    s_waitcnt lgkmcnt(2)
    v_perm_b32 v32, v25, v24, s28
    v_accvgpr_write_b32 a8, v32
    v_perm_b32 v33, v25, v24, s29
    v_accvgpr_write_b32 a12, v33
    v_perm_b32 v32, v27, v26, s28
    v_accvgpr_write_b32 a9, v32
    v_perm_b32 v33, v27, v26, s29
    v_accvgpr_write_b32 a13, v33
    s_add_u32 m0, s93, 1024
    s_mov_b32 s30, 270336
    buffer_load_dwordx4 v14, s[16:19], s30 offen  lds
    s_waitcnt vmcnt(29)
    ds_read2st64_b32 v[16:17], v15 offset0:16 offset1:17
    ds_read2st64_b32 v[18:19], v15 offset0:18 offset1:19
    s_waitcnt lgkmcnt(2)
    v_perm_b32 v32, v29, v28, s28
    v_accvgpr_write_b32 a10, v32
    v_perm_b32 v33, v29, v28, s29
    v_accvgpr_write_b32 a14, v33
    v_perm_b32 v32, v31, v30, s28
    v_accvgpr_write_b32 a11, v32
    v_perm_b32 v33, v31, v30, s29
    v_accvgpr_write_b32 a15, v33
    s_add_u32 m0, s93, 2048
    s_mov_b32 s30, 262208
    buffer_load_dwordx4 v14, s[16:19], s30 offen  lds
    s_waitcnt vmcnt(29)
    ds_read2st64_b32 v[20:21], v15 offset0:20 offset1:21
    ds_read2st64_b32 v[22:23], v15 offset0:22 offset1:23
    s_waitcnt lgkmcnt(2)
    v_perm_b32 v32, v17, v16, s28
    v_accvgpr_write_b32 a16, v32
    v_perm_b32 v33, v17, v16, s29
    v_accvgpr_write_b32 a20, v33
    v_perm_b32 v32, v19, v18, s28
    v_accvgpr_write_b32 a17, v32
    v_perm_b32 v33, v19, v18, s29
    v_accvgpr_write_b32 a21, v33
    s_add_u32 m0, s93, 3072
    s_mov_b32 s30, 270400
    buffer_load_dwordx4 v14, s[16:19], s30 offen  lds
    s_waitcnt vmcnt(29)
    ds_read2st64_b32 v[24:25], v15 offset0:24 offset1:25
    ds_read2st64_b32 v[26:27], v15 offset0:26 offset1:27
    s_waitcnt lgkmcnt(2)
    v_perm_b32 v32, v21, v20, s28
    v_accvgpr_write_b32 a18, v32
    v_perm_b32 v33, v21, v20, s29
    v_accvgpr_write_b32 a22, v33
    v_perm_b32 v32, v23, v22, s28
    v_accvgpr_write_b32 a19, v32
    v_perm_b32 v33, v23, v22, s29
    v_accvgpr_write_b32 a23, v33
    s_add_u32 m0, s93, 4096
    s_mov_b32 s30, 294912
    buffer_load_dwordx4 v14, s[16:19], s30 offen  lds
    s_waitcnt vmcnt(29)
    ds_read2st64_b32 v[28:29], v15 offset0:28 offset1:29
    ds_read2st64_b32 v[30:31], v15 offset0:30 offset1:31
    s_waitcnt lgkmcnt(2)
    v_perm_b32 v32, v25, v24, s28
    v_accvgpr_write_b32 a24, v32
    v_perm_b32 v33, v25, v24, s29
    v_accvgpr_write_b32 a28, v33
    v_perm_b32 v32, v27, v26, s28
    v_accvgpr_write_b32 a25, v32
    v_perm_b32 v33, v27, v26, s29
    v_accvgpr_write_b32 a29, v33
    s_add_u32 m0, s93, 5120
    s_mov_b32 s30, 303104
    buffer_load_dwordx4 v14, s[16:19], s30 offen  lds
    s_waitcnt vmcnt(29)
    ds_read2st64_b32 v[16:17], v15 offset0:32 offset1:33
    ds_read2st64_b32 v[18:19], v15 offset0:34 offset1:35
    s_waitcnt lgkmcnt(2)
    v_perm_b32 v32, v29, v28, s28
    v_accvgpr_write_b32 a26, v32
    v_perm_b32 v33, v29, v28, s29
    v_accvgpr_write_b32 a30, v33
    v_perm_b32 v32, v31, v30, s28
    v_accvgpr_write_b32 a27, v32
    v_perm_b32 v33, v31, v30, s29
    v_accvgpr_write_b32 a31, v33
    s_add_u32 m0, s93, 6144
    s_mov_b32 s30, 294976
    buffer_load_dwordx4 v14, s[16:19], s30 offen  lds
    s_waitcnt vmcnt(29)
    ds_read2st64_b32 v[20:21], v15 offset0:36 offset1:37
    ds_read2st64_b32 v[22:23], v15 offset0:38 offset1:39
    s_waitcnt lgkmcnt(2)
    v_perm_b32 v32, v17, v16, s28
    v_accvgpr_write_b32 a32, v32
    v_perm_b32 v33, v17, v16, s29
    v_accvgpr_write_b32 a36, v33
    v_perm_b32 v32, v19, v18, s28
    v_accvgpr_write_b32 a33, v32
    v_perm_b32 v33, v19, v18, s29
    v_accvgpr_write_b32 a37, v33
    s_add_u32 m0, s93, 7168
    s_mov_b32 s30, 303168
    buffer_load_dwordx4 v14, s[16:19], s30 offen  lds
    s_waitcnt vmcnt(29)
    ds_read2st64_b32 v[24:25], v15 offset0:40 offset1:41
    ds_read2st64_b32 v[26:27], v15 offset0:42 offset1:43
    s_waitcnt lgkmcnt(2)
    v_perm_b32 v32, v21, v20, s28
    v_accvgpr_write_b32 a34, v32
    v_perm_b32 v33, v21, v20, s29
    v_accvgpr_write_b32 a38, v33
    v_perm_b32 v32, v23, v22, s28
    v_accvgpr_write_b32 a35, v32
    v_perm_b32 v33, v23, v22, s29
    v_accvgpr_write_b32 a39, v33
    s_add_u32 m0, s93, 8192
    s_mov_b32 s30, 327680
    buffer_load_dwordx4 v14, s[16:19], s30 offen  lds
    s_waitcnt vmcnt(29)
    ds_read2st64_b32 v[28:29], v15 offset0:44 offset1:45
    ds_read2st64_b32 v[30:31], v15 offset0:46 offset1:47
    s_waitcnt lgkmcnt(2)
    v_perm_b32 v32, v25, v24, s28
    v_accvgpr_write_b32 a40, v32
    v_perm_b32 v33, v25, v24, s29
    v_accvgpr_write_b32 a44, v33
    v_perm_b32 v32, v27, v26, s28
    v_accvgpr_write_b32 a41, v32
    v_perm_b32 v33, v27, v26, s29
    v_accvgpr_write_b32 a45, v33
    s_add_u32 m0, s93, 9216
    s_mov_b32 s30, 335872
    buffer_load_dwordx4 v14, s[16:19], s30 offen  lds
    s_waitcnt vmcnt(29)
    ds_read2st64_b32 v[16:17], v15 offset0:48 offset1:49
    ds_read2st64_b32 v[18:19], v15 offset0:50 offset1:51
    s_waitcnt lgkmcnt(2)
    v_perm_b32 v32, v29, v28, s28
    v_accvgpr_write_b32 a42, v32
    v_perm_b32 v33, v29, v28, s29
    v_accvgpr_write_b32 a46, v33
    v_perm_b32 v32, v31, v30, s28
    v_accvgpr_write_b32 a43, v32
    v_perm_b32 v33, v31, v30, s29
    v_accvgpr_write_b32 a47, v33
    s_add_u32 m0, s93, 10240
    s_mov_b32 s30, 327744
    buffer_load_dwordx4 v14, s[16:19], s30 offen  lds
    s_waitcnt vmcnt(29)
    ds_read2st64_b32 v[20:21], v15 offset0:52 offset1:53
    ds_read2st64_b32 v[22:23], v15 offset0:54 offset1:55
    s_waitcnt lgkmcnt(2)
    v_perm_b32 v32, v17, v16, s28
    v_accvgpr_write_b32 a48, v32
    v_perm_b32 v33, v17, v16, s29
    v_accvgpr_write_b32 a52, v33
    v_perm_b32 v32, v19, v18, s28
    v_accvgpr_write_b32 a49, v32
    v_perm_b32 v33, v19, v18, s29
    v_accvgpr_write_b32 a53, v33
    s_add_u32 m0, s93, 11264
    s_mov_b32 s30, 335936
    buffer_load_dwordx4 v14, s[16:19], s30 offen  lds
    s_waitcnt vmcnt(29)
    ds_read2st64_b32 v[24:25], v15 offset0:56 offset1:57
    ds_read2st64_b32 v[26:27], v15 offset0:58 offset1:59
    s_waitcnt lgkmcnt(2)
    v_perm_b32 v32, v21, v20, s28
    v_accvgpr_write_b32 a50, v32
    v_perm_b32 v33, v21, v20, s29
    v_accvgpr_write_b32 a54, v33
    v_perm_b32 v32, v23, v22, s28
    v_accvgpr_write_b32 a51, v32
    v_perm_b32 v33, v23, v22, s29
    v_accvgpr_write_b32 a55, v33
    s_add_u32 m0, s93, 12288
    s_mov_b32 s30, 360448
    buffer_load_dwordx4 v14, s[16:19], s30 offen  lds
    s_waitcnt vmcnt(29)
    ds_read2st64_b32 v[28:29], v15 offset0:60 offset1:61
    ds_read2st64_b32 v[30:31], v15 offset0:62 offset1:63
    s_waitcnt lgkmcnt(2)
    v_perm_b32 v32, v25, v24, s28
    v_accvgpr_write_b32 a56, v32
    v_perm_b32 v33, v25, v24, s29
    v_accvgpr_write_b32 a60, v33
    v_perm_b32 v32, v27, v26, s28
    v_accvgpr_write_b32 a57, v32
    v_perm_b32 v33, v27, v26, s29
    v_accvgpr_write_b32 a61, v33
    s_add_u32 m0, s93, 13312
    s_mov_b32 s30, 368640
    buffer_load_dwordx4 v14, s[16:19], s30 offen  lds
    s_waitcnt vmcnt(29)
    ds_read2st64_b32 v[16:17], v15 offset0:64 offset1:65
    ds_read2st64_b32 v[18:19], v15 offset0:66 offset1:67
    s_waitcnt lgkmcnt(2)
    v_perm_b32 v32, v29, v28, s28
    v_accvgpr_write_b32 a58, v32
    v_perm_b32 v33, v29, v28, s29
    v_accvgpr_write_b32 a62, v33
    v_perm_b32 v32, v31, v30, s28
    v_accvgpr_write_b32 a59, v32
    v_perm_b32 v33, v31, v30, s29
    v_accvgpr_write_b32 a63, v33
    s_add_u32 m0, s93, 14336
    s_mov_b32 s30, 360512
    buffer_load_dwordx4 v14, s[16:19], s30 offen  lds
    s_waitcnt vmcnt(29)
    ds_read2st64_b32 v[20:21], v15 offset0:68 offset1:69
    ds_read2st64_b32 v[22:23], v15 offset0:70 offset1:71
    s_waitcnt lgkmcnt(2)
    v_perm_b32 v32, v17, v16, s28
    v_accvgpr_write_b32 a64, v32
    v_perm_b32 v33, v17, v16, s29
    v_accvgpr_write_b32 a68, v33
    v_perm_b32 v32, v19, v18, s28
    v_accvgpr_write_b32 a65, v32
    v_perm_b32 v33, v19, v18, s29
    v_accvgpr_write_b32 a69, v33
    s_add_u32 m0, s93, 15360
    s_mov_b32 s30, 368704
    buffer_load_dwordx4 v14, s[16:19], s30 offen  lds
    s_waitcnt vmcnt(29)
    ds_read2st64_b32 v[24:25], v15 offset0:72 offset1:73
    ds_read2st64_b32 v[26:27], v15 offset0:74 offset1:75
    s_waitcnt lgkmcnt(2)
    v_perm_b32 v32, v21, v20, s28
    v_accvgpr_write_b32 a66, v32
    v_perm_b32 v33, v21, v20, s29
    v_accvgpr_write_b32 a70, v33
    v_perm_b32 v32, v23, v22, s28
    v_accvgpr_write_b32 a67, v32
    v_perm_b32 v33, v23, v22, s29
    v_accvgpr_write_b32 a71, v33
    s_add_u32 m0, s93, 16384
    s_mov_b32 s30, 393216
    buffer_load_dwordx4 v14, s[16:19], s30 offen  lds
    s_waitcnt vmcnt(29)
    ds_read2st64_b32 v[28:29], v15 offset0:76 offset1:77
    ds_read2st64_b32 v[30:31], v15 offset0:78 offset1:79
    s_waitcnt lgkmcnt(2)
    v_perm_b32 v32, v25, v24, s28
    v_accvgpr_write_b32 a72, v32
    v_perm_b32 v33, v25, v24, s29
    v_accvgpr_write_b32 a76, v33
    v_perm_b32 v32, v27, v26, s28
    v_accvgpr_write_b32 a73, v32
    v_perm_b32 v33, v27, v26, s29
    v_accvgpr_write_b32 a77, v33
    s_add_u32 m0, s93, 17408
    s_mov_b32 s30, 401408
    buffer_load_dwordx4 v14, s[16:19], s30 offen  lds
    s_waitcnt vmcnt(29)
    ds_read2st64_b32 v[16:17], v15 offset0:80 offset1:81
    ds_read2st64_b32 v[18:19], v15 offset0:82 offset1:83
    s_waitcnt lgkmcnt(2)
    v_perm_b32 v32, v29, v28, s28
    v_accvgpr_write_b32 a74, v32
    v_perm_b32 v33, v29, v28, s29
    v_accvgpr_write_b32 a78, v33
    v_perm_b32 v32, v31, v30, s28
    v_accvgpr_write_b32 a75, v32
    v_perm_b32 v33, v31, v30, s29
    v_accvgpr_write_b32 a79, v33
    s_add_u32 m0, s93, 18432
    s_mov_b32 s30, 393280
    buffer_load_dwordx4 v14, s[16:19], s30 offen  lds
    s_waitcnt vmcnt(29)
    ds_read2st64_b32 v[20:21], v15 offset0:84 offset1:85
    ds_read2st64_b32 v[22:23], v15 offset0:86 offset1:87
    s_waitcnt lgkmcnt(2)
    v_perm_b32 v32, v17, v16, s28
    v_accvgpr_write_b32 a80, v32
    v_perm_b32 v33, v17, v16, s29
    v_accvgpr_write_b32 a84, v33
    v_perm_b32 v32, v19, v18, s28
    v_accvgpr_write_b32 a81, v32
    v_perm_b32 v33, v19, v18, s29
    v_accvgpr_write_b32 a85, v33
    s_add_u32 m0, s93, 19456
    s_mov_b32 s30, 401472
    buffer_load_dwordx4 v14, s[16:19], s30 offen  lds
    s_waitcnt vmcnt(29)
    ds_read2st64_b32 v[24:25], v15 offset0:88 offset1:89
    ds_read2st64_b32 v[26:27], v15 offset0:90 offset1:91
    s_waitcnt lgkmcnt(2)
    v_perm_b32 v32, v21, v20, s28
    v_accvgpr_write_b32 a82, v32
    v_perm_b32 v33, v21, v20, s29
    v_accvgpr_write_b32 a86, v33
    v_perm_b32 v32, v23, v22, s28
    v_accvgpr_write_b32 a83, v32
    v_perm_b32 v33, v23, v22, s29
    v_accvgpr_write_b32 a87, v33
    s_add_u32 m0, s93, 20480
    s_mov_b32 s30, 425984
    buffer_load_dwordx4 v14, s[16:19], s30 offen  lds
    s_waitcnt vmcnt(29)
    ds_read2st64_b32 v[28:29], v15 offset0:92 offset1:93
    ds_read2st64_b32 v[30:31], v15 offset0:94 offset1:95
    s_waitcnt lgkmcnt(2)
    v_perm_b32 v32, v25, v24, s28
    v_accvgpr_write_b32 a88, v32
    v_perm_b32 v33, v25, v24, s29
    v_accvgpr_write_b32 a92, v33
    v_perm_b32 v32, v27, v26, s28
    v_accvgpr_write_b32 a89, v32
    v_perm_b32 v33, v27, v26, s29
    v_accvgpr_write_b32 a93, v33
    s_add_u32 m0, s93, 21504
    s_mov_b32 s30, 434176
    buffer_load_dwordx4 v14, s[16:19], s30 offen  lds
    s_waitcnt vmcnt(29)
    ds_read2st64_b32 v[16:17], v15 offset0:96 offset1:97
    ds_read2st64_b32 v[18:19], v15 offset0:98 offset1:99
    s_waitcnt lgkmcnt(2)
    v_perm_b32 v32, v29, v28, s28
    v_accvgpr_write_b32 a90, v32
    v_perm_b32 v33, v29, v28, s29
    v_accvgpr_write_b32 a94, v33
    v_perm_b32 v32, v31, v30, s28
    v_accvgpr_write_b32 a91, v32
    v_perm_b32 v33, v31, v30, s29
    v_accvgpr_write_b32 a95, v33
    s_add_u32 m0, s93, 22528
    s_mov_b32 s30, 426048
    buffer_load_dwordx4 v14, s[16:19], s30 offen  lds
    s_waitcnt vmcnt(29)
    ds_read2st64_b32 v[20:21], v15 offset0:100 offset1:101
    ds_read2st64_b32 v[22:23], v15 offset0:102 offset1:103
    s_waitcnt lgkmcnt(2)
    v_perm_b32 v32, v17, v16, s28
    v_accvgpr_write_b32 a96, v32
    v_perm_b32 v33, v17, v16, s29
    v_accvgpr_write_b32 a100, v33
    v_perm_b32 v32, v19, v18, s28
    v_accvgpr_write_b32 a97, v32
    v_perm_b32 v33, v19, v18, s29
    v_accvgpr_write_b32 a101, v33
    s_add_u32 m0, s93, 23552
    s_mov_b32 s30, 434240
    buffer_load_dwordx4 v14, s[16:19], s30 offen  lds
    s_waitcnt vmcnt(29)
    ds_read2st64_b32 v[24:25], v15 offset0:104 offset1:105
    ds_read2st64_b32 v[26:27], v15 offset0:106 offset1:107
    s_waitcnt lgkmcnt(2)
    v_perm_b32 v32, v21, v20, s28
    v_accvgpr_write_b32 a98, v32
    v_perm_b32 v33, v21, v20, s29
    v_accvgpr_write_b32 a102, v33
    v_perm_b32 v32, v23, v22, s28
    v_accvgpr_write_b32 a99, v32
    v_perm_b32 v33, v23, v22, s29
    v_accvgpr_write_b32 a103, v33
    s_add_u32 m0, s93, 24576
    s_mov_b32 s30, 458752
    buffer_load_dwordx4 v14, s[16:19], s30 offen  lds
    s_waitcnt vmcnt(29)
    ds_read2st64_b32 v[28:29], v15 offset0:108 offset1:109
    ds_read2st64_b32 v[30:31], v15 offset0:110 offset1:111
    s_waitcnt lgkmcnt(2)
    v_perm_b32 v32, v25, v24, s28
    v_accvgpr_write_b32 a104, v32
    v_perm_b32 v33, v25, v24, s29
    v_accvgpr_write_b32 a108, v33
    v_perm_b32 v32, v27, v26, s28
    v_accvgpr_write_b32 a105, v32
    v_perm_b32 v33, v27, v26, s29
    v_accvgpr_write_b32 a109, v33
    s_add_u32 m0, s93, 25600
    s_mov_b32 s30, 466944
    buffer_load_dwordx4 v14, s[16:19], s30 offen  lds
    s_waitcnt vmcnt(29)
    ds_read2st64_b32 v[16:17], v15 offset0:112 offset1:113
    ds_read2st64_b32 v[18:19], v15 offset0:114 offset1:115
    s_waitcnt lgkmcnt(2)
    v_perm_b32 v32, v29, v28, s28
    v_accvgpr_write_b32 a106, v32
    v_perm_b32 v33, v29, v28, s29
    v_accvgpr_write_b32 a110, v33
    v_perm_b32 v32, v31, v30, s28
    v_accvgpr_write_b32 a107, v32
    v_perm_b32 v33, v31, v30, s29
    v_accvgpr_write_b32 a111, v33
    s_add_u32 m0, s93, 26624
    s_mov_b32 s30, 458816
    buffer_load_dwordx4 v14, s[16:19], s30 offen  lds
    s_waitcnt vmcnt(29)
    ds_read2st64_b32 v[20:21], v15 offset0:116 offset1:117
    ds_read2st64_b32 v[22:23], v15 offset0:118 offset1:119
    s_waitcnt lgkmcnt(2)
    v_perm_b32 v32, v17, v16, s28
    v_accvgpr_write_b32 a112, v32
    v_perm_b32 v33, v17, v16, s29
    v_accvgpr_write_b32 a116, v33
    v_perm_b32 v32, v19, v18, s28
    v_accvgpr_write_b32 a113, v32
    v_perm_b32 v33, v19, v18, s29
    v_accvgpr_write_b32 a117, v33
    s_add_u32 m0, s93, 27648
    s_mov_b32 s30, 467008
    buffer_load_dwordx4 v14, s[16:19], s30 offen  lds
    s_waitcnt vmcnt(29)
    ds_read2st64_b32 v[24:25], v15 offset0:120 offset1:121
    ds_read2st64_b32 v[26:27], v15 offset0:122 offset1:123
    s_waitcnt lgkmcnt(2)
    v_perm_b32 v32, v21, v20, s28
    v_accvgpr_write_b32 a114, v32
    v_perm_b32 v33, v21, v20, s29
    v_accvgpr_write_b32 a118, v33
    v_perm_b32 v32, v23, v22, s28
    v_accvgpr_write_b32 a115, v32
    v_perm_b32 v33, v23, v22, s29
    v_accvgpr_write_b32 a119, v33
    s_add_u32 m0, s93, 28672
    s_mov_b32 s30, 491520
    buffer_load_dwordx4 v14, s[16:19], s30 offen  lds
    s_waitcnt vmcnt(29)
    ds_read2st64_b32 v[28:29], v15 offset0:124 offset1:125
    ds_read2st64_b32 v[30:31], v15 offset0:126 offset1:127
    s_waitcnt lgkmcnt(2)
    v_perm_b32 v32, v25, v24, s28
    v_accvgpr_write_b32 a120, v32
    v_perm_b32 v33, v25, v24, s29
    v_accvgpr_write_b32 a124, v33
    v_perm_b32 v32, v27, v26, s28
    v_accvgpr_write_b32 a121, v32
    v_perm_b32 v33, v27, v26, s29
    v_accvgpr_write_b32 a125, v33
    s_add_u32 m0, s93, 29696
    s_mov_b32 s30, 499712
    buffer_load_dwordx4 v14, s[16:19], s30 offen  lds
    s_waitcnt vmcnt(29)
    ds_read2st64_b32 v[16:17], v15 offset0:0 offset1:1
    ds_read2st64_b32 v[18:19], v15 offset0:2 offset1:3
    s_waitcnt lgkmcnt(2)
    v_perm_b32 v32, v29, v28, s28
    v_accvgpr_write_b32 a122, v32
    v_perm_b32 v33, v29, v28, s29
    v_accvgpr_write_b32 a126, v33
    v_perm_b32 v32, v31, v30, s28
    v_accvgpr_write_b32 a123, v32
    v_perm_b32 v33, v31, v30, s29
    v_accvgpr_write_b32 a127, v33
    s_add_u32 m0, s93, 30720
    s_mov_b32 s30, 491584
    buffer_load_dwordx4 v14, s[16:19], s30 offen  lds
    s_waitcnt vmcnt(29)
    ds_read2st64_b32 v[20:21], v15 offset0:4 offset1:5
    ds_read2st64_b32 v[22:23], v15 offset0:6 offset1:7
    s_waitcnt lgkmcnt(2)
    v_perm_b32 v32, v17, v16, s28
    v_accvgpr_write_b32 a128, v32
    v_perm_b32 v33, v17, v16, s29
    v_accvgpr_write_b32 a132, v33
    v_perm_b32 v32, v19, v18, s28
    v_accvgpr_write_b32 a129, v32
    v_perm_b32 v33, v19, v18, s29
    v_accvgpr_write_b32 a133, v33
    s_add_u32 m0, s93, 31744
    s_mov_b32 s30, 499776
    buffer_load_dwordx4 v14, s[16:19], s30 offen  lds
    s_waitcnt vmcnt(29)
    ds_read2st64_b32 v[24:25], v15 offset0:8 offset1:9
    ds_read2st64_b32 v[26:27], v15 offset0:10 offset1:11
    s_waitcnt lgkmcnt(2)
    v_perm_b32 v32, v21, v20, s28
    v_accvgpr_write_b32 a130, v32
    v_perm_b32 v33, v21, v20, s29
    v_accvgpr_write_b32 a134, v33
    v_perm_b32 v32, v23, v22, s28
    v_accvgpr_write_b32 a131, v32
    v_perm_b32 v33, v23, v22, s29
    v_accvgpr_write_b32 a135, v33
    s_waitcnt vmcnt(28)
    ds_read2st64_b32 v[28:29], v15 offset0:12 offset1:13
    ds_read2st64_b32 v[30:31], v15 offset0:14 offset1:15
    s_waitcnt lgkmcnt(2)
    v_perm_b32 v32, v25, v24, s28
    v_accvgpr_write_b32 a136, v32
    v_perm_b32 v33, v25, v24, s29
    v_accvgpr_write_b32 a140, v33
    v_perm_b32 v32, v27, v26, s28
    v_accvgpr_write_b32 a137, v32
    v_perm_b32 v33, v27, v26, s29
    v_accvgpr_write_b32 a141, v33
    s_waitcnt vmcnt(27)
    ds_read2st64_b32 v[16:17], v15 offset0:16 offset1:17
    ds_read2st64_b32 v[18:19], v15 offset0:18 offset1:19
    s_waitcnt lgkmcnt(2)
    v_perm_b32 v32, v29, v28, s28
    v_accvgpr_write_b32 a138, v32
    v_perm_b32 v33, v29, v28, s29
    v_accvgpr_write_b32 a142, v33
    v_perm_b32 v32, v31, v30, s28
    v_accvgpr_write_b32 a139, v32
    v_perm_b32 v33, v31, v30, s29
    v_accvgpr_write_b32 a143, v33
    s_waitcnt vmcnt(26)
    ds_read2st64_b32 v[20:21], v15 offset0:20 offset1:21
    ds_read2st64_b32 v[22:23], v15 offset0:22 offset1:23
    s_waitcnt lgkmcnt(2)
    v_perm_b32 v32, v17, v16, s28
    v_accvgpr_write_b32 a144, v32
    v_perm_b32 v33, v17, v16, s29
    v_accvgpr_write_b32 a148, v33
    v_perm_b32 v32, v19, v18, s28
    v_accvgpr_write_b32 a145, v32
    v_perm_b32 v33, v19, v18, s29
    v_accvgpr_write_b32 a149, v33
    s_waitcnt vmcnt(25)
    ds_read2st64_b32 v[24:25], v15 offset0:24 offset1:25
    ds_read2st64_b32 v[26:27], v15 offset0:26 offset1:27
    s_waitcnt lgkmcnt(2)
    v_perm_b32 v32, v21, v20, s28
    v_accvgpr_write_b32 a146, v32
    v_perm_b32 v33, v21, v20, s29
    v_accvgpr_write_b32 a150, v33
    v_perm_b32 v32, v23, v22, s28
    v_accvgpr_write_b32 a147, v32
    v_perm_b32 v33, v23, v22, s29
    v_accvgpr_write_b32 a151, v33
    s_waitcnt vmcnt(24)
    ds_read2st64_b32 v[28:29], v15 offset0:28 offset1:29
    ds_read2st64_b32 v[30:31], v15 offset0:30 offset1:31
    s_waitcnt lgkmcnt(2)
    v_perm_b32 v32, v25, v24, s28
    v_accvgpr_write_b32 a152, v32
    v_perm_b32 v33, v25, v24, s29
    v_accvgpr_write_b32 a156, v33
    v_perm_b32 v32, v27, v26, s28
    v_accvgpr_write_b32 a153, v32
    v_perm_b32 v33, v27, v26, s29
    v_accvgpr_write_b32 a157, v33
    s_waitcnt vmcnt(23)
    ds_read2st64_b32 v[16:17], v15 offset0:32 offset1:33
    ds_read2st64_b32 v[18:19], v15 offset0:34 offset1:35
    s_waitcnt lgkmcnt(2)
    v_perm_b32 v32, v29, v28, s28
    v_accvgpr_write_b32 a154, v32
    v_perm_b32 v33, v29, v28, s29
    v_accvgpr_write_b32 a158, v33
    v_perm_b32 v32, v31, v30, s28
    v_accvgpr_write_b32 a155, v32
    v_perm_b32 v33, v31, v30, s29
    v_accvgpr_write_b32 a159, v33
    s_waitcnt vmcnt(22)
    ds_read2st64_b32 v[20:21], v15 offset0:36 offset1:37
    ds_read2st64_b32 v[22:23], v15 offset0:38 offset1:39
    s_waitcnt lgkmcnt(2)
    v_perm_b32 v32, v17, v16, s28
    v_accvgpr_write_b32 a160, v32
    v_perm_b32 v33, v17, v16, s29
    v_accvgpr_write_b32 a164, v33
    v_perm_b32 v32, v19, v18, s28
    v_accvgpr_write_b32 a161, v32
    v_perm_b32 v33, v19, v18, s29
    v_accvgpr_write_b32 a165, v33
    s_waitcnt vmcnt(21)
    ds_read2st64_b32 v[24:25], v15 offset0:40 offset1:41
    ds_read2st64_b32 v[26:27], v15 offset0:42 offset1:43
    s_waitcnt lgkmcnt(2)
    v_perm_b32 v32, v21, v20, s28
    v_accvgpr_write_b32 a162, v32
    v_perm_b32 v33, v21, v20, s29
    v_accvgpr_write_b32 a166, v33
    v_perm_b32 v32, v23, v22, s28
    v_accvgpr_write_b32 a163, v32
    v_perm_b32 v33, v23, v22, s29
    v_accvgpr_write_b32 a167, v33
    s_waitcnt vmcnt(20)
    ds_read2st64_b32 v[28:29], v15 offset0:44 offset1:45
    ds_read2st64_b32 v[30:31], v15 offset0:46 offset1:47
    s_waitcnt lgkmcnt(2)
    v_perm_b32 v32, v25, v24, s28
    v_accvgpr_write_b32 a168, v32
    v_perm_b32 v33, v25, v24, s29
    v_accvgpr_write_b32 a172, v33
    v_perm_b32 v32, v27, v26, s28
    v_accvgpr_write_b32 a169, v32
    v_perm_b32 v33, v27, v26, s29
    v_accvgpr_write_b32 a173, v33
    s_waitcnt vmcnt(19)
    ds_read2st64_b32 v[16:17], v15 offset0:48 offset1:49
    ds_read2st64_b32 v[18:19], v15 offset0:50 offset1:51
    s_waitcnt lgkmcnt(2)
    v_perm_b32 v32, v29, v28, s28
    v_accvgpr_write_b32 a170, v32
    v_perm_b32 v33, v29, v28, s29
    v_accvgpr_write_b32 a174, v33
    v_perm_b32 v32, v31, v30, s28
    v_accvgpr_write_b32 a171, v32
    v_perm_b32 v33, v31, v30, s29
    v_accvgpr_write_b32 a175, v33
    s_waitcnt vmcnt(18)
    ds_read2st64_b32 v[20:21], v15 offset0:52 offset1:53
    ds_read2st64_b32 v[22:23], v15 offset0:54 offset1:55
    s_waitcnt lgkmcnt(2)
    v_perm_b32 v32, v17, v16, s28
    v_accvgpr_write_b32 a176, v32
    v_perm_b32 v33, v17, v16, s29
    v_accvgpr_write_b32 a180, v33
    v_perm_b32 v32, v19, v18, s28
    v_accvgpr_write_b32 a177, v32
    v_perm_b32 v33, v19, v18, s29
    v_accvgpr_write_b32 a181, v33
    s_waitcnt vmcnt(17)
    ds_read2st64_b32 v[24:25], v15 offset0:56 offset1:57
    ds_read2st64_b32 v[26:27], v15 offset0:58 offset1:59
    s_waitcnt lgkmcnt(2)
    v_perm_b32 v32, v21, v20, s28
    v_accvgpr_write_b32 a178, v32
    v_perm_b32 v33, v21, v20, s29
    v_accvgpr_write_b32 a182, v33
    v_perm_b32 v32, v23, v22, s28
    v_accvgpr_write_b32 a179, v32
    v_perm_b32 v33, v23, v22, s29
    v_accvgpr_write_b32 a183, v33
    s_waitcnt vmcnt(16)
    ds_read2st64_b32 v[28:29], v15 offset0:60 offset1:61
    ds_read2st64_b32 v[30:31], v15 offset0:62 offset1:63
    s_waitcnt lgkmcnt(2)
    v_perm_b32 v32, v25, v24, s28
    v_accvgpr_write_b32 a184, v32
    v_perm_b32 v33, v25, v24, s29
    v_accvgpr_write_b32 a188, v33
    v_perm_b32 v32, v27, v26, s28
    v_accvgpr_write_b32 a185, v32
    v_perm_b32 v33, v27, v26, s29
    v_accvgpr_write_b32 a189, v33
    s_waitcnt vmcnt(15)
    ds_read2st64_b32 v[16:17], v15 offset0:64 offset1:65
    ds_read2st64_b32 v[18:19], v15 offset0:66 offset1:67
    s_waitcnt lgkmcnt(2)
    v_perm_b32 v32, v29, v28, s28
    v_accvgpr_write_b32 a186, v32
    v_perm_b32 v33, v29, v28, s29
    v_accvgpr_write_b32 a190, v33
    v_perm_b32 v32, v31, v30, s28
    v_accvgpr_write_b32 a187, v32
    v_perm_b32 v33, v31, v30, s29
    v_accvgpr_write_b32 a191, v33
    s_waitcnt vmcnt(14)
    ds_read2st64_b32 v[20:21], v15 offset0:68 offset1:69
    ds_read2st64_b32 v[22:23], v15 offset0:70 offset1:71
    s_waitcnt lgkmcnt(2)
    v_perm_b32 v32, v17, v16, s28
    v_accvgpr_write_b32 a192, v32
    v_perm_b32 v33, v17, v16, s29
    v_accvgpr_write_b32 a196, v33
    v_perm_b32 v32, v19, v18, s28
    v_accvgpr_write_b32 a193, v32
    v_perm_b32 v33, v19, v18, s29
    v_accvgpr_write_b32 a197, v33
    s_waitcnt vmcnt(13)
    ds_read2st64_b32 v[24:25], v15 offset0:72 offset1:73
    ds_read2st64_b32 v[26:27], v15 offset0:74 offset1:75
    s_waitcnt lgkmcnt(2)
    v_perm_b32 v32, v21, v20, s28
    v_accvgpr_write_b32 a194, v32
    v_perm_b32 v33, v21, v20, s29
    v_accvgpr_write_b32 a198, v33
    v_perm_b32 v32, v23, v22, s28
    v_accvgpr_write_b32 a195, v32
    v_perm_b32 v33, v23, v22, s29
    v_accvgpr_write_b32 a199, v33
    s_waitcnt vmcnt(12)
    ds_read2st64_b32 v[28:29], v15 offset0:76 offset1:77
    ds_read2st64_b32 v[30:31], v15 offset0:78 offset1:79
    s_waitcnt lgkmcnt(2)
    v_perm_b32 v32, v25, v24, s28
    v_accvgpr_write_b32 a200, v32
    v_perm_b32 v33, v25, v24, s29
    v_accvgpr_write_b32 a204, v33
    v_perm_b32 v32, v27, v26, s28
    v_accvgpr_write_b32 a201, v32
    v_perm_b32 v33, v27, v26, s29
    v_accvgpr_write_b32 a205, v33
    s_waitcnt vmcnt(11)
    ds_read2st64_b32 v[16:17], v15 offset0:80 offset1:81
    ds_read2st64_b32 v[18:19], v15 offset0:82 offset1:83
    s_waitcnt lgkmcnt(2)
    v_perm_b32 v32, v29, v28, s28
    v_accvgpr_write_b32 a202, v32
    v_perm_b32 v33, v29, v28, s29
    v_accvgpr_write_b32 a206, v33
    v_perm_b32 v32, v31, v30, s28
    v_accvgpr_write_b32 a203, v32
    v_perm_b32 v33, v31, v30, s29
    v_accvgpr_write_b32 a207, v33
    s_waitcnt vmcnt(10)
    ds_read2st64_b32 v[20:21], v15 offset0:84 offset1:85
    ds_read2st64_b32 v[22:23], v15 offset0:86 offset1:87
    s_waitcnt lgkmcnt(2)
    v_perm_b32 v32, v17, v16, s28
    v_accvgpr_write_b32 a208, v32
    v_perm_b32 v33, v17, v16, s29
    v_accvgpr_write_b32 a212, v33
    v_perm_b32 v32, v19, v18, s28
    v_accvgpr_write_b32 a209, v32
    v_perm_b32 v33, v19, v18, s29
    v_accvgpr_write_b32 a213, v33
    s_waitcnt vmcnt(9)
    ds_read2st64_b32 v[24:25], v15 offset0:88 offset1:89
    ds_read2st64_b32 v[26:27], v15 offset0:90 offset1:91
    s_waitcnt lgkmcnt(2)
    v_perm_b32 v32, v21, v20, s28
    v_accvgpr_write_b32 a210, v32
    v_perm_b32 v33, v21, v20, s29
    v_accvgpr_write_b32 a214, v33
    v_perm_b32 v32, v23, v22, s28
    v_accvgpr_write_b32 a211, v32
    v_perm_b32 v33, v23, v22, s29
    v_accvgpr_write_b32 a215, v33
    s_waitcnt vmcnt(8)
    ds_read2st64_b32 v[28:29], v15 offset0:92 offset1:93
    ds_read2st64_b32 v[30:31], v15 offset0:94 offset1:95
    s_waitcnt lgkmcnt(2)
    v_perm_b32 v32, v25, v24, s28
    v_accvgpr_write_b32 a216, v32
    v_perm_b32 v33, v25, v24, s29
    v_accvgpr_write_b32 a220, v33
    v_perm_b32 v32, v27, v26, s28
    v_accvgpr_write_b32 a217, v32
    v_perm_b32 v33, v27, v26, s29
    v_accvgpr_write_b32 a221, v33
    s_waitcnt vmcnt(7)
    ds_read2st64_b32 v[16:17], v15 offset0:96 offset1:97
    ds_read2st64_b32 v[18:19], v15 offset0:98 offset1:99
    s_waitcnt lgkmcnt(2)
    v_perm_b32 v32, v29, v28, s28
    v_accvgpr_write_b32 a218, v32
    v_perm_b32 v33, v29, v28, s29
    v_accvgpr_write_b32 a222, v33
    v_perm_b32 v32, v31, v30, s28
    v_accvgpr_write_b32 a219, v32
    v_perm_b32 v33, v31, v30, s29
    v_accvgpr_write_b32 a223, v33
    s_waitcnt vmcnt(6)
    ds_read2st64_b32 v[20:21], v15 offset0:100 offset1:101
    ds_read2st64_b32 v[22:23], v15 offset0:102 offset1:103
    s_waitcnt lgkmcnt(2)
    v_perm_b32 v32, v17, v16, s28
    v_accvgpr_write_b32 a224, v32
    v_perm_b32 v33, v17, v16, s29
    v_accvgpr_write_b32 a228, v33
    v_perm_b32 v32, v19, v18, s28
    v_accvgpr_write_b32 a225, v32
    v_perm_b32 v33, v19, v18, s29
    v_accvgpr_write_b32 a229, v33
    s_waitcnt vmcnt(5)
    ds_read2st64_b32 v[24:25], v15 offset0:104 offset1:105
    ds_read2st64_b32 v[26:27], v15 offset0:106 offset1:107
    s_waitcnt lgkmcnt(2)
    v_perm_b32 v32, v21, v20, s28
    v_accvgpr_write_b32 a226, v32
    v_perm_b32 v33, v21, v20, s29
    v_accvgpr_write_b32 a230, v33
    v_perm_b32 v32, v23, v22, s28
    v_accvgpr_write_b32 a227, v32
    v_perm_b32 v33, v23, v22, s29
    v_accvgpr_write_b32 a231, v33
    s_waitcnt vmcnt(4)
    ds_read2st64_b32 v[28:29], v15 offset0:108 offset1:109
    ds_read2st64_b32 v[30:31], v15 offset0:110 offset1:111
    s_waitcnt lgkmcnt(2)
    v_perm_b32 v32, v25, v24, s28
    v_accvgpr_write_b32 a232, v32
    v_perm_b32 v33, v25, v24, s29
    v_accvgpr_write_b32 a236, v33
    v_perm_b32 v32, v27, v26, s28
    v_accvgpr_write_b32 a233, v32
    v_perm_b32 v33, v27, v26, s29
    v_accvgpr_write_b32 a237, v33
    s_waitcnt vmcnt(3)
    ds_read2st64_b32 v[16:17], v15 offset0:112 offset1:113
    ds_read2st64_b32 v[18:19], v15 offset0:114 offset1:115
    s_waitcnt lgkmcnt(2)
    v_perm_b32 v32, v29, v28, s28
    v_accvgpr_write_b32 a234, v32
    v_perm_b32 v33, v29, v28, s29
    v_accvgpr_write_b32 a238, v33
    v_perm_b32 v32, v31, v30, s28
    v_accvgpr_write_b32 a235, v32
    v_perm_b32 v33, v31, v30, s29
    v_accvgpr_write_b32 a239, v33
    s_waitcnt vmcnt(2)
    ds_read2st64_b32 v[20:21], v15 offset0:116 offset1:117
    ds_read2st64_b32 v[22:23], v15 offset0:118 offset1:119
    s_waitcnt lgkmcnt(2)
    v_perm_b32 v32, v17, v16, s28
    v_accvgpr_write_b32 a240, v32
    v_perm_b32 v33, v17, v16, s29
    v_accvgpr_write_b32 a244, v33
    v_perm_b32 v32, v19, v18, s28
    v_accvgpr_write_b32 a241, v32
    v_perm_b32 v33, v19, v18, s29
    v_accvgpr_write_b32 a245, v33
    s_waitcnt vmcnt(1)
    ds_read2st64_b32 v[24:25], v15 offset0:120 offset1:121
    ds_read2st64_b32 v[26:27], v15 offset0:122 offset1:123
    s_waitcnt lgkmcnt(2)
    v_perm_b32 v32, v21, v20, s28
    v_accvgpr_write_b32 a242, v32
    v_perm_b32 v33, v21, v20, s29
    v_accvgpr_write_b32 a246, v33
    v_perm_b32 v32, v23, v22, s28
    v_accvgpr_write_b32 a243, v32
    v_perm_b32 v33, v23, v22, s29
    v_accvgpr_write_b32 a247, v33
    s_waitcnt vmcnt(0)
    ds_read2st64_b32 v[28:29], v15 offset0:124 offset1:125
    ds_read2st64_b32 v[30:31], v15 offset0:126 offset1:127
    s_waitcnt lgkmcnt(2)
    v_perm_b32 v32, v25, v24, s28
    v_accvgpr_write_b32 a248, v32
    v_perm_b32 v33, v25, v24, s29
    v_accvgpr_write_b32 a252, v33
    v_perm_b32 v32, v27, v26, s28
    v_accvgpr_write_b32 a249, v32
    v_perm_b32 v33, v27, v26, s29
    v_accvgpr_write_b32 a253, v33
    s_waitcnt lgkmcnt(0)
    v_perm_b32 v32, v29, v28, s28
    v_accvgpr_write_b32 a250, v32
    v_perm_b32 v33, v29, v28, s29
    v_accvgpr_write_b32 a254, v33
    v_perm_b32 v32, v31, v30, s28
    v_accvgpr_write_b32 a251, v32
    v_perm_b32 v33, v31, v30, s29
    v_accvgpr_write_b32 a255, v33
    s_barrier
    s_load_dwordx2 s[4:5], s[0:1], 0
    s_waitcnt lgkmcnt(0)
    s_mov_b32 s12, s4
    s_mov_b32 s13, s5
    s_mov_b32 s14, 2097152
    s_mov_b32 s15, 0x20000
    s_and_b32 s30, s25, 15
    s_lshl_b32 s30, s30, 2
    s_add_u32 s30, s30, s24
    s_lshl_b32 s30, s30, 13
    v_lshlrev_b32 v16, 7, v0
    buffer_load_dword v17, v16, s[12:15], s30 offen
    s_add_u32 s30, s30, 0x80000
    buffer_load_dword v17, v16, s[12:15], s30 offen
    s_add_u32 s30, s30, 0x80000
    buffer_load_dword v17, v16, s[12:15], s30 offen
    s_add_u32 s30, s30, 0x80000
    buffer_load_dword v17, v16, s[12:15], s30 offen
    s_add_u32 s30, s30, 0x80000
    s_waitcnt vmcnt(0)
    s_mov_b32 s34, 0
    s_mov_b32 s52, 0
    s_mov_b32 s53, 48
    s_branch L_b_setup
L_b_helper:
    s_mov_b32 s34, 1
    s_mov_b32 s52, 48
    s_mov_b32 s53, 64
L_b_setup:
    s_lshr_b32 s30, s25, 5
    s_sub_u32 s30, s30, 1
    s_lshl_b32 s30, s30, 3
    s_bfe_u32 s31, s25, 0x30001
    s_add_u32 s32, s30, s31
    s_and_b32 s33, s25, 1
    v_lshlrev_b32 v1, 4, v0
    v_mov_b32 v5, 0xdddddddd
    v_lshrrev_b32 v16, 5, v0
    v_and_b32 v17, 15, v0
    v_lshlrev_b32 v111, 8, v16
    v_lshl_add_u32 v111, v17, 4, v111
    v_bfe_u32 v16, v0, 4, 1
    v_lshl_add_u32 v11, v16, 14, v111
    s_lshl_b32 s30, s32, 9
    v_add_u32 v11, s30, v11
    v_add_u32 v15, -1, v16
    v_and_b32 v111, v111, v15
    v_lshl_add_u32 v111, v16, 12, v111
    v_add_u32 v111, 65536, v111
    s_lshl_b32 s31, s24, 10
    v_add_u32 v6, s31, v1
    v_and_b32 v109, s31, v15
    v_add_u32 v109, v109, v111
    v_and_b32 v110, 0x200, v15
    v_add_u32 v110, v110, v109
    v_mov_b32 v7, v109
    v_mov_b32 v8, v110
    s_mul_i32 s30, s24, 3072
    s_add_u32 s30, s30, 132096
    v_add_u32 v9, s30, v1
    v_add_u32 v10, 132096, v1
    v_lshlrev_b32 v12, 13, v0
    v_min_u32 v2, 2, v0
    v_cmp_gt_u32 vcc, 2, v0
    v_lshlrev_b32 v2, 2, v2
    s_lshl_b32 s39, s32, 7
    v_cndmask_b32 v14, 0, 1, vcc
    s_add_u32 s39, s39, 12288
    s_mov_b32 s43, 0x17800000
    s_mov_b32 s44, 0x50000000
    v_mul_u32_u24 v16, 4112, v17
    v_add_u32 v16, 69632, v16
    v_mov_b32 v24, 0x3f803f80
    v_mov_b32 v25, 0x3f803f80
    v_mov_b32 v26, 0x3f803f80
    v_mov_b32 v27, 0x3f803f80
    ds_write_b128 v16, v[24:27]
    s_waitcnt lgkmcnt(0)
    v_mov_b32 v16, 0
    s_mov_b32 s27, 0
L_wi_96:
    global_load_dword v17, v16, s[6:7] offset:64 sc1
    s_waitcnt vmcnt(0)
    v_cmp_gt_u32 vcc, 0x100, v17
    s_cbranch_vccz L_wiok_97
    s_sleep 2
    s_add_u32 s27, s27, 1
    s_cmp_lt_u32 s27, 200000
    s_cbranch_scc1 L_wi_96
    s_branch L_b_fail
L_wiok_97:
L_b_layer:
    s_mov_b32 s30, 0
    s_mul_i32 s36, s32, 196608
    s_add_u32 s36, s36, s30
    s_add_u32 s36, s36, 63963136
    s_lshl_b32 s31, s24, 1
    s_add_u32 s31, s31, s33
    s_add_u32 s31, s31, s52
    s_mov_b32 s30, 0
    s_lshl_b32 s41, s31, 15
    s_add_u32 s41, s41, s30
    s_add_u32 s41, s41, 70254592
    s_lshl_b32 s42, s31, 10
    s_lshl_b32 s30, s32, 5
    s_add_u32 s42, s42, s30
    s_add_u32 s42, s42, 65536
    s_mov_b32 s35, s52
    s_mov_b32 s37, 0
    s_mov_b32 s46, 0
    s_mov_b32 s55, 0
    s_mov_b32 s56, 0
    s_lshl_b32 s45, s34, 7
    s_lshl_b32 s30, s52, 1
    s_add_u32 s45, s45, s30
    s_cmp_eq_u32 s52, 0
    s_cbranch_scc1 L_b_step
    s_sub_u32 s31, s45, 2
    s_mov_b32 s27, 0
L_poll_98:
    buffer_load_dword v4, v2, s[8:11], s39 offen sc1
    s_waitcnt vmcnt(0)
    v_cmp_gt_u32 vcc, s31, v4
    s_cbranch_vccz L_pollok_99
    s_sleep 1
    s_add_u32 s27, s27, 1
    s_cmp_lt_u32 s27, 200000
    s_cbranch_scc1 L_poll_98
    s_branch L_b_fail
L_pollok_99:
    s_lshl_b32 s31, s24, 10
    s_add_u32 s40, s36, s31
    s_add_u32 s40, s40, 65536
    s_add_u32 s47, s40, 65536
    s_add_u32 m0, s31, 0
    s_nop 0
    buffer_load_dwordx4 v1, s[8:11], s40 offen sc1 lds
    s_add_u32 m0, s31, 65536
    s_add_u32 s40, s40, 4096
    buffer_load_dwordx4 v1, s[8:11], s47 offen sc1 lds
    s_add_u32 s47, s47, 4096
    s_add_u32 m0, s31, 4096
    s_nop 0
    buffer_load_dwordx4 v1, s[8:11], s40 offen sc1 lds
    s_add_u32 m0, s31, 69648
    s_add_u32 s40, s40, 4096
    buffer_load_dwordx4 v1, s[8:11], s47 offen sc1 lds
    s_add_u32 s47, s47, 4096
    s_add_u32 m0, s31, 8192
    s_nop 0
    buffer_load_dwordx4 v1, s[8:11], s40 offen sc1 lds
    s_add_u32 m0, s31, 73760
    s_add_u32 s40, s40, 4096
    buffer_load_dwordx4 v1, s[8:11], s47 offen sc1 lds
    s_add_u32 s47, s47, 4096
    s_add_u32 m0, s31, 12288
    s_nop 0
    buffer_load_dwordx4 v1, s[8:11], s40 offen sc1 lds
    s_add_u32 m0, s31, 77872
    s_add_u32 s40, s40, 4096
    buffer_load_dwordx4 v1, s[8:11], s47 offen sc1 lds
    s_add_u32 s47, s47, 4096
    s_add_u32 m0, s31, 16384
    s_nop 0
    buffer_load_dwordx4 v1, s[8:11], s40 offen sc1 lds
    s_add_u32 m0, s31, 81984
    s_add_u32 s40, s40, 4096
    buffer_load_dwordx4 v1, s[8:11], s47 offen sc1 lds
    s_add_u32 s47, s47, 4096
    s_add_u32 m0, s31, 20480
    s_nop 0
    buffer_load_dwordx4 v1, s[8:11], s40 offen sc1 lds
    s_add_u32 m0, s31, 86096
    s_add_u32 s40, s40, 4096
    buffer_load_dwordx4 v1, s[8:11], s47 offen sc1 lds
    s_add_u32 s47, s47, 4096
    s_add_u32 m0, s31, 24576
    s_nop 0
    buffer_load_dwordx4 v1, s[8:11], s40 offen sc1 lds
    s_add_u32 m0, s31, 90208
    s_add_u32 s40, s40, 4096
    buffer_load_dwordx4 v1, s[8:11], s47 offen sc1 lds
    s_add_u32 s47, s47, 4096
    s_add_u32 m0, s31, 28672
    s_nop 0
    buffer_load_dwordx4 v1, s[8:11], s40 offen sc1 lds
    s_add_u32 m0, s31, 94320
    s_add_u32 s40, s40, 4096
    buffer_load_dwordx4 v1, s[8:11], s47 offen sc1 lds
    s_add_u32 s47, s47, 4096
    s_add_u32 m0, s31, 32768
    s_nop 0
    buffer_load_dwordx4 v1, s[8:11], s40 offen sc1 lds
    s_add_u32 m0, s31, 98432
    s_add_u32 s40, s40, 4096
    buffer_load_dwordx4 v1, s[8:11], s47 offen sc1 lds
    s_add_u32 s47, s47, 4096
    s_add_u32 m0, s31, 36864
    s_nop 0
    buffer_load_dwordx4 v1, s[8:11], s40 offen sc1 lds
    s_add_u32 m0, s31, 102544
    s_add_u32 s40, s40, 4096
    buffer_load_dwordx4 v1, s[8:11], s47 offen sc1 lds
    s_add_u32 s47, s47, 4096
    s_add_u32 m0, s31, 40960
    s_nop 0
    buffer_load_dwordx4 v1, s[8:11], s40 offen sc1 lds
    s_add_u32 m0, s31, 106656
    s_add_u32 s40, s40, 4096
    buffer_load_dwordx4 v1, s[8:11], s47 offen sc1 lds
    s_add_u32 s47, s47, 4096
    s_add_u32 m0, s31, 45056
    s_nop 0
    buffer_load_dwordx4 v1, s[8:11], s40 offen sc1 lds
    s_add_u32 m0, s31, 110768
    s_add_u32 s40, s40, 4096
    buffer_load_dwordx4 v1, s[8:11], s47 offen sc1 lds
    s_add_u32 s47, s47, 4096
L_b_step:
    s_cmp_eq_u32 s46, 1
    s_cbranch_scc1 L_b_have
    v_max_u32 v3, s45, v14
    s_mov_b32 s27, 0
L_poll_100:
    buffer_load_dword v4, v2, s[8:11], s39 offen sc1
    s_waitcnt vmcnt(0)
    v_cmp_gt_u32 vcc, v3, v4
    s_cbranch_vccz L_pollok_101
    s_sleep 1
    s_add_u32 s27, s27, 1
    s_cmp_lt_u32 s27, 200000
    s_cbranch_scc1 L_poll_100
    s_branch L_b_fail
L_pollok_101:
    s_lshl_b32 s31, s35, 10
    s_add_u32 s40, s36, s31
    s_xor_b32 s30, s35, s33
    s_bitcmp1_b32 s30, 0
    s_cbranch_scc1 L_bl_102
    s_cmp_ge_u32 s35, s53
    s_cbranch_scc1 L_bl_102
    buffer_load_dwordx4 v[28:31], v1, s[8:11], s40 offen sc1
L_bl_102:
    s_cmp_ge_u32 s24, 2
    s_cbranch_scc1 L_bl_103
    s_lshr_b32 s30, s35, 2
    s_lshl_b32 s30, s30, 4
    s_add_u32 s30, s30, 65536
    s_mul_i32 s30, s30, s24
    s_add_u32 m0, s30, s31
    s_add_u32 s30, s24, 1
    s_lshl_b32 s30, s30, 16
    s_add_u32 s40, s40, s30
    buffer_load_dwordx4 v1, s[8:11], s40 offen sc1 lds
L_bl_103:
L_b_have:
    s_lshr_b32 s30, s35, 2
    s_lshl_b32 s30, s30, 4
    s_lshl_b32 s47, s35, 10
    s_add_u32 s47, s47, s30
    v_and_b32 v109, s47, v15
    v_add_u32 v109, v109, v111
    v_and_b32 v110, 0x200, v15
    v_add_u32 v110, v110, v109
    s_lshl_b32 s31, s35, 10
    v_add_u32 v108, s31, v1
    s_add_u32 s45, s45, 2
    s_waitcnt vmcnt(0)
    v_cmp_gt_u32 vcc, s45, v4
    s_barrier
    ds_read_b128 v[16:19], v108 offset:0
    ds_read_b128 v[20:23], v109 offset:0
    ds_read_b128 v[24:27], v110 offset:0
    s_mov_b32 s46, 0
    s_cmp_eq_u32 s35, 63
    s_cbranch_scc1 L_b_fin
    s_cbranch_vccnz L_b_nopf
    s_mov_b32 s46, 1
    s_add_u32 s47, s35, 1
    s_lshl_b32 s31, s47, 10
    s_add_u32 s40, s36, s31
    s_xor_b32 s30, s47, s33
    s_bitcmp1_b32 s30, 0
    s_cbranch_scc1 L_bl_104
    s_cmp_ge_u32 s47, s53
    s_cbranch_scc1 L_bl_104
    buffer_load_dwordx4 v[28:31], v1, s[8:11], s40 offen sc1
L_bl_104:
    s_cmp_ge_u32 s24, 2
    s_cbranch_scc1 L_bl_105
    s_lshr_b32 s30, s47, 2
    s_lshl_b32 s30, s30, 4
    s_add_u32 s30, s30, 65536
    s_mul_i32 s30, s30, s24
    s_add_u32 m0, s30, s31
    s_add_u32 s30, s24, 1
    s_lshl_b32 s30, s30, 16
    s_add_u32 s40, s40, s30
    buffer_load_dwordx4 v1, s[8:11], s40 offen sc1 lds
L_bl_105:
    buffer_load_dword v4, v2, s[8:11], s39 offen sc1
L_b_nopf:
    s_waitcnt lgkmcnt(0)
    s_cmp_gt_u32 s37, 3
    s_cbranch_scc1 L_tr_106
    s_cmp_gt_u32 s37, 1
    s_cbranch_scc1 L_tr_107
    s_cmp_gt_u32 s37, 0
    s_cbranch_scc1 L_b_ain0
    s_branch L_b_adone
L_tr_107:
    s_cmp_gt_u32 s37, 2
    s_cbranch_scc1 L_b_ain2
    s_branch L_b_ain1
L_tr_106:
    s_cmp_gt_u32 s37, 5
    s_cbranch_scc1 L_b_ain5
    s_cmp_gt_u32 s37, 4
    s_cbranch_scc1 L_b_ain4
    s_branch L_b_ain3
L_b_ain5:
    v_mfma_f32_32x32x16_bf16 v[48:63], v[16:19], v[244:247], 0
    s_nop 11
    v_exp_f32 v48, v48
    v_exp_f32 v49, v49
    s_branch L_b_a5
L_b_ain4:
    v_mfma_f32_32x32x16_bf16 v[32:47], v[16:19], v[240:243], 0
    s_nop 11
    v_exp_f32 v32, v32
    v_exp_f32 v33, v33
    s_branch L_b_a4
L_b_ain3:
    v_mfma_f32_32x32x16_bf16 v[48:63], v[16:19], v[236:239], 0
    s_nop 11
    v_exp_f32 v48, v48
    v_exp_f32 v49, v49
    s_branch L_b_a3
L_b_ain2:
    v_mfma_f32_32x32x16_bf16 v[32:47], v[16:19], v[232:235], 0
    s_nop 11
    v_exp_f32 v32, v32
    v_exp_f32 v33, v33
    s_branch L_b_a2
L_b_ain1:
    v_mfma_f32_32x32x16_bf16 v[48:63], v[16:19], v[228:231], 0
    s_nop 11
    v_exp_f32 v48, v48
    v_exp_f32 v49, v49
    s_branch L_b_a1
L_b_ain0:
    v_mfma_f32_32x32x16_bf16 v[32:47], v[16:19], v[224:227], 0
    s_nop 11
    v_exp_f32 v32, v32
    v_exp_f32 v33, v33
    s_branch L_b_a0
L_b_a5:
    v_exp_f32 v50, v50
    v_exp_f32 v51, v51
    v_exp_f32 v52, v52
    v_mfma_f32_32x32x16_bf16 v[32:47], v[16:19], v[240:243], 0
    v_exp_f32 v53, v53
    v_exp_f32 v54, v54
    v_exp_f32 v55, v55
    v_exp_f32 v56, v56
    v_exp_f32 v57, v57
    v_exp_f32 v58, v58
    v_smfmac_f32_32x32x32_bf16 v[208:223], v[20:23], v[48:55], v5
    v_exp_f32 v59, v59
    v_exp_f32 v60, v60
    v_exp_f32 v61, v61
    v_exp_f32 v62, v62
    v_exp_f32 v63, v63
    v_exp_f32 v32, v32
    v_exp_f32 v33, v33
    v_smfmac_f32_32x32x32_bf16 v[208:223], v[24:27], v[56:63], v5
L_b_a4:
    v_exp_f32 v34, v34
    v_exp_f32 v35, v35
    v_exp_f32 v36, v36
    v_mfma_f32_32x32x16_bf16 v[48:63], v[16:19], v[236:239], 0
    v_exp_f32 v37, v37
    v_exp_f32 v38, v38
    v_exp_f32 v39, v39
    v_exp_f32 v40, v40
    v_exp_f32 v41, v41
    v_exp_f32 v42, v42
    v_smfmac_f32_32x32x32_bf16 v[192:207], v[20:23], v[32:39], v5
    v_exp_f32 v43, v43
    v_exp_f32 v44, v44
    v_exp_f32 v45, v45
    v_exp_f32 v46, v46
    v_exp_f32 v47, v47
    v_exp_f32 v48, v48
    v_exp_f32 v49, v49
    v_smfmac_f32_32x32x32_bf16 v[192:207], v[24:27], v[40:47], v5
L_b_a3:
    v_exp_f32 v50, v50
    v_exp_f32 v51, v51
    v_exp_f32 v52, v52
    v_mfma_f32_32x32x16_bf16 v[32:47], v[16:19], v[232:235], 0
    v_exp_f32 v53, v53
    v_exp_f32 v54, v54
    v_exp_f32 v55, v55
    v_exp_f32 v56, v56
    v_exp_f32 v57, v57
    v_exp_f32 v58, v58
    v_smfmac_f32_32x32x32_bf16 v[176:191], v[20:23], v[48:55], v5
    v_exp_f32 v59, v59
    v_exp_f32 v60, v60
    v_exp_f32 v61, v61
    v_exp_f32 v62, v62
    v_exp_f32 v63, v63
    v_exp_f32 v32, v32
    v_exp_f32 v33, v33
    v_smfmac_f32_32x32x32_bf16 v[176:191], v[24:27], v[56:63], v5
L_b_a2:
    v_exp_f32 v34, v34
    v_exp_f32 v35, v35
    v_exp_f32 v36, v36
    v_mfma_f32_32x32x16_bf16 v[48:63], v[16:19], v[228:231], 0
    v_exp_f32 v37, v37
    v_exp_f32 v38, v38
    v_exp_f32 v39, v39
    v_exp_f32 v40, v40
    v_exp_f32 v41, v41
    v_exp_f32 v42, v42
    v_smfmac_f32_32x32x32_bf16 v[160:175], v[20:23], v[32:39], v5
    v_exp_f32 v43, v43
    v_exp_f32 v44, v44
    v_exp_f32 v45, v45
    v_exp_f32 v46, v46
    v_exp_f32 v47, v47
    v_exp_f32 v48, v48
    v_exp_f32 v49, v49
    v_smfmac_f32_32x32x32_bf16 v[160:175], v[24:27], v[40:47], v5
L_b_a1:
    v_exp_f32 v50, v50
    v_exp_f32 v51, v51
    v_exp_f32 v52, v52
    v_mfma_f32_32x32x16_bf16 v[32:47], v[16:19], v[224:227], 0
    v_exp_f32 v53, v53
    v_exp_f32 v54, v54
    v_exp_f32 v55, v55
    v_exp_f32 v56, v56
    v_exp_f32 v57, v57
    v_exp_f32 v58, v58
    v_smfmac_f32_32x32x32_bf16 v[144:159], v[20:23], v[48:55], v5
    v_exp_f32 v59, v59
    v_exp_f32 v60, v60
    v_exp_f32 v61, v61
    v_exp_f32 v62, v62
    v_exp_f32 v63, v63
    v_exp_f32 v32, v32
    v_exp_f32 v33, v33
    v_smfmac_f32_32x32x32_bf16 v[144:159], v[24:27], v[56:63], v5
L_b_a0:
    v_exp_f32 v34, v34
    v_exp_f32 v35, v35
    v_exp_f32 v36, v36
    v_exp_f32 v37, v37
    v_exp_f32 v38, v38
    v_exp_f32 v39, v39
    v_exp_f32 v40, v40
    v_exp_f32 v41, v41
    v_exp_f32 v42, v42
    v_smfmac_f32_32x32x32_bf16 v[128:143], v[20:23], v[32:39], v5
    v_exp_f32 v43, v43
    v_exp_f32 v44, v44
    v_exp_f32 v45, v45
    v_exp_f32 v46, v46
    v_exp_f32 v47, v47
    s_nop 1
    v_smfmac_f32_32x32x32_bf16 v[128:143], v[24:27], v[40:47], v5
L_b_adone:
    s_xor_b32 s30, s35, s33
    s_bitcmp1_b32 s30, 0
    s_cbranch_scc1 L_b_next
    s_cmp_ge_u32 s35, s53
    s_cbranch_scc1 L_b_next
    s_mov_b32 s54, s35
L_b_bgo:
    v_mov_b64 v[64:65], 0
    v_mov_b64 v[66:67], 0
    v_mov_b64 v[68:69], 0
    v_mov_b64 v[70:71], 0
    v_mov_b64 v[72:73], 0
    s_cmp_lt_u32 s54, s24
    s_cbranch_scc1 L_b_bdone
    s_sub_u32 s38, s54, s24
    s_lshr_b32 s38, s38, 2
    s_cmp_gt_u32 s38, 7
    s_cbranch_scc1 L_tr_108
    s_cmp_gt_u32 s38, 3
    s_cbranch_scc1 L_tr_109
    s_cmp_gt_u32 s38, 1
    s_cbranch_scc1 L_tr_110
    s_cmp_gt_u32 s38, 0
    s_cbranch_scc1 L_b_bin1
    s_branch L_b_bin0
L_tr_110:
    s_cmp_gt_u32 s38, 2
    s_cbranch_scc1 L_b_bin3
    s_branch L_b_bin2
L_tr_109:
    s_cmp_gt_u32 s38, 5
    s_cbranch_scc1 L_tr_111
    s_cmp_gt_u32 s38, 4
    s_cbranch_scc1 L_b_bin5
    s_branch L_b_bin4
L_tr_111:
    s_cmp_gt_u32 s38, 6
    s_cbranch_scc1 L_b_bin7
    s_branch L_b_bin6
L_tr_108:
    s_cmp_gt_u32 s38, 11
    s_cbranch_scc1 L_tr_112
    s_cmp_gt_u32 s38, 9
    s_cbranch_scc1 L_tr_113
    s_cmp_gt_u32 s38, 8
    s_cbranch_scc1 L_b_bin9
    s_branch L_b_bin8
L_tr_113:
    s_cmp_gt_u32 s38, 10
    s_cbranch_scc1 L_b_bin11
    s_branch L_b_bin10
L_tr_112:
    s_cmp_gt_u32 s38, 13
    s_cbranch_scc1 L_tr_114
    s_cmp_gt_u32 s38, 12
    s_cbranch_scc1 L_b_bin13
    s_branch L_b_bin12
L_tr_114:
    s_cmp_gt_u32 s38, 14
    s_cbranch_scc1 L_b_bin15
    s_branch L_b_bin14
L_b_bin15:
    ds_read_b128 v[16:19], v6 offset:61440
    ds_read_b128 v[20:23], v7 offset:61680
    s_waitcnt lgkmcnt(1)
    v_mfma_f32_32x32x16_bf16 v[48:63], v[16:19], v[28:31], 0
    ds_read_b128 v[16:19], v6 offset:57344
    s_nop 9
    s_waitcnt lgkmcnt(0)
    v_exp_f32 v48, v48
    v_exp_f32 v49, v49
    s_branch L_b_b15
L_b_bin14:
    ds_read_b128 v[16:19], v6 offset:57344
    ds_read_b128 v[20:23], v7 offset:57568
    s_waitcnt lgkmcnt(1)
    v_mfma_f32_32x32x16_bf16 v[32:47], v[16:19], v[28:31], 0
    ds_read_b128 v[16:19], v6 offset:53248
    s_nop 9
    s_waitcnt lgkmcnt(0)
    v_exp_f32 v32, v32
    v_exp_f32 v33, v33
    s_branch L_b_b14
L_b_bin13:
    ds_read_b128 v[16:19], v6 offset:53248
    ds_read_b128 v[20:23], v7 offset:53456
    s_waitcnt lgkmcnt(1)
    v_mfma_f32_32x32x16_bf16 v[48:63], v[16:19], v[28:31], 0
    ds_read_b128 v[16:19], v6 offset:49152
    s_nop 9
    s_waitcnt lgkmcnt(0)
    v_exp_f32 v48, v48
    v_exp_f32 v49, v49
    s_branch L_b_b13
L_b_bin12:
    ds_read_b128 v[16:19], v6 offset:49152
    ds_read_b128 v[20:23], v7 offset:49344
    s_waitcnt lgkmcnt(1)
    v_mfma_f32_32x32x16_bf16 v[32:47], v[16:19], v[28:31], 0
    ds_read_b128 v[16:19], v6 offset:45056
    s_nop 9
    s_waitcnt lgkmcnt(0)
    v_exp_f32 v32, v32
    v_exp_f32 v33, v33
    s_branch L_b_b12
L_b_bin11:
    ds_read_b128 v[16:19], v6 offset:45056
    ds_read_b128 v[20:23], v7 offset:45232
    s_waitcnt lgkmcnt(1)
    v_mfma_f32_32x32x16_bf16 v[48:63], v[16:19], v[28:31], 0
    ds_read_b128 v[16:19], v6 offset:40960
    s_nop 9
    s_waitcnt lgkmcnt(0)
    v_exp_f32 v48, v48
    v_exp_f32 v49, v49
    s_branch L_b_b11
L_b_bin10:
    ds_read_b128 v[16:19], v6 offset:40960
    ds_read_b128 v[20:23], v7 offset:41120
    s_waitcnt lgkmcnt(1)
    v_mfma_f32_32x32x16_bf16 v[32:47], v[16:19], v[28:31], 0
    ds_read_b128 v[16:19], v6 offset:36864
    s_nop 9
    s_waitcnt lgkmcnt(0)
    v_exp_f32 v32, v32
    v_exp_f32 v33, v33
    s_branch L_b_b10
L_b_bin9:
    ds_read_b128 v[16:19], v6 offset:36864
    ds_read_b128 v[20:23], v7 offset:37008
    s_waitcnt lgkmcnt(1)
    v_mfma_f32_32x32x16_bf16 v[48:63], v[16:19], v[28:31], 0
    ds_read_b128 v[16:19], v6 offset:32768
    s_nop 9
    s_waitcnt lgkmcnt(0)
    v_exp_f32 v48, v48
    v_exp_f32 v49, v49
    s_branch L_b_b9
L_b_bin8:
    ds_read_b128 v[16:19], v6 offset:32768
    ds_read_b128 v[20:23], v7 offset:32896
    s_waitcnt lgkmcnt(1)
    v_mfma_f32_32x32x16_bf16 v[32:47], v[16:19], v[28:31], 0
    ds_read_b128 v[16:19], v6 offset:28672
    s_nop 9
    s_waitcnt lgkmcnt(0)
    v_exp_f32 v32, v32
    v_exp_f32 v33, v33
    s_branch L_b_b8
L_b_bin7:
    ds_read_b128 v[16:19], v6 offset:28672
    ds_read_b128 v[20:23], v7 offset:28784
    s_waitcnt lgkmcnt(1)
    v_mfma_f32_32x32x16_bf16 v[48:63], v[16:19], v[28:31], 0
    ds_read_b128 v[16:19], v6 offset:24576
    s_nop 9
    s_waitcnt lgkmcnt(0)
    v_exp_f32 v48, v48
    v_exp_f32 v49, v49
    s_branch L_b_b7
L_b_bin6:
    ds_read_b128 v[16:19], v6 offset:24576
    ds_read_b128 v[20:23], v7 offset:24672
    s_waitcnt lgkmcnt(1)
    v_mfma_f32_32x32x16_bf16 v[32:47], v[16:19], v[28:31], 0
    ds_read_b128 v[16:19], v6 offset:20480
    s_nop 9
    s_waitcnt lgkmcnt(0)
    v_exp_f32 v32, v32
    v_exp_f32 v33, v33
    s_branch L_b_b6
L_b_bin5:
    ds_read_b128 v[16:19], v6 offset:20480
    ds_read_b128 v[20:23], v7 offset:20560
    s_waitcnt lgkmcnt(1)
    v_mfma_f32_32x32x16_bf16 v[48:63], v[16:19], v[28:31], 0
    ds_read_b128 v[16:19], v6 offset:16384
    s_nop 9
    s_waitcnt lgkmcnt(0)
    v_exp_f32 v48, v48
    v_exp_f32 v49, v49
    s_branch L_b_b5
L_b_bin4:
    ds_read_b128 v[16:19], v6 offset:16384
    ds_read_b128 v[20:23], v7 offset:16448
    s_waitcnt lgkmcnt(1)
    v_mfma_f32_32x32x16_bf16 v[32:47], v[16:19], v[28:31], 0
    ds_read_b128 v[16:19], v6 offset:12288
    s_nop 9
    s_waitcnt lgkmcnt(0)
    v_exp_f32 v32, v32
    v_exp_f32 v33, v33
    s_branch L_b_b4
L_b_bin3:
    ds_read_b128 v[16:19], v6 offset:12288
    ds_read_b128 v[20:23], v7 offset:12336
    s_waitcnt lgkmcnt(1)
    v_mfma_f32_32x32x16_bf16 v[48:63], v[16:19], v[28:31], 0
    ds_read_b128 v[16:19], v6 offset:8192
    s_nop 9
    s_waitcnt lgkmcnt(0)
    v_exp_f32 v48, v48
    v_exp_f32 v49, v49
    s_branch L_b_b3
L_b_bin2:
    ds_read_b128 v[16:19], v6 offset:8192
    ds_read_b128 v[20:23], v7 offset:8224
    s_waitcnt lgkmcnt(1)
    v_mfma_f32_32x32x16_bf16 v[32:47], v[16:19], v[28:31], 0
    ds_read_b128 v[16:19], v6 offset:4096
    s_nop 9
    s_waitcnt lgkmcnt(0)
    v_exp_f32 v32, v32
    v_exp_f32 v33, v33
    s_branch L_b_b2
L_b_bin1:
    ds_read_b128 v[16:19], v6 offset:4096
    ds_read_b128 v[20:23], v7 offset:4112
    s_waitcnt lgkmcnt(1)
    v_mfma_f32_32x32x16_bf16 v[48:63], v[16:19], v[28:31], 0
    ds_read_b128 v[16:19], v6 offset:0
    s_nop 9
    s_waitcnt lgkmcnt(0)
    v_exp_f32 v48, v48
    v_exp_f32 v49, v49
    s_branch L_b_b1
L_b_bin0:
    ds_read_b128 v[16:19], v6 offset:0
    ds_read_b128 v[20:23], v7 offset:0
    s_waitcnt lgkmcnt(1)
    v_mfma_f32_32x32x16_bf16 v[32:47], v[16:19], v[28:31], 0
    s_nop 10
    s_waitcnt lgkmcnt(0)
    v_exp_f32 v32, v32
    v_exp_f32 v33, v33
    s_branch L_b_b0
L_b_b15:
    ds_read_b128 v[24:27], v8 offset:61680
    v_exp_f32 v50, v50
    v_exp_f32 v51, v51
    v_exp_f32 v52, v52
    v_mfma_f32_32x32x16_bf16 v[32:47], v[16:19], v[28:31], 0
    ds_read_b128 v[16:19], v6 offset:53248
    v_exp_f32 v53, v53
    v_exp_f32 v54, v54
    v_exp_f32 v55, v55
    v_exp_f32 v56, v56
    v_exp_f32 v57, v57
    v_smfmac_f32_32x32x32_bf16 v[64:79], v[20:23], v[48:55], v5
    s_waitcnt lgkmcnt(1)
    ds_read_b128 v[20:23], v7 offset:57568
    v_exp_f32 v58, v58
    v_exp_f32 v59, v59
    v_exp_f32 v60, v60
    v_exp_f32 v61, v61
    v_exp_f32 v62, v62
    v_exp_f32 v63, v63
    v_exp_f32 v32, v32
    v_exp_f32 v33, v33
    v_smfmac_f32_32x32x32_bf16 v[64:79], v[24:27], v[56:63], v5
    s_waitcnt lgkmcnt(0)
L_b_b14:
    ds_read_b128 v[24:27], v8 offset:57568
    v_exp_f32 v34, v34
    v_exp_f32 v35, v35
    v_exp_f32 v36, v36
    v_mfma_f32_32x32x16_bf16 v[48:63], v[16:19], v[28:31], 0
    ds_read_b128 v[16:19], v6 offset:49152
    v_exp_f32 v37, v37
    v_exp_f32 v38, v38
    v_exp_f32 v39, v39
    v_exp_f32 v40, v40
    v_exp_f32 v41, v41
    v_smfmac_f32_32x32x32_bf16 v[64:79], v[20:23], v[32:39], v5
    s_waitcnt lgkmcnt(1)
    ds_read_b128 v[20:23], v7 offset:53456
    v_exp_f32 v42, v42
    v_exp_f32 v43, v43
    v_exp_f32 v44, v44
    v_exp_f32 v45, v45
    v_exp_f32 v46, v46
    v_exp_f32 v47, v47
    v_exp_f32 v48, v48
    v_exp_f32 v49, v49
    v_smfmac_f32_32x32x32_bf16 v[64:79], v[24:27], v[40:47], v5
    s_waitcnt lgkmcnt(0)
L_b_b13:
    ds_read_b128 v[24:27], v8 offset:53456
    v_exp_f32 v50, v50
    v_exp_f32 v51, v51
    v_exp_f32 v52, v52
    v_mfma_f32_32x32x16_bf16 v[32:47], v[16:19], v[28:31], 0
    ds_read_b128 v[16:19], v6 offset:45056
    v_exp_f32 v53, v53
    v_exp_f32 v54, v54
    v_exp_f32 v55, v55
    v_exp_f32 v56, v56
    v_exp_f32 v57, v57
    v_smfmac_f32_32x32x32_bf16 v[64:79], v[20:23], v[48:55], v5
    s_waitcnt lgkmcnt(1)
    ds_read_b128 v[20:23], v7 offset:49344
    v_exp_f32 v58, v58
    v_exp_f32 v59, v59
    v_exp_f32 v60, v60
    v_exp_f32 v61, v61
    v_exp_f32 v62, v62
    v_exp_f32 v63, v63
    v_exp_f32 v32, v32
    v_exp_f32 v33, v33
    v_smfmac_f32_32x32x32_bf16 v[64:79], v[24:27], v[56:63], v5
    s_waitcnt lgkmcnt(0)
L_b_b12:
    ds_read_b128 v[24:27], v8 offset:49344
    v_exp_f32 v34, v34
    v_exp_f32 v35, v35
    v_exp_f32 v36, v36
    v_mfma_f32_32x32x16_bf16 v[48:63], v[16:19], v[28:31], 0
    ds_read_b128 v[16:19], v6 offset:40960
    v_exp_f32 v37, v37
    v_exp_f32 v38, v38
    v_exp_f32 v39, v39
    v_exp_f32 v40, v40
    v_exp_f32 v41, v41
    v_smfmac_f32_32x32x32_bf16 v[64:79], v[20:23], v[32:39], v5
    s_waitcnt lgkmcnt(1)
    ds_read_b128 v[20:23], v7 offset:45232
    v_exp_f32 v42, v42
    v_exp_f32 v43, v43
    v_exp_f32 v44, v44
    v_exp_f32 v45, v45
    v_exp_f32 v46, v46
    v_exp_f32 v47, v47
    v_exp_f32 v48, v48
    v_exp_f32 v49, v49
    v_smfmac_f32_32x32x32_bf16 v[64:79], v[24:27], v[40:47], v5
    s_waitcnt lgkmcnt(0)
L_b_b11:
    ds_read_b128 v[24:27], v8 offset:45232
    v_exp_f32 v50, v50
    v_exp_f32 v51, v51
    v_exp_f32 v52, v52
    v_mfma_f32_32x32x16_bf16 v[32:47], v[16:19], v[28:31], 0
    ds_read_b128 v[16:19], v6 offset:36864
    v_exp_f32 v53, v53
    v_exp_f32 v54, v54
    v_exp_f32 v55, v55
    v_exp_f32 v56, v56
    v_exp_f32 v57, v57
    v_smfmac_f32_32x32x32_bf16 v[64:79], v[20:23], v[48:55], v5
    s_waitcnt lgkmcnt(1)
    ds_read_b128 v[20:23], v7 offset:41120
    v_exp_f32 v58, v58
    v_exp_f32 v59, v59
    v_exp_f32 v60, v60
    v_exp_f32 v61, v61
    v_exp_f32 v62, v62
    v_exp_f32 v63, v63
    v_exp_f32 v32, v32
    v_exp_f32 v33, v33
    v_smfmac_f32_32x32x32_bf16 v[64:79], v[24:27], v[56:63], v5
    s_waitcnt lgkmcnt(0)
L_b_b10:
    ds_read_b128 v[24:27], v8 offset:41120
    v_exp_f32 v34, v34
    v_exp_f32 v35, v35
    v_exp_f32 v36, v36
    v_mfma_f32_32x32x16_bf16 v[48:63], v[16:19], v[28:31], 0
    ds_read_b128 v[16:19], v6 offset:32768
    v_exp_f32 v37, v37
    v_exp_f32 v38, v38
    v_exp_f32 v39, v39
    v_exp_f32 v40, v40
    v_exp_f32 v41, v41
    v_smfmac_f32_32x32x32_bf16 v[64:79], v[20:23], v[32:39], v5
    s_waitcnt lgkmcnt(1)
    ds_read_b128 v[20:23], v7 offset:37008
    v_exp_f32 v42, v42
    v_exp_f32 v43, v43
    v_exp_f32 v44, v44
    v_exp_f32 v45, v45
    v_exp_f32 v46, v46
    v_exp_f32 v47, v47
    v_exp_f32 v48, v48
    v_exp_f32 v49, v49
    v_smfmac_f32_32x32x32_bf16 v[64:79], v[24:27], v[40:47], v5
    s_waitcnt lgkmcnt(0)
L_b_b9:
    ds_read_b128 v[24:27], v8 offset:37008
    v_exp_f32 v50, v50
    v_exp_f32 v51, v51
    v_exp_f32 v52, v52
    v_mfma_f32_32x32x16_bf16 v[32:47], v[16:19], v[28:31], 0
    ds_read_b128 v[16:19], v6 offset:28672
    v_exp_f32 v53, v53
    v_exp_f32 v54, v54
    v_exp_f32 v55, v55
    v_exp_f32 v56, v56
    v_exp_f32 v57, v57
    v_smfmac_f32_32x32x32_bf16 v[64:79], v[20:23], v[48:55], v5
    s_waitcnt lgkmcnt(1)
    ds_read_b128 v[20:23], v7 offset:32896
    v_exp_f32 v58, v58
    v_exp_f32 v59, v59
    v_exp_f32 v60, v60
    v_exp_f32 v61, v61
    v_exp_f32 v62, v62
    v_exp_f32 v63, v63
    v_exp_f32 v32, v32
    v_exp_f32 v33, v33
    v_smfmac_f32_32x32x32_bf16 v[64:79], v[24:27], v[56:63], v5
    s_waitcnt lgkmcnt(0)
L_b_b8:
    ds_read_b128 v[24:27], v8 offset:32896
    v_exp_f32 v34, v34
    v_exp_f32 v35, v35
    v_exp_f32 v36, v36
    v_mfma_f32_32x32x16_bf16 v[48:63], v[16:19], v[28:31], 0
    ds_read_b128 v[16:19], v6 offset:24576
    v_exp_f32 v37, v37
    v_exp_f32 v38, v38
    v_exp_f32 v39, v39
    v_exp_f32 v40, v40
    v_exp_f32 v41, v41
    v_smfmac_f32_32x32x32_bf16 v[64:79], v[20:23], v[32:39], v5
    s_waitcnt lgkmcnt(1)
    ds_read_b128 v[20:23], v7 offset:28784
    v_exp_f32 v42, v42
    v_exp_f32 v43, v43
    v_exp_f32 v44, v44
    v_exp_f32 v45, v45
    v_exp_f32 v46, v46
    v_exp_f32 v47, v47
    v_exp_f32 v48, v48
    v_exp_f32 v49, v49
    v_smfmac_f32_32x32x32_bf16 v[64:79], v[24:27], v[40:47], v5
    s_waitcnt lgkmcnt(0)
L_b_b7:
    ds_read_b128 v[24:27], v8 offset:28784
    v_exp_f32 v50, v50
    v_exp_f32 v51, v51
    v_exp_f32 v52, v52
    v_mfma_f32_32x32x16_bf16 v[32:47], v[16:19], v[28:31], 0
    ds_read_b128 v[16:19], v6 offset:20480
    v_exp_f32 v53, v53
    v_exp_f32 v54, v54
    v_exp_f32 v55, v55
    v_exp_f32 v56, v56
    v_exp_f32 v57, v57
    v_smfmac_f32_32x32x32_bf16 v[64:79], v[20:23], v[48:55], v5
    s_waitcnt lgkmcnt(1)
    ds_read_b128 v[20:23], v7 offset:24672
    v_exp_f32 v58, v58
    v_exp_f32 v59, v59
    v_exp_f32 v60, v60
    v_exp_f32 v61, v61
    v_exp_f32 v62, v62
    v_exp_f32 v63, v63
    v_exp_f32 v32, v32
    v_exp_f32 v33, v33
    v_smfmac_f32_32x32x32_bf16 v[64:79], v[24:27], v[56:63], v5
    s_waitcnt lgkmcnt(0)
L_b_b6:
    ds_read_b128 v[24:27], v8 offset:24672
    v_exp_f32 v34, v34
    v_exp_f32 v35, v35
    v_exp_f32 v36, v36
    v_mfma_f32_32x32x16_bf16 v[48:63], v[16:19], v[28:31], 0
    ds_read_b128 v[16:19], v6 offset:16384
    v_exp_f32 v37, v37
    v_exp_f32 v38, v38
    v_exp_f32 v39, v39
    v_exp_f32 v40, v40
    v_exp_f32 v41, v41
    v_smfmac_f32_32x32x32_bf16 v[64:79], v[20:23], v[32:39], v5
    s_waitcnt lgkmcnt(1)
    ds_read_b128 v[20:23], v7 offset:20560
    v_exp_f32 v42, v42
    v_exp_f32 v43, v43
    v_exp_f32 v44, v44
    v_exp_f32 v45, v45
    v_exp_f32 v46, v46
    v_exp_f32 v47, v47
    v_exp_f32 v48, v48
    v_exp_f32 v49, v49
    v_smfmac_f32_32x32x32_bf16 v[64:79], v[24:27], v[40:47], v5
    s_waitcnt lgkmcnt(0)
L_b_b5:
    ds_read_b128 v[24:27], v8 offset:20560
    v_exp_f32 v50, v50
    v_exp_f32 v51, v51
    v_exp_f32 v52, v52
    v_mfma_f32_32x32x16_bf16 v[32:47], v[16:19], v[28:31], 0
    ds_read_b128 v[16:19], v6 offset:12288
    v_exp_f32 v53, v53
    v_exp_f32 v54, v54
    v_exp_f32 v55, v55
    v_exp_f32 v56, v56
    v_exp_f32 v57, v57
    v_smfmac_f32_32x32x32_bf16 v[64:79], v[20:23], v[48:55], v5
    s_waitcnt lgkmcnt(1)
    ds_read_b128 v[20:23], v7 offset:16448
    v_exp_f32 v58, v58
    v_exp_f32 v59, v59
    v_exp_f32 v60, v60
    v_exp_f32 v61, v61
    v_exp_f32 v62, v62
    v_exp_f32 v63, v63
    v_exp_f32 v32, v32
    v_exp_f32 v33, v33
    v_smfmac_f32_32x32x32_bf16 v[64:79], v[24:27], v[56:63], v5
    s_waitcnt lgkmcnt(0)
L_b_b4:
    ds_read_b128 v[24:27], v8 offset:16448
    v_exp_f32 v34, v34
    v_exp_f32 v35, v35
    v_exp_f32 v36, v36
    v_mfma_f32_32x32x16_bf16 v[48:63], v[16:19], v[28:31], 0
    ds_read_b128 v[16:19], v6 offset:8192
    v_exp_f32 v37, v37
    v_exp_f32 v38, v38
    v_exp_f32 v39, v39
    v_exp_f32 v40, v40
    v_exp_f32 v41, v41
    v_smfmac_f32_32x32x32_bf16 v[64:79], v[20:23], v[32:39], v5
    s_waitcnt lgkmcnt(1)
    ds_read_b128 v[20:23], v7 offset:12336
    v_exp_f32 v42, v42
    v_exp_f32 v43, v43
    v_exp_f32 v44, v44
    v_exp_f32 v45, v45
    v_exp_f32 v46, v46
    v_exp_f32 v47, v47
    v_exp_f32 v48, v48
    v_exp_f32 v49, v49
    v_smfmac_f32_32x32x32_bf16 v[64:79], v[24:27], v[40:47], v5
    s_waitcnt lgkmcnt(0)
L_b_b3:
    ds_read_b128 v[24:27], v8 offset:12336
    v_exp_f32 v50, v50
    v_exp_f32 v51, v51
    v_exp_f32 v52, v52
    v_mfma_f32_32x32x16_bf16 v[32:47], v[16:19], v[28:31], 0
    ds_read_b128 v[16:19], v6 offset:4096
    v_exp_f32 v53, v53
    v_exp_f32 v54, v54
    v_exp_f32 v55, v55
    v_exp_f32 v56, v56
    v_exp_f32 v57, v57
    v_smfmac_f32_32x32x32_bf16 v[64:79], v[20:23], v[48:55], v5
    s_waitcnt lgkmcnt(1)
    ds_read_b128 v[20:23], v7 offset:8224
    v_exp_f32 v58, v58
    v_exp_f32 v59, v59
    v_exp_f32 v60, v60
    v_exp_f32 v61, v61
    v_exp_f32 v62, v62
    v_exp_f32 v63, v63
    v_exp_f32 v32, v32
    v_exp_f32 v33, v33
    v_smfmac_f32_32x32x32_bf16 v[64:79], v[24:27], v[56:63], v5
    s_waitcnt lgkmcnt(0)
L_b_b2:
    ds_read_b128 v[24:27], v8 offset:8224
    v_exp_f32 v34, v34
    v_exp_f32 v35, v35
    v_exp_f32 v36, v36
    v_mfma_f32_32x32x16_bf16 v[48:63], v[16:19], v[28:31], 0
    ds_read_b128 v[16:19], v6 offset:0
    v_exp_f32 v37, v37
    v_exp_f32 v38, v38
    v_exp_f32 v39, v39
    v_exp_f32 v40, v40
    v_exp_f32 v41, v41
    v_smfmac_f32_32x32x32_bf16 v[64:79], v[20:23], v[32:39], v5
    s_waitcnt lgkmcnt(1)
    ds_read_b128 v[20:23], v7 offset:4112
    v_exp_f32 v42, v42
    v_exp_f32 v43, v43
    v_exp_f32 v44, v44
    v_exp_f32 v45, v45
    v_exp_f32 v46, v46
    v_exp_f32 v47, v47
    v_exp_f32 v48, v48
    v_exp_f32 v49, v49
    v_smfmac_f32_32x32x32_bf16 v[64:79], v[24:27], v[40:47], v5
    s_waitcnt lgkmcnt(0)
L_b_b1:
    ds_read_b128 v[24:27], v8 offset:4112
    v_exp_f32 v50, v50
    v_exp_f32 v51, v51
    v_exp_f32 v52, v52
    v_mfma_f32_32x32x16_bf16 v[32:47], v[16:19], v[28:31], 0
    v_exp_f32 v53, v53
    v_exp_f32 v54, v54
    v_exp_f32 v55, v55
    v_exp_f32 v56, v56
    v_exp_f32 v57, v57
    v_smfmac_f32_32x32x32_bf16 v[64:79], v[20:23], v[48:55], v5
    s_waitcnt lgkmcnt(0)
    ds_read_b128 v[20:23], v7 offset:0
    v_exp_f32 v58, v58
    v_exp_f32 v59, v59
    v_exp_f32 v60, v60
    v_exp_f32 v61, v61
    v_exp_f32 v62, v62
    v_exp_f32 v63, v63
    v_exp_f32 v32, v32
    v_exp_f32 v33, v33
    v_smfmac_f32_32x32x32_bf16 v[64:79], v[24:27], v[56:63], v5
    s_waitcnt lgkmcnt(0)
L_b_b0:
    ds_read_b128 v[24:27], v8 offset:0
    v_exp_f32 v34, v34
    v_exp_f32 v35, v35
    v_exp_f32 v36, v36
    v_exp_f32 v37, v37
    v_exp_f32 v38, v38
    v_exp_f32 v39, v39
    v_exp_f32 v40, v40
    v_exp_f32 v41, v41
    v_smfmac_f32_32x32x32_bf16 v[64:79], v[20:23], v[32:39], v5
    s_waitcnt lgkmcnt(0)
    v_exp_f32 v42, v42
    v_exp_f32 v43, v43
    v_exp_f32 v44, v44
    v_exp_f32 v45, v45
    v_exp_f32 v46, v46
    v_exp_f32 v47, v47
    s_nop 1
    v_smfmac_f32_32x32x32_bf16 v[64:79], v[24:27], v[40:47], v5
    s_nop 11
L_b_bdone:
    s_waitcnt vmcnt(0)
    s_cmp_eq_u32 s56, 0
    s_cbranch_scc1 L_pf_115
    s_mov_b32 exec_lo, s56
    s_mov_b32 exec_hi, 0
    s_waitcnt vmcnt(0)
    buffer_store_dword v3, v12, s[8:11], s42 offen sc1
    s_mov_b64 exec, -1
    s_mov_b32 s56, 0
L_pf_115:
    ds_write_b128 v9, v[64:67]
    ds_write_b128 v9, v[68:71] offset:1024
    ds_write_b32 v9, v72 offset:2048
    s_bfe_u32 s30, s35, 0x20001
    s_cmp_lg_u32 s30, s24
    s_waitcnt lgkmcnt(0)
    s_barrier
    s_cbranch_scc1 L_b_next
    ds_read_b128 v[32:35], v10 offset:0
    ds_read_b128 v[36:39], v10 offset:1024
    ds_read_b32 v80, v10 offset:2048
    ds_read_b128 v[40:43], v10 offset:3072
    ds_read_b128 v[44:47], v10 offset:4096
    ds_read_b32 v81, v10 offset:5120
    ds_read_b128 v[48:51], v10 offset:6144
    ds_read_b128 v[52:55], v10 offset:7168
    ds_read_b32 v82, v10 offset:8192
    ds_read_b128 v[56:59], v10 offset:9216
    ds_read_b128 v[60:63], v10 offset:10240
    ds_read_b32 v83, v10 offset:11264
    s_cmp_gt_u32 s37, 2
    s_cbranch_scc1 L_tr_116
    s_cmp_gt_u32 s37, 1
    s_cbranch_scc1 L_b_put2
    s_cmp_gt_u32 s37, 0
    s_cbranch_scc1 L_b_put1
    s_branch L_b_put0
L_tr_116:
    s_cmp_gt_u32 s37, 4
    s_cbranch_scc1 L_b_put5
    s_cmp_gt_u32 s37, 3
    s_cbranch_scc1 L_b_put4
    s_branch L_b_put3
L_b_put5:
    v_mov_b32 v244, v28
    v_mov_b32 v245, v29
    v_mov_b32 v246, v30
    v_mov_b32 v247, v31
    s_waitcnt lgkmcnt(6)
    v_pk_add_f32 v[32:33], v[32:33], v[40:41]
    v_pk_add_f32 v[34:35], v[34:35], v[42:43]
    v_pk_add_f32 v[36:37], v[36:37], v[44:45]
    v_pk_add_f32 v[38:39], v[38:39], v[46:47]
    s_waitcnt lgkmcnt(0)
    v_pk_add_f32 v[48:49], v[48:49], v[56:57]
    v_pk_add_f32 v[50:51], v[50:51], v[58:59]
    v_pk_add_f32 v[52:53], v[52:53], v[60:61]
    v_pk_add_f32 v[54:55], v[54:55], v[62:63]
    v_pk_add_f32 v[80:81], v[80:81], v[82:83]
    v_pk_add_f32 v[208:209], v[32:33], v[48:49]
    v_pk_add_f32 v[210:211], v[34:35], v[50:51]
    v_pk_add_f32 v[212:213], v[36:37], v[52:53]
    v_pk_add_f32 v[214:215], v[38:39], v[54:55]
    v_add_f32 v216, v80, v81
    s_branch L_b_putdone
L_b_put4:
    v_mov_b32 v240, v28
    v_mov_b32 v241, v29
    v_mov_b32 v242, v30
    v_mov_b32 v243, v31
    s_waitcnt lgkmcnt(6)
    v_pk_add_f32 v[32:33], v[32:33], v[40:41]
    v_pk_add_f32 v[34:35], v[34:35], v[42:43]
    v_pk_add_f32 v[36:37], v[36:37], v[44:45]
    v_pk_add_f32 v[38:39], v[38:39], v[46:47]
    s_waitcnt lgkmcnt(0)
    v_pk_add_f32 v[48:49], v[48:49], v[56:57]
    v_pk_add_f32 v[50:51], v[50:51], v[58:59]
    v_pk_add_f32 v[52:53], v[52:53], v[60:61]
    v_pk_add_f32 v[54:55], v[54:55], v[62:63]
    v_pk_add_f32 v[80:81], v[80:81], v[82:83]
    v_pk_add_f32 v[192:193], v[32:33], v[48:49]
    v_pk_add_f32 v[194:195], v[34:35], v[50:51]
    v_pk_add_f32 v[196:197], v[36:37], v[52:53]
    v_pk_add_f32 v[198:199], v[38:39], v[54:55]
    v_add_f32 v200, v80, v81
    s_branch L_b_putdone
L_b_put3:
    v_mov_b32 v236, v28
    v_mov_b32 v237, v29
    v_mov_b32 v238, v30
    v_mov_b32 v239, v31
    s_waitcnt lgkmcnt(6)
    v_pk_add_f32 v[32:33], v[32:33], v[40:41]
    v_pk_add_f32 v[34:35], v[34:35], v[42:43]
    v_pk_add_f32 v[36:37], v[36:37], v[44:45]
    v_pk_add_f32 v[38:39], v[38:39], v[46:47]
    s_waitcnt lgkmcnt(0)
    v_pk_add_f32 v[48:49], v[48:49], v[56:57]
    v_pk_add_f32 v[50:51], v[50:51], v[58:59]
    v_pk_add_f32 v[52:53], v[52:53], v[60:61]
    v_pk_add_f32 v[54:55], v[54:55], v[62:63]
    v_pk_add_f32 v[80:81], v[80:81], v[82:83]
    v_pk_add_f32 v[176:177], v[32:33], v[48:49]
    v_pk_add_f32 v[178:179], v[34:35], v[50:51]
    v_pk_add_f32 v[180:181], v[36:37], v[52:53]
    v_pk_add_f32 v[182:183], v[38:39], v[54:55]
    v_add_f32 v184, v80, v81
    s_branch L_b_putdone
L_b_put2:
    v_mov_b32 v232, v28
    v_mov_b32 v233, v29
    v_mov_b32 v234, v30
    v_mov_b32 v235, v31
    s_waitcnt lgkmcnt(6)
    v_pk_add_f32 v[32:33], v[32:33], v[40:41]
    v_pk_add_f32 v[34:35], v[34:35], v[42:43]
    v_pk_add_f32 v[36:37], v[36:37], v[44:45]
    v_pk_add_f32 v[38:39], v[38:39], v[46:47]
    s_waitcnt lgkmcnt(0)
    v_pk_add_f32 v[48:49], v[48:49], v[56:57]
    v_pk_add_f32 v[50:51], v[50:51], v[58:59]
    v_pk_add_f32 v[52:53], v[52:53], v[60:61]
    v_pk_add_f32 v[54:55], v[54:55], v[62:63]
    v_pk_add_f32 v[80:81], v[80:81], v[82:83]
    v_pk_add_f32 v[160:161], v[32:33], v[48:49]
    v_pk_add_f32 v[162:163], v[34:35], v[50:51]
    v_pk_add_f32 v[164:165], v[36:37], v[52:53]
    v_pk_add_f32 v[166:167], v[38:39], v[54:55]
    v_add_f32 v168, v80, v81
    s_branch L_b_putdone
L_b_put1:
    v_mov_b32 v228, v28
    v_mov_b32 v229, v29
    v_mov_b32 v230, v30
    v_mov_b32 v231, v31
    s_waitcnt lgkmcnt(6)
    v_pk_add_f32 v[32:33], v[32:33], v[40:41]
    v_pk_add_f32 v[34:35], v[34:35], v[42:43]
    v_pk_add_f32 v[36:37], v[36:37], v[44:45]
    v_pk_add_f32 v[38:39], v[38:39], v[46:47]
    s_waitcnt lgkmcnt(0)
    v_pk_add_f32 v[48:49], v[48:49], v[56:57]
    v_pk_add_f32 v[50:51], v[50:51], v[58:59]
    v_pk_add_f32 v[52:53], v[52:53], v[60:61]
    v_pk_add_f32 v[54:55], v[54:55], v[62:63]
    v_pk_add_f32 v[80:81], v[80:81], v[82:83]
    v_pk_add_f32 v[144:145], v[32:33], v[48:49]
    v_pk_add_f32 v[146:147], v[34:35], v[50:51]
    v_pk_add_f32 v[148:149], v[36:37], v[52:53]
    v_pk_add_f32 v[150:151], v[38:39], v[54:55]
    v_add_f32 v152, v80, v81
    s_branch L_b_putdone
L_b_put0:
    v_mov_b32 v224, v28
    v_mov_b32 v225, v29
    v_mov_b32 v226, v30
    v_mov_b32 v227, v31
    s_waitcnt lgkmcnt(6)
    v_pk_add_f32 v[32:33], v[32:33], v[40:41]
    v_pk_add_f32 v[34:35], v[34:35], v[42:43]
    v_pk_add_f32 v[36:37], v[36:37], v[44:45]
    v_pk_add_f32 v[38:39], v[38:39], v[46:47]
    s_waitcnt lgkmcnt(0)
    v_pk_add_f32 v[48:49], v[48:49], v[56:57]
    v_pk_add_f32 v[50:51], v[50:51], v[58:59]
    v_pk_add_f32 v[52:53], v[52:53], v[60:61]
    v_pk_add_f32 v[54:55], v[54:55], v[62:63]
    v_pk_add_f32 v[80:81], v[80:81], v[82:83]
    v_pk_add_f32 v[128:129], v[32:33], v[48:49]
    v_pk_add_f32 v[130:131], v[34:35], v[50:51]
    v_pk_add_f32 v[132:133], v[36:37], v[52:53]
    v_pk_add_f32 v[134:135], v[38:39], v[54:55]
    v_add_f32 v136, v80, v81
L_b_putdone:
    s_cmp_eq_u32 s54, 63
    s_cbranch_scc1 L_b_fin1
    s_add_u32 s37, s37, 1
L_b_next:
    s_cmp_eq_u32 s55, 1
    s_cbranch_scc1 L_b_dnext
    s_add_u32 s35, s35, 1
    s_cmp_lt_u32 s35, 64
    s_cbranch_scc1 L_b_step
    s_cmp_lg_u32 s52, 0
    s_cbranch_scc1 L_b_fail
    s_cmp_eq_u32 s34, 1
    s_cbranch_scc1 L_b_out
    s_mov_b32 s55, 1
    s_mov_b32 s54, 63
    s_add_u32 s35, s33, 46
    s_add_u32 s31, s35, 2
    s_lshl_b32 s31, s31, 10
    s_add_u32 s40, s36, s31
    buffer_load_dwordx4 v[228:231], v1, s[8:11], s40 offen sc1
    s_waitcnt vmcnt(0)
L_b_dnext:
    s_add_u32 s35, s35, 2
    s_cmp_lt_u32 s35, 64
    s_cbranch_scc0 L_b_ddone
    v_mov_b64 v[28:29], v[228:229]
    v_mov_b64 v[30:31], v[230:231]
    s_add_u32 s40, s40, 2048
    v_xor_b32 v9, 0x4000, v9
    v_xor_b32 v10, 0x4000, v10
    buffer_load_dwordx4 v[228:231], v1, s[8:11], s40 offen sc1
    s_branch L_b_bgo
L_b_ddone:
    s_cmp_eq_u32 s56, 0
    s_cbranch_scc1 L_pf_117
    s_mov_b32 exec_lo, s56
    s_mov_b32 exec_hi, 0
    s_waitcnt vmcnt(0)
    buffer_store_dword v3, v12, s[8:11], s42 offen sc1
    s_mov_b64 exec, -1
    s_mov_b32 s56, 0
L_pf_117:
    s_barrier
    s_add_u32 s60, s32, 36
    s_mov_b32 s63, 0
    s_mov_b32 s61, 32
    s_mov_b32 s64, 128
    s_mov_b32 s101, 2
    s_branch L_bo
L_b_second:
    s_waitcnt vmcnt(0)
    s_barrier
    s_mov_b32 s34, 1
    s_branch L_b_layer
L_b_fail:
    s_endpgm
L_b_out:
    s_barrier
    s_add_u32 s60, s32, 12
    s_mov_b32 s63, 1
    s_mov_b32 s61, 44
    s_mov_b32 s64, 128
    s_mov_b32 s101, 0
    s_branch L_bo
L_b_fin:
    s_add_u32 s30, s34, 1
    v_mov_b32 v3, s30
    s_waitcnt lgkmcnt(0)
    v_mfma_f32_32x32x16_bf16 v[32:47], v[16:19], v[224:227], 0
    s_nop 11
    v_exp_f32 v32, v32
    v_exp_f32 v33, v33
    v_exp_f32 v34, v34
    v_exp_f32 v35, v35
    v_exp_f32 v36, v36
    v_mfma_f32_32x32x16_bf16 v[48:63], v[16:19], v[228:231], 0
    v_exp_f32 v37, v37
    v_exp_f32 v38, v38
    v_exp_f32 v39, v39
    v_exp_f32 v40, v40
    v_exp_f32 v41, v41
    v_exp_f32 v42, v42
    v_smfmac_f32_32x32x32_bf16 v[128:143], v[20:23], v[32:39], v5
    v_exp_f32 v43, v43
    v_exp_f32 v44, v44
    v_exp_f32 v45, v45
    v_exp_f32 v46, v46
    v_exp_f32 v47, v47
    s_cmp_eq_u32 s37, 1
    s_cbranch_scc1 L_b_fe0
    v_exp_f32 v48, v48
    v_exp_f32 v49, v49
    v_smfmac_f32_32x32x32_bf16 v[128:143], v[24:27], v[40:47], v5
    v_exp_f32 v50, v50
    v_exp_f32 v51, v51
    v_exp_f32 v52, v52
    v_mfma_f32_32x32x16_bf16 v[32:47], v[16:19], v[232:235], 0
    v_exp_f32 v53, v53
    v_exp_f32 v54, v54
    v_exp_f32 v55, v55
    v_exp_f32 v56, v56
    v_exp_f32 v57, v57
    v_exp_f32 v58, v58
    v_smfmac_f32_32x32x32_bf16 v[144:159], v[20:23], v[48:55], v5
    v_exp_f32 v59, v59
    v_exp_f32 v60, v60
    v_exp_f32 v61, v61
    v_exp_f32 v62, v62
    v_exp_f32 v63, v63
    v_subrev_u32 v13, s43, v136
    v_cmp_lt_u32 vcc, s44, v13
L_f_118r:
    v_rcp_f32 v13, v136
    s_add_u32 s30, s41, 0
    v_mul_f32 v80, v13, v128
    v_mul_f32 v81, v13, v129
    v_mul_f32 v82, v13, v130
    v_mul_f32 v83, v13, v131
    v_mul_f32 v84, v13, v132
    v_mul_f32 v85, v13, v133
    v_mul_f32 v86, v13, v134
    v_mul_f32 v87, v13, v135
    s_cbranch_vccnz L_f_118s
    v_cvt_pk_bf16_f32 v88, v80, v81
    v_cvt_pk_bf16_f32 v89, v82, v83
    v_cvt_pk_bf16_f32 v90, v84, v85
    v_cvt_pk_bf16_f32 v91, v86, v87
    buffer_store_dwordx4 v[88:91], v11, s[8:11], s30 offen sc1
    s_cmp_eq_u32 s37, 2
    s_cbranch_scc1 L_b_fe1
    v_exp_f32 v32, v32
    v_exp_f32 v33, v33
    v_smfmac_f32_32x32x32_bf16 v[144:159], v[24:27], v[56:63], v5
    v_exp_f32 v34, v34
    v_exp_f32 v35, v35
    v_exp_f32 v36, v36
    v_mfma_f32_32x32x16_bf16 v[48:63], v[16:19], v[236:239], 0
    v_exp_f32 v37, v37
    v_exp_f32 v38, v38
    v_exp_f32 v39, v39
    v_exp_f32 v40, v40
    v_exp_f32 v41, v41
    v_exp_f32 v42, v42
    v_smfmac_f32_32x32x32_bf16 v[160:175], v[20:23], v[32:39], v5
    v_exp_f32 v43, v43
    v_exp_f32 v44, v44
    v_exp_f32 v45, v45
    v_exp_f32 v46, v46
    v_exp_f32 v47, v47
    v_subrev_u32 v13, s43, v152
    v_cmp_lt_u32 vcc, s44, v13
L_f_119r:
    v_rcp_f32 v13, v152
    s_add_u32 s30, s41, 262144
    v_mul_f32 v80, v13, v144
    v_mul_f32 v81, v13, v145
    v_mul_f32 v82, v13, v146
    v_mul_f32 v83, v13, v147
    v_mul_f32 v84, v13, v148
    v_mul_f32 v85, v13, v149
    v_mul_f32 v86, v13, v150
    v_mul_f32 v87, v13, v151
    s_cbranch_vccnz L_f_119s
    v_cvt_pk_bf16_f32 v92, v80, v81
    v_cvt_pk_bf16_f32 v93, v82, v83
    v_cvt_pk_bf16_f32 v94, v84, v85
    v_cvt_pk_bf16_f32 v95, v86, v87
    buffer_store_dwordx4 v[92:95], v11, s[8:11], s30 offen sc1
    v_exp_f32 v48, v48
    v_exp_f32 v49, v49
    v_smfmac_f32_32x32x32_bf16 v[160:175], v[24:27], v[40:47], v5
    v_exp_f32 v50, v50
    v_exp_f32 v51, v51
    v_exp_f32 v52, v52
    v_mfma_f32_32x32x16_bf16 v[32:47], v[16:19], v[240:243], 0
    v_exp_f32 v53, v53
    v_exp_f32 v54, v54
    v_exp_f32 v55, v55
    v_exp_f32 v56, v56
    v_exp_f32 v57, v57
    v_exp_f32 v58, v58
    v_smfmac_f32_32x32x32_bf16 v[176:191], v[20:23], v[48:55], v5
    v_exp_f32 v59, v59
    v_exp_f32 v60, v60
    v_exp_f32 v61, v61
    v_exp_f32 v62, v62
    v_exp_f32 v63, v63
    v_subrev_u32 v13, s43, v168
    v_cmp_lt_u32 vcc, s44, v13
L_f_120r:
    v_rcp_f32 v13, v168
    s_add_u32 s30, s41, 524288
    v_mul_f32 v80, v13, v160
    v_mul_f32 v81, v13, v161
    v_mul_f32 v82, v13, v162
    v_mul_f32 v83, v13, v163
    v_mul_f32 v84, v13, v164
    v_mul_f32 v85, v13, v165
    v_mul_f32 v86, v13, v166
    v_mul_f32 v87, v13, v167
    s_cbranch_vccnz L_f_120s
    v_cvt_pk_bf16_f32 v88, v80, v81
    v_cvt_pk_bf16_f32 v89, v82, v83
    v_cvt_pk_bf16_f32 v90, v84, v85
    v_cvt_pk_bf16_f32 v91, v86, v87
    buffer_store_dwordx4 v[88:91], v11, s[8:11], s30 offen sc1
    v_exp_f32 v32, v32
    v_exp_f32 v33, v33
    v_smfmac_f32_32x32x32_bf16 v[176:191], v[24:27], v[56:63], v5
    v_exp_f32 v34, v34
    v_exp_f32 v35, v35
    v_exp_f32 v36, v36
    v_mfma_f32_32x32x16_bf16 v[48:63], v[16:19], v[244:247], 0
    v_exp_f32 v37, v37
    v_exp_f32 v38, v38
    v_exp_f32 v39, v39
    v_exp_f32 v40, v40
    v_exp_f32 v41, v41
    v_exp_f32 v42, v42
    v_smfmac_f32_32x32x32_bf16 v[192:207], v[20:23], v[32:39], v5
    v_exp_f32 v43, v43
    v_exp_f32 v44, v44
    v_exp_f32 v45, v45
    v_exp_f32 v46, v46
    v_exp_f32 v47, v47
    v_subrev_u32 v13, s43, v184
    v_cmp_lt_u32 vcc, s44, v13
L_f_121r:
    v_rcp_f32 v13, v184
    s_add_u32 s30, s41, 786432
    v_mul_f32 v80, v13, v176
    v_mul_f32 v81, v13, v177
    v_mul_f32 v82, v13, v178
    v_mul_f32 v83, v13, v179
    v_mul_f32 v84, v13, v180
    v_mul_f32 v85, v13, v181
    v_mul_f32 v86, v13, v182
    v_mul_f32 v87, v13, v183
    s_cbranch_vccnz L_f_121s
    v_cvt_pk_bf16_f32 v92, v80, v81
    v_cvt_pk_bf16_f32 v93, v82, v83
    v_cvt_pk_bf16_f32 v94, v84, v85
    v_cvt_pk_bf16_f32 v95, v86, v87
    buffer_store_dwordx4 v[92:95], v11, s[8:11], s30 offen sc1
    s_mov_b64 exec, 1
    s_waitcnt vmcnt(3)
    buffer_store_dword v3, v12, s[8:11], s42 offen sc1
    s_mov_b64 exec, -1
    v_exp_f32 v48, v48
    v_exp_f32 v49, v49
    v_smfmac_f32_32x32x32_bf16 v[192:207], v[24:27], v[40:47], v5
    v_exp_f32 v50, v50
    v_exp_f32 v51, v51
    v_exp_f32 v52, v52
    v_exp_f32 v53, v53
    v_exp_f32 v54, v54
    v_exp_f32 v55, v55
    v_exp_f32 v56, v56
    v_exp_f32 v57, v57
    v_exp_f32 v58, v58
    v_smfmac_f32_32x32x32_bf16 v[208:223], v[20:23], v[48:55], v5
    v_exp_f32 v59, v59
    v_exp_f32 v60, v60
    v_exp_f32 v61, v61
    v_exp_f32 v62, v62
    v_exp_f32 v63, v63
    v_subrev_u32 v13, s43, v200
    v_cmp_lt_u32 vcc, s44, v13
L_f_122r:
    v_rcp_f32 v13, v200
    s_add_u32 s30, s41, 1048576
    v_mul_f32 v80, v13, v192
    v_mul_f32 v81, v13, v193
    v_mul_f32 v82, v13, v194
    v_mul_f32 v83, v13, v195
    v_mul_f32 v84, v13, v196
    v_mul_f32 v85, v13, v197
    v_mul_f32 v86, v13, v198
    v_mul_f32 v87, v13, v199
    s_cbranch_vccnz L_f_122s
    v_cvt_pk_bf16_f32 v88, v80, v81
    v_cvt_pk_bf16_f32 v89, v82, v83
    v_cvt_pk_bf16_f32 v90, v84, v85
    v_cvt_pk_bf16_f32 v91, v86, v87
    buffer_store_dwordx4 v[88:91], v11, s[8:11], s30 offen sc1
L_b_fe5:
    s_nop 1
    v_smfmac_f32_32x32x32_bf16 v[208:223], v[24:27], v[56:63], v5
    s_nop 11
    v_subrev_u32 v13, s43, v216
    v_cmp_lt_u32 vcc, s44, v13
L_f_123r:
    v_rcp_f32 v13, v216
    s_add_u32 s30, s41, 1310720
    v_mul_f32 v80, v13, v208
    v_mul_f32 v81, v13, v209
    v_mul_f32 v82, v13, v210
    v_mul_f32 v83, v13, v211
    v_mul_f32 v84, v13, v212
    v_mul_f32 v85, v13, v213
    v_mul_f32 v86, v13, v214
    v_mul_f32 v87, v13, v215
    s_cbranch_vccnz L_f_123s
    v_cvt_pk_bf16_f32 v92, v80, v81
    v_cvt_pk_bf16_f32 v93, v82, v83
    v_cvt_pk_bf16_f32 v94, v84, v85
    v_cvt_pk_bf16_f32 v95, v86, v87
    buffer_store_dwordx4 v[92:95], v11, s[8:11], s30 offen sc1
    s_mov_b32 s56, 63
    s_branch L_b_fex
L_b_fe1:
    s_nop 1
    v_smfmac_f32_32x32x32_bf16 v[144:159], v[24:27], v[56:63], v5
    s_nop 11
    v_subrev_u32 v13, s43, v152
    v_cmp_lt_u32 vcc, s44, v13
L_f_124r:
    v_rcp_f32 v13, v152
    s_add_u32 s30, s41, 262144
    v_mul_f32 v80, v13, v144
    v_mul_f32 v81, v13, v145
    v_mul_f32 v82, v13, v146
    v_mul_f32 v83, v13, v147
    v_mul_f32 v84, v13, v148
    v_mul_f32 v85, v13, v149
    v_mul_f32 v86, v13, v150
    v_mul_f32 v87, v13, v151
    s_cbranch_vccnz L_f_124s
    v_cvt_pk_bf16_f32 v92, v80, v81
    v_cvt_pk_bf16_f32 v93, v82, v83
    v_cvt_pk_bf16_f32 v94, v84, v85
    v_cvt_pk_bf16_f32 v95, v86, v87
    buffer_store_dwordx4 v[92:95], v11, s[8:11], s30 offen sc1
    s_mov_b32 s56, 3
    s_branch L_b_fex
L_b_fe0:
    s_nop 1
    v_smfmac_f32_32x32x32_bf16 v[128:143], v[24:27], v[40:47], v5
    s_nop 11
    v_subrev_u32 v13, s43, v136
    v_cmp_lt_u32 vcc, s44, v13
L_f_125r:
    v_rcp_f32 v13, v136
    s_add_u32 s30, s41, 0
    v_mul_f32 v80, v13, v128
    v_mul_f32 v81, v13, v129
    v_mul_f32 v82, v13, v130
    v_mul_f32 v83, v13, v131
    v_mul_f32 v84, v13, v132
    v_mul_f32 v85, v13, v133
    v_mul_f32 v86, v13, v134
    v_mul_f32 v87, v13, v135
    s_cbranch_vccnz L_f_125s
    v_cvt_pk_bf16_f32 v88, v80, v81
    v_cvt_pk_bf16_f32 v89, v82, v83
    v_cvt_pk_bf16_f32 v90, v84, v85
    v_cvt_pk_bf16_f32 v91, v86, v87
    buffer_store_dwordx4 v[88:91], v11, s[8:11], s30 offen sc1
    s_mov_b32 s56, 1
L_b_fex:
    s_mov_b32 s37, 0
    s_add_u32 s30, s33, s53
    s_cmp_eq_u32 s30, 65
    s_cbranch_scc1 L_b_adone
    s_cmp_eq_u32 s56, 0
    s_cbranch_scc1 L_pf_126
    s_mov_b32 exec_lo, s56
    s_mov_b32 exec_hi, 0
    s_waitcnt vmcnt(0)
    buffer_store_dword v3, v12, s[8:11], s42 offen sc1
    s_mov_b64 exec, -1
    s_mov_b32 s56, 0
L_pf_126:
    s_branch L_b_adone
L_b_fin1:
    s_mov_b32 s30, 0
    s_lshl_b32 s41, s35, 15
    s_add_u32 s41, s41, s30
    s_add_u32 s41, s41, 70254592
    s_lshl_b32 s42, s35, 10
    s_lshl_b32 s30, s32, 5
    s_add_u32 s42, s42, s30
    s_add_u32 s42, s42, 65536
    v_subrev_u32 v13, s43, v136
    v_cmp_lt_u32 vcc, s44, v13
L_f_127r:
    v_rcp_f32 v13, v136
    s_add_u32 s30, s41, 0
    v_mul_f32 v80, v13, v128
    v_mul_f32 v81, v13, v129
    v_mul_f32 v82, v13, v130
    v_mul_f32 v83, v13, v131
    v_mul_f32 v84, v13, v132
    v_mul_f32 v85, v13, v133
    v_mul_f32 v86, v13, v134
    v_mul_f32 v87, v13, v135
    s_cbranch_vccnz L_f_127s
    v_cvt_pk_bf16_f32 v88, v80, v81
    v_cvt_pk_bf16_f32 v89, v82, v83
    v_cvt_pk_bf16_f32 v90, v84, v85
    v_cvt_pk_bf16_f32 v91, v86, v87
    buffer_store_dwordx4 v[88:91], v11, s[8:11], s30 offen sc1
    s_mov_b32 s56, 1
    s_cmp_eq_u32 s55, 1
    s_cbranch_scc1 L_b_next
    s_cmp_eq_u32 s56, 0
    s_cbranch_scc1 L_pf_128
    s_mov_b32 exec_lo, s56
    s_mov_b32 exec_hi, 0
    s_waitcnt vmcnt(0)
    buffer_store_dword v3, v12, s[8:11], s42 offen sc1
    s_mov_b64 exec, -1
    s_mov_b32 s56, 0
L_pf_128:
    s_branch L_b_next
L_f_118s:
    v_mov_b32 v96, v224
    v_mov_b32 v97, v225
    v_mov_b32 v98, v226
    v_mov_b32 v99, v227
    s_getpc_b64 s[50:51]
    s_add_u32 s50, s50, 12
    s_addc_u32 s51, s51, 0
    s_branch L_b_exact
    v_mov_b32 v128, v64
    v_mov_b32 v129, v65
    v_mov_b32 v130, v66
    v_mov_b32 v131, v67
    v_mov_b32 v132, v68
    v_mov_b32 v133, v69
    v_mov_b32 v134, v70
    v_mov_b32 v135, v71
    v_mov_b32 v136, v72
    s_mov_b64 vcc, 0
    s_branch L_f_118r
L_f_119s:
    v_mov_b32 v96, v228
    v_mov_b32 v97, v229
    v_mov_b32 v98, v230
    v_mov_b32 v99, v231
    s_getpc_b64 s[50:51]
    s_add_u32 s50, s50, 12
    s_addc_u32 s51, s51, 0
    s_branch L_b_exact
    v_mov_b32 v144, v64
    v_mov_b32 v145, v65
    v_mov_b32 v146, v66
    v_mov_b32 v147, v67
    v_mov_b32 v148, v68
    v_mov_b32 v149, v69
    v_mov_b32 v150, v70
    v_mov_b32 v151, v71
    v_mov_b32 v152, v72
    s_mov_b64 vcc, 0
    s_branch L_f_119r
L_f_120s:
    v_mov_b32 v96, v232
    v_mov_b32 v97, v233
    v_mov_b32 v98, v234
    v_mov_b32 v99, v235
    s_getpc_b64 s[50:51]
    s_add_u32 s50, s50, 12
    s_addc_u32 s51, s51, 0
    s_branch L_b_exact
    v_mov_b32 v160, v64
    v_mov_b32 v161, v65
    v_mov_b32 v162, v66
    v_mov_b32 v163, v67
    v_mov_b32 v164, v68
    v_mov_b32 v165, v69
    v_mov_b32 v166, v70
    v_mov_b32 v167, v71
    v_mov_b32 v168, v72
    s_mov_b64 vcc, 0
    s_branch L_f_120r
L_f_121s:
    v_mov_b32 v96, v236
    v_mov_b32 v97, v237
    v_mov_b32 v98, v238
    v_mov_b32 v99, v239
    s_getpc_b64 s[50:51]
    s_add_u32 s50, s50, 12
    s_addc_u32 s51, s51, 0
    s_branch L_b_exact
    v_mov_b32 v176, v64
    v_mov_b32 v177, v65
    v_mov_b32 v178, v66
    v_mov_b32 v179, v67
    v_mov_b32 v180, v68
    v_mov_b32 v181, v69
    v_mov_b32 v182, v70
    v_mov_b32 v183, v71
    v_mov_b32 v184, v72
    s_mov_b64 vcc, 0
    s_branch L_f_121r
L_f_122s:
    v_mov_b32 v96, v240
    v_mov_b32 v97, v241
    v_mov_b32 v98, v242
    v_mov_b32 v99, v243
    s_getpc_b64 s[50:51]
    s_add_u32 s50, s50, 12
    s_addc_u32 s51, s51, 0
    s_branch L_b_exact
    v_mov_b32 v192, v64
    v_mov_b32 v193, v65
    v_mov_b32 v194, v66
    v_mov_b32 v195, v67
    v_mov_b32 v196, v68
    v_mov_b32 v197, v69
    v_mov_b32 v198, v70
    v_mov_b32 v199, v71
    v_mov_b32 v200, v72
    s_mov_b64 vcc, 0
    s_branch L_f_122r
L_f_123s:
    v_mov_b32 v96, v244
    v_mov_b32 v97, v245
    v_mov_b32 v98, v246
    v_mov_b32 v99, v247
    s_getpc_b64 s[50:51]
    s_add_u32 s50, s50, 12
    s_addc_u32 s51, s51, 0
    s_branch L_b_exact
    v_mov_b32 v208, v64
    v_mov_b32 v209, v65
    v_mov_b32 v210, v66
    v_mov_b32 v211, v67
    v_mov_b32 v212, v68
    v_mov_b32 v213, v69
    v_mov_b32 v214, v70
    v_mov_b32 v215, v71
    v_mov_b32 v216, v72
    s_mov_b64 vcc, 0
    s_branch L_f_123r
L_f_124s:
    v_mov_b32 v96, v228
    v_mov_b32 v97, v229
    v_mov_b32 v98, v230
    v_mov_b32 v99, v231
    s_getpc_b64 s[50:51]
    s_add_u32 s50, s50, 12
    s_addc_u32 s51, s51, 0
    s_branch L_b_exact
    v_mov_b32 v144, v64
    v_mov_b32 v145, v65
    v_mov_b32 v146, v66
    v_mov_b32 v147, v67
    v_mov_b32 v148, v68
    v_mov_b32 v149, v69
    v_mov_b32 v150, v70
    v_mov_b32 v151, v71
    v_mov_b32 v152, v72
    s_mov_b64 vcc, 0
    s_branch L_f_124r
L_f_125s:
    v_mov_b32 v96, v224
    v_mov_b32 v97, v225
    v_mov_b32 v98, v226
    v_mov_b32 v99, v227
    s_getpc_b64 s[50:51]
    s_add_u32 s50, s50, 12
    s_addc_u32 s51, s51, 0
    s_branch L_b_exact
    v_mov_b32 v128, v64
    v_mov_b32 v129, v65
    v_mov_b32 v130, v66
    v_mov_b32 v131, v67
    v_mov_b32 v132, v68
    v_mov_b32 v133, v69
    v_mov_b32 v134, v70
    v_mov_b32 v135, v71
    v_mov_b32 v136, v72
    s_mov_b64 vcc, 0
    s_branch L_f_125r
L_f_127s:
    v_mov_b32 v96, v224
    v_mov_b32 v97, v225
    v_mov_b32 v98, v226
    v_mov_b32 v99, v227
    s_getpc_b64 s[50:51]
    s_add_u32 s50, s50, 12
    s_addc_u32 s51, s51, 0
    s_branch L_b_exact
    v_mov_b32 v128, v64
    v_mov_b32 v129, v65
    v_mov_b32 v130, v66
    v_mov_b32 v131, v67
    v_mov_b32 v132, v68
    v_mov_b32 v133, v69
    v_mov_b32 v134, v70
    v_mov_b32 v135, v71
    v_mov_b32 v136, v72
    s_mov_b64 vcc, 0
    s_branch L_f_127r
L_b_exact:
    v_mov_b32 v100, 0xff61b1e6
    v_mov_b32 v108, v1
    s_mov_b32 s38, 0
L_b_ex1:
    ds_read_b128 v[80:83], v108
    v_add_u32 v108, 0x400, v108
    s_waitcnt lgkmcnt(0)
    v_mfma_f32_32x32x16_bf16 v[112:127], v[80:83], v[96:99], 0
    s_nop 11
    v_max3_f32 v100, v100, v112, v113
    v_max3_f32 v100, v100, v114, v115
    v_max3_f32 v100, v100, v116, v117
    v_max3_f32 v100, v100, v118, v119
    v_max3_f32 v100, v100, v120, v121
    v_max3_f32 v100, v100, v122, v123
    v_max3_f32 v100, v100, v124, v125
    v_max3_f32 v100, v100, v126, v127
    s_add_u32 s38, s38, 1
    s_cmp_lt_u32 s38, 64
    s_cbranch_scc1 L_b_ex1
    v_mov_b32 v101, v100
    s_nop 1
    v_permlane32_swap_b32 v100, v101
    s_nop 1
    v_max_f32 v100, v100, v101
    v_mov_b64 v[64:65], 0
    v_mov_b64 v[66:67], 0
    v_mov_b64 v[68:69], 0
    v_mov_b64 v[70:71], 0
    v_mov_b64 v[72:73], 0
    v_mov_b32 v108, v1
    s_mov_b32 s38, 0
L_b_ex2:
    s_lshr_b32 s30, s38, 2
    s_lshl_b32 s30, s30, 4
    s_lshl_b32 s47, s38, 10
    s_add_u32 s47, s47, s30
    v_and_b32 v109, s47, v15
    v_add_u32 v109, v109, v111
    v_and_b32 v110, 0x200, v15
    v_add_u32 v110, v110, v109
    ds_read_b128 v[80:83], v108 offset:0
    ds_read_b128 v[84:87], v109 offset:0
    ds_read_b128 v[104:107], v110 offset:0
    v_add_u32 v108, 0x400, v108
    s_waitcnt lgkmcnt(0)
    v_mfma_f32_32x32x16_bf16 v[112:127], v[80:83], v[96:99], 0
    s_nop 11
    v_sub_f32 v112, v112, v100
    v_sub_f32 v113, v113, v100
    v_sub_f32 v114, v114, v100
    v_sub_f32 v115, v115, v100
    v_sub_f32 v116, v116, v100
    v_sub_f32 v117, v117, v100
    v_sub_f32 v118, v118, v100
    v_sub_f32 v119, v119, v100
    v_sub_f32 v120, v120, v100
    v_sub_f32 v121, v121, v100
    v_sub_f32 v122, v122, v100
    v_sub_f32 v123, v123, v100
    v_sub_f32 v124, v124, v100
    v_sub_f32 v125, v125, v100
    v_sub_f32 v126, v126, v100
    v_sub_f32 v127, v127, v100
    v_exp_f32 v112, v112
    v_exp_f32 v113, v113
    v_exp_f32 v114, v114
    v_exp_f32 v115, v115
    v_exp_f32 v116, v116
    v_exp_f32 v117, v117
    v_exp_f32 v118, v118
    v_exp_f32 v119, v119
    v_exp_f32 v120, v120
    v_exp_f32 v121, v121
    v_exp_f32 v122, v122
    v_exp_f32 v123, v123
    v_exp_f32 v124, v124
    v_exp_f32 v125, v125
    v_exp_f32 v126, v126
    v_exp_f32 v127, v127
    s_nop 1
    v_smfmac_f32_32x32x32_bf16 v[64:79], v[84:87], v[112:119], v5
    v_smfmac_f32_32x32x32_bf16 v[64:79], v[104:107], v[120:127], v5
    s_add_u32 s38, s38, 1
    s_cmp_lt_u32 s38, 64
    s_nop 7
    s_cbranch_scc1 L_b_ex2
    s_nop 7
    s_setpc_b64 s[50:51]
    s_endpgm
L_code_end:
.section .rodata,"a"
.p2align 6
.amdhsa_kernel interleave_layers__memory_aug_recurrent_mem_tr__softmax_full_mha__prompt_kernel
  .amdhsa_next_free_vgpr 512
  .amdhsa_next_free_sgpr 102
  .amdhsa_accum_offset 256
  .amdhsa_group_segment_fixed_size 0
  .amdhsa_kernarg_size 104
  .amdhsa_user_sgpr_count 2
  .amdhsa_user_sgpr_kernarg_segment_ptr 1
  .amdhsa_system_sgpr_workgroup_id_x 1
.end_amdhsa_kernel
```
